```python
import torch

def _softmax(x, axis=-1):
    return torch.softmax(x, dim=axis)

def _gelu(x):
    return torch.nn.functional.gelu(x, approximate='tanh')

def _silu(x):
    return torch.nn.functional.silu(x)

def _sigmoid(x):
    return torch.sigmoid(x)

def _layernorm(x, axis=-1, eps=1e-05):
    m = x.mean(dim=axis, keepdim=True)
    v = x.var(dim=axis, keepdim=True, unbiased=False)
    return (x - m) / torch.sqrt(v + eps)

def _scatter_add(tgt, idx, src, axis=0):
    return tgt.clone().index_add_(axis, idx, src)

def _segment_sum(src, seg, n):
    out = torch.zeros((n,) + src.shape[1:], dtype=src.dtype)
    return out.index_add_(0, seg, src)

def _pad(x, pw):
    flat = tuple((v for pair in reversed(pw) for v in pair))
    return torch.nn.functional.pad(x, flat)
kernel_name = 'adaLN_cond__memory_aug_recurrent_mem_tr__glu_gated_reglu__prompt'

def setup_inputs():

    _w = lambda a: (lambda t: t.to(torch.bfloat16) if t.is_floating_point() else t)(torch.as_tensor(a))

    def _A_setup():
        B, S, Dm = (1, 2048, 640)
        H, Dh = (32, 128)
        M, seg = (8, 32)
        seg = min(seg, S)
        S = S // seg * seg
        return {'x': _w((lambda *s: torch.randn(*s, dtype=torch.bfloat16) * 0.05)(B, S, Dm)), 'mem0': _w((lambda *s: torch.randn(*s, dtype=torch.bfloat16) * 0.8)(B, M, Dm)), 'Wq': _w((lambda *s: torch.randn(*s, dtype=torch.bfloat16) * 0.8)(Dm, H, Dh) * Dm ** (-0.5)), 'Wk': _w((lambda *s: torch.randn(*s, dtype=torch.bfloat16) * 0.8)(Dm, H, Dh) * Dm ** (-0.5)), 'Wv': _w((lambda *s: torch.randn(*s, dtype=torch.bfloat16) * 0.8)(Dm, H, Dh) * Dm ** (-0.5)), 'Wo': _w((lambda *s: torch.randn(*s, dtype=torch.bfloat16) * 0.8)(H, Dh, Dm) * (H * Dh) ** (-0.5)), 'seg_len': seg}
    _A_in = _A_setup()

    def _B_setup():
        B, S, D, F = (1, 2048, 640, 1728)
        return {'x': _w((lambda *s: torch.randn(*s, dtype=torch.bfloat16) * 0.05)(B, S, D)), 'W_gate': _w((lambda *s: torch.randn(*s, dtype=torch.bfloat16) * 0.4)(D, F) * (2.0 / D) ** 0.5), 'W_up': _w((lambda *s: torch.randn(*s, dtype=torch.bfloat16) * 0.4)(D, F) * (2.0 / D) ** 0.5), 'W_down': _w((lambda *s: torch.randn(*s, dtype=torch.bfloat16) * 0.4)(F, D) * (1.0 / F) ** 0.5)}
    _B_in = _B_setup()
    return {'A_x': _A_in['x'], 'A_mem0': _A_in['mem0'], 'A_Wq': _A_in['Wq'], 'A_Wk': _A_in['Wk'], 'A_Wv': _A_in['Wv'], 'A_Wo': _A_in['Wo'], 'A_seg_len': _A_in['seg_len'], 'B_x': _B_in['x'], 'B_W_gate': _B_in['W_gate'], 'B_W_up': _B_in['W_up'], 'B_W_down': _B_in['W_down'], 'c': _w((lambda *s: torch.randn(*s, dtype=torch.bfloat16) * 0.1)(1, 640) * 8.0), 'w_mod': _w((lambda *s: torch.randn(*s, dtype=torch.bfloat16) * 0.1)(640, 6 * 640) * 640 ** (-0.5) * 8.0)}

def reference(A_x, A_mem0, A_Wq, A_Wk, A_Wv, A_Wo, A_seg_len, B_x, B_W_gate, B_W_up, B_W_down, c, w_mod):

    def _A_ref(x, mem0, Wq, Wk, Wv, Wo, seg_len):
        B, S, Dm = x.shape
        H, Dh = (Wq.shape[1], Wq.shape[2])
        M = mem0.shape[1]
        scale = Dh ** (-0.5)
        n_seg = S // seg_len
        L = M + seg_len
        idx = torch.arange(L)
        mask = (idx[:, None] < M) | (idx[:, None] >= idx[None, :])
        mem = mem0
        outs = []
        for s in range(n_seg):
            xs = x[:, s * seg_len:(s + 1) * seg_len, :].clone()
            h = torch.concatenate([mem, xs], axis=1)
            q = torch.einsum('btd,dhe->bhte', h, Wq)
            k = torch.einsum('btd,dhe->bhte', h, Wk)
            v = torch.einsum('btd,dhe->bhte', h, Wv)
            scores = torch.einsum('bhqe,bhke->bhqk', q, k) * scale
            scores = torch.where(mask[None, None], scores, -1000000000.0)
            p = _softmax(scores, axis=-1)
            o = torch.einsum('bhqk,bhke->bhqe', p, v)
            o = torch.einsum('bhte,hed->btd', o, Wo)
            mem = o[:, :M, :].clone()
            outs.append(o[:, M:, :])
        return torch.concatenate(outs, axis=1)

    def _B_ref(x, W_gate, W_up, W_down):
        gate = torch.einsum('bsd,df->bsf', x, W_gate)
        up = torch.einsum('bsd,df->bsf', x, W_up)
        gate = gate * (lambda x, dt: x.to(dt))(gate > 0, gate.dtype)
        h = gate * up
        return torch.einsum('bsf,fd->bsd', h, W_down)
    x = A_x
    mod = (_silu(c) @ w_mod).reshape(c.shape[0], 6, 1, -1)
    sa, ca, ga, sb, cb, gb = (mod[:, 0].clone(), mod[:, 1].clone(), mod[:, 2].clone(), mod[:, 3].clone(), mod[:, 4].clone(), mod[:, 5].clone())
    h = _layernorm(x, axis=-1) * (1 + ca) + sa
    x = x + ga * _A_ref(h, A_mem0, A_Wq, A_Wk, A_Wv, A_Wo, A_seg_len)
    h = _layernorm(x, axis=-1) * (1 + cb) + sb
    x = x + gb * _B_ref(h, B_W_gate, B_W_up, B_W_down)
    return x
```

```asm
; @launch grid=(256,1,1) block=(256,1,1) lds=163840
.amdgcn_target "amdgcn-amd-amdhsa--gfx950"
.text
.globl adaLN_cond__memory_aug_recurrent_mem_tr__glu_gated_reglu__prompt_kernel
.p2align 8
.type adaLN_cond__memory_aug_recurrent_mem_tr__glu_gated_reglu__prompt_kernel,@function
adaLN_cond__memory_aug_recurrent_mem_tr__glu_gated_reglu__prompt_kernel:
  s_cmp_ge_u32 s2, 256
  s_cbranch_scc1 L_exit
  s_load_dwordx4 s[16:19], s[0:1], 112
  s_getreg_b32 s20, hwreg(HW_REG_XCC_ID)
  s_and_b32 s20, s20, 15
  s_lshl_b32 s14, s20, 2
  s_lshr_b32 s14, 0x76541023, s14
  s_and_b32 s14, s14, 7
  s_cmp_ge_u32 s20, 8
  s_cselect_b32 s14, 8, s14
  v_lshrrev_b32 v1, 6, v0
  s_nop 0
  v_readfirstlane_b32 s12, v1
  v_and_b32_e64 v0, 63, v0
  s_lshl_b32 s15, s14, 6
  s_lshl_b32 s20, s14, 2
  s_add_u32 s20, s20, 120
  s_cmp_lt_u32 s14, 2
  s_cselect_b32 s15, s15, s20
  v_mov_b32 v2, 0
  v_mov_b32_e64 v3, 1
  s_waitcnt lgkmcnt(0)
  s_mov_b32 s4, s18
  s_mov_b32 s5, s19
  s_mov_b32 s6, 268435456
  s_mov_b32 s7, 0x20000
  s_mov_b32 s8, s16
  s_mov_b32 s9, s17
  s_mov_b32 s10, 256
  s_mov_b32 s11, 0x20000
  s_cmp_lg_u32 s12, 0
  s_cbranch_scc1 L_noticket
  s_mov_b64 exec, 1
  buffer_atomic_add v3, v2, s[8:11], s15 offen sc0
  s_waitcnt vmcnt(0)
  ds_write_b32 v2, v3
  s_waitcnt lgkmcnt(0)
  s_mov_b64 exec, -1
L_noticket:
  s_barrier
  ds_read_b32 v3, v2
  s_waitcnt lgkmcnt(0)
  v_readfirstlane_b32 s13, v3
  s_barrier
  s_cmp_ge_u32 s13, 32
  s_cbranch_scc1 L_spare
  s_cmp_ge_u32 s14, 8
  s_cbranch_scc1 L_spare
L_placed:
  s_cmp_ge_u32 s14, 2
  s_cbranch_scc0 L_chain
  s_load_dwordx2 s[16:17], s[0:1], 0
  s_load_dwordx2 s[20:21], s[0:1], 88
  s_load_dwordx2 s[24:25], s[0:1], 96
  s_load_dwordx2 s[32:33], s[0:1], 40
  s_load_dwordx2 s[36:37], s[0:1], 64
  s_load_dwordx2 s[40:41], s[0:1], 72
  s_load_dwordx2 s[44:45], s[0:1], 80
  s_load_dwordx2 s[48:49], s[0:1], 104
  s_load_dwordx4 s[60:63], s[0:1], 16
  s_load_dwordx2 s[64:65], s[0:1], 32
  s_sub_u32 s52, s14, 2
  s_lshl_b32 s53, s52, 5
  s_add_u32 s53, s53, s13
  s_mov_b32 s54, 1000000
  s_add_u32 s55, s53, 44
  s_and_b32 s55, s55, 63
  s_mov_b32 s56, 0x05040100
  s_mov_b32 s57, 0x07060302
  v_lshlrev_b32_e64 v1, 4, v0
  s_waitcnt lgkmcnt(0)
  s_cmp_ge_u32 s52, 2
  s_cselect_b64 s[28:29], s[64:65], s[62:63]
  s_cmp_ge_u32 s52, 4
  s_cselect_b64 s[28:29], s[60:61], s[28:29]
  s_mov_b32 s18, 2621440
  s_mov_b32 s19, 0x20000
  s_mov_b32 s22, 1280
  s_mov_b32 s23, 0x20000
  s_mov_b32 s26, 4915200
  s_mov_b32 s27, 0x20000
  s_mov_b32 s34, 5242880
  s_mov_b32 s35, 0x20000
  s_mov_b32 s38, 2211840
  s_mov_b32 s39, 0x20000
  s_mov_b32 s42, 2211840
  s_mov_b32 s43, 0x20000
  s_mov_b32 s46, 2211840
  s_mov_b32 s47, 0x20000
  s_mov_b32 s50, 2621440
  s_mov_b32 s51, 0x20000
  s_mov_b32 s30, 5242880
  s_mov_b32 s31, 0x20000
  s_mov_b64 s[68:69], s[60:61]
  s_mov_b32 s70, 5242880
  s_mov_b32 s71, 0x20000
  s_cmp_lt_u32 s52, 4
  s_cbranch_scc1 L_w_kv
  s_sub_u32 s60, s52, 4
  s_cmp_ge_u32 s13, 20
  s_cbranch_scc1 L_w_nomod
  v_lshrrev_b32 v2, 2, v0
  s_mul_i32 s58, s12, 160
  v_add_u32 v2, s58, v2
  v_lshlrev_b32_e64 v3, 1, v2
  v_mul_u32_u24 v2, 7680, v2
  v_and_b32_e64 v80, 3, v0
  v_lshl_add_u32 v2, v80, 4, v2
  s_mul_i32 s58, s60, 1280
  s_lshl_b32 s59, s13, 6
  s_add_u32 s58, s58, s59
  buffer_load_ushort v120, v3, s[20:23], 0 offen offset:0
  buffer_load_ushort v121, v3, s[20:23], 0 offen offset:32
  buffer_load_ushort v122, v3, s[20:23], 0 offen offset:64
  buffer_load_ushort v123, v3, s[20:23], 0 offen offset:96
  buffer_load_ushort v124, v3, s[20:23], 0 offen offset:128
  buffer_load_ushort v125, v3, s[20:23], 0 offen offset:160
  buffer_load_ushort v126, v3, s[20:23], 0 offen offset:192
  buffer_load_ushort v127, v3, s[20:23], 0 offen offset:224
  buffer_load_ushort v128, v3, s[20:23], 0 offen offset:256
  buffer_load_ushort v129, v3, s[20:23], 0 offen offset:288
  buffer_load_dwordx4 v[80:83], v2, s[24:27], s58 offen
  s_add_u32 s58, s58, 122880
  buffer_load_dwordx4 v[84:87], v2, s[24:27], s58 offen
  s_add_u32 s58, s58, 122880
  buffer_load_dwordx4 v[88:91], v2, s[24:27], s58 offen
  s_add_u32 s58, s58, 122880
  buffer_load_dwordx4 v[92:95], v2, s[24:27], s58 offen
  s_add_u32 s58, s58, 122880
  buffer_load_dwordx4 v[96:99], v2, s[24:27], s58 offen
  s_add_u32 s58, s58, 122880
  buffer_load_dwordx4 v[100:103], v2, s[24:27], s58 offen
  s_add_u32 s58, s58, 122880
  buffer_load_dwordx4 v[104:107], v2, s[24:27], s58 offen
  s_add_u32 s58, s58, 122880
  buffer_load_dwordx4 v[108:111], v2, s[24:27], s58 offen
  s_add_u32 s58, s58, 122880
  buffer_load_dwordx4 v[112:115], v2, s[24:27], s58 offen
  s_add_u32 s58, s58, 122880
  buffer_load_dwordx4 v[116:119], v2, s[24:27], s58 offen
  s_add_u32 s58, s58, 122880
  v_and_b32_e64 v2, 7, v0
  v_mul_u32_u24 v2, 1280, v2
  v_lshrrev_b32 v3, 3, v0
  v_lshl_add_u32 v2, v3, 4, v2
  s_mov_b32 s58, s55
  s_lshl_b32 s58, s58, 2
  s_add_u32 s58, s58, s12
  s_mul_i32 s58, s58, 10240
  buffer_load_dwordx4 v[40:43], v2, s[16:19], s58 offen offset:0
  buffer_load_dwordx4 v[44:47], v2, s[16:19], s58 offen offset:128
  buffer_load_dwordx4 v[48:51], v2, s[16:19], s58 offen offset:256
  buffer_load_dwordx4 v[52:55], v2, s[16:19], s58 offen offset:384
  buffer_load_dwordx4 v[56:59], v2, s[16:19], s58 offen offset:512
  buffer_load_dwordx4 v[60:63], v2, s[16:19], s58 offen offset:640
  buffer_load_dwordx4 v[64:67], v2, s[16:19], s58 offen offset:768
  buffer_load_dwordx4 v[68:71], v2, s[16:19], s58 offen offset:896
  buffer_load_dwordx4 v[72:75], v2, s[16:19], s58 offen offset:1024
  buffer_load_dwordx4 v[76:79], v2, s[16:19], s58 offen offset:1152
  s_waitcnt vmcnt(29)
  v_lshlrev_b32 v120, 16, v120
  v_mul_f32 v24, 0xbfb8aa3b, v120
  v_exp_f32 v24, v24
  s_nop 0
  v_add_f32 v24, 1.0, v24
  v_rcp_f32 v24, v24
  s_nop 0
  v_mul_f32 v120, v120, v24
  v_cvt_pk_bf16_f32 v120, v120, v120
  v_and_b32 v120, 0xffff0000, v120
  s_waitcnt vmcnt(28)
  v_lshlrev_b32 v121, 16, v121
  v_mul_f32 v24, 0xbfb8aa3b, v121
  v_exp_f32 v24, v24
  s_nop 0
  v_add_f32 v24, 1.0, v24
  v_rcp_f32 v24, v24
  s_nop 0
  v_mul_f32 v121, v121, v24
  v_cvt_pk_bf16_f32 v121, v121, v121
  v_and_b32 v121, 0xffff0000, v121
  s_waitcnt vmcnt(27)
  v_lshlrev_b32 v122, 16, v122
  v_mul_f32 v24, 0xbfb8aa3b, v122
  v_exp_f32 v24, v24
  s_nop 0
  v_add_f32 v24, 1.0, v24
  v_rcp_f32 v24, v24
  s_nop 0
  v_mul_f32 v122, v122, v24
  v_cvt_pk_bf16_f32 v122, v122, v122
  v_and_b32 v122, 0xffff0000, v122
  s_waitcnt vmcnt(26)
  v_lshlrev_b32 v123, 16, v123
  v_mul_f32 v24, 0xbfb8aa3b, v123
  v_exp_f32 v24, v24
  s_nop 0
  v_add_f32 v24, 1.0, v24
  v_rcp_f32 v24, v24
  s_nop 0
  v_mul_f32 v123, v123, v24
  v_cvt_pk_bf16_f32 v123, v123, v123
  v_and_b32 v123, 0xffff0000, v123
  s_waitcnt vmcnt(25)
  v_lshlrev_b32 v124, 16, v124
  v_mul_f32 v24, 0xbfb8aa3b, v124
  v_exp_f32 v24, v24
  s_nop 0
  v_add_f32 v24, 1.0, v24
  v_rcp_f32 v24, v24
  s_nop 0
  v_mul_f32 v124, v124, v24
  v_cvt_pk_bf16_f32 v124, v124, v124
  v_and_b32 v124, 0xffff0000, v124
  s_waitcnt vmcnt(24)
  v_lshlrev_b32 v125, 16, v125
  v_mul_f32 v24, 0xbfb8aa3b, v125
  v_exp_f32 v24, v24
  s_nop 0
  v_add_f32 v24, 1.0, v24
  v_rcp_f32 v24, v24
  s_nop 0
  v_mul_f32 v125, v125, v24
  v_cvt_pk_bf16_f32 v125, v125, v125
  v_and_b32 v125, 0xffff0000, v125
  s_waitcnt vmcnt(23)
  v_lshlrev_b32 v126, 16, v126
  v_mul_f32 v24, 0xbfb8aa3b, v126
  v_exp_f32 v24, v24
  s_nop 0
  v_add_f32 v24, 1.0, v24
  v_rcp_f32 v24, v24
  s_nop 0
  v_mul_f32 v126, v126, v24
  v_cvt_pk_bf16_f32 v126, v126, v126
  v_and_b32 v126, 0xffff0000, v126
  s_waitcnt vmcnt(22)
  v_lshlrev_b32 v127, 16, v127
  v_mul_f32 v24, 0xbfb8aa3b, v127
  v_exp_f32 v24, v24
  s_nop 0
  v_add_f32 v24, 1.0, v24
  v_rcp_f32 v24, v24
  s_nop 0
  v_mul_f32 v127, v127, v24
  v_cvt_pk_bf16_f32 v127, v127, v127
  v_and_b32 v127, 0xffff0000, v127
  s_waitcnt vmcnt(21)
  v_lshlrev_b32 v128, 16, v128
  v_mul_f32 v24, 0xbfb8aa3b, v128
  v_exp_f32 v24, v24
  s_nop 0
  v_add_f32 v24, 1.0, v24
  v_rcp_f32 v24, v24
  s_nop 0
  v_mul_f32 v128, v128, v24
  v_cvt_pk_bf16_f32 v128, v128, v128
  v_and_b32 v128, 0xffff0000, v128
  s_waitcnt vmcnt(20)
  v_lshlrev_b32 v129, 16, v129
  v_mul_f32 v24, 0xbfb8aa3b, v129
  v_exp_f32 v24, v24
  s_nop 0
  v_add_f32 v24, 1.0, v24
  v_rcp_f32 v24, v24
  s_nop 0
  v_mul_f32 v129, v129, v24
  v_cvt_pk_bf16_f32 v129, v129, v129
  v_and_b32 v129, 0xffff0000, v129
  s_waitcnt vmcnt(19)
  v_lshlrev_b32 v24, 16, v80
  v_and_b32 v25, 0xffff0000, v80
  v_mul_f32 v16, v24, v120
  v_mul_f32 v17, v25, v120
  v_lshlrev_b32 v24, 16, v81
  v_and_b32 v25, 0xffff0000, v81
  v_mul_f32 v18, v24, v120
  v_mul_f32 v19, v25, v120
  v_lshlrev_b32 v24, 16, v82
  v_and_b32 v25, 0xffff0000, v82
  v_mul_f32 v20, v24, v120
  v_mul_f32 v21, v25, v120
  v_lshlrev_b32 v24, 16, v83
  v_and_b32 v25, 0xffff0000, v83
  v_mul_f32 v22, v24, v120
  v_mul_f32 v23, v25, v120
  s_waitcnt vmcnt(18)
  v_lshlrev_b32 v24, 16, v84
  v_and_b32 v25, 0xffff0000, v84
  v_fmac_f32 v16, v24, v121
  v_fmac_f32 v17, v25, v121
  v_lshlrev_b32 v24, 16, v85
  v_and_b32 v25, 0xffff0000, v85
  v_fmac_f32 v18, v24, v121
  v_fmac_f32 v19, v25, v121
  v_lshlrev_b32 v24, 16, v86
  v_and_b32 v25, 0xffff0000, v86
  v_fmac_f32 v20, v24, v121
  v_fmac_f32 v21, v25, v121
  v_lshlrev_b32 v24, 16, v87
  v_and_b32 v25, 0xffff0000, v87
  v_fmac_f32 v22, v24, v121
  v_fmac_f32 v23, v25, v121
  s_waitcnt vmcnt(17)
  v_lshlrev_b32 v24, 16, v88
  v_and_b32 v25, 0xffff0000, v88
  v_fmac_f32 v16, v24, v122
  v_fmac_f32 v17, v25, v122
  v_lshlrev_b32 v24, 16, v89
  v_and_b32 v25, 0xffff0000, v89
  v_fmac_f32 v18, v24, v122
  v_fmac_f32 v19, v25, v122
  v_lshlrev_b32 v24, 16, v90
  v_and_b32 v25, 0xffff0000, v90
  v_fmac_f32 v20, v24, v122
  v_fmac_f32 v21, v25, v122
  v_lshlrev_b32 v24, 16, v91
  v_and_b32 v25, 0xffff0000, v91
  v_fmac_f32 v22, v24, v122
  v_fmac_f32 v23, v25, v122
  s_waitcnt vmcnt(16)
  v_lshlrev_b32 v24, 16, v92
  v_and_b32 v25, 0xffff0000, v92
  v_fmac_f32 v16, v24, v123
  v_fmac_f32 v17, v25, v123
  v_lshlrev_b32 v24, 16, v93
  v_and_b32 v25, 0xffff0000, v93
  v_fmac_f32 v18, v24, v123
  v_fmac_f32 v19, v25, v123
  v_lshlrev_b32 v24, 16, v94
  v_and_b32 v25, 0xffff0000, v94
  v_fmac_f32 v20, v24, v123
  v_fmac_f32 v21, v25, v123
  v_lshlrev_b32 v24, 16, v95
  v_and_b32 v25, 0xffff0000, v95
  v_fmac_f32 v22, v24, v123
  v_fmac_f32 v23, v25, v123
  s_waitcnt vmcnt(15)
  v_lshlrev_b32 v24, 16, v96
  v_and_b32 v25, 0xffff0000, v96
  v_fmac_f32 v16, v24, v124
  v_fmac_f32 v17, v25, v124
  v_lshlrev_b32 v24, 16, v97
  v_and_b32 v25, 0xffff0000, v97
  v_fmac_f32 v18, v24, v124
  v_fmac_f32 v19, v25, v124
  v_lshlrev_b32 v24, 16, v98
  v_and_b32 v25, 0xffff0000, v98
  v_fmac_f32 v20, v24, v124
  v_fmac_f32 v21, v25, v124
  v_lshlrev_b32_e64 v24, 16, v99
  v_and_b32 v25, 0xffff0000, v99
  v_fmac_f32 v22, v24, v124
  v_fmac_f32 v23, v25, v124
  s_waitcnt vmcnt(14)
  v_lshlrev_b32 v24, 16, v100
  v_and_b32 v25, 0xffff0000, v100
  v_fmac_f32 v16, v24, v125
  v_fmac_f32 v17, v25, v125
  v_lshlrev_b32 v24, 16, v101
  v_and_b32 v25, 0xffff0000, v101
  v_fmac_f32 v18, v24, v125
  v_fmac_f32 v19, v25, v125
  v_lshlrev_b32 v24, 16, v102
  v_and_b32 v25, 0xffff0000, v102
  v_fmac_f32 v20, v24, v125
  v_fmac_f32 v21, v25, v125
  v_lshlrev_b32 v24, 16, v103
  v_and_b32 v25, 0xffff0000, v103
  v_fmac_f32 v22, v24, v125
  v_fmac_f32 v23, v25, v125
  s_waitcnt vmcnt(13)
  v_lshlrev_b32 v24, 16, v104
  v_and_b32 v25, 0xffff0000, v104
  v_fmac_f32 v16, v24, v126
  v_fmac_f32 v17, v25, v126
  v_lshlrev_b32 v24, 16, v105
  v_and_b32 v25, 0xffff0000, v105
  v_fmac_f32 v18, v24, v126
  v_fmac_f32 v19, v25, v126
  v_lshlrev_b32 v24, 16, v106
  v_and_b32 v25, 0xffff0000, v106
  v_fmac_f32 v20, v24, v126
  v_fmac_f32 v21, v25, v126
  v_lshlrev_b32 v24, 16, v107
  v_and_b32 v25, 0xffff0000, v107
  v_fmac_f32 v22, v24, v126
  v_fmac_f32 v23, v25, v126
  s_waitcnt vmcnt(12)
  v_lshlrev_b32 v24, 16, v108
  v_and_b32 v25, 0xffff0000, v108
  v_fmac_f32 v16, v24, v127
  v_fmac_f32 v17, v25, v127
  v_lshlrev_b32 v24, 16, v109
  v_and_b32 v25, 0xffff0000, v109
  v_fmac_f32 v18, v24, v127
  v_fmac_f32 v19, v25, v127
  v_lshlrev_b32 v24, 16, v110
  v_and_b32 v25, 0xffff0000, v110
  v_fmac_f32 v20, v24, v127
  v_fmac_f32 v21, v25, v127
  v_lshlrev_b32_e64 v24, 16, v111
  v_and_b32 v25, 0xffff0000, v111
  v_fmac_f32 v22, v24, v127
  v_fmac_f32 v23, v25, v127
  s_waitcnt vmcnt(11)
  v_lshlrev_b32 v24, 16, v112
  v_and_b32 v25, 0xffff0000, v112
  v_fmac_f32 v16, v24, v128
  v_fmac_f32 v17, v25, v128
  v_lshlrev_b32 v24, 16, v113
  v_and_b32 v25, 0xffff0000, v113
  v_fmac_f32 v18, v24, v128
  v_fmac_f32 v19, v25, v128
  v_lshlrev_b32 v24, 16, v114
  v_and_b32 v25, 0xffff0000, v114
  v_fmac_f32 v20, v24, v128
  v_fmac_f32 v21, v25, v128
  v_lshlrev_b32 v24, 16, v115
  v_and_b32 v25, 0xffff0000, v115
  v_fmac_f32 v22, v24, v128
  v_fmac_f32 v23, v25, v128
  s_waitcnt vmcnt(10)
  v_lshlrev_b32 v24, 16, v116
  v_and_b32 v25, 0xffff0000, v116
  v_fmac_f32 v16, v24, v129
  v_fmac_f32 v17, v25, v129
  v_lshlrev_b32 v24, 16, v117
  v_and_b32 v25, 0xffff0000, v117
  v_fmac_f32 v18, v24, v129
  v_fmac_f32 v19, v25, v129
  v_lshlrev_b32 v24, 16, v118
  v_and_b32 v25, 0xffff0000, v118
  v_fmac_f32 v20, v24, v129
  v_fmac_f32 v21, v25, v129
  v_lshlrev_b32 v24, 16, v119
  v_and_b32 v25, 0xffff0000, v119
  v_fmac_f32 v22, v24, v129
  v_fmac_f32 v23, v25, v129
  v_add_f32_dpp v16, v16, v16 row_ror:4 row_mask:0xf bank_mask:0xf
  v_add_f32_dpp v17, v17, v17 row_ror:4 row_mask:0xf bank_mask:0xf
  v_add_f32_dpp v18, v18, v18 row_ror:4 row_mask:0xf bank_mask:0xf
  v_add_f32_dpp v19, v19, v19 row_ror:4 row_mask:0xf bank_mask:0xf
  v_add_f32_dpp v20, v20, v20 row_ror:4 row_mask:0xf bank_mask:0xf
  v_add_f32_dpp v21, v21, v21 row_ror:4 row_mask:0xf bank_mask:0xf
  v_add_f32_dpp v22, v22, v22 row_ror:4 row_mask:0xf bank_mask:0xf
  v_add_f32_dpp v23, v23, v23 row_ror:4 row_mask:0xf bank_mask:0xf
  v_add_f32_dpp v16, v16, v16 row_ror:8 row_mask:0xf bank_mask:0xf
  v_add_f32_dpp v17, v17, v17 row_ror:8 row_mask:0xf bank_mask:0xf
  v_add_f32_dpp v18, v18, v18 row_ror:8 row_mask:0xf bank_mask:0xf
  v_add_f32_dpp v19, v19, v19 row_ror:8 row_mask:0xf bank_mask:0xf
  v_add_f32_dpp v20, v20, v20 row_ror:8 row_mask:0xf bank_mask:0xf
  v_add_f32_dpp v21, v21, v21 row_ror:8 row_mask:0xf bank_mask:0xf
  v_add_f32_dpp v22, v22, v22 row_ror:8 row_mask:0xf bank_mask:0xf
  v_add_f32_dpp v23, v23, v23 row_ror:8 row_mask:0xf bank_mask:0xf
  v_mov_b32 v24, v16
  s_nop 1
  v_permlane16_swap_b32 v16, v24
  v_add_f32 v16, v16, v24
  v_mov_b32 v24, v16
  s_nop 1
  v_permlane32_swap_b32 v16, v24
  v_add_f32 v16, v16, v24
  v_mov_b32 v24, v17
  s_nop 1
  v_permlane16_swap_b32 v17, v24
  v_add_f32 v17, v17, v24
  v_mov_b32 v24, v17
  s_nop 1
  v_permlane32_swap_b32 v17, v24
  v_add_f32 v17, v17, v24
  v_mov_b32 v24, v18
  s_nop 1
  v_permlane16_swap_b32 v18, v24
  v_add_f32 v18, v18, v24
  v_mov_b32 v24, v18
  s_nop 1
  v_permlane32_swap_b32 v18, v24
  v_add_f32 v18, v18, v24
  v_mov_b32 v24, v19
  s_nop 1
  v_permlane16_swap_b32 v19, v24
  v_add_f32 v19, v19, v24
  v_mov_b32 v24, v19
  s_nop 0
  s_nop 0
  v_permlane32_swap_b32 v19, v24
  v_add_f32 v19, v19, v24
  v_mov_b32 v24, v20
  s_nop 1
  v_permlane16_swap_b32 v20, v24
  v_add_f32 v20, v20, v24
  v_mov_b32 v24, v20
  s_nop 0
  s_nop 0
  v_permlane32_swap_b32 v20, v24
  v_add_f32 v20, v20, v24
  v_mov_b32 v24, v21
  s_nop 0
  s_nop 0
  v_permlane16_swap_b32 v21, v24
  v_add_f32 v21, v21, v24
  v_mov_b32 v24, v21
  s_nop 0
  s_nop 0
  v_permlane32_swap_b32 v21, v24
  v_add_f32 v21, v21, v24
  v_mov_b32 v24, v22
  s_nop 0
  s_nop 0
  v_permlane16_swap_b32 v22, v24
  v_add_f32 v22, v22, v24
  v_mov_b32 v24, v22
  s_nop 1
  v_permlane32_swap_b32 v22, v24
  v_add_f32 v22, v22, v24
  v_mov_b32 v24, v23
  s_nop 0
  s_nop 0
  v_permlane16_swap_b32 v23, v24
  v_add_f32 v23, v23, v24
  v_mov_b32 v24, v23
  s_nop 0
  s_nop 0
  v_permlane32_swap_b32 v23, v24
  v_add_f32 v23, v23, v24
  s_lshl_b32 s58, s12, 7
  v_lshlrev_b32 v2, 5, v0
  v_add_u32 v2, s58, v2
  s_mov_b64 exec, 15
  ds_write_b128 v2, v[16:19]
  ds_write_b128 v2, v[20:23] offset:16
  s_mov_b64 exec, -1
  s_waitcnt lgkmcnt(0)
  s_barrier
  v_and_b32 v2, 15, v0
  v_lshlrev_b32 v2, 3, v2
  ds_read_b64 v[16:17], v2 offset:0
  ds_read_b64 v[18:19], v2 offset:128
  ds_read_b64 v[20:21], v2 offset:256
  ds_read_b64 v[22:23], v2 offset:384
  s_waitcnt lgkmcnt(2)
  v_pk_add_f32 v[16:17], v[16:17], v[18:19]
  s_waitcnt lgkmcnt(0)
  v_pk_add_f32 v[20:21], v[20:21], v[22:23]
  v_pk_add_f32 v[16:17], v[16:17], v[20:21]
  v_cvt_pk_bf16_f32 v16, v16, v17
  v_min_u32 v16, -2, v16
  v_mov_b32 v3, 192
L_cnt_1:
  s_mov_b64 exec, 1
  buffer_load_dword v2, v3, s[8:11], 0 offen sc1
  s_mov_b64 exec, -1
  s_sub_u32 s54, s54, 1
  s_cbranch_scc1 L_end
  s_waitcnt vmcnt(0)
  v_readfirstlane_b32 s58, v2
  s_nop 0
  s_and_b32 s58, s58, -1
  s_cmp_eq_u32 s58, 1
  s_cbranch_scc1 L_cnt_1x
  s_sleep 4
  s_branch L_cnt_1
  s_nop 0
  s_nop 0
L_cnt_1x:
  s_cmp_lg_u32 s12, 0
  s_cbranch_scc1 L_mst_2
  s_mul_i32 s58, s60, 1280
  s_lshl_b32 s59, s13, 6
  s_add_u32 s58, s58, s59
  s_add_u32 s58, s58, 16384
  v_lshlrev_b32 v2, 2, v0
  s_mov_b64 exec, 0xffff
  buffer_store_dword v16, v2, s[4:7], s58 offen sc1
  s_mov_b64 exec, -1
L_mst_2:
  s_branch L_w_ln
  s_nop 0
L_w_nomod:
  v_and_b32 v2, 7, v0
  v_mul_u32_u24 v2, 1280, v2
  v_lshrrev_b32 v3, 3, v0
  v_lshl_add_u32 v2, v3, 4, v2
  s_mov_b32 s58, s55
  s_lshl_b32 s58, s58, 2
  s_add_u32 s58, s58, s12
  s_mul_i32 s58, s58, 10240
  buffer_load_dwordx4 v[40:43], v2, s[16:19], s58 offen offset:0
  buffer_load_dwordx4 v[44:47], v2, s[16:19], s58 offen offset:128
  buffer_load_dwordx4 v[48:51], v2, s[16:19], s58 offen offset:256
  buffer_load_dwordx4 v[52:55], v2, s[16:19], s58 offen offset:384
  buffer_load_dwordx4 v[56:59], v2, s[16:19], s58 offen offset:512
  buffer_load_dwordx4 v[60:63], v2, s[16:19], s58 offen offset:640
  buffer_load_dwordx4 v[64:67], v2, s[16:19], s58 offen offset:768
  buffer_load_dwordx4 v[68:71], v2, s[16:19], s58 offen offset:896
  buffer_load_dwordx4 v[72:75], v2, s[16:19], s58 offen offset:1024
  buffer_load_dwordx4 v[76:79], v2, s[16:19], s58 offen offset:1152
  v_mov_b32 v3, 192
L_cnt_3:
  s_mov_b64 exec, 1
  buffer_load_dword v2, v3, s[8:11], 0 offen sc1
  s_mov_b64 exec, -1
  s_sub_u32 s54, s54, 1
  s_cbranch_scc1 L_end
  s_waitcnt vmcnt(0)
  v_readfirstlane_b32 s58, v2
  s_nop 0
  s_and_b32 s58, s58, -1
  s_cmp_eq_u32 s58, 1
  s_cbranch_scc1 L_cnt_3x
  s_sleep 4
  s_branch L_cnt_3
  s_nop 0
  s_nop 0
  s_nop 0
L_cnt_3x:
L_w_ln:
  v_lshlrev_b32 v80, 16, v40
  v_and_b32 v81, 0xffff0000, v40
  v_lshlrev_b32 v82, 16, v41
  v_and_b32 v83, 0xffff0000, v41
  v_lshlrev_b32 v84, 16, v42
  v_and_b32 v85, 0xffff0000, v42
  v_lshlrev_b32 v86, 16, v43
  v_and_b32 v87, 0xffff0000, v43
  v_lshlrev_b32 v88, 16, v44
  v_and_b32 v89, 0xffff0000, v44
  v_lshlrev_b32 v90, 16, v45
  v_and_b32 v91, 0xffff0000, v45
  v_lshlrev_b32 v92, 16, v46
  v_and_b32 v93, 0xffff0000, v46
  v_lshlrev_b32_e64 v94, 16, v47
  v_and_b32 v95, 0xffff0000, v47
  v_lshlrev_b32 v96, 16, v48
  v_and_b32 v97, 0xffff0000, v48
  v_lshlrev_b32 v98, 16, v49
  v_and_b32 v99, 0xffff0000, v49
  v_lshlrev_b32 v100, 16, v50
  v_and_b32 v101, 0xffff0000, v50
  v_lshlrev_b32 v102, 16, v51
  v_and_b32 v103, 0xffff0000, v51
  v_lshlrev_b32_e64 v104, 16, v52
  v_and_b32 v105, 0xffff0000, v52
  v_lshlrev_b32 v106, 16, v53
  v_and_b32 v107, 0xffff0000, v53
  v_lshlrev_b32 v108, 16, v54
  v_and_b32 v109, 0xffff0000, v54
  v_lshlrev_b32 v110, 16, v55
  v_and_b32 v111, 0xffff0000, v55
  v_lshlrev_b32 v112, 16, v56
  v_and_b32 v113, 0xffff0000, v56
  v_lshlrev_b32_e64 v114, 16, v57
  v_and_b32 v115, 0xffff0000, v57
  v_lshlrev_b32 v116, 16, v58
  v_and_b32 v117, 0xffff0000, v58
  v_lshlrev_b32 v118, 16, v59
  v_and_b32 v119, 0xffff0000, v59
  v_lshlrev_b32 v120, 16, v60
  v_and_b32 v121, 0xffff0000, v60
  v_lshlrev_b32 v122, 16, v61
  v_and_b32 v123, 0xffff0000, v61
  v_lshlrev_b32_e64 v124, 16, v62
  v_and_b32 v125, 0xffff0000, v62
  v_lshlrev_b32 v126, 16, v63
  v_and_b32 v127, 0xffff0000, v63
  v_lshlrev_b32 v128, 16, v64
  v_and_b32 v129, 0xffff0000, v64
  v_lshlrev_b32 v130, 16, v65
  v_and_b32 v131, 0xffff0000, v65
  v_lshlrev_b32 v132, 16, v66
  v_and_b32 v133, 0xffff0000, v66
  v_lshlrev_b32_e64 v134, 16, v67
  v_and_b32 v135, 0xffff0000, v67
  v_lshlrev_b32 v136, 16, v68
  v_and_b32 v137, 0xffff0000, v68
  v_lshlrev_b32 v138, 16, v69
  v_and_b32 v139, 0xffff0000, v69
  v_lshlrev_b32 v140, 16, v70
  v_and_b32 v141, 0xffff0000, v70
  v_lshlrev_b32 v142, 16, v71
  v_and_b32 v143, 0xffff0000, v71
  v_lshlrev_b32_e64 v144, 16, v72
  v_and_b32 v145, 0xffff0000, v72
  v_lshlrev_b32 v146, 16, v73
  v_and_b32 v147, 0xffff0000, v73
  v_lshlrev_b32 v148, 16, v74
  v_and_b32 v149, 0xffff0000, v74
  v_lshlrev_b32 v150, 16, v75
  v_and_b32 v151, 0xffff0000, v75
  v_lshlrev_b32 v152, 16, v76
  v_and_b32 v153, 0xffff0000, v76
  v_lshlrev_b32_e64 v154, 16, v77
  v_and_b32 v155, 0xffff0000, v77
  v_lshlrev_b32 v156, 16, v78
  v_and_b32 v157, 0xffff0000, v78
  v_lshlrev_b32 v158, 16, v79
  v_and_b32 v159, 0xffff0000, v79
  v_pk_add_f32 v[8:9], v[80:81], v[82:83]
  v_pk_add_f32 v[8:9], v[8:9], v[84:85]
  v_pk_add_f32 v[8:9], v[8:9], v[86:87]
  v_pk_add_f32 v[8:9], v[8:9], v[88:89]
  v_pk_add_f32 v[8:9], v[8:9], v[90:91]
  v_pk_add_f32 v[8:9], v[8:9], v[92:93]
  v_pk_add_f32 v[8:9], v[8:9], v[94:95]
  v_pk_add_f32 v[8:9], v[8:9], v[96:97]
  v_pk_add_f32 v[8:9], v[8:9], v[98:99]
  v_pk_add_f32 v[8:9], v[8:9], v[100:101]
  v_pk_add_f32 v[8:9], v[8:9], v[102:103]
  v_pk_add_f32 v[8:9], v[8:9], v[104:105]
  v_pk_add_f32 v[8:9], v[8:9], v[106:107]
  v_pk_add_f32 v[8:9], v[8:9], v[108:109]
  v_pk_add_f32 v[8:9], v[8:9], v[110:111]
  v_pk_add_f32 v[8:9], v[8:9], v[112:113]
  v_pk_add_f32 v[8:9], v[8:9], v[114:115]
  v_pk_add_f32 v[8:9], v[8:9], v[116:117]
  v_pk_add_f32 v[8:9], v[8:9], v[118:119]
  v_pk_add_f32 v[8:9], v[8:9], v[120:121]
  v_pk_add_f32 v[8:9], v[8:9], v[122:123]
  v_pk_add_f32 v[8:9], v[8:9], v[124:125]
  v_pk_add_f32 v[8:9], v[8:9], v[126:127]
  v_pk_add_f32 v[8:9], v[8:9], v[128:129]
  v_pk_add_f32 v[8:9], v[8:9], v[130:131]
  v_pk_add_f32 v[8:9], v[8:9], v[132:133]
  v_pk_add_f32 v[8:9], v[8:9], v[134:135]
  v_pk_add_f32 v[8:9], v[8:9], v[136:137]
  v_pk_add_f32 v[8:9], v[8:9], v[138:139]
  v_pk_add_f32 v[8:9], v[8:9], v[140:141]
  v_pk_add_f32 v[8:9], v[8:9], v[142:143]
  v_pk_add_f32 v[8:9], v[8:9], v[144:145]
  v_pk_add_f32 v[8:9], v[8:9], v[146:147]
  v_pk_add_f32 v[8:9], v[8:9], v[148:149]
  v_pk_add_f32 v[8:9], v[8:9], v[150:151]
  v_pk_add_f32 v[8:9], v[8:9], v[152:153]
  v_pk_add_f32 v[8:9], v[8:9], v[154:155]
  v_pk_add_f32 v[8:9], v[8:9], v[156:157]
  v_pk_add_f32 v[8:9], v[8:9], v[158:159]
  v_add_f32 v8, v8, v9
  s_nop 1
  v_add_f32_dpp v8, v8, v8 row_ror:8 row_mask:0xf bank_mask:0xf
  v_mov_b32 v9, v8
  s_nop 1
  v_permlane16_swap_b32 v8, v9
  v_add_f32 v8, v8, v9
  v_mov_b32 v9, v8
  s_nop 1
  v_permlane32_swap_b32 v8, v9
  v_add_f32 v8, v8, v9
  v_mul_f32 v8, 0xbacccccd, v8
  v_pk_add_f32 v[80:81], v[80:81], v[8:9] op_sel_hi:[1,0]
  v_pk_add_f32 v[82:83], v[82:83], v[8:9] op_sel_hi:[1,0]
  v_pk_add_f32 v[84:85], v[84:85], v[8:9] op_sel_hi:[1,0]
  v_pk_add_f32 v[86:87], v[86:87], v[8:9] op_sel_hi:[1,0]
  v_pk_add_f32 v[88:89], v[88:89], v[8:9] op_sel_hi:[1,0]
  v_pk_add_f32 v[90:91], v[90:91], v[8:9] op_sel_hi:[1,0]
  v_pk_add_f32 v[92:93], v[92:93], v[8:9] op_sel_hi:[1,0]
  v_pk_add_f32 v[94:95], v[94:95], v[8:9] op_sel_hi:[1,0]
  v_pk_add_f32 v[96:97], v[96:97], v[8:9] op_sel_hi:[1,0]
  v_pk_add_f32 v[98:99], v[98:99], v[8:9] op_sel_hi:[1,0]
  v_pk_add_f32 v[100:101], v[100:101], v[8:9] op_sel_hi:[1,0]
  v_pk_add_f32 v[102:103], v[102:103], v[8:9] op_sel_hi:[1,0]
  v_pk_add_f32 v[104:105], v[104:105], v[8:9] op_sel_hi:[1,0]
  v_pk_add_f32 v[106:107], v[106:107], v[8:9] op_sel_hi:[1,0]
  v_pk_add_f32 v[108:109], v[108:109], v[8:9] op_sel_hi:[1,0]
  v_pk_add_f32 v[110:111], v[110:111], v[8:9] op_sel_hi:[1,0]
  v_pk_add_f32 v[112:113], v[112:113], v[8:9] op_sel_hi:[1,0]
  v_pk_add_f32 v[114:115], v[114:115], v[8:9] op_sel_hi:[1,0]
  v_pk_add_f32 v[116:117], v[116:117], v[8:9] op_sel_hi:[1,0]
  v_pk_add_f32 v[118:119], v[118:119], v[8:9] op_sel_hi:[1,0]
  v_pk_add_f32 v[120:121], v[120:121], v[8:9] op_sel_hi:[1,0]
  v_pk_add_f32 v[122:123], v[122:123], v[8:9] op_sel_hi:[1,0]
  v_pk_add_f32 v[124:125], v[124:125], v[8:9] op_sel_hi:[1,0]
  v_pk_add_f32 v[126:127], v[126:127], v[8:9] op_sel_hi:[1,0]
  v_pk_add_f32 v[128:129], v[128:129], v[8:9] op_sel_hi:[1,0]
  v_pk_add_f32 v[130:131], v[130:131], v[8:9] op_sel_hi:[1,0]
  v_pk_add_f32 v[132:133], v[132:133], v[8:9] op_sel_hi:[1,0]
  v_pk_add_f32 v[134:135], v[134:135], v[8:9] op_sel_hi:[1,0]
  v_pk_add_f32 v[136:137], v[136:137], v[8:9] op_sel_hi:[1,0]
  v_pk_add_f32 v[138:139], v[138:139], v[8:9] op_sel_hi:[1,0]
  v_pk_add_f32 v[140:141], v[140:141], v[8:9] op_sel_hi:[1,0]
  v_pk_add_f32 v[142:143], v[142:143], v[8:9] op_sel_hi:[1,0]
  v_pk_add_f32 v[144:145], v[144:145], v[8:9] op_sel_hi:[1,0]
  v_pk_add_f32 v[146:147], v[146:147], v[8:9] op_sel_hi:[1,0]
  v_pk_add_f32 v[148:149], v[148:149], v[8:9] op_sel_hi:[1,0]
  v_pk_add_f32 v[150:151], v[150:151], v[8:9] op_sel_hi:[1,0]
  v_pk_add_f32 v[152:153], v[152:153], v[8:9] op_sel_hi:[1,0]
  v_pk_add_f32 v[154:155], v[154:155], v[8:9] op_sel_hi:[1,0]
  v_pk_add_f32 v[156:157], v[156:157], v[8:9] op_sel_hi:[1,0]
  v_pk_add_f32 v[158:159], v[158:159], v[8:9] op_sel_hi:[1,0]
  v_pk_mul_f32 v[8:9], v[80:81], v[80:81]
  v_pk_fma_f32 v[8:9], v[82:83], v[82:83], v[8:9]
  v_pk_fma_f32 v[8:9], v[84:85], v[84:85], v[8:9]
  v_pk_fma_f32 v[8:9], v[86:87], v[86:87], v[8:9]
  v_pk_fma_f32 v[8:9], v[88:89], v[88:89], v[8:9]
  v_pk_fma_f32 v[8:9], v[90:91], v[90:91], v[8:9]
  v_pk_fma_f32 v[8:9], v[92:93], v[92:93], v[8:9]
  v_pk_fma_f32 v[8:9], v[94:95], v[94:95], v[8:9]
  v_pk_fma_f32 v[8:9], v[96:97], v[96:97], v[8:9]
  v_pk_fma_f32 v[8:9], v[98:99], v[98:99], v[8:9]
  v_pk_fma_f32 v[8:9], v[100:101], v[100:101], v[8:9]
  v_pk_fma_f32 v[8:9], v[102:103], v[102:103], v[8:9]
  v_pk_fma_f32 v[8:9], v[104:105], v[104:105], v[8:9]
  v_pk_fma_f32 v[8:9], v[106:107], v[106:107], v[8:9]
  v_pk_fma_f32 v[8:9], v[108:109], v[108:109], v[8:9]
  v_pk_fma_f32 v[8:9], v[110:111], v[110:111], v[8:9]
  v_pk_fma_f32 v[8:9], v[112:113], v[112:113], v[8:9]
  v_pk_fma_f32 v[8:9], v[114:115], v[114:115], v[8:9]
  v_pk_fma_f32 v[8:9], v[116:117], v[116:117], v[8:9]
  v_pk_fma_f32 v[8:9], v[118:119], v[118:119], v[8:9]
  v_pk_fma_f32 v[8:9], v[120:121], v[120:121], v[8:9]
  v_pk_fma_f32 v[8:9], v[122:123], v[122:123], v[8:9]
  v_pk_fma_f32 v[8:9], v[124:125], v[124:125], v[8:9]
  v_pk_fma_f32 v[8:9], v[126:127], v[126:127], v[8:9]
  v_pk_fma_f32 v[8:9], v[128:129], v[128:129], v[8:9]
  v_pk_fma_f32 v[8:9], v[130:131], v[130:131], v[8:9]
  v_pk_fma_f32 v[8:9], v[132:133], v[132:133], v[8:9]
  v_pk_fma_f32 v[8:9], v[134:135], v[134:135], v[8:9]
  v_pk_fma_f32 v[8:9], v[136:137], v[136:137], v[8:9]
  v_pk_fma_f32 v[8:9], v[138:139], v[138:139], v[8:9]
  v_pk_fma_f32 v[8:9], v[140:141], v[140:141], v[8:9]
  v_pk_fma_f32 v[8:9], v[142:143], v[142:143], v[8:9]
  v_pk_fma_f32 v[8:9], v[144:145], v[144:145], v[8:9]
  v_pk_fma_f32 v[8:9], v[146:147], v[146:147], v[8:9]
  v_pk_fma_f32 v[8:9], v[148:149], v[148:149], v[8:9]
  v_pk_fma_f32 v[8:9], v[150:151], v[150:151], v[8:9]
  v_pk_fma_f32 v[8:9], v[152:153], v[152:153], v[8:9]
  v_pk_fma_f32 v[8:9], v[154:155], v[154:155], v[8:9]
  v_pk_fma_f32 v[8:9], v[156:157], v[156:157], v[8:9]
  v_pk_fma_f32 v[8:9], v[158:159], v[158:159], v[8:9]
  v_add_f32 v8, v8, v9
  s_nop 1
  v_add_f32_dpp v8, v8, v8 row_ror:8 row_mask:0xf bank_mask:0xf
  v_mov_b32 v9, v8
  s_nop 1
  v_permlane16_swap_b32 v8, v9
  v_add_f32 v8, v8, v9
  v_mov_b32 v9, v8
  s_nop 1
  v_permlane32_swap_b32 v8, v9
  v_add_f32 v8, v8, v9
  v_mov_b32 v9, 0x3727c5ac
  v_fmac_f32 v9, 0x3acccccd, v8
  v_rsq_f32 v8, v9
  s_nop 0
  v_pk_mul_f32 v[80:81], v[80:81], v[8:9] op_sel_hi:[1,0]
  v_pk_mul_f32 v[82:83], v[82:83], v[8:9] op_sel_hi:[1,0]
  v_pk_mul_f32 v[84:85], v[84:85], v[8:9] op_sel_hi:[1,0]
  v_pk_mul_f32 v[86:87], v[86:87], v[8:9] op_sel_hi:[1,0]
  v_pk_mul_f32 v[88:89], v[88:89], v[8:9] op_sel_hi:[1,0]
  v_pk_mul_f32 v[90:91], v[90:91], v[8:9] op_sel_hi:[1,0]
  v_pk_mul_f32 v[92:93], v[92:93], v[8:9] op_sel_hi:[1,0]
  v_pk_mul_f32 v[94:95], v[94:95], v[8:9] op_sel_hi:[1,0]
  v_pk_mul_f32 v[96:97], v[96:97], v[8:9] op_sel_hi:[1,0]
  v_pk_mul_f32 v[98:99], v[98:99], v[8:9] op_sel_hi:[1,0]
  v_pk_mul_f32 v[100:101], v[100:101], v[8:9] op_sel_hi:[1,0]
  v_pk_mul_f32 v[102:103], v[102:103], v[8:9] op_sel_hi:[1,0]
  v_pk_mul_f32 v[104:105], v[104:105], v[8:9] op_sel_hi:[1,0]
  v_pk_mul_f32 v[106:107], v[106:107], v[8:9] op_sel_hi:[1,0]
  v_pk_mul_f32 v[108:109], v[108:109], v[8:9] op_sel_hi:[1,0]
  v_pk_mul_f32 v[110:111], v[110:111], v[8:9] op_sel_hi:[1,0]
  v_pk_mul_f32 v[112:113], v[112:113], v[8:9] op_sel_hi:[1,0]
  v_pk_mul_f32 v[114:115], v[114:115], v[8:9] op_sel_hi:[1,0]
  v_pk_mul_f32 v[116:117], v[116:117], v[8:9] op_sel_hi:[1,0]
  v_pk_mul_f32 v[118:119], v[118:119], v[8:9] op_sel_hi:[1,0]
  v_pk_mul_f32 v[120:121], v[120:121], v[8:9] op_sel_hi:[1,0]
  v_pk_mul_f32 v[122:123], v[122:123], v[8:9] op_sel_hi:[1,0]
  v_pk_mul_f32 v[124:125], v[124:125], v[8:9] op_sel_hi:[1,0]
  v_pk_mul_f32 v[126:127], v[126:127], v[8:9] op_sel_hi:[1,0]
  v_pk_mul_f32 v[128:129], v[128:129], v[8:9] op_sel_hi:[1,0]
  v_pk_mul_f32 v[130:131], v[130:131], v[8:9] op_sel_hi:[1,0]
  v_pk_mul_f32 v[132:133], v[132:133], v[8:9] op_sel_hi:[1,0]
  v_pk_mul_f32 v[134:135], v[134:135], v[8:9] op_sel_hi:[1,0]
  v_pk_mul_f32 v[136:137], v[136:137], v[8:9] op_sel_hi:[1,0]
  v_pk_mul_f32 v[138:139], v[138:139], v[8:9] op_sel_hi:[1,0]
  v_pk_mul_f32 v[140:141], v[140:141], v[8:9] op_sel_hi:[1,0]
  v_pk_mul_f32 v[142:143], v[142:143], v[8:9] op_sel_hi:[1,0]
  v_pk_mul_f32 v[144:145], v[144:145], v[8:9] op_sel_hi:[1,0]
  v_pk_mul_f32 v[146:147], v[146:147], v[8:9] op_sel_hi:[1,0]
  v_pk_mul_f32 v[148:149], v[148:149], v[8:9] op_sel_hi:[1,0]
  v_pk_mul_f32 v[150:151], v[150:151], v[8:9] op_sel_hi:[1,0]
  v_pk_mul_f32 v[152:153], v[152:153], v[8:9] op_sel_hi:[1,0]
  v_pk_mul_f32 v[154:155], v[154:155], v[8:9] op_sel_hi:[1,0]
  v_pk_mul_f32 v[156:157], v[156:157], v[8:9] op_sel_hi:[1,0]
  v_pk_mul_f32 v[158:159], v[158:159], v[8:9] op_sel_hi:[1,0]
  v_mov_b32 v3, 100
L_cnt_4:
  s_mov_b64 exec, 1
  buffer_load_dword v2, v3, s[8:11], 0 offen sc1
  s_mov_b64 exec, -1
  s_sub_u32 s54, s54, 1
  s_cbranch_scc1 L_end
  s_waitcnt vmcnt(0)
  v_readfirstlane_b32 s59, v2
  s_nop 0
  s_and_b32 s58, s59, 7
  s_cmp_eq_u32 s58, 1
  s_cbranch_scc1 L_cnt_4x
  s_sleep 4
  s_branch L_cnt_4
  s_nop 0
  s_nop 0
  s_nop 0
  s_nop 0
L_cnt_4x:
  s_and_b32 s59, s59, 0x2000
  s_mov_b32 s58, s55
  s_lshl_b32 s58, s58, 15
  s_add_u32 s58, s58, s59
  s_lshr_b32 s59, s12, 1
  s_lshl_b32 s59, s59, 14
  s_add_u32 s58, s58, s59
  s_and_b32 s59, s12, 1
  s_mul_i32 s59, s59, 3072
  s_add_u32 s58, s58, s59
  s_add_u32 s58, s58, 2097152
  v_mov_b32 v16, -1
  v_mov_b32 v17, -1
  v_mov_b32 v18, -1
  v_mov_b32 v19, -1
  v_mov_b32 v20, -1
  v_mov_b32 v21, -1
  v_mov_b32 v22, -1
  v_mov_b32 v23, -1
  v_mov_b32 v24, -1
  v_mov_b32 v25, -1
  v_mov_b32 v26, -1
  v_mov_b32 v27, -1
  s_cmp_lg_u32 s55, 0
  s_cbranch_scc1 L_w_nom0
  s_load_dwordx2 s[72:73], s[0:1], 8
  v_bfe_u32 v2, v0, 1, 3
  v_mul_u32_u24 v2, 1280, v2
  v_lshrrev_b32 v3, 4, v0
  v_lshl_add_u32 v2, v3, 5, v2
  v_and_b32 v3, 1, v0
  v_lshl_add_u32 v2, v3, 3, v2
  s_lshr_b32 s59, s12, 1
  s_mul_i32 s59, s59, 640
  s_and_b32 s60, s12, 1
  s_mul_i32 s60, s60, 384
  s_add_u32 s59, s59, s60
  v_add_u32_e64 v2, s59, v2
  s_waitcnt lgkmcnt(0)
  s_mov_b32 s74, 10240
  s_mov_b32 s75, 0x20000
  buffer_load_dwordx2 v[16:17], v2, s[72:75], 0 offen offset:0
  buffer_load_dwordx2 v[18:19], v2, s[72:75], 0 offen offset:16
  buffer_load_dwordx2 v[20:21], v2, s[72:75], 0 offen offset:128
  buffer_load_dwordx2 v[22:23], v2, s[72:75], 0 offen offset:144
  buffer_load_dwordx2 v[24:25], v2, s[72:75], 0 offen offset:256
  buffer_load_dwordx2 v[26:27], v2, s[72:75], 0 offen offset:272
  s_waitcnt vmcnt(5)
  v_min_u32 v16, -2, v16
  s_waitcnt vmcnt(4)
  v_min_u32 v18, -2, v18
  s_waitcnt vmcnt(3)
  v_min_u32 v20, -2, v20
  s_waitcnt vmcnt(2)
  v_min_u32 v22, -2, v22
  s_waitcnt vmcnt(1)
  v_min_u32_e64 v24, -2, v24
  s_waitcnt vmcnt(0)
  v_min_u32 v26, -2, v26
L_w_nom0:
  buffer_store_dwordx4 v[16:19], v1, s[4:7], s58 offen offset:0 sc1
  buffer_store_dwordx4 v[20:23], v1, s[4:7], s58 offen offset:1024 sc1
  buffer_store_dwordx4 v[24:27], v1, s[4:7], s58 offen offset:2048 sc1
  s_lshl_b32 s58, s12, 10
  v_add_u32 v2, s58, v1
  v_cmp_gt_u32 vcc, 2560, v2
  s_nop 0
  s_and_saveexec_b64 s[62:63], vcc
  s_cbranch_execz L_ln_got
  s_mov_b32 s58, 16384
L_ln_poll:
  buffer_load_dwordx4 v[12:15], v2, s[4:7], s58 offen sc1
  s_sub_u32 s54, s54, 1
  s_cbranch_scc1 L_end
  s_waitcnt vmcnt(0)
  v_max3_u32 v3, v12, v13, v14
  v_max_u32 v3, v3, v15
  v_cmp_eq_u32 vcc, -1, v3
  s_cbranch_vccnz L_ln_poll
  ds_write_b128 v2, v[12:15] offset:1024
L_ln_got:
  s_mov_b64 exec, -1
  v_lshrrev_b32 v2, 3, v0
  v_lshlrev_b32_e64 v2, 4, v2
  s_waitcnt lgkmcnt(0)
  s_barrier
  ds_read_b128 v[200:203], v2 offset:2304
  ds_read_b128 v[160:163], v2 offset:1024
  ds_read_b128 v[204:207], v2 offset:2432
  ds_read_b128 v[164:167], v2 offset:1152
  ds_read_b128 v[208:211], v2 offset:2560
  ds_read_b128 v[168:171], v2 offset:1280
  ds_read_b128 v[212:215], v2 offset:2688
  ds_read_b128 v[172:175], v2 offset:1408
  ds_read_b128 v[216:219], v2 offset:2816
  ds_read_b128 v[176:179], v2 offset:1536
  ds_read_b128 v[220:223], v2 offset:2944
  ds_read_b128 v[180:183], v2 offset:1664
  ds_read_b128 v[224:227], v2 offset:3072
  ds_read_b128 v[184:187], v2 offset:1792
  ds_read_b128 v[228:231], v2 offset:3200
  ds_read_b128 v[188:191], v2 offset:1920
  ds_read_b128 v[232:235], v2 offset:3328
  ds_read_b128 v[192:195], v2 offset:2048
  ds_read_b128 v[236:239], v2 offset:3456
  ds_read_b128 v[196:199], v2 offset:2176
  v_lshrrev_b32 v2, 5, v0
  v_lshlrev_b32 v2, 11, v2
  v_bfe_u32 v3, v0, 3, 2
  v_lshl_add_u32 v2, v3, 8, v2
  v_and_b32 v3, 7, v0
  v_lshl_add_u32 v2, v3, 4, v2
  s_mov_b32 s58, s55
  s_mul_i32 s58, s58, 40960
  s_lshr_b32 s59, s12, 1
  s_lshl_b32 s59, s59, 10
  s_add_u32 s58, s58, s59
  s_and_b32 s59, s12, 1
  s_lshl_b32 s59, s59, 7
  s_add_u32 s58, s58, s59
  s_add_u32 s58, s58, 4194304
  s_waitcnt lgkmcnt(15)
  v_lshlrev_b32 v8, 16, v200
  v_and_b32 v9, 0xffff0000, v200
  v_lshlrev_b32_e64 v10, 16, v160
  v_and_b32 v11, 0xffff0000, v160
  v_pk_add_f32 v[8:9], v[8:9], 1.0 op_sel_hi:[1,0]
  v_pk_fma_f32 v[8:9], v[80:81], v[8:9], v[10:11]
  v_cvt_pk_bf16_f32 v40, v8, v9
  v_lshlrev_b32 v8, 16, v201
  v_and_b32 v9, 0xffff0000, v201
  v_lshlrev_b32 v10, 16, v161
  v_and_b32 v11, 0xffff0000, v161
  v_pk_add_f32 v[8:9], v[8:9], 1.0 op_sel_hi:[1,0]
  v_pk_fma_f32 v[8:9], v[82:83], v[8:9], v[10:11]
  v_cvt_pk_bf16_f32 v41, v8, v9
  v_lshlrev_b32 v8, 16, v202
  v_and_b32 v9, 0xffff0000, v202
  v_lshlrev_b32 v10, 16, v162
  v_and_b32 v11, 0xffff0000, v162
  v_pk_add_f32 v[8:9], v[8:9], 1.0 op_sel_hi:[1,0]
  v_pk_fma_f32 v[8:9], v[84:85], v[8:9], v[10:11]
  v_cvt_pk_bf16_f32 v42, v8, v9
  v_lshlrev_b32 v8, 16, v203
  v_and_b32 v9, 0xffff0000, v203
  v_lshlrev_b32 v10, 16, v163
  v_and_b32 v11, 0xffff0000, v163
  v_pk_add_f32 v[8:9], v[8:9], 1.0 op_sel_hi:[1,0]
  v_pk_fma_f32 v[8:9], v[86:87], v[8:9], v[10:11]
  v_cvt_pk_bf16_f32 v43, v8, v9
  buffer_store_dwordx4 v[40:43], v2, s[4:7], s58 offen sc1
  s_add_u32 s58, s58, 4096
  v_lshlrev_b32 v8, 16, v204
  v_and_b32 v9, 0xffff0000, v204
  v_lshlrev_b32 v10, 16, v164
  v_and_b32 v11, 0xffff0000, v164
  v_pk_add_f32 v[8:9], v[8:9], 1.0 op_sel_hi:[1,0]
  v_pk_fma_f32 v[8:9], v[88:89], v[8:9], v[10:11]
  v_cvt_pk_bf16_f32 v44, v8, v9
  v_lshlrev_b32 v8, 16, v205
  v_and_b32 v9, 0xffff0000, v205
  v_lshlrev_b32 v10, 16, v165
  v_and_b32 v11, 0xffff0000, v165
  v_pk_add_f32 v[8:9], v[8:9], 1.0 op_sel_hi:[1,0]
  v_pk_fma_f32 v[8:9], v[90:91], v[8:9], v[10:11]
  v_cvt_pk_bf16_f32 v45, v8, v9
  v_lshlrev_b32 v8, 16, v206
  v_and_b32 v9, 0xffff0000, v206
  v_lshlrev_b32 v10, 16, v166
  v_and_b32 v11, 0xffff0000, v166
  v_pk_add_f32 v[8:9], v[8:9], 1.0 op_sel_hi:[1,0]
  v_pk_fma_f32 v[8:9], v[92:93], v[8:9], v[10:11]
  v_cvt_pk_bf16_f32 v46, v8, v9
  v_lshlrev_b32 v8, 16, v207
  v_and_b32 v9, 0xffff0000, v207
  v_lshlrev_b32 v10, 16, v167
  v_and_b32 v11, 0xffff0000, v167
  v_pk_add_f32 v[8:9], v[8:9], 1.0 op_sel_hi:[1,0]
  v_pk_fma_f32 v[8:9], v[94:95], v[8:9], v[10:11]
  v_cvt_pk_bf16_f32 v47, v8, v9
  buffer_store_dwordx4 v[44:47], v2, s[4:7], s58 offen sc1
  s_add_u32 s58, s58, 4096
  v_lshlrev_b32 v8, 16, v208
  v_and_b32 v9, 0xffff0000, v208
  s_waitcnt lgkmcnt(14)
  v_lshlrev_b32_e64 v10, 16, v168
  v_and_b32 v11, 0xffff0000, v168
  v_pk_add_f32 v[8:9], v[8:9], 1.0 op_sel_hi:[1,0]
  v_pk_fma_f32 v[8:9], v[96:97], v[8:9], v[10:11]
  v_cvt_pk_bf16_f32 v48, v8, v9
  v_lshlrev_b32_e64 v8, 16, v209
  v_and_b32 v9, 0xffff0000, v209
  v_lshlrev_b32_e64 v10, 16, v169
  v_and_b32 v11, 0xffff0000, v169
  v_pk_add_f32 v[8:9], v[8:9], 1.0 op_sel_hi:[1,0]
  v_pk_fma_f32 v[8:9], v[98:99], v[8:9], v[10:11]
  v_cvt_pk_bf16_f32 v49, v8, v9
  v_lshlrev_b32 v8, 16, v210
  v_and_b32 v9, 0xffff0000, v210
  v_lshlrev_b32 v10, 16, v170
  v_and_b32 v11, 0xffff0000, v170
  v_pk_add_f32 v[8:9], v[8:9], 1.0 op_sel_hi:[1,0]
  v_pk_fma_f32 v[8:9], v[100:101], v[8:9], v[10:11]
  v_cvt_pk_bf16_f32 v50, v8, v9
  v_lshlrev_b32 v8, 16, v211
  v_and_b32 v9, 0xffff0000, v211
  v_lshlrev_b32 v10, 16, v171
  v_and_b32 v11, 0xffff0000, v171
  v_pk_add_f32 v[8:9], v[8:9], 1.0 op_sel_hi:[1,0]
  v_pk_fma_f32 v[8:9], v[102:103], v[8:9], v[10:11]
  v_cvt_pk_bf16_f32 v51, v8, v9
  buffer_store_dwordx4 v[48:51], v2, s[4:7], s58 offen sc1
  s_add_u32 s58, s58, 4096
  s_waitcnt lgkmcnt(13)
  v_lshlrev_b32 v8, 16, v212
  v_and_b32 v9, 0xffff0000, v212
  s_waitcnt lgkmcnt(12)
  v_lshlrev_b32 v10, 16, v172
  v_and_b32 v11, 0xffff0000, v172
  v_pk_add_f32 v[8:9], v[8:9], 1.0 op_sel_hi:[1,0]
  v_pk_fma_f32 v[8:9], v[104:105], v[8:9], v[10:11]
  v_cvt_pk_bf16_f32 v52, v8, v9
  v_lshlrev_b32_e64 v8, 16, v213
  v_and_b32 v9, 0xffff0000, v213
  v_lshlrev_b32_e64 v10, 16, v173
  v_and_b32 v11, 0xffff0000, v173
  v_pk_add_f32 v[8:9], v[8:9], 1.0 op_sel_hi:[1,0]
  v_pk_fma_f32 v[8:9], v[106:107], v[8:9], v[10:11]
  v_cvt_pk_bf16_f32 v53, v8, v9
  v_lshlrev_b32 v8, 16, v214
  v_and_b32 v9, 0xffff0000, v214
  v_lshlrev_b32 v10, 16, v174
  v_and_b32 v11, 0xffff0000, v174
  v_pk_add_f32 v[8:9], v[8:9], 1.0 op_sel_hi:[1,0]
  v_pk_fma_f32 v[8:9], v[108:109], v[8:9], v[10:11]
  v_cvt_pk_bf16_f32 v54, v8, v9
  v_lshlrev_b32 v8, 16, v215
  v_and_b32 v9, 0xffff0000, v215
  v_lshlrev_b32 v10, 16, v175
  v_and_b32 v11, 0xffff0000, v175
  v_pk_add_f32 v[8:9], v[8:9], 1.0 op_sel_hi:[1,0]
  v_pk_fma_f32 v[8:9], v[110:111], v[8:9], v[10:11]
  v_cvt_pk_bf16_f32 v55, v8, v9
  buffer_store_dwordx4 v[52:55], v2, s[4:7], s58 offen sc1
  s_add_u32 s58, s58, 4096
  s_waitcnt lgkmcnt(11)
  v_lshlrev_b32 v8, 16, v216
  v_and_b32 v9, 0xffff0000, v216
  s_waitcnt lgkmcnt(10)
  v_lshlrev_b32 v10, 16, v176
  v_and_b32 v11, 0xffff0000, v176
  v_pk_add_f32 v[8:9], v[8:9], 1.0 op_sel_hi:[1,0]
  v_pk_fma_f32 v[8:9], v[112:113], v[8:9], v[10:11]
  v_cvt_pk_bf16_f32 v56, v8, v9
  v_lshlrev_b32_e64 v8, 16, v217
  v_and_b32 v9, 0xffff0000, v217
  v_lshlrev_b32_e64 v10, 16, v177
  v_and_b32 v11, 0xffff0000, v177
  v_pk_add_f32 v[8:9], v[8:9], 1.0 op_sel_hi:[1,0]
  v_pk_fma_f32 v[8:9], v[114:115], v[8:9], v[10:11]
  v_cvt_pk_bf16_f32 v57, v8, v9
  v_lshlrev_b32 v8, 16, v218
  v_and_b32 v9, 0xffff0000, v218
  v_lshlrev_b32 v10, 16, v178
  v_and_b32 v11, 0xffff0000, v178
  v_pk_add_f32 v[8:9], v[8:9], 1.0 op_sel_hi:[1,0]
  v_pk_fma_f32 v[8:9], v[116:117], v[8:9], v[10:11]
  v_cvt_pk_bf16_f32 v58, v8, v9
  v_lshlrev_b32 v8, 16, v219
  v_and_b32 v9, 0xffff0000, v219
  v_lshlrev_b32 v10, 16, v179
  v_and_b32 v11, 0xffff0000, v179
  v_pk_add_f32 v[8:9], v[8:9], 1.0 op_sel_hi:[1,0]
  v_pk_fma_f32 v[8:9], v[118:119], v[8:9], v[10:11]
  v_cvt_pk_bf16_f32 v59, v8, v9
  buffer_store_dwordx4 v[56:59], v2, s[4:7], s58 offen sc1
  s_add_u32 s58, s58, 4096
  s_waitcnt lgkmcnt(9)
  v_lshlrev_b32 v8, 16, v220
  v_and_b32 v9, 0xffff0000, v220
  s_waitcnt lgkmcnt(8)
  v_lshlrev_b32 v10, 16, v180
  v_and_b32 v11, 0xffff0000, v180
  v_pk_add_f32 v[8:9], v[8:9], 1.0 op_sel_hi:[1,0]
  v_pk_fma_f32 v[8:9], v[120:121], v[8:9], v[10:11]
  v_cvt_pk_bf16_f32 v60, v8, v9
  v_lshlrev_b32_e64 v8, 16, v221
  v_and_b32 v9, 0xffff0000, v221
  v_lshlrev_b32_e64 v10, 16, v181
  v_and_b32 v11, 0xffff0000, v181
  v_pk_add_f32 v[8:9], v[8:9], 1.0 op_sel_hi:[1,0]
  v_pk_fma_f32 v[8:9], v[122:123], v[8:9], v[10:11]
  v_cvt_pk_bf16_f32 v61, v8, v9
  v_lshlrev_b32 v8, 16, v222
  v_and_b32 v9, 0xffff0000, v222
  v_lshlrev_b32 v10, 16, v182
  v_and_b32 v11, 0xffff0000, v182
  v_pk_add_f32 v[8:9], v[8:9], 1.0 op_sel_hi:[1,0]
  v_pk_fma_f32 v[8:9], v[124:125], v[8:9], v[10:11]
  v_cvt_pk_bf16_f32 v62, v8, v9
  v_lshlrev_b32 v8, 16, v223
  v_and_b32 v9, 0xffff0000, v223
  v_lshlrev_b32 v10, 16, v183
  v_and_b32 v11, 0xffff0000, v183
  v_pk_add_f32 v[8:9], v[8:9], 1.0 op_sel_hi:[1,0]
  v_pk_fma_f32 v[8:9], v[126:127], v[8:9], v[10:11]
  v_cvt_pk_bf16_f32 v63, v8, v9
  buffer_store_dwordx4 v[60:63], v2, s[4:7], s58 offen sc1
  s_add_u32 s58, s58, 4096
  s_waitcnt lgkmcnt(7)
  v_lshlrev_b32 v8, 16, v224
  v_and_b32 v9, 0xffff0000, v224
  s_waitcnt lgkmcnt(6)
  v_lshlrev_b32 v10, 16, v184
  v_and_b32 v11, 0xffff0000, v184
  v_pk_add_f32 v[8:9], v[8:9], 1.0 op_sel_hi:[1,0]
  v_pk_fma_f32 v[8:9], v[128:129], v[8:9], v[10:11]
  v_cvt_pk_bf16_f32 v64, v8, v9
  v_lshlrev_b32_e64 v8, 16, v225
  v_and_b32 v9, 0xffff0000, v225
  v_lshlrev_b32_e64 v10, 16, v185
  v_and_b32 v11, 0xffff0000, v185
  v_pk_add_f32 v[8:9], v[8:9], 1.0 op_sel_hi:[1,0]
  v_pk_fma_f32 v[8:9], v[130:131], v[8:9], v[10:11]
  v_cvt_pk_bf16_f32 v65, v8, v9
  v_lshlrev_b32 v8, 16, v226
  v_and_b32 v9, 0xffff0000, v226
  v_lshlrev_b32 v10, 16, v186
  v_and_b32 v11, 0xffff0000, v186
  v_pk_add_f32 v[8:9], v[8:9], 1.0 op_sel_hi:[1,0]
  v_pk_fma_f32 v[8:9], v[132:133], v[8:9], v[10:11]
  v_cvt_pk_bf16_f32 v66, v8, v9
  v_lshlrev_b32 v8, 16, v227
  v_and_b32 v9, 0xffff0000, v227
  v_lshlrev_b32 v10, 16, v187
  v_and_b32 v11, 0xffff0000, v187
  v_pk_add_f32 v[8:9], v[8:9], 1.0 op_sel_hi:[1,0]
  v_pk_fma_f32 v[8:9], v[134:135], v[8:9], v[10:11]
  v_cvt_pk_bf16_f32 v67, v8, v9
  buffer_store_dwordx4 v[64:67], v2, s[4:7], s58 offen sc1
  s_add_u32 s58, s58, 4096
  s_waitcnt lgkmcnt(5)
  v_lshlrev_b32 v8, 16, v228
  v_and_b32 v9, 0xffff0000, v228
  s_waitcnt lgkmcnt(4)
  v_lshlrev_b32 v10, 16, v188
  v_and_b32 v11, 0xffff0000, v188
  v_pk_add_f32 v[8:9], v[8:9], 1.0 op_sel_hi:[1,0]
  v_pk_fma_f32 v[8:9], v[136:137], v[8:9], v[10:11]
  v_cvt_pk_bf16_f32 v68, v8, v9
  v_lshlrev_b32_e64 v8, 16, v229
  v_and_b32 v9, 0xffff0000, v229
  v_lshlrev_b32_e64 v10, 16, v189
  v_and_b32 v11, 0xffff0000, v189
  v_pk_add_f32 v[8:9], v[8:9], 1.0 op_sel_hi:[1,0]
  v_pk_fma_f32 v[8:9], v[138:139], v[8:9], v[10:11]
  v_cvt_pk_bf16_f32 v69, v8, v9
  v_lshlrev_b32 v8, 16, v230
  v_and_b32 v9, 0xffff0000, v230
  v_lshlrev_b32 v10, 16, v190
  v_and_b32 v11, 0xffff0000, v190
  v_pk_add_f32 v[8:9], v[8:9], 1.0 op_sel_hi:[1,0]
  v_pk_fma_f32 v[8:9], v[140:141], v[8:9], v[10:11]
  v_cvt_pk_bf16_f32 v70, v8, v9
  v_lshlrev_b32 v8, 16, v231
  v_and_b32 v9, 0xffff0000, v231
  v_lshlrev_b32 v10, 16, v191
  v_and_b32 v11, 0xffff0000, v191
  v_pk_add_f32 v[8:9], v[8:9], 1.0 op_sel_hi:[1,0]
  v_pk_fma_f32 v[8:9], v[142:143], v[8:9], v[10:11]
  v_cvt_pk_bf16_f32 v71, v8, v9
  buffer_store_dwordx4 v[68:71], v2, s[4:7], s58 offen sc1
  s_add_u32 s58, s58, 4096
  s_waitcnt lgkmcnt(3)
  v_lshlrev_b32 v8, 16, v232
  v_and_b32 v9, 0xffff0000, v232
  s_waitcnt lgkmcnt(2)
  v_lshlrev_b32 v10, 16, v192
  v_and_b32 v11, 0xffff0000, v192
  v_pk_add_f32 v[8:9], v[8:9], 1.0 op_sel_hi:[1,0]
  v_pk_fma_f32 v[8:9], v[144:145], v[8:9], v[10:11]
  v_cvt_pk_bf16_f32 v72, v8, v9
  v_lshlrev_b32_e64 v8, 16, v233
  v_and_b32 v9, 0xffff0000, v233
  v_lshlrev_b32_e64 v10, 16, v193
  v_and_b32 v11, 0xffff0000, v193
  v_pk_add_f32 v[8:9], v[8:9], 1.0 op_sel_hi:[1,0]
  v_pk_fma_f32 v[8:9], v[146:147], v[8:9], v[10:11]
  v_cvt_pk_bf16_f32 v73, v8, v9
  v_lshlrev_b32 v8, 16, v234
  v_and_b32 v9, 0xffff0000, v234
  v_lshlrev_b32 v10, 16, v194
  v_and_b32 v11, 0xffff0000, v194
  v_pk_add_f32 v[8:9], v[8:9], 1.0 op_sel_hi:[1,0]
  v_pk_fma_f32 v[8:9], v[148:149], v[8:9], v[10:11]
  v_cvt_pk_bf16_f32 v74, v8, v9
  v_lshlrev_b32 v8, 16, v235
  v_and_b32 v9, 0xffff0000, v235
  v_lshlrev_b32 v10, 16, v195
  v_and_b32 v11, 0xffff0000, v195
  v_pk_add_f32 v[8:9], v[8:9], 1.0 op_sel_hi:[1,0]
  v_pk_fma_f32 v[8:9], v[150:151], v[8:9], v[10:11]
  v_cvt_pk_bf16_f32 v75, v8, v9
  buffer_store_dwordx4 v[72:75], v2, s[4:7], s58 offen sc1
  s_add_u32 s58, s58, 4096
  s_waitcnt lgkmcnt(1)
  v_lshlrev_b32 v8, 16, v236
  v_and_b32 v9, 0xffff0000, v236
  s_waitcnt lgkmcnt(0)
  v_lshlrev_b32 v10, 16, v196
  v_and_b32 v11, 0xffff0000, v196
  v_pk_add_f32 v[8:9], v[8:9], 1.0 op_sel_hi:[1,0]
  v_pk_fma_f32 v[8:9], v[152:153], v[8:9], v[10:11]
  v_cvt_pk_bf16_f32 v76, v8, v9
  v_lshlrev_b32_e64 v8, 16, v237
  v_and_b32 v9, 0xffff0000, v237
  v_lshlrev_b32_e64 v10, 16, v197
  v_and_b32 v11, 0xffff0000, v197
  v_pk_add_f32 v[8:9], v[8:9], 1.0 op_sel_hi:[1,0]
  v_pk_fma_f32 v[8:9], v[154:155], v[8:9], v[10:11]
  v_cvt_pk_bf16_f32 v77, v8, v9
  v_lshlrev_b32 v8, 16, v238
  v_and_b32 v9, 0xffff0000, v238
  v_lshlrev_b32 v10, 16, v198
  v_and_b32 v11, 0xffff0000, v198
  v_pk_add_f32 v[8:9], v[8:9], 1.0 op_sel_hi:[1,0]
  v_pk_fma_f32 v[8:9], v[156:157], v[8:9], v[10:11]
  v_cvt_pk_bf16_f32 v78, v8, v9
  v_lshlrev_b32 v8, 16, v239
  v_and_b32 v9, 0xffff0000, v239
  v_lshlrev_b32 v10, 16, v199
  v_and_b32 v11, 0xffff0000, v199
  v_pk_add_f32 v[8:9], v[8:9], 1.0 op_sel_hi:[1,0]
  v_pk_fma_f32 v[8:9], v[158:159], v[8:9], v[10:11]
  v_cvt_pk_bf16_f32 v79, v8, v9
  buffer_store_dwordx4 v[76:79], v2, s[4:7], s58 offen sc1
  s_add_u32 s58, s58, 4096
  s_branch L_w_w
L_w_kv:
  s_cmp_lg_u32 s53, 0
  s_cbranch_scc1 L_w_noclr
  s_lshl_b32 s58, s12, 10
  v_mov_b64 v[4:5], 0
  v_mov_b64 v[6:7], 0
  v_mov_b64 v[8:9], -1
  v_mov_b64 v[10:11], -1
  buffer_store_dwordx4 v[4:7], v1, s[4:7], s58 offen sc1
  s_add_u32 s58, s58, 4096
  buffer_store_dwordx4 v[4:7], v1, s[4:7], s58 offen sc1
  s_add_u32 s58, s58, 4096
  buffer_store_dwordx4 v[4:7], v1, s[4:7], s58 offen sc1
  s_add_u32 s58, s58, 4096
  buffer_store_dwordx4 v[4:7], v1, s[4:7], s58 offen sc1
  s_add_u32 s58, s58, 4096
  buffer_store_dwordx4 v[8:11], v1, s[4:7], s58 offen sc1
  s_add_u32 s58, s58, 4096
  buffer_store_dwordx4 v[8:11], v1, s[4:7], s58 offen sc1
  s_add_u32 s58, s58, 4096
  s_waitcnt vmcnt(0)
  s_barrier
  s_cmp_lg_u32 s12, 0
  s_cbranch_scc1 L_arr_5
  v_mov_b32_e64 v2, 1
  v_mov_b32 v3, 192
  s_mov_b64 exec, 1
  buffer_atomic_add v2, v3, s[8:11], 0 offen
  s_mov_b64 exec, -1
L_arr_5:
L_w_noclr:
  s_cmp_lg_u32 s12, 0
  s_cbranch_scc1 L_w_noprobe
  s_sub_u32 s74, s53, 1
  s_cmp_ge_u32 s74, 1
  s_cbranch_scc1 L_w_noprobe
  s_mov_b32 s66, -1
  s_mov_b32 s67, -1
  s_lshl_b32 s58, s74, 21
  s_add_u32 s58, s58, 2104832
  s_add_u32 s59, s58, 0x2000
  s_mov_b32 s60, 3
  v_mov_b32_e64 v2, -1
  s_mov_b64 exec, 1
L_w_probe:
  s_waitcnt vmcnt(0)
  s_memtime s[76:77]
  s_waitcnt lgkmcnt(0)
  buffer_store_dword v2, v0, s[4:7], s58 offen sc1
  s_waitcnt vmcnt(0)
  s_memtime s[78:79]
  s_waitcnt lgkmcnt(0)
  buffer_store_dword v2, v0, s[4:7], s59 offen sc1
  s_waitcnt vmcnt(0)
  s_memtime s[72:73]
  s_waitcnt lgkmcnt(0)
  s_sub_u32 s76, s78, s76
  s_min_u32 s66, s66, s76
  s_sub_u32 s78, s72, s78
  s_min_u32 s67, s67, s78
  s_sub_u32 s60, s60, 1
  s_cmp_lg_u32 s60, 0
  s_cbranch_scc1 L_w_probe
  s_cmp_lt_u32 s67, s66
  s_cselect_b32 s58, 0x2000, 0
  s_lshl_b32 s58, s58, s74
  s_add_u32 s58, s58, 1
  v_mov_b32_e64 v2, s58
  buffer_atomic_add v2, v0, s[8:11], 0 offen offset:100
  s_mov_b64 exec, -1
L_w_noprobe:
  s_barrier
  s_lshl_b32 s58, s53, 2
  s_add_u32 s58, s58, s12
  s_mul_i32 s58, s58, 10240
  v_lshlrev_b32 v4, 7, v0
  v_add_u32 v4, s58, v4
  v_add_u32 v5, 2048, v4
  buffer_load_dword v6, v4, s[32:35], 0 offen
  buffer_load_dword v6, v5, s[32:35], 0 offen
L_w_w:
  v_lshrrev_b32 v2, 4, v0
  v_lshlrev_b32 v2, 16, v2
  v_and_b32 v3, 8, v0
  v_and_b32 v4, 3, v0
  v_lshl_add_u32 v3, v4, 1, v3
  v_bfe_u32 v4, v0, 2, 1
  v_add_u32 v3, v3, v4
  v_and_b32 v4, 7, v0
  v_bfe_u32 v5, v0, 3, 1
  v_lshl_add_u32 v4, v4, 1, v5
  s_lshr_b32 s58, s52, 1
  s_cmp_eq_u32 s58, 1
  s_cselect_b64 vcc, -1, 0
  v_cndmask_b32 v3, v3, v4, vcc
  v_lshl_add_u32 v2, v3, 3, v2
  s_and_b32 s58, s52, 1
  s_lshl_b32 s58, s58, 3
  s_lshr_b32 s59, s13, 2
  s_add_u32 s61, s58, s59
  s_lshl_b32 s58, s61, 9
  s_lshl_b32 s59, s12, 7
  s_add_u32 s58, s58, s59
  v_add_u32_e64 v2, s58, v2
  s_mov_b32 s58, 0
  buffer_load_dwordx2 v[16:17], v2, s[28:31], s58 offen
  s_mov_b32 s58, 8192
  buffer_load_dwordx2 v[18:19], v2, s[28:31], s58 offen
  s_mov_b32 s58, 16384
  buffer_load_dwordx2 v[20:21], v2, s[28:31], s58 offen
  s_mov_b32 s58, 24576
  buffer_load_dwordx2 v[22:23], v2, s[28:31], s58 offen
  s_mov_b32 s58, 32768
  buffer_load_dwordx2 v[24:25], v2, s[28:31], s58 offen
  s_mov_b32 s58, 40960
  buffer_load_dwordx2 v[26:27], v2, s[28:31], s58 offen
  s_mov_b32 s58, 49152
  buffer_load_dwordx2 v[28:29], v2, s[28:31], s58 offen
  s_mov_b32 s58, 57344
  buffer_load_dwordx2 v[30:31], v2, s[28:31], s58 offen
  s_mov_b32 s58, 262144
  buffer_load_dwordx2 v[32:33], v2, s[28:31], s58 offen
  s_mov_b32 s58, 270336
  buffer_load_dwordx2 v[34:35], v2, s[28:31], s58 offen
  s_mov_b32 s58, 278528
  buffer_load_dwordx2 v[36:37], v2, s[28:31], s58 offen
  s_mov_b32 s58, 286720
  buffer_load_dwordx2 v[38:39], v2, s[28:31], s58 offen
  s_mov_b32 s58, 294912
  buffer_load_dwordx2 v[40:41], v2, s[28:31], s58 offen
  s_mov_b32 s58, 303104
  buffer_load_dwordx2 v[42:43], v2, s[28:31], s58 offen
  s_mov_b32 s58, 311296
  buffer_load_dwordx2 v[44:45], v2, s[28:31], s58 offen
  s_mov_b32 s58, 319488
  buffer_load_dwordx2 v[46:47], v2, s[28:31], s58 offen
  s_cmp_lt_u32 s52, 4
  s_cbranch_scc1 L_w_nfl
  s_lshl_b32 s58, s55, 2
  s_add_u32 s58, s58, s12
  s_lshl_b32 s58, s58, 2
  s_add_u32 s58, s58, 4096
  v_mov_b32 v4, 1
  s_waitcnt vmcnt(16)
  s_mov_b64 exec, 1
  buffer_store_dword v4, v0, s[4:7], s58 offen sc1
  s_mov_b64 exec, -1
  s_barrier
  s_cmp_lg_u32 s12, 0
  s_cbranch_scc1 L_arr_6
  v_mov_b32_e64 v4, 1
  v_mov_b32 v5, 96
  s_mov_b64 exec, 1
  buffer_atomic_add v4, v5, s[8:11], 0 offen
  s_mov_b64 exec, -1
L_arr_6:
L_w_nfl:
  s_mov_b32 s58, 524288
  buffer_load_dwordx2 v[48:49], v2, s[28:31], s58 offen
  s_mov_b32 s58, 532480
  buffer_load_dwordx2 v[50:51], v2, s[28:31], s58 offen
  s_mov_b32 s58, 540672
  buffer_load_dwordx2 v[52:53], v2, s[28:31], s58 offen
  s_mov_b32 s58, 548864
  buffer_load_dwordx2 v[54:55], v2, s[28:31], s58 offen
  s_mov_b32 s58, 557056
  buffer_load_dwordx2 v[56:57], v2, s[28:31], s58 offen
  s_mov_b32 s58, 565248
  buffer_load_dwordx2 v[58:59], v2, s[28:31], s58 offen
  s_mov_b32 s58, 573440
  buffer_load_dwordx2 v[60:61], v2, s[28:31], s58 offen
  s_mov_b32 s58, 581632
  buffer_load_dwordx2 v[62:63], v2, s[28:31], s58 offen
  s_mov_b32 s58, 786432
  buffer_load_dwordx2 v[64:65], v2, s[28:31], s58 offen
  s_mov_b32 s58, 794624
  buffer_load_dwordx2 v[66:67], v2, s[28:31], s58 offen
  s_mov_b32 s58, 802816
  buffer_load_dwordx2 v[68:69], v2, s[28:31], s58 offen
  s_mov_b32 s58, 811008
  buffer_load_dwordx2 v[70:71], v2, s[28:31], s58 offen
  s_mov_b32 s58, 819200
  buffer_load_dwordx2 v[72:73], v2, s[28:31], s58 offen
  s_mov_b32 s58, 827392
  buffer_load_dwordx2 v[74:75], v2, s[28:31], s58 offen
  s_mov_b32 s58, 835584
  buffer_load_dwordx2 v[76:77], v2, s[28:31], s58 offen
  s_mov_b32 s58, 843776
  buffer_load_dwordx2 v[78:79], v2, s[28:31], s58 offen
  s_mov_b32 s58, 1048576
  buffer_load_dwordx2 v[80:81], v2, s[28:31], s58 offen
  s_mov_b32 s58, 1056768
  buffer_load_dwordx2 v[82:83], v2, s[28:31], s58 offen
  s_mov_b32 s58, 1064960
  buffer_load_dwordx2 v[84:85], v2, s[28:31], s58 offen
  s_mov_b32 s58, 1073152
  buffer_load_dwordx2 v[86:87], v2, s[28:31], s58 offen
  s_mov_b32 s58, 1081344
  buffer_load_dwordx2 v[88:89], v2, s[28:31], s58 offen
  s_mov_b32 s58, 1089536
  buffer_load_dwordx2 v[90:91], v2, s[28:31], s58 offen
  s_mov_b32 s58, 1097728
  buffer_load_dwordx2 v[92:93], v2, s[28:31], s58 offen
  s_mov_b32 s58, 1105920
  buffer_load_dwordx2 v[94:95], v2, s[28:31], s58 offen
  s_mov_b32 s58, 1310720
  buffer_load_dwordx2 v[96:97], v2, s[28:31], s58 offen
  s_mov_b32 s58, 1318912
  buffer_load_dwordx2 v[98:99], v2, s[28:31], s58 offen
  s_mov_b32 s58, 1327104
  buffer_load_dwordx2 v[100:101], v2, s[28:31], s58 offen
  s_mov_b32 s58, 1335296
  buffer_load_dwordx2 v[102:103], v2, s[28:31], s58 offen
  s_mov_b32 s58, 1343488
  buffer_load_dwordx2 v[104:105], v2, s[28:31], s58 offen
  s_mov_b32 s58, 1351680
  buffer_load_dwordx2 v[106:107], v2, s[28:31], s58 offen
  s_mov_b32 s58, 1359872
  buffer_load_dwordx2 v[108:109], v2, s[28:31], s58 offen
  s_mov_b32 s58, 1368064
  buffer_load_dwordx2 v[110:111], v2, s[28:31], s58 offen
  s_mov_b32 s58, 1572864
  buffer_load_dwordx2 v[112:113], v2, s[28:31], s58 offen
  s_mov_b32 s58, 1581056
  buffer_load_dwordx2 v[114:115], v2, s[28:31], s58 offen
  s_mov_b32 s58, 1589248
  buffer_load_dwordx2 v[116:117], v2, s[28:31], s58 offen
  s_mov_b32 s58, 1597440
  buffer_load_dwordx2 v[118:119], v2, s[28:31], s58 offen
  s_mov_b32 s58, 1605632
  buffer_load_dwordx2 v[120:121], v2, s[28:31], s58 offen
  s_mov_b32 s58, 1613824
  buffer_load_dwordx2 v[122:123], v2, s[28:31], s58 offen
  s_mov_b32 s58, 1622016
  buffer_load_dwordx2 v[124:125], v2, s[28:31], s58 offen
  s_mov_b32 s58, 1630208
  buffer_load_dwordx2 v[126:127], v2, s[28:31], s58 offen
  s_mov_b32 s58, 1835008
  buffer_load_dwordx2 v[128:129], v2, s[28:31], s58 offen
  s_mov_b32 s58, 1843200
  buffer_load_dwordx2 v[130:131], v2, s[28:31], s58 offen
  s_mov_b32 s58, 1851392
  buffer_load_dwordx2 v[132:133], v2, s[28:31], s58 offen
  s_mov_b32 s58, 1859584
  buffer_load_dwordx2 v[134:135], v2, s[28:31], s58 offen
  s_mov_b32 s58, 1867776
  buffer_load_dwordx2 v[136:137], v2, s[28:31], s58 offen
  s_mov_b32 s58, 1875968
  buffer_load_dwordx2 v[138:139], v2, s[28:31], s58 offen
  s_mov_b32 s58, 1884160
  buffer_load_dwordx2 v[140:141], v2, s[28:31], s58 offen
  s_mov_b32 s58, 1892352
  buffer_load_dwordx2 v[142:143], v2, s[28:31], s58 offen
  s_waitcnt vmcnt(62)
  v_perm_b32 v8, v18, v16, s56
  v_accvgpr_write_b32 a0, v8
  v_perm_b32 v9, v18, v16, s57
  v_accvgpr_write_b32 a4, v9
  v_perm_b32 v10, v19, v17, s56
  v_accvgpr_write_b32 a8, v10
  v_perm_b32 v11, v19, v17, s57
  v_accvgpr_write_b32 a12, v11
  s_waitcnt vmcnt(60)
  v_perm_b32 v8, v22, v20, s56
  v_accvgpr_write_b32 a1, v8
  v_perm_b32 v9, v22, v20, s57
  v_accvgpr_write_b32 a5, v9
  v_perm_b32 v10, v23, v21, s56
  v_accvgpr_write_b32 a9, v10
  v_perm_b32 v11, v23, v21, s57
  v_accvgpr_write_b32 a13, v11
  s_waitcnt vmcnt(58)
  v_perm_b32 v8, v26, v24, s56
  v_accvgpr_write_b32 a2, v8
  v_perm_b32 v9, v26, v24, s57
  v_accvgpr_write_b32 a6, v9
  v_perm_b32 v10, v27, v25, s56
  v_accvgpr_write_b32 a10, v10
  v_perm_b32 v11, v27, v25, s57
  v_accvgpr_write_b32 a14, v11
  s_waitcnt vmcnt(56)
  v_perm_b32 v8, v30, v28, s56
  v_accvgpr_write_b32 a3, v8
  v_perm_b32 v9, v30, v28, s57
  v_accvgpr_write_b32 a7, v9
  v_perm_b32 v10, v31, v29, s56
  v_accvgpr_write_b32 a11, v10
  v_perm_b32 v11, v31, v29, s57
  v_accvgpr_write_b32 a15, v11
  s_mov_b32 s58, 2097152
  buffer_load_dwordx2 v[16:17], v2, s[28:31], s58 offen
  s_mov_b32 s58, 2105344
  buffer_load_dwordx2 v[18:19], v2, s[28:31], s58 offen
  s_mov_b32 s58, 2113536
  buffer_load_dwordx2 v[20:21], v2, s[28:31], s58 offen
  s_mov_b32 s58, 2121728
  buffer_load_dwordx2 v[22:23], v2, s[28:31], s58 offen
  s_mov_b32 s58, 2129920
  buffer_load_dwordx2 v[24:25], v2, s[28:31], s58 offen
  s_mov_b32 s58, 2138112
  buffer_load_dwordx2 v[26:27], v2, s[28:31], s58 offen
  s_mov_b32 s58, 2146304
  buffer_load_dwordx2 v[28:29], v2, s[28:31], s58 offen
  s_mov_b32 s58, 2154496
  buffer_load_dwordx2 v[30:31], v2, s[28:31], s58 offen
  s_waitcnt vmcnt(62)
  v_perm_b32 v8, v34, v32, s56
  v_accvgpr_write_b32 a16, v8
  v_perm_b32 v9, v34, v32, s57
  v_accvgpr_write_b32 a20, v9
  v_perm_b32 v10, v35, v33, s56
  v_accvgpr_write_b32 a24, v10
  v_perm_b32 v11, v35, v33, s57
  v_accvgpr_write_b32 a28, v11
  s_waitcnt vmcnt(60)
  v_perm_b32 v8, v38, v36, s56
  v_accvgpr_write_b32 a17, v8
  v_perm_b32 v9, v38, v36, s57
  v_accvgpr_write_b32 a21, v9
  v_perm_b32 v10, v39, v37, s56
  v_accvgpr_write_b32 a25, v10
  v_perm_b32 v11, v39, v37, s57
  v_accvgpr_write_b32 a29, v11
  s_waitcnt vmcnt(58)
  v_perm_b32 v8, v42, v40, s56
  v_accvgpr_write_b32 a18, v8
  v_perm_b32 v9, v42, v40, s57
  v_accvgpr_write_b32 a22, v9
  v_perm_b32 v10, v43, v41, s56
  v_accvgpr_write_b32 a26, v10
  v_perm_b32 v11, v43, v41, s57
  v_accvgpr_write_b32 a30, v11
  s_waitcnt vmcnt(56)
  v_perm_b32 v8, v46, v44, s56
  v_accvgpr_write_b32 a19, v8
  v_perm_b32 v9, v46, v44, s57
  v_accvgpr_write_b32 a23, v9
  v_perm_b32 v10, v47, v45, s56
  v_accvgpr_write_b32 a27, v10
  v_perm_b32 v11, v47, v45, s57
  v_accvgpr_write_b32 a31, v11
  s_mov_b32 s58, 2359296
  buffer_load_dwordx2 v[32:33], v2, s[28:31], s58 offen
  s_mov_b32 s58, 2367488
  buffer_load_dwordx2 v[34:35], v2, s[28:31], s58 offen
  s_mov_b32 s58, 2375680
  buffer_load_dwordx2 v[36:37], v2, s[28:31], s58 offen
  s_mov_b32 s58, 2383872
  buffer_load_dwordx2 v[38:39], v2, s[28:31], s58 offen
  s_mov_b32 s58, 2392064
  buffer_load_dwordx2 v[40:41], v2, s[28:31], s58 offen
  s_mov_b32 s58, 2400256
  buffer_load_dwordx2 v[42:43], v2, s[28:31], s58 offen
  s_mov_b32 s58, 2408448
  buffer_load_dwordx2 v[44:45], v2, s[28:31], s58 offen
  s_mov_b32 s58, 2416640
  buffer_load_dwordx2 v[46:47], v2, s[28:31], s58 offen
  s_waitcnt vmcnt(62)
  v_perm_b32 v8, v50, v48, s56
  v_accvgpr_write_b32 a32, v8
  v_perm_b32 v9, v50, v48, s57
  v_accvgpr_write_b32 a36, v9
  v_perm_b32 v10, v51, v49, s56
  v_accvgpr_write_b32 a40, v10
  v_perm_b32 v11, v51, v49, s57
  v_accvgpr_write_b32 a44, v11
  s_waitcnt vmcnt(60)
  v_perm_b32 v8, v54, v52, s56
  v_accvgpr_write_b32 a33, v8
  v_perm_b32 v9, v54, v52, s57
  v_accvgpr_write_b32 a37, v9
  v_perm_b32 v10, v55, v53, s56
  v_accvgpr_write_b32 a41, v10
  v_perm_b32 v11, v55, v53, s57
  v_accvgpr_write_b32 a45, v11
  s_waitcnt vmcnt(58)
  v_perm_b32 v8, v58, v56, s56
  v_accvgpr_write_b32 a34, v8
  v_perm_b32 v9, v58, v56, s57
  v_accvgpr_write_b32 a38, v9
  v_perm_b32 v10, v59, v57, s56
  v_accvgpr_write_b32 a42, v10
  v_perm_b32 v11, v59, v57, s57
  v_accvgpr_write_b32 a46, v11
  s_waitcnt vmcnt(56)
  v_perm_b32 v8, v62, v60, s56
  v_accvgpr_write_b32 a35, v8
  v_perm_b32 v9, v62, v60, s57
  v_accvgpr_write_b32 a39, v9
  v_perm_b32 v10, v63, v61, s56
  v_accvgpr_write_b32 a43, v10
  v_perm_b32 v11, v63, v61, s57
  v_accvgpr_write_b32 a47, v11
  s_mov_b32 s58, 2621440
  buffer_load_dwordx2 v[48:49], v2, s[28:31], s58 offen
  s_mov_b32 s58, 2629632
  buffer_load_dwordx2 v[50:51], v2, s[28:31], s58 offen
  s_mov_b32 s58, 2637824
  buffer_load_dwordx2 v[52:53], v2, s[28:31], s58 offen
  s_mov_b32 s58, 2646016
  buffer_load_dwordx2 v[54:55], v2, s[28:31], s58 offen
  s_mov_b32 s58, 2654208
  buffer_load_dwordx2 v[56:57], v2, s[28:31], s58 offen
  s_mov_b32 s58, 2662400
  buffer_load_dwordx2 v[58:59], v2, s[28:31], s58 offen
  s_mov_b32 s58, 2670592
  buffer_load_dwordx2 v[60:61], v2, s[28:31], s58 offen
  s_mov_b32 s58, 2678784
  buffer_load_dwordx2 v[62:63], v2, s[28:31], s58 offen
  s_waitcnt vmcnt(62)
  v_perm_b32 v8, v66, v64, s56
  v_accvgpr_write_b32 a48, v8
  v_perm_b32 v9, v66, v64, s57
  v_accvgpr_write_b32 a52, v9
  v_perm_b32 v10, v67, v65, s56
  v_accvgpr_write_b32 a56, v10
  v_perm_b32 v11, v67, v65, s57
  v_accvgpr_write_b32 a60, v11
  s_waitcnt vmcnt(60)
  v_perm_b32 v8, v70, v68, s56
  v_accvgpr_write_b32 a49, v8
  v_perm_b32 v9, v70, v68, s57
  v_accvgpr_write_b32 a53, v9
  v_perm_b32 v10, v71, v69, s56
  v_accvgpr_write_b32 a57, v10
  v_perm_b32 v11, v71, v69, s57
  v_accvgpr_write_b32 a61, v11
  s_waitcnt vmcnt(58)
  v_perm_b32 v8, v74, v72, s56
  v_accvgpr_write_b32 a50, v8
  v_perm_b32 v9, v74, v72, s57
  v_accvgpr_write_b32 a54, v9
  v_perm_b32 v10, v75, v73, s56
  v_accvgpr_write_b32 a58, v10
  v_perm_b32 v11, v75, v73, s57
  v_accvgpr_write_b32 a62, v11
  s_waitcnt vmcnt(56)
  v_perm_b32 v8, v78, v76, s56
  v_accvgpr_write_b32 a51, v8
  v_perm_b32 v9, v78, v76, s57
  v_accvgpr_write_b32 a55, v9
  v_perm_b32 v10, v79, v77, s56
  v_accvgpr_write_b32 a59, v10
  v_perm_b32 v11, v79, v77, s57
  v_accvgpr_write_b32 a63, v11
  s_mov_b32 s58, 2883584
  buffer_load_dwordx2 v[64:65], v2, s[28:31], s58 offen
  s_mov_b32 s58, 2891776
  buffer_load_dwordx2 v[66:67], v2, s[28:31], s58 offen
  s_mov_b32 s58, 2899968
  buffer_load_dwordx2 v[68:69], v2, s[28:31], s58 offen
  s_mov_b32 s58, 2908160
  buffer_load_dwordx2 v[70:71], v2, s[28:31], s58 offen
  s_mov_b32 s58, 2916352
  buffer_load_dwordx2 v[72:73], v2, s[28:31], s58 offen
  s_mov_b32 s58, 2924544
  buffer_load_dwordx2 v[74:75], v2, s[28:31], s58 offen
  s_mov_b32 s58, 2932736
  buffer_load_dwordx2 v[76:77], v2, s[28:31], s58 offen
  s_mov_b32 s58, 2940928
  buffer_load_dwordx2 v[78:79], v2, s[28:31], s58 offen
  s_waitcnt vmcnt(62)
  v_perm_b32 v8, v82, v80, s56
  v_accvgpr_write_b32 a64, v8
  v_perm_b32 v9, v82, v80, s57
  v_accvgpr_write_b32 a68, v9
  v_perm_b32 v10, v83, v81, s56
  v_accvgpr_write_b32 a72, v10
  v_perm_b32 v11, v83, v81, s57
  v_accvgpr_write_b32 a76, v11
  s_waitcnt vmcnt(60)
  v_perm_b32 v8, v86, v84, s56
  v_accvgpr_write_b32 a65, v8
  v_perm_b32 v9, v86, v84, s57
  v_accvgpr_write_b32 a69, v9
  v_perm_b32 v10, v87, v85, s56
  v_accvgpr_write_b32 a73, v10
  v_perm_b32 v11, v87, v85, s57
  v_accvgpr_write_b32 a77, v11
  s_waitcnt vmcnt(58)
  v_perm_b32 v8, v90, v88, s56
  v_accvgpr_write_b32 a66, v8
  v_perm_b32 v9, v90, v88, s57
  v_accvgpr_write_b32 a70, v9
  v_perm_b32 v10, v91, v89, s56
  v_accvgpr_write_b32 a74, v10
  v_perm_b32 v11, v91, v89, s57
  v_accvgpr_write_b32 a78, v11
  s_waitcnt vmcnt(56)
  v_perm_b32 v8, v94, v92, s56
  v_accvgpr_write_b32 a67, v8
  v_perm_b32 v9, v94, v92, s57
  v_accvgpr_write_b32 a71, v9
  v_perm_b32 v10, v95, v93, s56
  v_accvgpr_write_b32 a75, v10
  v_perm_b32 v11, v95, v93, s57
  v_accvgpr_write_b32 a79, v11
  s_mov_b32 s58, 3145728
  buffer_load_dwordx2 v[80:81], v2, s[28:31], s58 offen
  s_mov_b32 s58, 3153920
  buffer_load_dwordx2 v[82:83], v2, s[28:31], s58 offen
  s_mov_b32 s58, 3162112
  buffer_load_dwordx2 v[84:85], v2, s[28:31], s58 offen
  s_mov_b32 s58, 3170304
  buffer_load_dwordx2 v[86:87], v2, s[28:31], s58 offen
  s_mov_b32 s58, 3178496
  buffer_load_dwordx2 v[88:89], v2, s[28:31], s58 offen
  s_mov_b32 s58, 3186688
  buffer_load_dwordx2 v[90:91], v2, s[28:31], s58 offen
  s_mov_b32 s58, 3194880
  buffer_load_dwordx2 v[92:93], v2, s[28:31], s58 offen
  s_mov_b32 s58, 3203072
  buffer_load_dwordx2 v[94:95], v2, s[28:31], s58 offen
  s_waitcnt vmcnt(62)
  v_perm_b32 v8, v98, v96, s56
  v_accvgpr_write_b32 a80, v8
  v_perm_b32 v9, v98, v96, s57
  v_accvgpr_write_b32 a84, v9
  v_perm_b32 v10, v99, v97, s56
  v_accvgpr_write_b32 a88, v10
  v_perm_b32 v11, v99, v97, s57
  v_accvgpr_write_b32 a92, v11
  s_waitcnt vmcnt(60)
  v_perm_b32 v8, v102, v100, s56
  v_accvgpr_write_b32 a81, v8
  v_perm_b32 v9, v102, v100, s57
  v_accvgpr_write_b32 a85, v9
  v_perm_b32 v10, v103, v101, s56
  v_accvgpr_write_b32 a89, v10
  v_perm_b32 v11, v103, v101, s57
  v_accvgpr_write_b32 a93, v11
  s_waitcnt vmcnt(58)
  v_perm_b32 v8, v106, v104, s56
  v_accvgpr_write_b32 a82, v8
  v_perm_b32 v9, v106, v104, s57
  v_accvgpr_write_b32 a86, v9
  v_perm_b32 v10, v107, v105, s56
  v_accvgpr_write_b32 a90, v10
  v_perm_b32 v11, v107, v105, s57
  v_accvgpr_write_b32 a94, v11
  s_waitcnt vmcnt(56)
  v_perm_b32 v8, v110, v108, s56
  v_accvgpr_write_b32 a83, v8
  v_perm_b32 v9, v110, v108, s57
  v_accvgpr_write_b32 a87, v9
  v_perm_b32 v10, v111, v109, s56
  v_accvgpr_write_b32 a91, v10
  v_perm_b32 v11, v111, v109, s57
  v_accvgpr_write_b32 a95, v11
  s_mov_b32 s58, 3407872
  buffer_load_dwordx2 v[96:97], v2, s[28:31], s58 offen
  s_mov_b32 s58, 3416064
  buffer_load_dwordx2 v[98:99], v2, s[28:31], s58 offen
  s_mov_b32 s58, 3424256
  buffer_load_dwordx2 v[100:101], v2, s[28:31], s58 offen
  s_mov_b32 s58, 3432448
  buffer_load_dwordx2 v[102:103], v2, s[28:31], s58 offen
  s_mov_b32 s58, 3440640
  buffer_load_dwordx2 v[104:105], v2, s[28:31], s58 offen
  s_mov_b32 s58, 3448832
  buffer_load_dwordx2 v[106:107], v2, s[28:31], s58 offen
  s_mov_b32 s58, 3457024
  buffer_load_dwordx2 v[108:109], v2, s[28:31], s58 offen
  s_mov_b32 s58, 3465216
  buffer_load_dwordx2 v[110:111], v2, s[28:31], s58 offen
  s_waitcnt vmcnt(62)
  v_perm_b32 v8, v114, v112, s56
  v_accvgpr_write_b32 a96, v8
  v_perm_b32 v9, v114, v112, s57
  v_accvgpr_write_b32 a100, v9
  v_perm_b32 v10, v115, v113, s56
  v_accvgpr_write_b32 a104, v10
  v_perm_b32 v11, v115, v113, s57
  v_accvgpr_write_b32 a108, v11
  s_waitcnt vmcnt(60)
  v_perm_b32 v8, v118, v116, s56
  v_accvgpr_write_b32 a97, v8
  v_perm_b32 v9, v118, v116, s57
  v_accvgpr_write_b32 a101, v9
  v_perm_b32 v10, v119, v117, s56
  v_accvgpr_write_b32 a105, v10
  v_perm_b32 v11, v119, v117, s57
  v_accvgpr_write_b32 a109, v11
  s_waitcnt vmcnt(58)
  v_perm_b32 v8, v122, v120, s56
  v_accvgpr_write_b32 a98, v8
  v_perm_b32 v9, v122, v120, s57
  v_accvgpr_write_b32 a102, v9
  v_perm_b32 v10, v123, v121, s56
  v_accvgpr_write_b32 a106, v10
  v_perm_b32 v11, v123, v121, s57
  v_accvgpr_write_b32 a110, v11
  s_waitcnt vmcnt(56)
  v_perm_b32 v8, v126, v124, s56
  v_accvgpr_write_b32 a99, v8
  v_perm_b32 v9, v126, v124, s57
  v_accvgpr_write_b32 a103, v9
  v_perm_b32 v10, v127, v125, s56
  v_accvgpr_write_b32 a107, v10
  v_perm_b32 v11, v127, v125, s57
  v_accvgpr_write_b32 a111, v11
  s_mov_b32 s58, 3670016
  buffer_load_dwordx2 v[112:113], v2, s[28:31], s58 offen
  s_mov_b32 s58, 3678208
  buffer_load_dwordx2 v[114:115], v2, s[28:31], s58 offen
  s_mov_b32 s58, 3686400
  buffer_load_dwordx2 v[116:117], v2, s[28:31], s58 offen
  s_mov_b32 s58, 3694592
  buffer_load_dwordx2 v[118:119], v2, s[28:31], s58 offen
  s_mov_b32 s58, 3702784
  buffer_load_dwordx2 v[120:121], v2, s[28:31], s58 offen
  s_mov_b32 s58, 3710976
  buffer_load_dwordx2 v[122:123], v2, s[28:31], s58 offen
  s_mov_b32 s58, 3719168
  buffer_load_dwordx2 v[124:125], v2, s[28:31], s58 offen
  s_mov_b32 s58, 3727360
  buffer_load_dwordx2 v[126:127], v2, s[28:31], s58 offen
  s_waitcnt vmcnt(62)
  v_perm_b32 v8, v130, v128, s56
  v_accvgpr_write_b32 a112, v8
  v_perm_b32 v9, v130, v128, s57
  v_accvgpr_write_b32 a116, v9
  v_perm_b32 v10, v131, v129, s56
  v_accvgpr_write_b32 a120, v10
  v_perm_b32 v11, v131, v129, s57
  v_accvgpr_write_b32 a124, v11
  s_waitcnt vmcnt(60)
  v_perm_b32 v8, v134, v132, s56
  v_accvgpr_write_b32 a113, v8
  v_perm_b32 v9, v134, v132, s57
  v_accvgpr_write_b32 a117, v9
  v_perm_b32 v10, v135, v133, s56
  v_accvgpr_write_b32 a121, v10
  v_perm_b32 v11, v135, v133, s57
  v_accvgpr_write_b32 a125, v11
  s_waitcnt vmcnt(58)
  v_perm_b32 v8, v138, v136, s56
  v_accvgpr_write_b32 a114, v8
  v_perm_b32 v9, v138, v136, s57
  v_accvgpr_write_b32 a118, v9
  v_perm_b32 v10, v139, v137, s56
  v_accvgpr_write_b32 a122, v10
  v_perm_b32 v11, v139, v137, s57
  v_accvgpr_write_b32 a126, v11
  s_waitcnt vmcnt(56)
  v_perm_b32 v8, v142, v140, s56
  v_accvgpr_write_b32 a115, v8
  v_perm_b32 v9, v142, v140, s57
  v_accvgpr_write_b32 a119, v9
  v_perm_b32 v10, v143, v141, s56
  v_accvgpr_write_b32 a123, v10
  v_perm_b32 v11, v143, v141, s57
  v_accvgpr_write_b32 a127, v11
  s_mov_b32 s58, 3932160
  buffer_load_dwordx2 v[128:129], v2, s[28:31], s58 offen
  s_mov_b32 s58, 3940352
  buffer_load_dwordx2 v[130:131], v2, s[28:31], s58 offen
  s_mov_b32 s58, 3948544
  buffer_load_dwordx2 v[132:133], v2, s[28:31], s58 offen
  s_mov_b32 s58, 3956736
  buffer_load_dwordx2 v[134:135], v2, s[28:31], s58 offen
  s_mov_b32 s58, 3964928
  buffer_load_dwordx2 v[136:137], v2, s[28:31], s58 offen
  s_mov_b32 s58, 3973120
  buffer_load_dwordx2 v[138:139], v2, s[28:31], s58 offen
  s_mov_b32 s58, 3981312
  buffer_load_dwordx2 v[140:141], v2, s[28:31], s58 offen
  s_mov_b32 s58, 3989504
  buffer_load_dwordx2 v[142:143], v2, s[28:31], s58 offen
  s_waitcnt vmcnt(62)
  v_perm_b32 v8, v18, v16, s56
  v_accvgpr_write_b32 a128, v8
  v_perm_b32 v9, v18, v16, s57
  v_accvgpr_write_b32 a132, v9
  v_perm_b32 v10, v19, v17, s56
  v_accvgpr_write_b32 a136, v10
  v_perm_b32 v11, v19, v17, s57
  v_accvgpr_write_b32 a140, v11
  s_waitcnt vmcnt(60)
  v_perm_b32 v8, v22, v20, s56
  v_accvgpr_write_b32 a129, v8
  v_perm_b32 v9, v22, v20, s57
  v_accvgpr_write_b32 a133, v9
  v_perm_b32 v10, v23, v21, s56
  v_accvgpr_write_b32 a137, v10
  v_perm_b32 v11, v23, v21, s57
  v_accvgpr_write_b32 a141, v11
  s_waitcnt vmcnt(58)
  v_perm_b32 v8, v26, v24, s56
  v_accvgpr_write_b32 a130, v8
  v_perm_b32 v9, v26, v24, s57
  v_accvgpr_write_b32 a134, v9
  v_perm_b32 v10, v27, v25, s56
  v_accvgpr_write_b32 a138, v10
  v_perm_b32 v11, v27, v25, s57
  v_accvgpr_write_b32 a142, v11
  s_waitcnt vmcnt(56)
  v_perm_b32 v8, v30, v28, s56
  v_accvgpr_write_b32 a131, v8
  v_perm_b32 v9, v30, v28, s57
  v_accvgpr_write_b32 a135, v9
  v_perm_b32 v10, v31, v29, s56
  v_accvgpr_write_b32 a139, v10
  v_perm_b32 v11, v31, v29, s57
  v_accvgpr_write_b32 a143, v11
  s_mov_b32 s58, 4194304
  buffer_load_dwordx2 v[16:17], v2, s[28:31], s58 offen
  s_mov_b32 s58, 4202496
  buffer_load_dwordx2 v[18:19], v2, s[28:31], s58 offen
  s_mov_b32 s58, 4210688
  buffer_load_dwordx2 v[20:21], v2, s[28:31], s58 offen
  s_mov_b32 s58, 4218880
  buffer_load_dwordx2 v[22:23], v2, s[28:31], s58 offen
  s_mov_b32 s58, 4227072
  buffer_load_dwordx2 v[24:25], v2, s[28:31], s58 offen
  s_mov_b32 s58, 4235264
  buffer_load_dwordx2 v[26:27], v2, s[28:31], s58 offen
  s_mov_b32 s58, 4243456
  buffer_load_dwordx2 v[28:29], v2, s[28:31], s58 offen
  s_mov_b32 s58, 4251648
  buffer_load_dwordx2 v[30:31], v2, s[28:31], s58 offen
  s_waitcnt vmcnt(62)
  v_perm_b32 v8, v34, v32, s56
  v_accvgpr_write_b32 a144, v8
  v_perm_b32 v9, v34, v32, s57
  v_accvgpr_write_b32 a148, v9
  v_perm_b32 v10, v35, v33, s56
  v_accvgpr_write_b32 a152, v10
  v_perm_b32 v11, v35, v33, s57
  v_accvgpr_write_b32 a156, v11
  s_waitcnt vmcnt(60)
  v_perm_b32 v8, v38, v36, s56
  v_accvgpr_write_b32 a145, v8
  v_perm_b32 v9, v38, v36, s57
  v_accvgpr_write_b32 a149, v9
  v_perm_b32 v10, v39, v37, s56
  v_accvgpr_write_b32 a153, v10
  v_perm_b32 v11, v39, v37, s57
  v_accvgpr_write_b32 a157, v11
  s_waitcnt vmcnt(58)
  v_perm_b32 v8, v42, v40, s56
  v_accvgpr_write_b32 a146, v8
  v_perm_b32 v9, v42, v40, s57
  v_accvgpr_write_b32 a150, v9
  v_perm_b32 v10, v43, v41, s56
  v_accvgpr_write_b32 a154, v10
  v_perm_b32 v11, v43, v41, s57
  v_accvgpr_write_b32 a158, v11
  s_waitcnt vmcnt(56)
  v_perm_b32 v8, v46, v44, s56
  v_accvgpr_write_b32 a147, v8
  v_perm_b32 v9, v46, v44, s57
  v_accvgpr_write_b32 a151, v9
  v_perm_b32 v10, v47, v45, s56
  v_accvgpr_write_b32 a155, v10
  v_perm_b32 v11, v47, v45, s57
  v_accvgpr_write_b32 a159, v11
  s_mov_b32 s58, 4456448
  buffer_load_dwordx2 v[32:33], v2, s[28:31], s58 offen
  s_mov_b32 s58, 4464640
  buffer_load_dwordx2 v[34:35], v2, s[28:31], s58 offen
  s_mov_b32 s58, 4472832
  buffer_load_dwordx2 v[36:37], v2, s[28:31], s58 offen
  s_mov_b32 s58, 4481024
  buffer_load_dwordx2 v[38:39], v2, s[28:31], s58 offen
  s_mov_b32 s58, 4489216
  buffer_load_dwordx2 v[40:41], v2, s[28:31], s58 offen
  s_mov_b32 s58, 4497408
  buffer_load_dwordx2 v[42:43], v2, s[28:31], s58 offen
  s_mov_b32 s58, 4505600
  buffer_load_dwordx2 v[44:45], v2, s[28:31], s58 offen
  s_mov_b32 s58, 4513792
  buffer_load_dwordx2 v[46:47], v2, s[28:31], s58 offen
  s_waitcnt vmcnt(62)
  v_perm_b32 v8, v50, v48, s56
  v_accvgpr_write_b32 a160, v8
  v_perm_b32 v9, v50, v48, s57
  v_accvgpr_write_b32 a164, v9
  v_perm_b32 v10, v51, v49, s56
  v_accvgpr_write_b32 a168, v10
  v_perm_b32 v11, v51, v49, s57
  v_accvgpr_write_b32 a172, v11
  s_waitcnt vmcnt(60)
  v_perm_b32 v8, v54, v52, s56
  v_accvgpr_write_b32 a161, v8
  v_perm_b32 v9, v54, v52, s57
  v_accvgpr_write_b32 a165, v9
  v_perm_b32 v10, v55, v53, s56
  v_accvgpr_write_b32 a169, v10
  v_perm_b32 v11, v55, v53, s57
  v_accvgpr_write_b32 a173, v11
  s_waitcnt vmcnt(58)
  v_perm_b32 v8, v58, v56, s56
  v_accvgpr_write_b32 a162, v8
  v_perm_b32 v9, v58, v56, s57
  v_accvgpr_write_b32 a166, v9
  v_perm_b32 v10, v59, v57, s56
  v_accvgpr_write_b32 a170, v10
  v_perm_b32 v11, v59, v57, s57
  v_accvgpr_write_b32 a174, v11
  s_waitcnt vmcnt(56)
  v_perm_b32 v8, v62, v60, s56
  v_accvgpr_write_b32 a163, v8
  v_perm_b32 v9, v62, v60, s57
  v_accvgpr_write_b32 a167, v9
  v_perm_b32 v10, v63, v61, s56
  v_accvgpr_write_b32 a171, v10
  v_perm_b32 v11, v63, v61, s57
  v_accvgpr_write_b32 a175, v11
  s_mov_b32 s58, 4718592
  buffer_load_dwordx2 v[48:49], v2, s[28:31], s58 offen
  s_mov_b32 s58, 4726784
  buffer_load_dwordx2 v[50:51], v2, s[28:31], s58 offen
  s_mov_b32 s58, 4734976
  buffer_load_dwordx2 v[52:53], v2, s[28:31], s58 offen
  s_mov_b32 s58, 4743168
  buffer_load_dwordx2 v[54:55], v2, s[28:31], s58 offen
  s_mov_b32 s58, 4751360
  buffer_load_dwordx2 v[56:57], v2, s[28:31], s58 offen
  s_mov_b32 s58, 4759552
  buffer_load_dwordx2 v[58:59], v2, s[28:31], s58 offen
  s_mov_b32 s58, 4767744
  buffer_load_dwordx2 v[60:61], v2, s[28:31], s58 offen
  s_mov_b32 s58, 4775936
  buffer_load_dwordx2 v[62:63], v2, s[28:31], s58 offen
  s_waitcnt vmcnt(62)
  v_perm_b32 v8, v66, v64, s56
  v_accvgpr_write_b32 a176, v8
  v_perm_b32 v9, v66, v64, s57
  v_accvgpr_write_b32 a180, v9
  v_perm_b32 v10, v67, v65, s56
  v_accvgpr_write_b32 a184, v10
  v_perm_b32 v11, v67, v65, s57
  v_accvgpr_write_b32 a188, v11
  s_waitcnt vmcnt(60)
  v_perm_b32 v8, v70, v68, s56
  v_accvgpr_write_b32 a177, v8
  v_perm_b32 v9, v70, v68, s57
  v_accvgpr_write_b32 a181, v9
  v_perm_b32 v10, v71, v69, s56
  v_accvgpr_write_b32 a185, v10
  v_perm_b32 v11, v71, v69, s57
  v_accvgpr_write_b32 a189, v11
  s_waitcnt vmcnt(58)
  v_perm_b32 v8, v74, v72, s56
  v_accvgpr_write_b32 a178, v8
  v_perm_b32 v9, v74, v72, s57
  v_accvgpr_write_b32 a182, v9
  v_perm_b32 v10, v75, v73, s56
  v_accvgpr_write_b32 a186, v10
  v_perm_b32 v11, v75, v73, s57
  v_accvgpr_write_b32 a190, v11
  s_waitcnt vmcnt(56)
  v_perm_b32 v8, v78, v76, s56
  v_accvgpr_write_b32 a179, v8
  v_perm_b32 v9, v78, v76, s57
  v_accvgpr_write_b32 a183, v9
  v_perm_b32 v10, v79, v77, s56
  v_accvgpr_write_b32 a187, v10
  v_perm_b32 v11, v79, v77, s57
  v_accvgpr_write_b32 a191, v11
  s_mov_b32 s58, 4980736
  buffer_load_dwordx2 v[64:65], v2, s[28:31], s58 offen
  s_mov_b32 s58, 4988928
  buffer_load_dwordx2 v[66:67], v2, s[28:31], s58 offen
  s_mov_b32 s58, 4997120
  buffer_load_dwordx2 v[68:69], v2, s[28:31], s58 offen
  s_mov_b32 s58, 5005312
  buffer_load_dwordx2 v[70:71], v2, s[28:31], s58 offen
  s_mov_b32 s58, 5013504
  buffer_load_dwordx2 v[72:73], v2, s[28:31], s58 offen
  s_mov_b32 s58, 5021696
  buffer_load_dwordx2 v[74:75], v2, s[28:31], s58 offen
  s_mov_b32 s58, 5029888
  buffer_load_dwordx2 v[76:77], v2, s[28:31], s58 offen
  s_mov_b32 s58, 5038080
  buffer_load_dwordx2 v[78:79], v2, s[28:31], s58 offen
  s_waitcnt vmcnt(62)
  v_perm_b32 v8, v82, v80, s56
  v_accvgpr_write_b32 a192, v8
  v_perm_b32 v9, v82, v80, s57
  v_accvgpr_write_b32 a196, v9
  v_perm_b32 v10, v83, v81, s56
  v_accvgpr_write_b32 a200, v10
  v_perm_b32 v11, v83, v81, s57
  v_accvgpr_write_b32 a204, v11
  s_waitcnt vmcnt(60)
  v_perm_b32 v8, v86, v84, s56
  v_accvgpr_write_b32 a193, v8
  v_perm_b32 v9, v86, v84, s57
  v_accvgpr_write_b32 a197, v9
  v_perm_b32 v10, v87, v85, s56
  v_accvgpr_write_b32 a201, v10
  v_perm_b32 v11, v87, v85, s57
  v_accvgpr_write_b32 a205, v11
  s_waitcnt vmcnt(58)
  v_perm_b32 v8, v90, v88, s56
  v_accvgpr_write_b32 a194, v8
  v_perm_b32 v9, v90, v88, s57
  v_accvgpr_write_b32 a198, v9
  v_perm_b32 v10, v91, v89, s56
  v_accvgpr_write_b32 a202, v10
  v_perm_b32 v11, v91, v89, s57
  v_accvgpr_write_b32 a206, v11
  s_waitcnt vmcnt(56)
  v_perm_b32 v8, v94, v92, s56
  v_accvgpr_write_b32 a195, v8
  v_perm_b32 v9, v94, v92, s57
  v_accvgpr_write_b32 a199, v9
  v_perm_b32 v10, v95, v93, s56
  v_accvgpr_write_b32 a203, v10
  v_perm_b32 v11, v95, v93, s57
  v_accvgpr_write_b32 a207, v11
  s_waitcnt vmcnt(54)
  v_perm_b32 v8, v98, v96, s56
  v_accvgpr_write_b32 a208, v8
  v_perm_b32 v9, v98, v96, s57
  v_accvgpr_write_b32 a212, v9
  v_perm_b32 v10, v99, v97, s56
  v_accvgpr_write_b32 a216, v10
  v_perm_b32 v11, v99, v97, s57
  v_accvgpr_write_b32 a220, v11
  s_waitcnt vmcnt(52)
  v_perm_b32 v8, v102, v100, s56
  v_accvgpr_write_b32 a209, v8
  v_perm_b32 v9, v102, v100, s57
  v_accvgpr_write_b32 a213, v9
  v_perm_b32 v10, v103, v101, s56
  v_accvgpr_write_b32 a217, v10
  v_perm_b32 v11, v103, v101, s57
  v_accvgpr_write_b32 a221, v11
  s_waitcnt vmcnt(50)
  v_perm_b32 v8, v106, v104, s56
  v_accvgpr_write_b32 a210, v8
  v_perm_b32 v9, v106, v104, s57
  v_accvgpr_write_b32 a214, v9
  v_perm_b32 v10, v107, v105, s56
  v_accvgpr_write_b32 a218, v10
  v_perm_b32 v11, v107, v105, s57
  v_accvgpr_write_b32 a222, v11
  s_waitcnt vmcnt(48)
  v_perm_b32 v8, v110, v108, s56
  v_accvgpr_write_b32 a211, v8
  v_perm_b32 v9, v110, v108, s57
  v_accvgpr_write_b32 a215, v9
  v_perm_b32 v10, v111, v109, s56
  v_accvgpr_write_b32 a219, v10
  v_perm_b32 v11, v111, v109, s57
  v_accvgpr_write_b32 a223, v11
  s_waitcnt vmcnt(46)
  v_perm_b32 v8, v114, v112, s56
  v_accvgpr_write_b32 a224, v8
  v_perm_b32 v9, v114, v112, s57
  v_accvgpr_write_b32 a228, v9
  v_perm_b32 v10, v115, v113, s56
  v_accvgpr_write_b32 a232, v10
  v_perm_b32 v11, v115, v113, s57
  v_accvgpr_write_b32 a236, v11
  s_waitcnt vmcnt(44)
  v_perm_b32 v8, v118, v116, s56
  v_accvgpr_write_b32 a225, v8
  v_perm_b32 v9, v118, v116, s57
  v_accvgpr_write_b32 a229, v9
  v_perm_b32 v10, v119, v117, s56
  v_accvgpr_write_b32 a233, v10
  v_perm_b32 v11, v119, v117, s57
  v_accvgpr_write_b32 a237, v11
  s_waitcnt vmcnt(42)
  v_perm_b32 v8, v122, v120, s56
  v_accvgpr_write_b32 a226, v8
  v_perm_b32 v9, v122, v120, s57
  v_accvgpr_write_b32 a230, v9
  v_perm_b32 v10, v123, v121, s56
  v_accvgpr_write_b32 a234, v10
  v_perm_b32 v11, v123, v121, s57
  v_accvgpr_write_b32 a238, v11
  s_waitcnt vmcnt(40)
  v_perm_b32 v8, v126, v124, s56
  v_accvgpr_write_b32 a227, v8
  v_perm_b32 v9, v126, v124, s57
  v_accvgpr_write_b32 a231, v9
  v_perm_b32 v10, v127, v125, s56
  v_accvgpr_write_b32 a235, v10
  v_perm_b32 v11, v127, v125, s57
  v_accvgpr_write_b32 a239, v11
  s_waitcnt vmcnt(38)
  v_perm_b32 v8, v130, v128, s56
  v_accvgpr_write_b32 a240, v8
  v_perm_b32 v9, v130, v128, s57
  v_accvgpr_write_b32 a244, v9
  v_perm_b32 v10, v131, v129, s56
  v_accvgpr_write_b32 a248, v10
  v_perm_b32 v11, v131, v129, s57
  v_accvgpr_write_b32 a252, v11
  s_waitcnt vmcnt(36)
  v_perm_b32 v8, v134, v132, s56
  v_accvgpr_write_b32 a241, v8
  v_perm_b32 v9, v134, v132, s57
  v_accvgpr_write_b32 a245, v9
  v_perm_b32 v10, v135, v133, s56
  v_accvgpr_write_b32 a249, v10
  v_perm_b32 v11, v135, v133, s57
  v_accvgpr_write_b32 a253, v11
  s_waitcnt vmcnt(34)
  v_perm_b32 v8, v138, v136, s56
  v_accvgpr_write_b32 a242, v8
  v_perm_b32 v9, v138, v136, s57
  v_accvgpr_write_b32 a246, v9
  v_perm_b32 v10, v139, v137, s56
  v_accvgpr_write_b32 a250, v10
  v_perm_b32 v11, v139, v137, s57
  v_accvgpr_write_b32 a254, v11
  s_waitcnt vmcnt(32)
  v_perm_b32 v8, v142, v140, s56
  v_accvgpr_write_b32 a243, v8
  v_perm_b32 v9, v142, v140, s57
  v_accvgpr_write_b32 a247, v9
  v_perm_b32 v10, v143, v141, s56
  v_accvgpr_write_b32 a251, v10
  v_perm_b32 v11, v143, v141, s57
  v_accvgpr_write_b32 a255, v11
  s_waitcnt vmcnt(30)
  v_perm_b32 v192, v18, v16, s56
  v_perm_b32 v196, v18, v16, s57
  v_perm_b32 v200, v19, v17, s56
  v_perm_b32 v204, v19, v17, s57
  s_waitcnt vmcnt(28)
  v_perm_b32 v193, v22, v20, s56
  v_perm_b32 v197, v22, v20, s57
  v_perm_b32 v201, v23, v21, s56
  v_perm_b32 v205, v23, v21, s57
  s_waitcnt vmcnt(26)
  v_perm_b32 v194, v26, v24, s56
  v_perm_b32 v198, v26, v24, s57
  v_perm_b32 v202, v27, v25, s56
  v_perm_b32 v206, v27, v25, s57
  s_waitcnt vmcnt(24)
  v_perm_b32 v195, v30, v28, s56
  v_perm_b32 v199, v30, v28, s57
  v_perm_b32 v203, v31, v29, s56
  v_perm_b32 v207, v31, v29, s57
  s_waitcnt vmcnt(22)
  v_perm_b32 v208, v34, v32, s56
  v_perm_b32 v212, v34, v32, s57
  v_perm_b32 v216, v35, v33, s56
  v_perm_b32 v220, v35, v33, s57
  s_waitcnt vmcnt(20)
  v_perm_b32 v209, v38, v36, s56
  v_perm_b32 v213, v38, v36, s57
  v_perm_b32 v217, v39, v37, s56
  v_perm_b32 v221, v39, v37, s57
  s_waitcnt vmcnt(18)
  v_perm_b32 v210, v42, v40, s56
  v_perm_b32 v214, v42, v40, s57
  v_perm_b32 v218, v43, v41, s56
  v_perm_b32 v222, v43, v41, s57
  s_waitcnt vmcnt(16)
  v_perm_b32 v211, v46, v44, s56
  v_perm_b32 v215, v46, v44, s57
  v_perm_b32 v219, v47, v45, s56
  v_perm_b32 v223, v47, v45, s57
  s_waitcnt vmcnt(14)
  v_perm_b32 v224, v50, v48, s56
  v_perm_b32 v228, v50, v48, s57
  v_perm_b32 v232, v51, v49, s56
  v_perm_b32 v236, v51, v49, s57
  s_waitcnt vmcnt(12)
  v_perm_b32 v225, v54, v52, s56
  v_perm_b32 v229, v54, v52, s57
  v_perm_b32 v233, v55, v53, s56
  v_perm_b32 v237, v55, v53, s57
  s_waitcnt vmcnt(10)
  v_perm_b32 v226, v58, v56, s56
  v_perm_b32 v230, v58, v56, s57
  v_perm_b32 v234, v59, v57, s56
  v_perm_b32 v238, v59, v57, s57
  s_waitcnt vmcnt(8)
  v_perm_b32 v227, v62, v60, s56
  v_perm_b32 v231, v62, v60, s57
  v_perm_b32 v235, v63, v61, s56
  v_perm_b32 v239, v63, v61, s57
  s_waitcnt vmcnt(6)
  v_perm_b32 v240, v66, v64, s56
  v_perm_b32 v244, v66, v64, s57
  v_perm_b32 v248, v67, v65, s56
  v_perm_b32 v252, v67, v65, s57
  s_waitcnt vmcnt(4)
  v_perm_b32 v241, v70, v68, s56
  v_perm_b32 v245, v70, v68, s57
  v_perm_b32 v249, v71, v69, s56
  v_perm_b32 v253, v71, v69, s57
  s_waitcnt vmcnt(2)
  v_perm_b32 v242, v74, v72, s56
  v_perm_b32 v246, v74, v72, s57
  v_perm_b32 v250, v75, v73, s56
  v_perm_b32 v254, v75, v73, s57
  s_waitcnt vmcnt(0)
  v_perm_b32 v243, v78, v76, s56
  v_perm_b32 v247, v78, v76, s57
  v_perm_b32 v251, v79, v77, s56
  v_perm_b32 v255, v79, v77, s57
  v_mov_b32 v3, 192
L_cnt_7:
  s_mov_b64 exec, 1
  buffer_load_dword v2, v3, s[8:11], 0 offen sc1
  s_mov_b64 exec, -1
  s_sub_u32 s54, s54, 1
  s_cbranch_scc1 L_end
  s_waitcnt vmcnt(0)
  v_readfirstlane_b32 s58, v2
  s_nop 0
  s_and_b32 s58, s58, -1
  s_cmp_eq_u32 s58, 1
  s_cbranch_scc1 L_cnt_7x
  s_sleep 4
  s_branch L_cnt_7
  s_nop 0
  s_nop 0
L_cnt_7x:
  s_and_b32 s58, s13, 3
  s_mul_i32 s63, s58, 40960
  s_mul_i32 s64, s12, 10240
  s_add_u32 s63, s63, s64
  s_add_u32 s63, s63, 4194304
  s_lshl_b32 s67, s61, 8
  s_lshl_b32 s59, s58, 6
  s_add_u32 s67, s67, s59
  s_lshr_b32 s59, s52, 1
  s_lshl_b32 s59, s59, 4
  s_add_u32 s67, s67, s59
  s_add_u32 s67, s67, 0
  s_cmp_ge_u32 s52, 4
  s_cselect_b32 s60, 13, 14
  s_mov_b32 s65, 33554432
  s_cselect_b32 s65, 16777216, s65
  s_lshl_b32 s66, 128, s60
  s_lshl_b32 s58, s58, 5
  s_lshl_b32 s59, s61, 1
  s_add_u32 s58, s58, s59
  s_lshr_b32 s59, s12, 1
  s_add_u32 s58, s58, s59
  s_lshl_b32 s58, s58, s60
  s_add_u32 s65, s65, s58
  s_mov_b32 s62, 0
  v_mov_b32 v2, v1
  s_and_b32 s58, s13, 3
  s_lshl_b32 s69, s58, 17
  s_lshr_b32 s58, s61, 1
  s_lshl_b32 s58, s58, 14
  s_add_u32 s69, s69, s58
  s_and_b32 s58, s61, 1
  s_lshl_b32 s58, s58, 12
  s_add_u32 s69, s69, s58
  s_and_b32 s58, s52, 2
  s_lshl_b32 s58, s58, 12
  s_add_u32 s69, s69, s58
  s_lshl_b32 s58, s12, 10
  s_add_u32 s69, s69, s58
  s_add_u32 s69, s69, 8388608
  v_mov_b64 v[80:81], -1
  v_mov_b64 v[82:83], -1
  v_lshrrev_b32 v6, 2, v0
  v_lshlrev_b32 v6, 6, v6
  v_and_b32 v7, 3, v0
  v_lshl_add_u32 v6, v7, 2, v6
  s_and_b32 s58, s13, 3
  s_lshl_b32 s58, s58, 4
  s_add_u32 s58, s58, 4096
  s_mov_b64 exec, 15
L_q_hw_8:
  buffer_load_dword v7, v6, s[4:7], s58 offen sc1
  s_sub_u32 s54, s54, 1
  s_cbranch_scc1 L_end
  s_waitcnt vmcnt(0)
  v_cmp_ne_u32 vcc, 1, v7
  s_cbranch_vccz L_q_hw_8x
  s_sleep 2
  s_branch L_q_hw_8
  s_nop 0
L_q_hw_8x:
  s_mov_b64 exec, -1
  s_add_u32 m0, s64, 0
  s_add_u32 s68, s63, 0
  buffer_load_dwordx4 v1, s[4:7], s68 offen offset:0 sc1 lds
  buffer_load_dwordx4 v1, s[4:7], s68 offen offset:1024 sc1 lds
  buffer_load_dwordx4 v1, s[4:7], s68 offen offset:2048 sc1 lds
  buffer_load_dwordx4 v1, s[4:7], s68 offen offset:3072 sc1 lds
  s_add_u32 m0, s64, 4096
  s_add_u32 s68, s63, 4096
  buffer_load_dwordx4 v1, s[4:7], s68 offen offset:0 sc1 lds
  buffer_load_dwordx4 v1, s[4:7], s68 offen offset:1024 sc1 lds
  buffer_load_dwordx4 v1, s[4:7], s68 offen offset:2048 sc1 lds
  buffer_load_dwordx4 v1, s[4:7], s68 offen offset:3072 sc1 lds
  s_add_u32 m0, s64, 8192
  s_add_u32 s68, s63, 8192
  buffer_load_dwordx4 v1, s[4:7], s68 offen offset:0 sc1 lds
  buffer_load_dwordx4 v1, s[4:7], s68 offen offset:1024 sc1 lds
  s_add_u32 s63, s63, 163840
  s_xor_b32 s64, s64, 0x10000
  s_lshr_b32 s58, s52, 1
  s_cmp_eq_u32 s58, 1
  s_cbranch_scc1 L_q_v
  s_and_b32 s58, s12, 1
  s_lshl_b32 s58, s58, 9
  v_bfe_u32 v4, v0, 4, 1
  s_sub_u32 s60, s60, 1
  v_lshlrev_b32 v4, s60, v4
  v_lshrrev_b32 v5, 5, v0
  v_lshl_add_u32 v4, v5, 8, v4
  v_and_b32 v5, 15, v0
  v_lshl_add_u32 v4, v5, 4, v4
  v_add_u32 v3, s58, v4
  s_sub_u32 s60, s60, 1
  s_lshl_b32 s70, 1, s60
  s_waitcnt vmcnt(0)
  s_barrier
  ds_read_b128 v[8:11], v2 offset:0
  ds_read_b128 v[12:15], v2 offset:1024
  ds_read_b128 v[16:19], v2 offset:2048
  ds_read_b128 v[20:23], v2 offset:3072
  s_waitcnt lgkmcnt(3)
  v_mfma_f32_16x16x32_bf16 v[32:35], a[0:3], v[8:11], 0
  s_nop 0
  ds_read_b128 v[24:27], v2 offset:4096
  v_mfma_f32_16x16x32_bf16 v[36:39], a[4:7], v[8:11], 0
  v_mfma_f32_16x16x32_bf16 v[40:43], a[8:11], v[8:11], 0
  v_mfma_f32_16x16x32_bf16 v[44:47], a[12:15], v[8:11], 0
  s_waitcnt lgkmcnt(3)
  v_mfma_f32_16x16x32_bf16 v[48:51], a[0:3], v[12:15], 0
  ds_read_b128 v[28:31], v2 offset:5120
  v_mfma_f32_16x16x32_bf16 v[52:55], a[4:7], v[12:15], 0
  s_nop 0
  v_mfma_f32_16x16x32_bf16 v[56:59], a[8:11], v[12:15], 0
  v_mfma_f32_16x16x32_bf16 v[60:63], a[12:15], v[12:15], 0
  s_waitcnt lgkmcnt(3)
  v_mfma_f32_16x16x32_bf16 v[32:35], a[16:19], v[16:19], v[32:35]
  s_nop 0
  ds_read_b128 v[8:11], v2 offset:6144
  v_mfma_f32_16x16x32_bf16 v[36:39], a[20:23], v[16:19], v[36:39]
  v_mfma_f32_16x16x32_bf16 v[40:43], a[24:27], v[16:19], v[40:43]
  v_mfma_f32_16x16x32_bf16 v[44:47], a[28:31], v[16:19], v[44:47]
  s_waitcnt lgkmcnt(3)
  v_mfma_f32_16x16x32_bf16 v[48:51], a[16:19], v[20:23], v[48:51]
  ds_read_b128 v[12:15], v2 offset:7168
  v_mfma_f32_16x16x32_bf16 v[52:55], a[20:23], v[20:23], v[52:55]
  s_nop 0
  v_mfma_f32_16x16x32_bf16 v[56:59], a[24:27], v[20:23], v[56:59]
  v_mfma_f32_16x16x32_bf16 v[60:63], a[28:31], v[20:23], v[60:63]
  s_waitcnt lgkmcnt(3)
  v_mfma_f32_16x16x32_bf16 v[32:35], a[32:35], v[24:27], v[32:35]
  s_nop 0
  ds_read_b128 v[16:19], v2 offset:8192
  v_mfma_f32_16x16x32_bf16 v[36:39], a[36:39], v[24:27], v[36:39]
  v_mfma_f32_16x16x32_bf16 v[40:43], a[40:43], v[24:27], v[40:43]
  v_mfma_f32_16x16x32_bf16 v[44:47], a[44:47], v[24:27], v[44:47]
  s_waitcnt lgkmcnt(3)
  v_mfma_f32_16x16x32_bf16 v[48:51], a[32:35], v[28:31], v[48:51]
  ds_read_b128 v[20:23], v2 offset:9216
  v_mfma_f32_16x16x32_bf16 v[52:55], a[36:39], v[28:31], v[52:55]
  s_nop 0
  v_mfma_f32_16x16x32_bf16 v[56:59], a[40:43], v[28:31], v[56:59]
  v_mfma_f32_16x16x32_bf16 v[60:63], a[44:47], v[28:31], v[60:63]
  s_waitcnt lgkmcnt(3)
  v_mfma_f32_16x16x32_bf16 v[32:35], a[48:51], v[8:11], v[32:35]
  s_nop 0
  ds_read_b128 v[24:27], v2 offset:10240
  v_mfma_f32_16x16x32_bf16 v[36:39], a[52:55], v[8:11], v[36:39]
  v_mfma_f32_16x16x32_bf16 v[40:43], a[56:59], v[8:11], v[40:43]
  v_mfma_f32_16x16x32_bf16 v[44:47], a[60:63], v[8:11], v[44:47]
  s_waitcnt lgkmcnt(3)
  v_mfma_f32_16x16x32_bf16 v[48:51], a[48:51], v[12:15], v[48:51]
  ds_read_b128 v[28:31], v2 offset:11264
  v_mfma_f32_16x16x32_bf16 v[52:55], a[52:55], v[12:15], v[52:55]
  s_nop 0
  v_mfma_f32_16x16x32_bf16 v[56:59], a[56:59], v[12:15], v[56:59]
  v_mfma_f32_16x16x32_bf16 v[60:63], a[60:63], v[12:15], v[60:63]
  s_waitcnt lgkmcnt(3)
  v_mfma_f32_16x16x32_bf16 v[32:35], a[64:67], v[16:19], v[32:35]
  s_nop 0
  ds_read_b128 v[8:11], v2 offset:12288
  v_mfma_f32_16x16x32_bf16 v[36:39], a[68:71], v[16:19], v[36:39]
  v_mfma_f32_16x16x32_bf16 v[40:43], a[72:75], v[16:19], v[40:43]
  v_mfma_f32_16x16x32_bf16 v[44:47], a[76:79], v[16:19], v[44:47]
  s_waitcnt lgkmcnt(3)
  v_mfma_f32_16x16x32_bf16 v[48:51], a[64:67], v[20:23], v[48:51]
  ds_read_b128 v[12:15], v2 offset:13312
  v_mfma_f32_16x16x32_bf16 v[52:55], a[68:71], v[20:23], v[52:55]
  s_nop 0
  v_mfma_f32_16x16x32_bf16 v[56:59], a[72:75], v[20:23], v[56:59]
  v_mfma_f32_16x16x32_bf16 v[60:63], a[76:79], v[20:23], v[60:63]
  s_waitcnt lgkmcnt(3)
  v_mfma_f32_16x16x32_bf16 v[32:35], a[80:83], v[24:27], v[32:35]
  s_nop 0
  ds_read_b128 v[16:19], v2 offset:14336
  v_mfma_f32_16x16x32_bf16 v[36:39], a[84:87], v[24:27], v[36:39]
  v_mfma_f32_16x16x32_bf16 v[40:43], a[88:91], v[24:27], v[40:43]
  v_mfma_f32_16x16x32_bf16 v[44:47], a[92:95], v[24:27], v[44:47]
  s_waitcnt lgkmcnt(3)
  v_mfma_f32_16x16x32_bf16 v[48:51], a[80:83], v[28:31], v[48:51]
  ds_read_b128 v[20:23], v2 offset:15360
  v_mfma_f32_16x16x32_bf16 v[52:55], a[84:87], v[28:31], v[52:55]
  s_nop 0
  v_mfma_f32_16x16x32_bf16 v[56:59], a[88:91], v[28:31], v[56:59]
  v_mfma_f32_16x16x32_bf16 v[60:63], a[92:95], v[28:31], v[60:63]
  s_waitcnt lgkmcnt(3)
  v_mfma_f32_16x16x32_bf16 v[32:35], a[96:99], v[8:11], v[32:35]
  s_nop 0
  ds_read_b128 v[24:27], v2 offset:16384
  v_mfma_f32_16x16x32_bf16 v[36:39], a[100:103], v[8:11], v[36:39]
  v_mfma_f32_16x16x32_bf16 v[40:43], a[104:107], v[8:11], v[40:43]
  v_mfma_f32_16x16x32_bf16 v[44:47], a[108:111], v[8:11], v[44:47]
  s_waitcnt lgkmcnt(3)
  v_mfma_f32_16x16x32_bf16 v[48:51], a[96:99], v[12:15], v[48:51]
  ds_read_b128 v[28:31], v2 offset:17408
  v_mfma_f32_16x16x32_bf16 v[52:55], a[100:103], v[12:15], v[52:55]
  s_nop 0
  v_mfma_f32_16x16x32_bf16 v[56:59], a[104:107], v[12:15], v[56:59]
  v_mfma_f32_16x16x32_bf16 v[60:63], a[108:111], v[12:15], v[60:63]
  s_waitcnt lgkmcnt(3)
  v_mfma_f32_16x16x32_bf16 v[32:35], a[112:115], v[16:19], v[32:35]
  s_nop 0
  ds_read_b128 v[8:11], v2 offset:18432
  v_mfma_f32_16x16x32_bf16 v[36:39], a[116:119], v[16:19], v[36:39]
  v_mfma_f32_16x16x32_bf16 v[40:43], a[120:123], v[16:19], v[40:43]
  v_mfma_f32_16x16x32_bf16 v[44:47], a[124:127], v[16:19], v[44:47]
  s_waitcnt lgkmcnt(3)
  v_mfma_f32_16x16x32_bf16 v[48:51], a[112:115], v[20:23], v[48:51]
  ds_read_b128 v[12:15], v2 offset:19456
  v_mfma_f32_16x16x32_bf16 v[52:55], a[116:119], v[20:23], v[52:55]
  s_nop 0
  v_mfma_f32_16x16x32_bf16 v[56:59], a[120:123], v[20:23], v[56:59]
  v_mfma_f32_16x16x32_bf16 v[60:63], a[124:127], v[20:23], v[60:63]
  s_waitcnt lgkmcnt(3)
  v_mfma_f32_16x16x32_bf16 v[32:35], a[128:131], v[24:27], v[32:35]
  s_nop 0
  ds_read_b128 v[16:19], v2 offset:20480
  v_mfma_f32_16x16x32_bf16 v[36:39], a[132:135], v[24:27], v[36:39]
  v_mfma_f32_16x16x32_bf16 v[40:43], a[136:139], v[24:27], v[40:43]
  v_mfma_f32_16x16x32_bf16 v[44:47], a[140:143], v[24:27], v[44:47]
  s_waitcnt lgkmcnt(3)
  v_mfma_f32_16x16x32_bf16 v[48:51], a[128:131], v[28:31], v[48:51]
  ds_read_b128 v[20:23], v2 offset:21504
  v_mfma_f32_16x16x32_bf16 v[52:55], a[132:135], v[28:31], v[52:55]
  s_nop 0
  v_mfma_f32_16x16x32_bf16 v[56:59], a[136:139], v[28:31], v[56:59]
  v_mfma_f32_16x16x32_bf16 v[60:63], a[140:143], v[28:31], v[60:63]
  s_waitcnt lgkmcnt(3)
  v_mfma_f32_16x16x32_bf16 v[32:35], a[144:147], v[8:11], v[32:35]
  s_nop 0
  ds_read_b128 v[24:27], v2 offset:22528
  v_mfma_f32_16x16x32_bf16 v[36:39], a[148:151], v[8:11], v[36:39]
  v_mfma_f32_16x16x32_bf16 v[40:43], a[152:155], v[8:11], v[40:43]
  v_mfma_f32_16x16x32_bf16 v[44:47], a[156:159], v[8:11], v[44:47]
  s_waitcnt lgkmcnt(3)
  v_mfma_f32_16x16x32_bf16 v[48:51], a[144:147], v[12:15], v[48:51]
  ds_read_b128 v[28:31], v2 offset:23552
  v_mfma_f32_16x16x32_bf16 v[52:55], a[148:151], v[12:15], v[52:55]
  s_nop 0
  v_mfma_f32_16x16x32_bf16 v[56:59], a[152:155], v[12:15], v[56:59]
  v_mfma_f32_16x16x32_bf16 v[60:63], a[156:159], v[12:15], v[60:63]
  s_waitcnt lgkmcnt(3)
  v_mfma_f32_16x16x32_bf16 v[32:35], a[160:163], v[16:19], v[32:35]
  s_nop 0
  ds_read_b128 v[8:11], v2 offset:24576
  v_mfma_f32_16x16x32_bf16 v[36:39], a[164:167], v[16:19], v[36:39]
  v_mfma_f32_16x16x32_bf16 v[40:43], a[168:171], v[16:19], v[40:43]
  v_mfma_f32_16x16x32_bf16 v[44:47], a[172:175], v[16:19], v[44:47]
  s_waitcnt lgkmcnt(3)
  v_mfma_f32_16x16x32_bf16 v[48:51], a[160:163], v[20:23], v[48:51]
  ds_read_b128 v[12:15], v2 offset:25600
  v_mfma_f32_16x16x32_bf16 v[52:55], a[164:167], v[20:23], v[52:55]
  s_nop 0
  v_mfma_f32_16x16x32_bf16 v[56:59], a[168:171], v[20:23], v[56:59]
  v_mfma_f32_16x16x32_bf16 v[60:63], a[172:175], v[20:23], v[60:63]
  s_waitcnt lgkmcnt(3)
  v_mfma_f32_16x16x32_bf16 v[32:35], a[176:179], v[24:27], v[32:35]
  s_nop 0
  ds_read_b128 v[16:19], v2 offset:26624
  v_mfma_f32_16x16x32_bf16 v[36:39], a[180:183], v[24:27], v[36:39]
  v_mfma_f32_16x16x32_bf16 v[40:43], a[184:187], v[24:27], v[40:43]
  v_mfma_f32_16x16x32_bf16 v[44:47], a[188:191], v[24:27], v[44:47]
  s_waitcnt lgkmcnt(3)
  v_mfma_f32_16x16x32_bf16 v[48:51], a[176:179], v[28:31], v[48:51]
  ds_read_b128 v[20:23], v2 offset:27648
  v_mfma_f32_16x16x32_bf16 v[52:55], a[180:183], v[28:31], v[52:55]
  s_nop 0
  v_mfma_f32_16x16x32_bf16 v[56:59], a[184:187], v[28:31], v[56:59]
  v_mfma_f32_16x16x32_bf16 v[60:63], a[188:191], v[28:31], v[60:63]
  s_waitcnt lgkmcnt(3)
  v_mfma_f32_16x16x32_bf16 v[32:35], a[192:195], v[8:11], v[32:35]
  s_nop 0
  ds_read_b128 v[24:27], v2 offset:28672
  v_mfma_f32_16x16x32_bf16 v[36:39], a[196:199], v[8:11], v[36:39]
  v_mfma_f32_16x16x32_bf16 v[40:43], a[200:203], v[8:11], v[40:43]
  v_mfma_f32_16x16x32_bf16 v[44:47], a[204:207], v[8:11], v[44:47]
  s_waitcnt lgkmcnt(3)
  v_mfma_f32_16x16x32_bf16 v[48:51], a[192:195], v[12:15], v[48:51]
  ds_read_b128 v[28:31], v2 offset:29696
  v_mfma_f32_16x16x32_bf16 v[52:55], a[196:199], v[12:15], v[52:55]
  s_nop 0
  v_mfma_f32_16x16x32_bf16 v[56:59], a[200:203], v[12:15], v[56:59]
  v_mfma_f32_16x16x32_bf16 v[60:63], a[204:207], v[12:15], v[60:63]
  s_waitcnt lgkmcnt(3)
  v_mfma_f32_16x16x32_bf16 v[32:35], a[208:211], v[16:19], v[32:35]
  s_nop 0
  ds_read_b128 v[8:11], v2 offset:30720
  v_mfma_f32_16x16x32_bf16 v[36:39], a[212:215], v[16:19], v[36:39]
  v_mfma_f32_16x16x32_bf16 v[40:43], a[216:219], v[16:19], v[40:43]
  s_cmp_ge_u32 s52, 4
  s_cbranch_scc1 L_qn_9
  buffer_store_dwordx4 v[80:83], v1, s[4:7], s69 offen sc1
  s_add_u32 s69, s69, 0x80000
L_qn_9:
  v_mfma_f32_16x16x32_bf16 v[44:47], a[220:223], v[16:19], v[44:47]
  s_nop 0
  s_waitcnt lgkmcnt(3)
  v_mfma_f32_16x16x32_bf16 v[48:51], a[208:211], v[20:23], v[48:51]
  ds_read_b128 v[12:15], v2 offset:31744
  v_mfma_f32_16x16x32_bf16 v[52:55], a[212:215], v[20:23], v[52:55]
  v_mfma_f32_16x16x32_bf16 v[56:59], a[216:219], v[20:23], v[56:59]
  v_mfma_f32_16x16x32_bf16 v[60:63], a[220:223], v[20:23], v[60:63]
  s_waitcnt lgkmcnt(3)
  v_mfma_f32_16x16x32_bf16 v[32:35], a[224:227], v[24:27], v[32:35]
  s_nop 0
  ds_read_b128 v[16:19], v2 offset:32768
  v_mfma_f32_16x16x32_bf16 v[36:39], a[228:231], v[24:27], v[36:39]
  v_mfma_f32_16x16x32_bf16 v[40:43], a[232:235], v[24:27], v[40:43]
  v_mfma_f32_16x16x32_bf16 v[44:47], a[236:239], v[24:27], v[44:47]
  s_nop 0
  s_waitcnt lgkmcnt(3)
  v_mfma_f32_16x16x32_bf16 v[48:51], a[224:227], v[28:31], v[48:51]
  ds_read_b128 v[20:23], v2 offset:33792
  v_mfma_f32_16x16x32_bf16 v[52:55], a[228:231], v[28:31], v[52:55]
  v_mfma_f32_16x16x32_bf16 v[56:59], a[232:235], v[28:31], v[56:59]
  v_mfma_f32_16x16x32_bf16 v[60:63], a[236:239], v[28:31], v[60:63]
  s_waitcnt lgkmcnt(3)
  v_mfma_f32_16x16x32_bf16 v[32:35], a[240:243], v[8:11], v[32:35]
  s_nop 0
  ds_read_b128 v[24:27], v2 offset:34816
  v_mfma_f32_16x16x32_bf16 v[36:39], a[244:247], v[8:11], v[36:39]
  v_mfma_f32_16x16x32_bf16 v[40:43], a[248:251], v[8:11], v[40:43]
  v_mfma_f32_16x16x32_bf16 v[44:47], a[252:255], v[8:11], v[44:47]
  s_nop 0
  s_waitcnt lgkmcnt(3)
  v_mfma_f32_16x16x32_bf16 v[48:51], a[240:243], v[12:15], v[48:51]
  ds_read_b128 v[28:31], v2 offset:35840
  v_mfma_f32_16x16x32_bf16 v[52:55], a[244:247], v[12:15], v[52:55]
  v_mfma_f32_16x16x32_bf16 v[56:59], a[248:251], v[12:15], v[56:59]
  v_mfma_f32_16x16x32_bf16 v[60:63], a[252:255], v[12:15], v[60:63]
  s_waitcnt lgkmcnt(3)
  v_mfma_f32_16x16x32_bf16 v[32:35], v[192:195], v[16:19], v[32:35]
  s_nop 0
  ds_read_b128 v[8:11], v2 offset:36864
  v_mfma_f32_16x16x32_bf16 v[36:39], v[196:199], v[16:19], v[36:39]
  v_mfma_f32_16x16x32_bf16 v[40:43], v[200:203], v[16:19], v[40:43]
  v_mfma_f32_16x16x32_bf16 v[44:47], v[204:207], v[16:19], v[44:47]
  s_nop 0
  s_waitcnt lgkmcnt(3)
  v_mfma_f32_16x16x32_bf16 v[48:51], v[192:195], v[20:23], v[48:51]
  ds_read_b128 v[12:15], v2 offset:37888
  v_mfma_f32_16x16x32_bf16 v[52:55], v[196:199], v[20:23], v[52:55]
  v_mfma_f32_16x16x32_bf16 v[56:59], v[200:203], v[20:23], v[56:59]
  v_mfma_f32_16x16x32_bf16 v[60:63], v[204:207], v[20:23], v[60:63]
  s_waitcnt lgkmcnt(3)
  v_mfma_f32_16x16x32_bf16 v[32:35], v[208:211], v[24:27], v[32:35]
  s_nop 0
  ds_read_b128 v[16:19], v2 offset:38912
  v_mfma_f32_16x16x32_bf16 v[36:39], v[212:215], v[24:27], v[36:39]
  v_mfma_f32_16x16x32_bf16 v[40:43], v[216:219], v[24:27], v[40:43]
  v_mfma_f32_16x16x32_bf16 v[44:47], v[220:223], v[24:27], v[44:47]
  s_nop 0
  s_waitcnt lgkmcnt(3)
  v_mfma_f32_16x16x32_bf16 v[48:51], v[208:211], v[28:31], v[48:51]
  ds_read_b128 v[20:23], v2 offset:39936
  v_mfma_f32_16x16x32_bf16 v[52:55], v[212:215], v[28:31], v[52:55]
  v_mfma_f32_16x16x32_bf16 v[56:59], v[216:219], v[28:31], v[56:59]
  v_mfma_f32_16x16x32_bf16 v[60:63], v[220:223], v[28:31], v[60:63]
  s_waitcnt lgkmcnt(3)
  v_mfma_f32_16x16x32_bf16 v[32:35], v[224:227], v[8:11], v[32:35]
  v_mfma_f32_16x16x32_bf16 v[36:39], v[228:231], v[8:11], v[36:39]
  s_nop 0
  v_mfma_f32_16x16x32_bf16 v[40:43], v[232:235], v[8:11], v[40:43]
  v_mfma_f32_16x16x32_bf16 v[44:47], v[236:239], v[8:11], v[44:47]
  s_waitcnt lgkmcnt(2)
  v_mfma_f32_16x16x32_bf16 v[48:51], v[224:227], v[12:15], v[48:51]
  s_nop 0
  v_mfma_f32_16x16x32_bf16 v[52:55], v[228:231], v[12:15], v[52:55]
  v_mfma_f32_16x16x32_bf16 v[56:59], v[232:235], v[12:15], v[56:59]
  v_mfma_f32_16x16x32_bf16 v[60:63], v[236:239], v[12:15], v[60:63]
  s_nop 0
  s_waitcnt lgkmcnt(1)
  v_mfma_f32_16x16x32_bf16 v[32:35], v[240:243], v[16:19], v[32:35]
  v_mfma_f32_16x16x32_bf16 v[36:39], v[244:247], v[16:19], v[36:39]
  v_mfma_f32_16x16x32_bf16 v[40:43], v[248:251], v[16:19], v[40:43]
  v_mfma_f32_16x16x32_bf16 v[44:47], v[252:255], v[16:19], v[44:47]
  s_waitcnt lgkmcnt(0)
  v_mfma_f32_16x16x32_bf16 v[48:51], v[240:243], v[20:23], v[48:51]
  v_mfma_f32_16x16x32_bf16 v[52:55], v[244:247], v[20:23], v[52:55]
  s_nop 0
  v_mfma_f32_16x16x32_bf16 v[56:59], v[248:251], v[20:23], v[56:59]
  s_nop 0
  v_mfma_f32_16x16x32_bf16 v[60:63], v[252:255], v[20:23], v[60:63]
  s_add_u32 s62, s62, 1
  v_xor_b32 v2, 0x10000, v2
  v_cvt_pk_bf16_f32 v64, v32, v36
  v_cvt_pk_bf16_f32 v65, v33, v37
  v_cvt_pk_bf16_f32 v66, v34, v38
  v_cvt_pk_bf16_f32 v67, v35, v39
  v_cvt_pk_bf16_f32 v68, v48, v52
  v_cvt_pk_bf16_f32 v69, v49, v53
  v_cvt_pk_bf16_f32 v70, v50, v54
  v_cvt_pk_bf16_f32 v71, v51, v55
  v_cvt_pk_bf16_f32 v72, v40, v44
  v_cvt_pk_bf16_f32 v73, v41, v45
  v_cvt_pk_bf16_f32 v74, v42, v46
  v_cvt_pk_bf16_f32 v75, v43, v47
  v_cvt_pk_bf16_f32 v76, v56, v60
  v_cvt_pk_bf16_f32 v77, v57, v61
  v_cvt_pk_bf16_f32 v78, v58, v62
  v_cvt_pk_bf16_f32 v79, v59, v63
  buffer_store_dwordx4 v[64:67], v3, s[4:7], s65 offen offset:0 sc1
  buffer_store_dwordx4 v[68:71], v3, s[4:7], s65 offen offset:1024 sc1
  s_add_u32 s71, s65, s70
  buffer_store_dwordx4 v[72:75], v3, s[4:7], s71 offen offset:0 sc1
  buffer_store_dwordx4 v[76:79], v3, s[4:7], s71 offen offset:1024 sc1
  s_add_u32 s65, s65, s66
  s_sub_u32 s65, s65, s66
  s_waitcnt vmcnt(0)
  s_barrier
  s_cmp_lg_u32 s12, 0
  s_cbranch_scc1 L_qf_10
  v_mov_b32_e64 v4, s62
  s_mov_b64 exec, 1
  buffer_store_dword v4, v0, s[4:7], s67 offen sc1
  s_mov_b64 exec, -1
L_qf_10:
  v_lshrrev_b32 v6, 2, v0
  v_lshlrev_b32 v6, 6, v6
  v_and_b32 v7, 3, v0
  v_lshl_add_u32 v6, v7, 2, v6
  s_and_b32 s58, s13, 3
  s_lshl_b32 s58, s58, 4
  s_add_u32 s58, s58, 4096
  s_mov_b64 exec, -1
L_q_hw_11:
  buffer_load_dword v7, v6, s[4:7], s58 offen sc1
  s_sub_u32 s54, s54, 1
  s_cbranch_scc1 L_end
  s_waitcnt vmcnt(0)
  v_cmp_ne_u32 vcc, 1, v7
  s_cbranch_vccz L_q_hw_11x
  s_sleep 2
  s_branch L_q_hw_11
  s_nop 0
  s_nop 0
  s_nop 0
L_q_hw_11x:
  s_mov_b64 exec, -1
  s_add_u32 m0, s64, 0
  s_add_u32 s68, s63, 0
  buffer_load_dwordx4 v1, s[4:7], s68 offen offset:0 sc1 lds
  buffer_load_dwordx4 v1, s[4:7], s68 offen offset:1024 sc1 lds
  buffer_load_dwordx4 v1, s[4:7], s68 offen offset:2048 sc1 lds
  buffer_load_dwordx4 v1, s[4:7], s68 offen offset:3072 sc1 lds
  s_add_u32 m0, s64, 4096
  s_add_u32 s68, s63, 4096
  buffer_load_dwordx4 v1, s[4:7], s68 offen offset:0 sc1 lds
  buffer_load_dwordx4 v1, s[4:7], s68 offen offset:1024 sc1 lds
  buffer_load_dwordx4 v1, s[4:7], s68 offen offset:2048 sc1 lds
  buffer_load_dwordx4 v1, s[4:7], s68 offen offset:3072 sc1 lds
  s_add_u32 m0, s64, 8192
  s_add_u32 s68, s63, 8192
  buffer_load_dwordx4 v1, s[4:7], s68 offen offset:0 sc1 lds
  buffer_load_dwordx4 v1, s[4:7], s68 offen offset:1024 sc1 lds
  s_add_u32 s63, s63, 163840
  s_xor_b32 s64, s64, 0x10000
  s_lshl_b32 s58, s53, 2
  s_add_u32 s58, s58, s12
  s_mul_i32 s58, s58, 23
  v_add_u32 v6, s58, v0
  v_lshlrev_b32_e64 v6, 7, v6
  s_mov_b64 exec, 0x7fffff
  buffer_load_dword v7, v6, s[36:39], 0 offen
  buffer_load_dword v7, v6, s[40:43], 0 offen
  buffer_load_dword v7, v6, s[44:47], 0 offen
  s_mov_b64 exec, -1
  s_lshl_b32 s58, s53, 2
  s_add_u32 s58, s58, s12
  s_mul_i32 s58, s58, 7680
  v_lshlrev_b32 v6, 7, v0
  v_add_u32_e64 v6, s58, v6
  s_mov_b32 exec_hi, 0xff
  buffer_load_dword v7, v6, s[24:27], 0 offen offset:2560
  s_mov_b64 exec, -1
L_q_loopk:
  s_nop 0
  s_waitcnt vmcnt(0)
  s_barrier
  ds_read_b128 v[8:11], v2 offset:0
  ds_read_b128 v[12:15], v2 offset:1024
  ds_read_b128 v[16:19], v2 offset:2048
  ds_read_b128 v[20:23], v2 offset:3072
  s_waitcnt lgkmcnt(3)
  v_mfma_f32_16x16x32_bf16 v[32:35], a[0:3], v[8:11], 0
  s_nop 0
  ds_read_b128 v[24:27], v2 offset:4096
  v_mfma_f32_16x16x32_bf16 v[36:39], a[4:7], v[8:11], 0
  v_mfma_f32_16x16x32_bf16 v[40:43], a[8:11], v[8:11], 0
  buffer_store_dwordx4 v[64:67], v3, s[4:7], s65 offen offset:0 sc1
  v_mfma_f32_16x16x32_bf16 v[44:47], a[12:15], v[8:11], 0
  s_waitcnt lgkmcnt(3)
  v_mfma_f32_16x16x32_bf16 v[48:51], a[0:3], v[12:15], 0
  ds_read_b128 v[28:31], v2 offset:5120
  v_mfma_f32_16x16x32_bf16 v[52:55], a[4:7], v[12:15], 0
  s_nop 0
  v_mfma_f32_16x16x32_bf16 v[56:59], a[8:11], v[12:15], 0
  buffer_store_dwordx4 v[68:71], v3, s[4:7], s65 offen offset:1024 sc1
  v_mfma_f32_16x16x32_bf16 v[60:63], a[12:15], v[12:15], 0
  s_nop 0
  s_waitcnt lgkmcnt(3)
  v_mfma_f32_16x16x32_bf16 v[32:35], a[16:19], v[16:19], v[32:35]
  ds_read_b128 v[8:11], v2 offset:6144
  v_mfma_f32_16x16x32_bf16 v[36:39], a[20:23], v[16:19], v[36:39]
  v_mfma_f32_16x16x32_bf16 v[40:43], a[24:27], v[16:19], v[40:43]
  s_add_u32 s71, s65, s70
  buffer_store_dwordx4 v[72:75], v3, s[4:7], s71 offen offset:0 sc1
  v_mfma_f32_16x16x32_bf16 v[44:47], a[28:31], v[16:19], v[44:47]
  s_waitcnt lgkmcnt(3)
  v_mfma_f32_16x16x32_bf16 v[48:51], a[16:19], v[20:23], v[48:51]
  ds_read_b128 v[12:15], v2 offset:7168
  v_mfma_f32_16x16x32_bf16 v[52:55], a[20:23], v[20:23], v[52:55]
  v_mfma_f32_16x16x32_bf16 v[56:59], a[24:27], v[20:23], v[56:59]
  buffer_store_dwordx4 v[76:79], v3, s[4:7], s71 offen offset:1024 sc1
  s_add_u32 s65, s65, s66
  v_mfma_f32_16x16x32_bf16 v[60:63], a[28:31], v[20:23], v[60:63]
  s_waitcnt lgkmcnt(3)
  v_mfma_f32_16x16x32_bf16 v[32:35], a[32:35], v[24:27], v[32:35]
  ds_read_b128 v[16:19], v2 offset:8192
  v_mfma_f32_16x16x32_bf16 v[36:39], a[36:39], v[24:27], v[36:39]
  v_mfma_f32_16x16x32_bf16 v[40:43], a[40:43], v[24:27], v[40:43]
  s_add_u32 m0, s64, 0
  s_add_u32 s68, s63, 0
  buffer_load_dwordx4 v1, s[4:7], s68 offen offset:0 sc1 lds
  v_mfma_f32_16x16x32_bf16 v[44:47], a[44:47], v[24:27], v[44:47]
  s_waitcnt lgkmcnt(3)
  v_mfma_f32_16x16x32_bf16 v[48:51], a[32:35], v[28:31], v[48:51]
  s_nop 0
  ds_read_b128 v[20:23], v2 offset:9216
  v_mfma_f32_16x16x32_bf16 v[52:55], a[36:39], v[28:31], v[52:55]
  v_mfma_f32_16x16x32_bf16 v[56:59], a[40:43], v[28:31], v[56:59]
  v_mfma_f32_16x16x32_bf16 v[60:63], a[44:47], v[28:31], v[60:63]
  s_nop 0
  s_waitcnt lgkmcnt(3)
  v_mfma_f32_16x16x32_bf16 v[32:35], a[48:51], v[8:11], v[32:35]
  ds_read_b128 v[24:27], v2 offset:10240
  v_mfma_f32_16x16x32_bf16 v[36:39], a[52:55], v[8:11], v[36:39]
  v_mfma_f32_16x16x32_bf16 v[40:43], a[56:59], v[8:11], v[40:43]
  buffer_load_dwordx4 v1, s[4:7], s68 offen offset:1024 sc1 lds
  v_mfma_f32_16x16x32_bf16 v[44:47], a[60:63], v[8:11], v[44:47]
  s_waitcnt lgkmcnt(3)
  v_mfma_f32_16x16x32_bf16 v[48:51], a[48:51], v[12:15], v[48:51]
  s_nop 0
  ds_read_b128 v[28:31], v2 offset:11264
  v_mfma_f32_16x16x32_bf16 v[52:55], a[52:55], v[12:15], v[52:55]
  v_mfma_f32_16x16x32_bf16 v[56:59], a[56:59], v[12:15], v[56:59]
  v_mfma_f32_16x16x32_bf16 v[60:63], a[60:63], v[12:15], v[60:63]
  s_waitcnt lgkmcnt(3)
  v_mfma_f32_16x16x32_bf16 v[32:35], a[64:67], v[16:19], v[32:35]
  ds_read_b128 v[8:11], v2 offset:12288
  v_mfma_f32_16x16x32_bf16 v[36:39], a[68:71], v[16:19], v[36:39]
  s_nop 0
  v_mfma_f32_16x16x32_bf16 v[40:43], a[72:75], v[16:19], v[40:43]
  buffer_load_dwordx4 v1, s[4:7], s68 offen offset:2048 sc1 lds
  v_mfma_f32_16x16x32_bf16 v[44:47], a[76:79], v[16:19], v[44:47]
  s_nop 0
  s_waitcnt lgkmcnt(3)
  v_mfma_f32_16x16x32_bf16 v[48:51], a[64:67], v[20:23], v[48:51]
  ds_read_b128 v[12:15], v2 offset:13312
  v_mfma_f32_16x16x32_bf16 v[52:55], a[68:71], v[20:23], v[52:55]
  v_mfma_f32_16x16x32_bf16 v[56:59], a[72:75], v[20:23], v[56:59]
  v_mfma_f32_16x16x32_bf16 v[60:63], a[76:79], v[20:23], v[60:63]
  s_waitcnt lgkmcnt(3)
  v_mfma_f32_16x16x32_bf16 v[32:35], a[80:83], v[24:27], v[32:35]
  s_nop 0
  ds_read_b128 v[16:19], v2 offset:14336
  v_mfma_f32_16x16x32_bf16 v[36:39], a[84:87], v[24:27], v[36:39]
  v_mfma_f32_16x16x32_bf16 v[40:43], a[88:91], v[24:27], v[40:43]
  buffer_load_dwordx4 v1, s[4:7], s68 offen offset:3072 sc1 lds
  v_mfma_f32_16x16x32_bf16 v[44:47], a[92:95], v[24:27], v[44:47]
  s_waitcnt lgkmcnt(3)
  v_mfma_f32_16x16x32_bf16 v[48:51], a[80:83], v[28:31], v[48:51]
  ds_read_b128 v[20:23], v2 offset:15360
  v_mfma_f32_16x16x32_bf16 v[52:55], a[84:87], v[28:31], v[52:55]
  s_nop 0
  v_mfma_f32_16x16x32_bf16 v[56:59], a[88:91], v[28:31], v[56:59]
  v_mfma_f32_16x16x32_bf16 v[60:63], a[92:95], v[28:31], v[60:63]
  s_waitcnt lgkmcnt(3)
  v_mfma_f32_16x16x32_bf16 v[32:35], a[96:99], v[8:11], v[32:35]
  s_nop 0
  ds_read_b128 v[24:27], v2 offset:16384
  v_mfma_f32_16x16x32_bf16 v[36:39], a[100:103], v[8:11], v[36:39]
  v_mfma_f32_16x16x32_bf16 v[40:43], a[104:107], v[8:11], v[40:43]
  s_add_u32 m0, s64, 4096
  s_add_u32 s68, s63, 4096
  buffer_load_dwordx4 v1, s[4:7], s68 offen offset:0 sc1 lds
  v_mfma_f32_16x16x32_bf16 v[44:47], a[108:111], v[8:11], v[44:47]
  s_nop 0
  s_waitcnt lgkmcnt(3)
  v_mfma_f32_16x16x32_bf16 v[48:51], a[96:99], v[12:15], v[48:51]
  ds_read_b128 v[28:31], v2 offset:17408
  v_mfma_f32_16x16x32_bf16 v[52:55], a[100:103], v[12:15], v[52:55]
  v_mfma_f32_16x16x32_bf16 v[56:59], a[104:107], v[12:15], v[56:59]
  v_mfma_f32_16x16x32_bf16 v[60:63], a[108:111], v[12:15], v[60:63]
  s_waitcnt lgkmcnt(3)
  v_mfma_f32_16x16x32_bf16 v[32:35], a[112:115], v[16:19], v[32:35]
  s_nop 0
  ds_read_b128 v[8:11], v2 offset:18432
  v_mfma_f32_16x16x32_bf16 v[36:39], a[116:119], v[16:19], v[36:39]
  v_mfma_f32_16x16x32_bf16 v[40:43], a[120:123], v[16:19], v[40:43]
  buffer_load_dwordx4 v1, s[4:7], s68 offen offset:1024 sc1 lds
  v_mfma_f32_16x16x32_bf16 v[44:47], a[124:127], v[16:19], v[44:47]
  s_waitcnt lgkmcnt(3)
  v_mfma_f32_16x16x32_bf16 v[48:51], a[112:115], v[20:23], v[48:51]
  ds_read_b128 v[12:15], v2 offset:19456
  v_mfma_f32_16x16x32_bf16 v[52:55], a[116:119], v[20:23], v[52:55]
  s_nop 0
  v_mfma_f32_16x16x32_bf16 v[56:59], a[120:123], v[20:23], v[56:59]
  v_mfma_f32_16x16x32_bf16 v[60:63], a[124:127], v[20:23], v[60:63]
  s_waitcnt lgkmcnt(3)
  v_mfma_f32_16x16x32_bf16 v[32:35], a[128:131], v[24:27], v[32:35]
  s_nop 0
  ds_read_b128 v[16:19], v2 offset:20480
  v_mfma_f32_16x16x32_bf16 v[36:39], a[132:135], v[24:27], v[36:39]
  v_mfma_f32_16x16x32_bf16 v[40:43], a[136:139], v[24:27], v[40:43]
  buffer_load_dwordx4 v1, s[4:7], s68 offen offset:2048 sc1 lds
  v_mfma_f32_16x16x32_bf16 v[44:47], a[140:143], v[24:27], v[44:47]
  s_waitcnt lgkmcnt(3)
  v_mfma_f32_16x16x32_bf16 v[48:51], a[128:131], v[28:31], v[48:51]
  s_nop 0
  ds_read_b128 v[20:23], v2 offset:21504
  v_mfma_f32_16x16x32_bf16 v[52:55], a[132:135], v[28:31], v[52:55]
  v_mfma_f32_16x16x32_bf16 v[56:59], a[136:139], v[28:31], v[56:59]
  v_mfma_f32_16x16x32_bf16 v[60:63], a[140:143], v[28:31], v[60:63]
  s_nop 0
  s_waitcnt lgkmcnt(3)
  v_mfma_f32_16x16x32_bf16 v[32:35], a[144:147], v[8:11], v[32:35]
  ds_read_b128 v[24:27], v2 offset:22528
  v_mfma_f32_16x16x32_bf16 v[36:39], a[148:151], v[8:11], v[36:39]
  v_mfma_f32_16x16x32_bf16 v[40:43], a[152:155], v[8:11], v[40:43]
  buffer_load_dwordx4 v1, s[4:7], s68 offen offset:3072 sc1 lds
  v_mfma_f32_16x16x32_bf16 v[44:47], a[156:159], v[8:11], v[44:47]
  s_waitcnt lgkmcnt(3)
  v_mfma_f32_16x16x32_bf16 v[48:51], a[144:147], v[12:15], v[48:51]
  s_nop 0
  ds_read_b128 v[28:31], v2 offset:23552
  v_mfma_f32_16x16x32_bf16 v[52:55], a[148:151], v[12:15], v[52:55]
  v_mfma_f32_16x16x32_bf16 v[56:59], a[152:155], v[12:15], v[56:59]
  v_mfma_f32_16x16x32_bf16 v[60:63], a[156:159], v[12:15], v[60:63]
  s_waitcnt lgkmcnt(3)
  v_mfma_f32_16x16x32_bf16 v[32:35], a[160:163], v[16:19], v[32:35]
  ds_read_b128 v[8:11], v2 offset:24576
  v_mfma_f32_16x16x32_bf16 v[36:39], a[164:167], v[16:19], v[36:39]
  s_nop 0
  v_mfma_f32_16x16x32_bf16 v[40:43], a[168:171], v[16:19], v[40:43]
  s_add_u32 m0, s64, 8192
  s_add_u32 s68, s63, 8192
  buffer_load_dwordx4 v1, s[4:7], s68 offen offset:0 sc1 lds
  v_mfma_f32_16x16x32_bf16 v[44:47], a[172:175], v[16:19], v[44:47]
  s_waitcnt lgkmcnt(3)
  v_mfma_f32_16x16x32_bf16 v[48:51], a[160:163], v[20:23], v[48:51]
  s_nop 0
  ds_read_b128 v[12:15], v2 offset:25600
  v_mfma_f32_16x16x32_bf16 v[52:55], a[164:167], v[20:23], v[52:55]
  v_mfma_f32_16x16x32_bf16 v[56:59], a[168:171], v[20:23], v[56:59]
  v_mfma_f32_16x16x32_bf16 v[60:63], a[172:175], v[20:23], v[60:63]
  s_nop 0
  s_waitcnt lgkmcnt(3)
  v_mfma_f32_16x16x32_bf16 v[32:35], a[176:179], v[24:27], v[32:35]
  ds_read_b128 v[16:19], v2 offset:26624
  v_mfma_f32_16x16x32_bf16 v[36:39], a[180:183], v[24:27], v[36:39]
  v_mfma_f32_16x16x32_bf16 v[40:43], a[184:187], v[24:27], v[40:43]
  buffer_load_dwordx4 v1, s[4:7], s68 offen offset:1024 sc1 lds
  s_add_u32 s63, s63, 163840
  s_xor_b32 s64, s64, 0x10000
  v_mfma_f32_16x16x32_bf16 v[44:47], a[188:191], v[24:27], v[44:47]
  s_waitcnt lgkmcnt(3)
  v_mfma_f32_16x16x32_bf16 v[48:51], a[176:179], v[28:31], v[48:51]
  ds_read_b128 v[20:23], v2 offset:27648
  v_mfma_f32_16x16x32_bf16 v[52:55], a[180:183], v[28:31], v[52:55]
  s_nop 0
  v_mfma_f32_16x16x32_bf16 v[56:59], a[184:187], v[28:31], v[56:59]
  v_mfma_f32_16x16x32_bf16 v[60:63], a[188:191], v[28:31], v[60:63]
  s_waitcnt vmcnt(10)
  s_barrier
  s_cmp_lg_u32 s12, 0
  s_cbranch_scc1 L_qf_12
  v_mov_b32 v4, s62
  s_mov_b64 exec, 1
  buffer_store_dword v4, v0, s[4:7], s67 offen sc1
  s_mov_b64 exec, -1
L_qf_12:
  s_waitcnt lgkmcnt(3)
  v_mfma_f32_16x16x32_bf16 v[32:35], a[192:195], v[8:11], v[32:35]
  ds_read_b128 v[24:27], v2 offset:28672
  v_mfma_f32_16x16x32_bf16 v[36:39], a[196:199], v[8:11], v[36:39]
  v_mfma_f32_16x16x32_bf16 v[40:43], a[200:203], v[8:11], v[40:43]
  v_mfma_f32_16x16x32_bf16 v[44:47], a[204:207], v[8:11], v[44:47]
  s_waitcnt lgkmcnt(3)
  v_mfma_f32_16x16x32_bf16 v[48:51], a[192:195], v[12:15], v[48:51]
  ds_read_b128 v[28:31], v2 offset:29696
  v_mfma_f32_16x16x32_bf16 v[52:55], a[196:199], v[12:15], v[52:55]
  s_nop 0
  v_mfma_f32_16x16x32_bf16 v[56:59], a[200:203], v[12:15], v[56:59]
  v_mfma_f32_16x16x32_bf16 v[60:63], a[204:207], v[12:15], v[60:63]
  s_waitcnt lgkmcnt(3)
  v_mfma_f32_16x16x32_bf16 v[32:35], a[208:211], v[16:19], v[32:35]
  s_nop 0
  ds_read_b128 v[8:11], v2 offset:30720
  v_mfma_f32_16x16x32_bf16 v[36:39], a[212:215], v[16:19], v[36:39]
  v_mfma_f32_16x16x32_bf16 v[40:43], a[216:219], v[16:19], v[40:43]
  s_cmp_ge_u32 s52, 4
  s_cbranch_scc1 L_qn_13
  buffer_store_dwordx4 v[80:83], v1, s[4:7], s69 offen sc1
  s_add_u32 s69, s69, 0x80000
L_qn_13:
  v_mfma_f32_16x16x32_bf16 v[44:47], a[220:223], v[16:19], v[44:47]
  s_nop 0
  s_waitcnt lgkmcnt(3)
  v_mfma_f32_16x16x32_bf16 v[48:51], a[208:211], v[20:23], v[48:51]
  ds_read_b128 v[12:15], v2 offset:31744
  v_mfma_f32_16x16x32_bf16 v[52:55], a[212:215], v[20:23], v[52:55]
  v_mfma_f32_16x16x32_bf16 v[56:59], a[216:219], v[20:23], v[56:59]
  v_mfma_f32_16x16x32_bf16 v[60:63], a[220:223], v[20:23], v[60:63]
  s_waitcnt lgkmcnt(3)
  v_mfma_f32_16x16x32_bf16 v[32:35], a[224:227], v[24:27], v[32:35]
  s_nop 0
  ds_read_b128 v[16:19], v2 offset:32768
  v_mfma_f32_16x16x32_bf16 v[36:39], a[228:231], v[24:27], v[36:39]
  v_mfma_f32_16x16x32_bf16 v[40:43], a[232:235], v[24:27], v[40:43]
  v_mfma_f32_16x16x32_bf16 v[44:47], a[236:239], v[24:27], v[44:47]
  s_nop 0
  s_waitcnt lgkmcnt(3)
  v_mfma_f32_16x16x32_bf16 v[48:51], a[224:227], v[28:31], v[48:51]
  ds_read_b128 v[20:23], v2 offset:33792
  v_mfma_f32_16x16x32_bf16 v[52:55], a[228:231], v[28:31], v[52:55]
  v_mfma_f32_16x16x32_bf16 v[56:59], a[232:235], v[28:31], v[56:59]
  v_mfma_f32_16x16x32_bf16 v[60:63], a[236:239], v[28:31], v[60:63]
  s_waitcnt lgkmcnt(3)
  v_mfma_f32_16x16x32_bf16 v[32:35], a[240:243], v[8:11], v[32:35]
  s_nop 0
  ds_read_b128 v[24:27], v2 offset:34816
  v_mfma_f32_16x16x32_bf16 v[36:39], a[244:247], v[8:11], v[36:39]
  v_mfma_f32_16x16x32_bf16 v[40:43], a[248:251], v[8:11], v[40:43]
  v_mfma_f32_16x16x32_bf16 v[44:47], a[252:255], v[8:11], v[44:47]
  s_nop 0
  s_waitcnt lgkmcnt(3)
  v_mfma_f32_16x16x32_bf16 v[48:51], a[240:243], v[12:15], v[48:51]
  ds_read_b128 v[28:31], v2 offset:35840
  v_mfma_f32_16x16x32_bf16 v[52:55], a[244:247], v[12:15], v[52:55]
  v_mfma_f32_16x16x32_bf16 v[56:59], a[248:251], v[12:15], v[56:59]
  v_mfma_f32_16x16x32_bf16 v[60:63], a[252:255], v[12:15], v[60:63]
  s_waitcnt lgkmcnt(3)
  v_mfma_f32_16x16x32_bf16 v[32:35], v[192:195], v[16:19], v[32:35]
  s_nop 0
  ds_read_b128 v[8:11], v2 offset:36864
  v_mfma_f32_16x16x32_bf16 v[36:39], v[196:199], v[16:19], v[36:39]
  v_mfma_f32_16x16x32_bf16 v[40:43], v[200:203], v[16:19], v[40:43]
  v_mfma_f32_16x16x32_bf16 v[44:47], v[204:207], v[16:19], v[44:47]
  s_nop 0
  s_waitcnt lgkmcnt(3)
  v_mfma_f32_16x16x32_bf16 v[48:51], v[192:195], v[20:23], v[48:51]
  ds_read_b128 v[12:15], v2 offset:37888
  v_mfma_f32_16x16x32_bf16 v[52:55], v[196:199], v[20:23], v[52:55]
  v_mfma_f32_16x16x32_bf16 v[56:59], v[200:203], v[20:23], v[56:59]
  v_mfma_f32_16x16x32_bf16 v[60:63], v[204:207], v[20:23], v[60:63]
  s_waitcnt lgkmcnt(3)
  v_mfma_f32_16x16x32_bf16 v[32:35], v[208:211], v[24:27], v[32:35]
  s_nop 0
  ds_read_b128 v[16:19], v2 offset:38912
  v_mfma_f32_16x16x32_bf16 v[36:39], v[212:215], v[24:27], v[36:39]
  v_mfma_f32_16x16x32_bf16 v[40:43], v[216:219], v[24:27], v[40:43]
  v_mfma_f32_16x16x32_bf16 v[44:47], v[220:223], v[24:27], v[44:47]
  s_nop 0
  s_waitcnt lgkmcnt(3)
  v_mfma_f32_16x16x32_bf16 v[48:51], v[208:211], v[28:31], v[48:51]
  ds_read_b128 v[20:23], v2 offset:39936
  v_mfma_f32_16x16x32_bf16 v[52:55], v[212:215], v[28:31], v[52:55]
  v_mfma_f32_16x16x32_bf16 v[56:59], v[216:219], v[28:31], v[56:59]
  v_mfma_f32_16x16x32_bf16 v[60:63], v[220:223], v[28:31], v[60:63]
  s_waitcnt lgkmcnt(3)
  v_mfma_f32_16x16x32_bf16 v[32:35], v[224:227], v[8:11], v[32:35]
  v_mfma_f32_16x16x32_bf16 v[36:39], v[228:231], v[8:11], v[36:39]
  s_nop 0
  v_mfma_f32_16x16x32_bf16 v[40:43], v[232:235], v[8:11], v[40:43]
  v_mfma_f32_16x16x32_bf16 v[44:47], v[236:239], v[8:11], v[44:47]
  s_waitcnt lgkmcnt(2)
  v_mfma_f32_16x16x32_bf16 v[48:51], v[224:227], v[12:15], v[48:51]
  s_nop 0
  v_mfma_f32_16x16x32_bf16 v[52:55], v[228:231], v[12:15], v[52:55]
  v_mfma_f32_16x16x32_bf16 v[56:59], v[232:235], v[12:15], v[56:59]
  v_mfma_f32_16x16x32_bf16 v[60:63], v[236:239], v[12:15], v[60:63]
  s_nop 0
  s_waitcnt lgkmcnt(1)
  v_mfma_f32_16x16x32_bf16 v[32:35], v[240:243], v[16:19], v[32:35]
  v_mfma_f32_16x16x32_bf16 v[36:39], v[244:247], v[16:19], v[36:39]
  v_mfma_f32_16x16x32_bf16 v[40:43], v[248:251], v[16:19], v[40:43]
  v_mfma_f32_16x16x32_bf16 v[44:47], v[252:255], v[16:19], v[44:47]
  s_waitcnt lgkmcnt(0)
  v_mfma_f32_16x16x32_bf16 v[48:51], v[240:243], v[20:23], v[48:51]
  v_mfma_f32_16x16x32_bf16 v[52:55], v[244:247], v[20:23], v[52:55]
  v_mfma_f32_16x16x32_bf16 v[56:59], v[248:251], v[20:23], v[56:59]
  v_mfma_f32_16x16x32_bf16 v[60:63], v[252:255], v[20:23], v[60:63]
  s_add_u32 s62, s62, 1
  v_xor_b32 v2, 0x10000, v2
  v_cvt_pk_bf16_f32 v64, v32, v36
  v_cvt_pk_bf16_f32 v65, v33, v37
  v_cvt_pk_bf16_f32 v66, v34, v38
  v_cvt_pk_bf16_f32 v67, v35, v39
  v_cvt_pk_bf16_f32 v68, v48, v52
  v_cvt_pk_bf16_f32 v69, v49, v53
  v_cvt_pk_bf16_f32 v70, v50, v54
  v_cvt_pk_bf16_f32 v71, v51, v55
  v_cvt_pk_bf16_f32 v72, v40, v44
  v_cvt_pk_bf16_f32 v73, v41, v45
  v_cvt_pk_bf16_f32 v74, v42, v46
  v_cvt_pk_bf16_f32 v75, v43, v47
  v_cvt_pk_bf16_f32 v76, v56, v60
  v_cvt_pk_bf16_f32 v77, v57, v61
  v_cvt_pk_bf16_f32 v78, v58, v62
  v_cvt_pk_bf16_f32 v79, v59, v63
  s_cmp_lt_u32 s62, 16
  s_cbranch_scc1 L_q_loopk
  buffer_store_dwordx4 v[64:67], v3, s[4:7], s65 offen offset:0 sc1
  buffer_store_dwordx4 v[68:71], v3, s[4:7], s65 offen offset:1024 sc1
  s_add_u32 s71, s65, s70
  buffer_store_dwordx4 v[72:75], v3, s[4:7], s71 offen offset:0 sc1
  buffer_store_dwordx4 v[76:79], v3, s[4:7], s71 offen offset:1024 sc1
  s_add_u32 s65, s65, s66
  s_branch L_q_done
  s_nop 0
L_q_v:
  s_and_b32 s58, s12, 1
  s_lshl_b32 s58, s58, 7
  s_add_u32 s58, s58, 2048
  v_and_b32 v4, 0x370, v1
  v_bfe_u32 v5, v0, 3, 1
  v_lshl_add_u32 v4, v5, 13, v4
  v_add_u32 v3, s58, v4
  s_movk_i32 s70, 0x1000
  s_waitcnt vmcnt(0)
  s_barrier
  ds_read_b128 v[8:11], v2 offset:0
  ds_read_b128 v[12:15], v2 offset:1024
  ds_read_b128 v[16:19], v2 offset:2048
  ds_read_b128 v[20:23], v2 offset:3072
  s_waitcnt lgkmcnt(3)
  v_mfma_f32_16x16x32_bf16 v[32:35], v[8:11], a[0:3], 0
  ds_read_b128 v[24:27], v2 offset:4096
  v_mfma_f32_16x16x32_bf16 v[36:39], v[8:11], a[4:7], 0
  v_mfma_f32_16x16x32_bf16 v[40:43], v[8:11], a[8:11], 0
  v_mfma_f32_16x16x32_bf16 v[44:47], v[8:11], a[12:15], 0
  s_waitcnt lgkmcnt(3)
  v_mfma_f32_16x16x32_bf16 v[48:51], v[12:15], a[0:3], 0
  ds_read_b128 v[28:31], v2 offset:5120
  v_mfma_f32_16x16x32_bf16 v[52:55], v[12:15], a[4:7], 0
  v_mfma_f32_16x16x32_bf16 v[56:59], v[12:15], a[8:11], 0
  v_mfma_f32_16x16x32_bf16 v[60:63], v[12:15], a[12:15], 0
  s_nop 0
  s_waitcnt lgkmcnt(3)
  v_mfma_f32_16x16x32_bf16 v[32:35], v[16:19], a[16:19], v[32:35]
  ds_read_b128 v[8:11], v2 offset:6144
  v_mfma_f32_16x16x32_bf16 v[36:39], v[16:19], a[20:23], v[36:39]
  v_mfma_f32_16x16x32_bf16 v[40:43], v[16:19], a[24:27], v[40:43]
  v_mfma_f32_16x16x32_bf16 v[44:47], v[16:19], a[28:31], v[44:47]
  s_waitcnt lgkmcnt(3)
  v_mfma_f32_16x16x32_bf16 v[48:51], v[20:23], a[16:19], v[48:51]
  s_nop 0
  ds_read_b128 v[12:15], v2 offset:7168
  v_mfma_f32_16x16x32_bf16 v[52:55], v[20:23], a[20:23], v[52:55]
  v_mfma_f32_16x16x32_bf16 v[56:59], v[20:23], a[24:27], v[56:59]
  v_mfma_f32_16x16x32_bf16 v[60:63], v[20:23], a[28:31], v[60:63]
  s_nop 0
  s_waitcnt lgkmcnt(3)
  v_mfma_f32_16x16x32_bf16 v[32:35], v[24:27], a[32:35], v[32:35]
  ds_read_b128 v[16:19], v2 offset:8192
  v_mfma_f32_16x16x32_bf16 v[36:39], v[24:27], a[36:39], v[36:39]
  v_mfma_f32_16x16x32_bf16 v[40:43], v[24:27], a[40:43], v[40:43]
  v_mfma_f32_16x16x32_bf16 v[44:47], v[24:27], a[44:47], v[44:47]
  s_waitcnt lgkmcnt(3)
  v_mfma_f32_16x16x32_bf16 v[48:51], v[28:31], a[32:35], v[48:51]
  s_nop 0
  ds_read_b128 v[20:23], v2 offset:9216
  v_mfma_f32_16x16x32_bf16 v[52:55], v[28:31], a[36:39], v[52:55]
  v_mfma_f32_16x16x32_bf16 v[56:59], v[28:31], a[40:43], v[56:59]
  v_mfma_f32_16x16x32_bf16 v[60:63], v[28:31], a[44:47], v[60:63]
  s_nop 0
  s_waitcnt lgkmcnt(3)
  v_mfma_f32_16x16x32_bf16 v[32:35], v[8:11], a[48:51], v[32:35]
  ds_read_b128 v[24:27], v2 offset:10240
  v_mfma_f32_16x16x32_bf16 v[36:39], v[8:11], a[52:55], v[36:39]
  v_mfma_f32_16x16x32_bf16 v[40:43], v[8:11], a[56:59], v[40:43]
  v_mfma_f32_16x16x32_bf16 v[44:47], v[8:11], a[60:63], v[44:47]
  s_waitcnt lgkmcnt(3)
  v_mfma_f32_16x16x32_bf16 v[48:51], v[12:15], a[48:51], v[48:51]
  s_nop 0
  ds_read_b128 v[28:31], v2 offset:11264
  v_mfma_f32_16x16x32_bf16 v[52:55], v[12:15], a[52:55], v[52:55]
  v_mfma_f32_16x16x32_bf16 v[56:59], v[12:15], a[56:59], v[56:59]
  v_mfma_f32_16x16x32_bf16 v[60:63], v[12:15], a[60:63], v[60:63]
  s_nop 0
  s_waitcnt lgkmcnt(3)
  v_mfma_f32_16x16x32_bf16 v[32:35], v[16:19], a[64:67], v[32:35]
  ds_read_b128 v[8:11], v2 offset:12288
  v_mfma_f32_16x16x32_bf16 v[36:39], v[16:19], a[68:71], v[36:39]
  v_mfma_f32_16x16x32_bf16 v[40:43], v[16:19], a[72:75], v[40:43]
  v_mfma_f32_16x16x32_bf16 v[44:47], v[16:19], a[76:79], v[44:47]
  s_waitcnt lgkmcnt(3)
  v_mfma_f32_16x16x32_bf16 v[48:51], v[20:23], a[64:67], v[48:51]
  s_nop 0
  ds_read_b128 v[12:15], v2 offset:13312
  v_mfma_f32_16x16x32_bf16 v[52:55], v[20:23], a[68:71], v[52:55]
  v_mfma_f32_16x16x32_bf16 v[56:59], v[20:23], a[72:75], v[56:59]
  v_mfma_f32_16x16x32_bf16 v[60:63], v[20:23], a[76:79], v[60:63]
  s_nop 0
  s_waitcnt lgkmcnt(3)
  v_mfma_f32_16x16x32_bf16 v[32:35], v[24:27], a[80:83], v[32:35]
  ds_read_b128 v[16:19], v2 offset:14336
  v_mfma_f32_16x16x32_bf16 v[36:39], v[24:27], a[84:87], v[36:39]
  v_mfma_f32_16x16x32_bf16 v[40:43], v[24:27], a[88:91], v[40:43]
  v_mfma_f32_16x16x32_bf16 v[44:47], v[24:27], a[92:95], v[44:47]
  s_waitcnt lgkmcnt(3)
  v_mfma_f32_16x16x32_bf16 v[48:51], v[28:31], a[80:83], v[48:51]
  s_nop 0
  ds_read_b128 v[20:23], v2 offset:15360
  v_mfma_f32_16x16x32_bf16 v[52:55], v[28:31], a[84:87], v[52:55]
  v_mfma_f32_16x16x32_bf16 v[56:59], v[28:31], a[88:91], v[56:59]
  v_mfma_f32_16x16x32_bf16 v[60:63], v[28:31], a[92:95], v[60:63]
  s_nop 0
  s_waitcnt lgkmcnt(3)
  v_mfma_f32_16x16x32_bf16 v[32:35], v[8:11], a[96:99], v[32:35]
  ds_read_b128 v[24:27], v2 offset:16384
  v_mfma_f32_16x16x32_bf16 v[36:39], v[8:11], a[100:103], v[36:39]
  v_mfma_f32_16x16x32_bf16 v[40:43], v[8:11], a[104:107], v[40:43]
  v_mfma_f32_16x16x32_bf16 v[44:47], v[8:11], a[108:111], v[44:47]
  s_waitcnt lgkmcnt(3)
  v_mfma_f32_16x16x32_bf16 v[48:51], v[12:15], a[96:99], v[48:51]
  s_nop 0
  ds_read_b128 v[28:31], v2 offset:17408
  v_mfma_f32_16x16x32_bf16 v[52:55], v[12:15], a[100:103], v[52:55]
  v_mfma_f32_16x16x32_bf16 v[56:59], v[12:15], a[104:107], v[56:59]
  v_mfma_f32_16x16x32_bf16 v[60:63], v[12:15], a[108:111], v[60:63]
  s_nop 0
  s_waitcnt lgkmcnt(3)
  v_mfma_f32_16x16x32_bf16 v[32:35], v[16:19], a[112:115], v[32:35]
  ds_read_b128 v[8:11], v2 offset:18432
  v_mfma_f32_16x16x32_bf16 v[36:39], v[16:19], a[116:119], v[36:39]
  v_mfma_f32_16x16x32_bf16 v[40:43], v[16:19], a[120:123], v[40:43]
  v_mfma_f32_16x16x32_bf16 v[44:47], v[16:19], a[124:127], v[44:47]
  s_waitcnt lgkmcnt(3)
  v_mfma_f32_16x16x32_bf16 v[48:51], v[20:23], a[112:115], v[48:51]
  s_nop 0
  ds_read_b128 v[12:15], v2 offset:19456
  v_mfma_f32_16x16x32_bf16 v[52:55], v[20:23], a[116:119], v[52:55]
  v_mfma_f32_16x16x32_bf16 v[56:59], v[20:23], a[120:123], v[56:59]
  v_mfma_f32_16x16x32_bf16 v[60:63], v[20:23], a[124:127], v[60:63]
  s_nop 0
  s_waitcnt lgkmcnt(3)
  v_mfma_f32_16x16x32_bf16 v[32:35], v[24:27], a[128:131], v[32:35]
  ds_read_b128 v[16:19], v2 offset:20480
  v_mfma_f32_16x16x32_bf16 v[36:39], v[24:27], a[132:135], v[36:39]
  v_mfma_f32_16x16x32_bf16 v[40:43], v[24:27], a[136:139], v[40:43]
  v_mfma_f32_16x16x32_bf16 v[44:47], v[24:27], a[140:143], v[44:47]
  s_waitcnt lgkmcnt(3)
  v_mfma_f32_16x16x32_bf16 v[48:51], v[28:31], a[128:131], v[48:51]
  s_nop 0
  ds_read_b128 v[20:23], v2 offset:21504
  v_mfma_f32_16x16x32_bf16 v[52:55], v[28:31], a[132:135], v[52:55]
  v_mfma_f32_16x16x32_bf16 v[56:59], v[28:31], a[136:139], v[56:59]
  v_mfma_f32_16x16x32_bf16 v[60:63], v[28:31], a[140:143], v[60:63]
  s_nop 0
  s_waitcnt lgkmcnt(3)
  v_mfma_f32_16x16x32_bf16 v[32:35], v[8:11], a[144:147], v[32:35]
  ds_read_b128 v[24:27], v2 offset:22528
  v_mfma_f32_16x16x32_bf16 v[36:39], v[8:11], a[148:151], v[36:39]
  v_mfma_f32_16x16x32_bf16 v[40:43], v[8:11], a[152:155], v[40:43]
  v_mfma_f32_16x16x32_bf16 v[44:47], v[8:11], a[156:159], v[44:47]
  s_waitcnt lgkmcnt(3)
  v_mfma_f32_16x16x32_bf16 v[48:51], v[12:15], a[144:147], v[48:51]
  s_nop 0
  ds_read_b128 v[28:31], v2 offset:23552
  v_mfma_f32_16x16x32_bf16 v[52:55], v[12:15], a[148:151], v[52:55]
  v_mfma_f32_16x16x32_bf16 v[56:59], v[12:15], a[152:155], v[56:59]
  v_mfma_f32_16x16x32_bf16 v[60:63], v[12:15], a[156:159], v[60:63]
  s_nop 0
  s_waitcnt lgkmcnt(3)
  v_mfma_f32_16x16x32_bf16 v[32:35], v[16:19], a[160:163], v[32:35]
  ds_read_b128 v[8:11], v2 offset:24576
  v_mfma_f32_16x16x32_bf16 v[36:39], v[16:19], a[164:167], v[36:39]
  v_mfma_f32_16x16x32_bf16 v[40:43], v[16:19], a[168:171], v[40:43]
  v_mfma_f32_16x16x32_bf16 v[44:47], v[16:19], a[172:175], v[44:47]
  s_waitcnt lgkmcnt(3)
  v_mfma_f32_16x16x32_bf16 v[48:51], v[20:23], a[160:163], v[48:51]
  s_nop 0
  ds_read_b128 v[12:15], v2 offset:25600
  v_mfma_f32_16x16x32_bf16 v[52:55], v[20:23], a[164:167], v[52:55]
  v_mfma_f32_16x16x32_bf16 v[56:59], v[20:23], a[168:171], v[56:59]
  v_mfma_f32_16x16x32_bf16 v[60:63], v[20:23], a[172:175], v[60:63]
  s_nop 0
  s_waitcnt lgkmcnt(3)
  v_mfma_f32_16x16x32_bf16 v[32:35], v[24:27], a[176:179], v[32:35]
  ds_read_b128 v[16:19], v2 offset:26624
  v_mfma_f32_16x16x32_bf16 v[36:39], v[24:27], a[180:183], v[36:39]
  v_mfma_f32_16x16x32_bf16 v[40:43], v[24:27], a[184:187], v[40:43]
  v_mfma_f32_16x16x32_bf16 v[44:47], v[24:27], a[188:191], v[44:47]
  s_waitcnt lgkmcnt(3)
  v_mfma_f32_16x16x32_bf16 v[48:51], v[28:31], a[176:179], v[48:51]
  s_nop 0
  ds_read_b128 v[20:23], v2 offset:27648
  v_mfma_f32_16x16x32_bf16 v[52:55], v[28:31], a[180:183], v[52:55]
  v_mfma_f32_16x16x32_bf16 v[56:59], v[28:31], a[184:187], v[56:59]
  v_mfma_f32_16x16x32_bf16 v[60:63], v[28:31], a[188:191], v[60:63]
  s_nop 0
  s_waitcnt lgkmcnt(3)
  v_mfma_f32_16x16x32_bf16 v[32:35], v[8:11], a[192:195], v[32:35]
  ds_read_b128 v[24:27], v2 offset:28672
  v_mfma_f32_16x16x32_bf16 v[36:39], v[8:11], a[196:199], v[36:39]
  v_mfma_f32_16x16x32_bf16 v[40:43], v[8:11], a[200:203], v[40:43]
  v_mfma_f32_16x16x32_bf16 v[44:47], v[8:11], a[204:207], v[44:47]
  s_waitcnt lgkmcnt(3)
  v_mfma_f32_16x16x32_bf16 v[48:51], v[12:15], a[192:195], v[48:51]
  s_nop 0
  ds_read_b128 v[28:31], v2 offset:29696
  v_mfma_f32_16x16x32_bf16 v[52:55], v[12:15], a[196:199], v[52:55]
  v_mfma_f32_16x16x32_bf16 v[56:59], v[12:15], a[200:203], v[56:59]
  v_mfma_f32_16x16x32_bf16 v[60:63], v[12:15], a[204:207], v[60:63]
  s_nop 0
  s_waitcnt lgkmcnt(3)
  v_mfma_f32_16x16x32_bf16 v[32:35], v[16:19], a[208:211], v[32:35]
  ds_read_b128 v[8:11], v2 offset:30720
  v_mfma_f32_16x16x32_bf16 v[36:39], v[16:19], a[212:215], v[36:39]
  v_mfma_f32_16x16x32_bf16 v[40:43], v[16:19], a[216:219], v[40:43]
  buffer_store_dwordx4 v[80:83], v1, s[4:7], s69 offen sc1
  s_add_u32 s69, s69, 0x80000
L_qn_14:
  v_mfma_f32_16x16x32_bf16 v[44:47], v[16:19], a[220:223], v[44:47]
  s_nop 0
  s_waitcnt lgkmcnt(3)
  v_mfma_f32_16x16x32_bf16 v[48:51], v[20:23], a[208:211], v[48:51]
  ds_read_b128 v[12:15], v2 offset:31744
  v_mfma_f32_16x16x32_bf16 v[52:55], v[20:23], a[212:215], v[52:55]
  v_mfma_f32_16x16x32_bf16 v[56:59], v[20:23], a[216:219], v[56:59]
  v_mfma_f32_16x16x32_bf16 v[60:63], v[20:23], a[220:223], v[60:63]
  s_waitcnt lgkmcnt(3)
  v_mfma_f32_16x16x32_bf16 v[32:35], v[24:27], a[224:227], v[32:35]
  s_nop 0
  ds_read_b128 v[16:19], v2 offset:32768
  v_mfma_f32_16x16x32_bf16 v[36:39], v[24:27], a[228:231], v[36:39]
  v_mfma_f32_16x16x32_bf16 v[40:43], v[24:27], a[232:235], v[40:43]
  v_mfma_f32_16x16x32_bf16 v[44:47], v[24:27], a[236:239], v[44:47]
  s_nop 0
  s_waitcnt lgkmcnt(3)
  v_mfma_f32_16x16x32_bf16 v[48:51], v[28:31], a[224:227], v[48:51]
  ds_read_b128 v[20:23], v2 offset:33792
  v_mfma_f32_16x16x32_bf16 v[52:55], v[28:31], a[228:231], v[52:55]
  v_mfma_f32_16x16x32_bf16 v[56:59], v[28:31], a[232:235], v[56:59]
  v_mfma_f32_16x16x32_bf16 v[60:63], v[28:31], a[236:239], v[60:63]
  s_waitcnt lgkmcnt(3)
  v_mfma_f32_16x16x32_bf16 v[32:35], v[8:11], a[240:243], v[32:35]
  s_nop 0
  ds_read_b128 v[24:27], v2 offset:34816
  v_mfma_f32_16x16x32_bf16 v[36:39], v[8:11], a[244:247], v[36:39]
  v_mfma_f32_16x16x32_bf16 v[40:43], v[8:11], a[248:251], v[40:43]
  v_mfma_f32_16x16x32_bf16 v[44:47], v[8:11], a[252:255], v[44:47]
  s_nop 0
  s_waitcnt lgkmcnt(3)
  v_mfma_f32_16x16x32_bf16 v[48:51], v[12:15], a[240:243], v[48:51]
  ds_read_b128 v[28:31], v2 offset:35840
  v_mfma_f32_16x16x32_bf16 v[52:55], v[12:15], a[244:247], v[52:55]
  v_mfma_f32_16x16x32_bf16 v[56:59], v[12:15], a[248:251], v[56:59]
  v_mfma_f32_16x16x32_bf16 v[60:63], v[12:15], a[252:255], v[60:63]
  s_waitcnt lgkmcnt(3)
  v_mfma_f32_16x16x32_bf16 v[32:35], v[16:19], v[192:195], v[32:35]
  s_nop 0
  ds_read_b128 v[8:11], v2 offset:36864
  v_mfma_f32_16x16x32_bf16 v[36:39], v[16:19], v[196:199], v[36:39]
  v_mfma_f32_16x16x32_bf16 v[40:43], v[16:19], v[200:203], v[40:43]
  v_mfma_f32_16x16x32_bf16 v[44:47], v[16:19], v[204:207], v[44:47]
  s_nop 0
  s_waitcnt lgkmcnt(3)
  v_mfma_f32_16x16x32_bf16 v[48:51], v[20:23], v[192:195], v[48:51]
  ds_read_b128 v[12:15], v2 offset:37888
  v_mfma_f32_16x16x32_bf16 v[52:55], v[20:23], v[196:199], v[52:55]
  v_mfma_f32_16x16x32_bf16 v[56:59], v[20:23], v[200:203], v[56:59]
  v_mfma_f32_16x16x32_bf16 v[60:63], v[20:23], v[204:207], v[60:63]
  s_waitcnt lgkmcnt(3)
  v_mfma_f32_16x16x32_bf16 v[32:35], v[24:27], v[208:211], v[32:35]
  s_nop 0
  ds_read_b128 v[16:19], v2 offset:38912
  v_mfma_f32_16x16x32_bf16 v[36:39], v[24:27], v[212:215], v[36:39]
  v_mfma_f32_16x16x32_bf16 v[40:43], v[24:27], v[216:219], v[40:43]
  v_mfma_f32_16x16x32_bf16 v[44:47], v[24:27], v[220:223], v[44:47]
  s_nop 0
  s_waitcnt lgkmcnt(3)
  v_mfma_f32_16x16x32_bf16 v[48:51], v[28:31], v[208:211], v[48:51]
  ds_read_b128 v[20:23], v2 offset:39936
  v_mfma_f32_16x16x32_bf16 v[52:55], v[28:31], v[212:215], v[52:55]
  v_mfma_f32_16x16x32_bf16 v[56:59], v[28:31], v[216:219], v[56:59]
  v_mfma_f32_16x16x32_bf16 v[60:63], v[28:31], v[220:223], v[60:63]
  s_waitcnt lgkmcnt(3)
  v_mfma_f32_16x16x32_bf16 v[32:35], v[8:11], v[224:227], v[32:35]
  v_mfma_f32_16x16x32_bf16 v[36:39], v[8:11], v[228:231], v[36:39]
  s_nop 0
  v_mfma_f32_16x16x32_bf16 v[40:43], v[8:11], v[232:235], v[40:43]
  v_mfma_f32_16x16x32_bf16 v[44:47], v[8:11], v[236:239], v[44:47]
  s_waitcnt lgkmcnt(2)
  v_mfma_f32_16x16x32_bf16 v[48:51], v[12:15], v[224:227], v[48:51]
  s_nop 0
  v_mfma_f32_16x16x32_bf16 v[52:55], v[12:15], v[228:231], v[52:55]
  v_mfma_f32_16x16x32_bf16 v[56:59], v[12:15], v[232:235], v[56:59]
  v_mfma_f32_16x16x32_bf16 v[60:63], v[12:15], v[236:239], v[60:63]
  s_nop 0
  s_waitcnt lgkmcnt(1)
  v_mfma_f32_16x16x32_bf16 v[32:35], v[16:19], v[240:243], v[32:35]
  v_mfma_f32_16x16x32_bf16 v[36:39], v[16:19], v[244:247], v[36:39]
  v_mfma_f32_16x16x32_bf16 v[40:43], v[16:19], v[248:251], v[40:43]
  v_mfma_f32_16x16x32_bf16 v[44:47], v[16:19], v[252:255], v[44:47]
  s_waitcnt lgkmcnt(0)
  v_mfma_f32_16x16x32_bf16 v[48:51], v[20:23], v[240:243], v[48:51]
  v_mfma_f32_16x16x32_bf16 v[52:55], v[20:23], v[244:247], v[52:55]
  s_nop 0
  v_mfma_f32_16x16x32_bf16 v[56:59], v[20:23], v[248:251], v[56:59]
  s_nop 0
  v_mfma_f32_16x16x32_bf16 v[60:63], v[20:23], v[252:255], v[60:63]
  s_add_u32 s62, s62, 1
  v_xor_b32 v2, 0x10000, v2
  v_cvt_pk_bf16_f32 v64, v32, v33
  v_cvt_pk_bf16_f32 v65, v34, v35
  v_cvt_pk_bf16_f32 v66, v48, v49
  v_cvt_pk_bf16_f32 v67, v50, v51
  v_cvt_pk_bf16_f32 v68, v36, v37
  v_cvt_pk_bf16_f32 v69, v38, v39
  v_cvt_pk_bf16_f32 v70, v52, v53
  v_cvt_pk_bf16_f32 v71, v54, v55
  v_cvt_pk_bf16_f32 v72, v40, v41
  v_cvt_pk_bf16_f32 v73, v42, v43
  v_cvt_pk_bf16_f32 v74, v56, v57
  v_cvt_pk_bf16_f32 v75, v58, v59
  v_cvt_pk_bf16_f32 v76, v44, v45
  v_cvt_pk_bf16_f32 v77, v46, v47
  v_cvt_pk_bf16_f32 v78, v60, v61
  v_cvt_pk_bf16_f32 v79, v62, v63
  buffer_store_dwordx4 v[64:67], v3, s[4:7], s65 offen offset:0 sc1
  buffer_store_dwordx4 v[68:71], v3, s[4:7], s65 offen offset:1024 sc1
  s_add_u32 s71, s65, s70
  buffer_store_dwordx4 v[72:75], v3, s[4:7], s71 offen offset:0 sc1
  buffer_store_dwordx4 v[76:79], v3, s[4:7], s71 offen offset:1024 sc1
  s_add_u32 s65, s65, s66
  s_sub_u32 s65, s65, s66
  s_waitcnt vmcnt(0)
  s_barrier
  s_cmp_lg_u32 s12, 0
  s_cbranch_scc1 L_qf_15
  v_mov_b32_e64 v4, s62
  s_mov_b64 exec, 1
  buffer_store_dword v4, v0, s[4:7], s67 offen sc1
  s_mov_b64 exec, -1
L_qf_15:
  v_lshrrev_b32 v6, 2, v0
  v_lshlrev_b32 v6, 6, v6
  v_and_b32 v7, 3, v0
  v_lshl_add_u32 v6, v7, 2, v6
  s_and_b32 s58, s13, 3
  s_lshl_b32 s58, s58, 4
  s_add_u32 s58, s58, 4096
  s_mov_b64 exec, -1
L_q_hw_16:
  buffer_load_dword v7, v6, s[4:7], s58 offen sc1
  s_sub_u32 s54, s54, 1
  s_cbranch_scc1 L_end
  s_waitcnt vmcnt(0)
  v_cmp_ne_u32 vcc, 1, v7
  s_cbranch_vccz L_q_hw_16x
  s_sleep 2
  s_branch L_q_hw_16
  s_nop 0
  s_nop 0
  s_nop 0
L_q_hw_16x:
  s_mov_b64 exec, -1
  s_add_u32 m0, s64, 0
  s_add_u32 s68, s63, 0
  buffer_load_dwordx4 v1, s[4:7], s68 offen offset:0 sc1 lds
  buffer_load_dwordx4 v1, s[4:7], s68 offen offset:1024 sc1 lds
  buffer_load_dwordx4 v1, s[4:7], s68 offen offset:2048 sc1 lds
  buffer_load_dwordx4 v1, s[4:7], s68 offen offset:3072 sc1 lds
  s_add_u32 m0, s64, 4096
  s_add_u32 s68, s63, 4096
  buffer_load_dwordx4 v1, s[4:7], s68 offen offset:0 sc1 lds
  buffer_load_dwordx4 v1, s[4:7], s68 offen offset:1024 sc1 lds
  buffer_load_dwordx4 v1, s[4:7], s68 offen offset:2048 sc1 lds
  buffer_load_dwordx4 v1, s[4:7], s68 offen offset:3072 sc1 lds
  s_add_u32 m0, s64, 8192
  s_add_u32 s68, s63, 8192
  buffer_load_dwordx4 v1, s[4:7], s68 offen offset:0 sc1 lds
  buffer_load_dwordx4 v1, s[4:7], s68 offen offset:1024 sc1 lds
  s_add_u32 s63, s63, 163840
  s_xor_b32 s64, s64, 0x10000
  s_lshl_b32 s58, s53, 2
  s_add_u32 s58, s58, s12
  s_mul_i32 s58, s58, 23
  v_add_u32 v6, s58, v0
  v_lshlrev_b32_e64 v6, 7, v6
  s_mov_b64 exec, 0x7fffff
  buffer_load_dword v7, v6, s[36:39], 0 offen
  buffer_load_dword v7, v6, s[40:43], 0 offen
  buffer_load_dword v7, v6, s[44:47], 0 offen
  s_mov_b64 exec, -1
  s_lshl_b32 s58, s53, 2
  s_add_u32 s58, s58, s12
  s_mul_i32 s58, s58, 7680
  v_lshlrev_b32 v6, 7, v0
  v_add_u32_e64 v6, s58, v6
  s_mov_b32 exec_hi, 0xff
  buffer_load_dword v7, v6, s[24:27], 0 offen offset:2560
  s_mov_b64 exec, -1
L_q_loopv:
  s_nop 0
  s_waitcnt vmcnt(0)
  s_barrier
  ds_read_b128 v[8:11], v2 offset:0
  ds_read_b128 v[12:15], v2 offset:1024
  ds_read_b128 v[16:19], v2 offset:2048
  ds_read_b128 v[20:23], v2 offset:3072
  s_waitcnt lgkmcnt(3)
  v_mfma_f32_16x16x32_bf16 v[32:35], v[8:11], a[0:3], 0
  s_nop 0
  ds_read_b128 v[24:27], v2 offset:4096
  v_mfma_f32_16x16x32_bf16 v[36:39], v[8:11], a[4:7], 0
  v_mfma_f32_16x16x32_bf16 v[40:43], v[8:11], a[8:11], 0
  buffer_store_dwordx4 v[64:67], v3, s[4:7], s65 offen offset:0 sc1
  v_mfma_f32_16x16x32_bf16 v[44:47], v[8:11], a[12:15], 0
  s_waitcnt lgkmcnt(3)
  v_mfma_f32_16x16x32_bf16 v[48:51], v[12:15], a[0:3], 0
  ds_read_b128 v[28:31], v2 offset:5120
  v_mfma_f32_16x16x32_bf16 v[52:55], v[12:15], a[4:7], 0
  s_nop 0
  v_mfma_f32_16x16x32_bf16 v[56:59], v[12:15], a[8:11], 0
  buffer_store_dwordx4 v[68:71], v3, s[4:7], s65 offen offset:1024 sc1
  v_mfma_f32_16x16x32_bf16 v[60:63], v[12:15], a[12:15], 0
  s_nop 0
  s_waitcnt lgkmcnt(3)
  v_mfma_f32_16x16x32_bf16 v[32:35], v[16:19], a[16:19], v[32:35]
  ds_read_b128 v[8:11], v2 offset:6144
  v_mfma_f32_16x16x32_bf16 v[36:39], v[16:19], a[20:23], v[36:39]
  v_mfma_f32_16x16x32_bf16 v[40:43], v[16:19], a[24:27], v[40:43]
  s_add_u32 s71, s65, s70
  buffer_store_dwordx4 v[72:75], v3, s[4:7], s71 offen offset:0 sc1
  v_mfma_f32_16x16x32_bf16 v[44:47], v[16:19], a[28:31], v[44:47]
  s_waitcnt lgkmcnt(3)
  v_mfma_f32_16x16x32_bf16 v[48:51], v[20:23], a[16:19], v[48:51]
  ds_read_b128 v[12:15], v2 offset:7168
  v_mfma_f32_16x16x32_bf16 v[52:55], v[20:23], a[20:23], v[52:55]
  v_mfma_f32_16x16x32_bf16 v[56:59], v[20:23], a[24:27], v[56:59]
  buffer_store_dwordx4 v[76:79], v3, s[4:7], s71 offen offset:1024 sc1
  s_add_u32 s65, s65, s66
  v_mfma_f32_16x16x32_bf16 v[60:63], v[20:23], a[28:31], v[60:63]
  s_waitcnt lgkmcnt(3)
  v_mfma_f32_16x16x32_bf16 v[32:35], v[24:27], a[32:35], v[32:35]
  ds_read_b128 v[16:19], v2 offset:8192
  v_mfma_f32_16x16x32_bf16 v[36:39], v[24:27], a[36:39], v[36:39]
  v_mfma_f32_16x16x32_bf16 v[40:43], v[24:27], a[40:43], v[40:43]
  s_add_u32 m0, s64, 0
  s_add_u32 s68, s63, 0
  buffer_load_dwordx4 v1, s[4:7], s68 offen offset:0 sc1 lds
  v_mfma_f32_16x16x32_bf16 v[44:47], v[24:27], a[44:47], v[44:47]
  s_waitcnt lgkmcnt(3)
  v_mfma_f32_16x16x32_bf16 v[48:51], v[28:31], a[32:35], v[48:51]
  s_nop 0
  ds_read_b128 v[20:23], v2 offset:9216
  v_mfma_f32_16x16x32_bf16 v[52:55], v[28:31], a[36:39], v[52:55]
  v_mfma_f32_16x16x32_bf16 v[56:59], v[28:31], a[40:43], v[56:59]
  v_mfma_f32_16x16x32_bf16 v[60:63], v[28:31], a[44:47], v[60:63]
  s_nop 0
  s_waitcnt lgkmcnt(3)
  v_mfma_f32_16x16x32_bf16 v[32:35], v[8:11], a[48:51], v[32:35]
  ds_read_b128 v[24:27], v2 offset:10240
  v_mfma_f32_16x16x32_bf16 v[36:39], v[8:11], a[52:55], v[36:39]
  v_mfma_f32_16x16x32_bf16 v[40:43], v[8:11], a[56:59], v[40:43]
  buffer_load_dwordx4 v1, s[4:7], s68 offen offset:1024 sc1 lds
  v_mfma_f32_16x16x32_bf16 v[44:47], v[8:11], a[60:63], v[44:47]
  s_waitcnt lgkmcnt(3)
  v_mfma_f32_16x16x32_bf16 v[48:51], v[12:15], a[48:51], v[48:51]
  s_nop 0
  ds_read_b128 v[28:31], v2 offset:11264
  v_mfma_f32_16x16x32_bf16 v[52:55], v[12:15], a[52:55], v[52:55]
  v_mfma_f32_16x16x32_bf16 v[56:59], v[12:15], a[56:59], v[56:59]
  v_mfma_f32_16x16x32_bf16 v[60:63], v[12:15], a[60:63], v[60:63]
  s_waitcnt lgkmcnt(3)
  v_mfma_f32_16x16x32_bf16 v[32:35], v[16:19], a[64:67], v[32:35]
  ds_read_b128 v[8:11], v2 offset:12288
  v_mfma_f32_16x16x32_bf16 v[36:39], v[16:19], a[68:71], v[36:39]
  s_nop 0
  v_mfma_f32_16x16x32_bf16 v[40:43], v[16:19], a[72:75], v[40:43]
  buffer_load_dwordx4 v1, s[4:7], s68 offen offset:2048 sc1 lds
  v_mfma_f32_16x16x32_bf16 v[44:47], v[16:19], a[76:79], v[44:47]
  s_nop 0
  s_waitcnt lgkmcnt(3)
  v_mfma_f32_16x16x32_bf16 v[48:51], v[20:23], a[64:67], v[48:51]
  ds_read_b128 v[12:15], v2 offset:13312
  v_mfma_f32_16x16x32_bf16 v[52:55], v[20:23], a[68:71], v[52:55]
  v_mfma_f32_16x16x32_bf16 v[56:59], v[20:23], a[72:75], v[56:59]
  v_mfma_f32_16x16x32_bf16 v[60:63], v[20:23], a[76:79], v[60:63]
  s_waitcnt lgkmcnt(3)
  v_mfma_f32_16x16x32_bf16 v[32:35], v[24:27], a[80:83], v[32:35]
  s_nop 0
  ds_read_b128 v[16:19], v2 offset:14336
  v_mfma_f32_16x16x32_bf16 v[36:39], v[24:27], a[84:87], v[36:39]
  v_mfma_f32_16x16x32_bf16 v[40:43], v[24:27], a[88:91], v[40:43]
  buffer_load_dwordx4 v1, s[4:7], s68 offen offset:3072 sc1 lds
  v_mfma_f32_16x16x32_bf16 v[44:47], v[24:27], a[92:95], v[44:47]
  s_waitcnt lgkmcnt(3)
  v_mfma_f32_16x16x32_bf16 v[48:51], v[28:31], a[80:83], v[48:51]
  ds_read_b128 v[20:23], v2 offset:15360
  v_mfma_f32_16x16x32_bf16 v[52:55], v[28:31], a[84:87], v[52:55]
  s_nop 0
  v_mfma_f32_16x16x32_bf16 v[56:59], v[28:31], a[88:91], v[56:59]
  v_mfma_f32_16x16x32_bf16 v[60:63], v[28:31], a[92:95], v[60:63]
  s_waitcnt lgkmcnt(3)
  v_mfma_f32_16x16x32_bf16 v[32:35], v[8:11], a[96:99], v[32:35]
  s_nop 0
  ds_read_b128 v[24:27], v2 offset:16384
  v_mfma_f32_16x16x32_bf16 v[36:39], v[8:11], a[100:103], v[36:39]
  v_mfma_f32_16x16x32_bf16 v[40:43], v[8:11], a[104:107], v[40:43]
  s_add_u32 m0, s64, 4096
  s_add_u32 s68, s63, 4096
  buffer_load_dwordx4 v1, s[4:7], s68 offen offset:0 sc1 lds
  v_mfma_f32_16x16x32_bf16 v[44:47], v[8:11], a[108:111], v[44:47]
  s_nop 0
  s_waitcnt lgkmcnt(3)
  v_mfma_f32_16x16x32_bf16 v[48:51], v[12:15], a[96:99], v[48:51]
  ds_read_b128 v[28:31], v2 offset:17408
  v_mfma_f32_16x16x32_bf16 v[52:55], v[12:15], a[100:103], v[52:55]
  v_mfma_f32_16x16x32_bf16 v[56:59], v[12:15], a[104:107], v[56:59]
  v_mfma_f32_16x16x32_bf16 v[60:63], v[12:15], a[108:111], v[60:63]
  s_waitcnt lgkmcnt(3)
  v_mfma_f32_16x16x32_bf16 v[32:35], v[16:19], a[112:115], v[32:35]
  s_nop 0
  ds_read_b128 v[8:11], v2 offset:18432
  v_mfma_f32_16x16x32_bf16 v[36:39], v[16:19], a[116:119], v[36:39]
  v_mfma_f32_16x16x32_bf16 v[40:43], v[16:19], a[120:123], v[40:43]
  buffer_load_dwordx4 v1, s[4:7], s68 offen offset:1024 sc1 lds
  v_mfma_f32_16x16x32_bf16 v[44:47], v[16:19], a[124:127], v[44:47]
  s_waitcnt lgkmcnt(3)
  v_mfma_f32_16x16x32_bf16 v[48:51], v[20:23], a[112:115], v[48:51]
  ds_read_b128 v[12:15], v2 offset:19456
  v_mfma_f32_16x16x32_bf16 v[52:55], v[20:23], a[116:119], v[52:55]
  s_nop 0
  v_mfma_f32_16x16x32_bf16 v[56:59], v[20:23], a[120:123], v[56:59]
  v_mfma_f32_16x16x32_bf16 v[60:63], v[20:23], a[124:127], v[60:63]
  s_waitcnt lgkmcnt(3)
  v_mfma_f32_16x16x32_bf16 v[32:35], v[24:27], a[128:131], v[32:35]
  s_nop 0
  ds_read_b128 v[16:19], v2 offset:20480
  v_mfma_f32_16x16x32_bf16 v[36:39], v[24:27], a[132:135], v[36:39]
  v_mfma_f32_16x16x32_bf16 v[40:43], v[24:27], a[136:139], v[40:43]
  buffer_load_dwordx4 v1, s[4:7], s68 offen offset:2048 sc1 lds
  v_mfma_f32_16x16x32_bf16 v[44:47], v[24:27], a[140:143], v[44:47]
  s_waitcnt lgkmcnt(3)
  v_mfma_f32_16x16x32_bf16 v[48:51], v[28:31], a[128:131], v[48:51]
  s_nop 0
  ds_read_b128 v[20:23], v2 offset:21504
  v_mfma_f32_16x16x32_bf16 v[52:55], v[28:31], a[132:135], v[52:55]
  v_mfma_f32_16x16x32_bf16 v[56:59], v[28:31], a[136:139], v[56:59]
  v_mfma_f32_16x16x32_bf16 v[60:63], v[28:31], a[140:143], v[60:63]
  s_nop 0
  s_waitcnt lgkmcnt(3)
  v_mfma_f32_16x16x32_bf16 v[32:35], v[8:11], a[144:147], v[32:35]
  ds_read_b128 v[24:27], v2 offset:22528
  v_mfma_f32_16x16x32_bf16 v[36:39], v[8:11], a[148:151], v[36:39]
  v_mfma_f32_16x16x32_bf16 v[40:43], v[8:11], a[152:155], v[40:43]
  buffer_load_dwordx4 v1, s[4:7], s68 offen offset:3072 sc1 lds
  v_mfma_f32_16x16x32_bf16 v[44:47], v[8:11], a[156:159], v[44:47]
  s_waitcnt lgkmcnt(3)
  v_mfma_f32_16x16x32_bf16 v[48:51], v[12:15], a[144:147], v[48:51]
  s_nop 0
  ds_read_b128 v[28:31], v2 offset:23552
  v_mfma_f32_16x16x32_bf16 v[52:55], v[12:15], a[148:151], v[52:55]
  v_mfma_f32_16x16x32_bf16 v[56:59], v[12:15], a[152:155], v[56:59]
  v_mfma_f32_16x16x32_bf16 v[60:63], v[12:15], a[156:159], v[60:63]
  s_waitcnt lgkmcnt(3)
  v_mfma_f32_16x16x32_bf16 v[32:35], v[16:19], a[160:163], v[32:35]
  ds_read_b128 v[8:11], v2 offset:24576
  v_mfma_f32_16x16x32_bf16 v[36:39], v[16:19], a[164:167], v[36:39]
  s_nop 0
  v_mfma_f32_16x16x32_bf16 v[40:43], v[16:19], a[168:171], v[40:43]
  s_add_u32 m0, s64, 8192
  s_add_u32 s68, s63, 8192
  buffer_load_dwordx4 v1, s[4:7], s68 offen offset:0 sc1 lds
  v_mfma_f32_16x16x32_bf16 v[44:47], v[16:19], a[172:175], v[44:47]
  s_waitcnt lgkmcnt(3)
  v_mfma_f32_16x16x32_bf16 v[48:51], v[20:23], a[160:163], v[48:51]
  s_nop 0
  ds_read_b128 v[12:15], v2 offset:25600
  v_mfma_f32_16x16x32_bf16 v[52:55], v[20:23], a[164:167], v[52:55]
  v_mfma_f32_16x16x32_bf16 v[56:59], v[20:23], a[168:171], v[56:59]
  v_mfma_f32_16x16x32_bf16 v[60:63], v[20:23], a[172:175], v[60:63]
  s_nop 0
  s_waitcnt lgkmcnt(3)
  v_mfma_f32_16x16x32_bf16 v[32:35], v[24:27], a[176:179], v[32:35]
  ds_read_b128 v[16:19], v2 offset:26624
  v_mfma_f32_16x16x32_bf16 v[36:39], v[24:27], a[180:183], v[36:39]
  v_mfma_f32_16x16x32_bf16 v[40:43], v[24:27], a[184:187], v[40:43]
  buffer_load_dwordx4 v1, s[4:7], s68 offen offset:1024 sc1 lds
  s_add_u32 s63, s63, 163840
  s_xor_b32 s64, s64, 0x10000
  v_mfma_f32_16x16x32_bf16 v[44:47], v[24:27], a[188:191], v[44:47]
  s_waitcnt lgkmcnt(3)
  v_mfma_f32_16x16x32_bf16 v[48:51], v[28:31], a[176:179], v[48:51]
  ds_read_b128 v[20:23], v2 offset:27648
  v_mfma_f32_16x16x32_bf16 v[52:55], v[28:31], a[180:183], v[52:55]
  s_nop 0
  v_mfma_f32_16x16x32_bf16 v[56:59], v[28:31], a[184:187], v[56:59]
  v_mfma_f32_16x16x32_bf16 v[60:63], v[28:31], a[188:191], v[60:63]
  s_waitcnt vmcnt(10)
  s_barrier
  s_cmp_lg_u32 s12, 0
  s_cbranch_scc1 L_qf_17
  v_mov_b32 v4, s62
  s_mov_b64 exec, 1
  buffer_store_dword v4, v0, s[4:7], s67 offen sc1
  s_mov_b64 exec, -1
L_qf_17:
  s_waitcnt lgkmcnt(3)
  v_mfma_f32_16x16x32_bf16 v[32:35], v[8:11], a[192:195], v[32:35]
  ds_read_b128 v[24:27], v2 offset:28672
  v_mfma_f32_16x16x32_bf16 v[36:39], v[8:11], a[196:199], v[36:39]
  v_mfma_f32_16x16x32_bf16 v[40:43], v[8:11], a[200:203], v[40:43]
  v_mfma_f32_16x16x32_bf16 v[44:47], v[8:11], a[204:207], v[44:47]
  s_waitcnt lgkmcnt(3)
  v_mfma_f32_16x16x32_bf16 v[48:51], v[12:15], a[192:195], v[48:51]
  ds_read_b128 v[28:31], v2 offset:29696
  v_mfma_f32_16x16x32_bf16 v[52:55], v[12:15], a[196:199], v[52:55]
  s_nop 0
  v_mfma_f32_16x16x32_bf16 v[56:59], v[12:15], a[200:203], v[56:59]
  v_mfma_f32_16x16x32_bf16 v[60:63], v[12:15], a[204:207], v[60:63]
  s_waitcnt lgkmcnt(3)
  v_mfma_f32_16x16x32_bf16 v[32:35], v[16:19], a[208:211], v[32:35]
  s_nop 0
  ds_read_b128 v[8:11], v2 offset:30720
  v_mfma_f32_16x16x32_bf16 v[36:39], v[16:19], a[212:215], v[36:39]
  v_mfma_f32_16x16x32_bf16 v[40:43], v[16:19], a[216:219], v[40:43]
  buffer_store_dwordx4 v[80:83], v1, s[4:7], s69 offen sc1
  s_add_u32 s69, s69, 0x80000
L_qn_18:
  v_mfma_f32_16x16x32_bf16 v[44:47], v[16:19], a[220:223], v[44:47]
  s_waitcnt lgkmcnt(3)
  v_mfma_f32_16x16x32_bf16 v[48:51], v[20:23], a[208:211], v[48:51]
  s_nop 0
  ds_read_b128 v[12:15], v2 offset:31744
  v_mfma_f32_16x16x32_bf16 v[52:55], v[20:23], a[212:215], v[52:55]
  v_mfma_f32_16x16x32_bf16 v[56:59], v[20:23], a[216:219], v[56:59]
  v_mfma_f32_16x16x32_bf16 v[60:63], v[20:23], a[220:223], v[60:63]
  s_waitcnt lgkmcnt(3)
  v_mfma_f32_16x16x32_bf16 v[32:35], v[24:27], a[224:227], v[32:35]
  ds_read_b128 v[16:19], v2 offset:32768
  v_mfma_f32_16x16x32_bf16 v[36:39], v[24:27], a[228:231], v[36:39]
  s_nop 0
  v_mfma_f32_16x16x32_bf16 v[40:43], v[24:27], a[232:235], v[40:43]
  v_mfma_f32_16x16x32_bf16 v[44:47], v[24:27], a[236:239], v[44:47]
  s_waitcnt lgkmcnt(3)
  v_mfma_f32_16x16x32_bf16 v[48:51], v[28:31], a[224:227], v[48:51]
  s_nop 0
  ds_read_b128 v[20:23], v2 offset:33792
  v_mfma_f32_16x16x32_bf16 v[52:55], v[28:31], a[228:231], v[52:55]
  v_mfma_f32_16x16x32_bf16 v[56:59], v[28:31], a[232:235], v[56:59]
  v_mfma_f32_16x16x32_bf16 v[60:63], v[28:31], a[236:239], v[60:63]
  s_waitcnt lgkmcnt(3)
  v_mfma_f32_16x16x32_bf16 v[32:35], v[8:11], a[240:243], v[32:35]
  ds_read_b128 v[24:27], v2 offset:34816
  v_mfma_f32_16x16x32_bf16 v[36:39], v[8:11], a[244:247], v[36:39]
  s_nop 0
  v_mfma_f32_16x16x32_bf16 v[40:43], v[8:11], a[248:251], v[40:43]
  v_mfma_f32_16x16x32_bf16 v[44:47], v[8:11], a[252:255], v[44:47]
  s_waitcnt lgkmcnt(3)
  v_mfma_f32_16x16x32_bf16 v[48:51], v[12:15], a[240:243], v[48:51]
  s_nop 0
  ds_read_b128 v[28:31], v2 offset:35840
  v_mfma_f32_16x16x32_bf16 v[52:55], v[12:15], a[244:247], v[52:55]
  v_mfma_f32_16x16x32_bf16 v[56:59], v[12:15], a[248:251], v[56:59]
  v_mfma_f32_16x16x32_bf16 v[60:63], v[12:15], a[252:255], v[60:63]
  s_waitcnt lgkmcnt(3)
  v_mfma_f32_16x16x32_bf16 v[32:35], v[16:19], v[192:195], v[32:35]
  ds_read_b128 v[8:11], v2 offset:36864
  v_mfma_f32_16x16x32_bf16 v[36:39], v[16:19], v[196:199], v[36:39]
  s_nop 0
  v_mfma_f32_16x16x32_bf16 v[40:43], v[16:19], v[200:203], v[40:43]
  v_mfma_f32_16x16x32_bf16 v[44:47], v[16:19], v[204:207], v[44:47]
  s_waitcnt lgkmcnt(3)
  v_mfma_f32_16x16x32_bf16 v[48:51], v[20:23], v[192:195], v[48:51]
  s_nop 0
  ds_read_b128 v[12:15], v2 offset:37888
  v_mfma_f32_16x16x32_bf16 v[52:55], v[20:23], v[196:199], v[52:55]
  v_mfma_f32_16x16x32_bf16 v[56:59], v[20:23], v[200:203], v[56:59]
  v_mfma_f32_16x16x32_bf16 v[60:63], v[20:23], v[204:207], v[60:63]
  s_waitcnt lgkmcnt(3)
  v_mfma_f32_16x16x32_bf16 v[32:35], v[24:27], v[208:211], v[32:35]
  ds_read_b128 v[16:19], v2 offset:38912
  v_mfma_f32_16x16x32_bf16 v[36:39], v[24:27], v[212:215], v[36:39]
  s_nop 0
  v_mfma_f32_16x16x32_bf16 v[40:43], v[24:27], v[216:219], v[40:43]
  v_mfma_f32_16x16x32_bf16 v[44:47], v[24:27], v[220:223], v[44:47]
  s_waitcnt lgkmcnt(3)
  v_mfma_f32_16x16x32_bf16 v[48:51], v[28:31], v[208:211], v[48:51]
  s_nop 0
  ds_read_b128 v[20:23], v2 offset:39936
  v_mfma_f32_16x16x32_bf16 v[52:55], v[28:31], v[212:215], v[52:55]
  v_mfma_f32_16x16x32_bf16 v[56:59], v[28:31], v[216:219], v[56:59]
  v_mfma_f32_16x16x32_bf16 v[60:63], v[28:31], v[220:223], v[60:63]
  s_waitcnt lgkmcnt(3)
  v_mfma_f32_16x16x32_bf16 v[32:35], v[8:11], v[224:227], v[32:35]
  v_mfma_f32_16x16x32_bf16 v[36:39], v[8:11], v[228:231], v[36:39]
  v_mfma_f32_16x16x32_bf16 v[40:43], v[8:11], v[232:235], v[40:43]
  s_nop 0
  v_mfma_f32_16x16x32_bf16 v[44:47], v[8:11], v[236:239], v[44:47]
  s_waitcnt lgkmcnt(2)
  v_mfma_f32_16x16x32_bf16 v[48:51], v[12:15], v[224:227], v[48:51]
  v_mfma_f32_16x16x32_bf16 v[52:55], v[12:15], v[228:231], v[52:55]
  s_nop 0
  v_mfma_f32_16x16x32_bf16 v[56:59], v[12:15], v[232:235], v[56:59]
  v_mfma_f32_16x16x32_bf16 v[60:63], v[12:15], v[236:239], v[60:63]
  s_waitcnt lgkmcnt(1)
  v_mfma_f32_16x16x32_bf16 v[32:35], v[16:19], v[240:243], v[32:35]
  s_nop 0
  v_mfma_f32_16x16x32_bf16 v[36:39], v[16:19], v[244:247], v[36:39]
  v_mfma_f32_16x16x32_bf16 v[40:43], v[16:19], v[248:251], v[40:43]
  v_mfma_f32_16x16x32_bf16 v[44:47], v[16:19], v[252:255], v[44:47]
  s_waitcnt lgkmcnt(0)
  v_mfma_f32_16x16x32_bf16 v[48:51], v[20:23], v[240:243], v[48:51]
  v_mfma_f32_16x16x32_bf16 v[52:55], v[20:23], v[244:247], v[52:55]
  v_mfma_f32_16x16x32_bf16 v[56:59], v[20:23], v[248:251], v[56:59]
  v_mfma_f32_16x16x32_bf16 v[60:63], v[20:23], v[252:255], v[60:63]
  s_add_u32 s62, s62, 1
  v_xor_b32 v2, 0x10000, v2
  v_cvt_pk_bf16_f32 v64, v32, v33
  v_cvt_pk_bf16_f32 v65, v34, v35
  v_cvt_pk_bf16_f32 v66, v48, v49
  v_cvt_pk_bf16_f32 v67, v50, v51
  v_cvt_pk_bf16_f32 v68, v36, v37
  v_cvt_pk_bf16_f32 v69, v38, v39
  v_cvt_pk_bf16_f32 v70, v52, v53
  v_cvt_pk_bf16_f32 v71, v54, v55
  v_cvt_pk_bf16_f32 v72, v40, v41
  v_cvt_pk_bf16_f32 v73, v42, v43
  v_cvt_pk_bf16_f32 v74, v56, v57
  v_cvt_pk_bf16_f32 v75, v58, v59
  v_cvt_pk_bf16_f32 v76, v44, v45
  v_cvt_pk_bf16_f32 v77, v46, v47
  v_cvt_pk_bf16_f32 v78, v60, v61
  v_cvt_pk_bf16_f32 v79, v62, v63
  s_cmp_lt_u32 s62, 16
  s_cbranch_scc1 L_q_loopv
  buffer_store_dwordx4 v[64:67], v3, s[4:7], s65 offen offset:0 sc1
  buffer_store_dwordx4 v[68:71], v3, s[4:7], s65 offen offset:1024 sc1
  s_add_u32 s71, s65, s70
  buffer_store_dwordx4 v[72:75], v3, s[4:7], s71 offen offset:0 sc1
  buffer_store_dwordx4 v[76:79], v3, s[4:7], s71 offen offset:1024 sc1
  s_add_u32 s65, s65, s66
L_q_done:
  s_waitcnt vmcnt(0)
  s_barrier
  s_cmp_lg_u32 s12, 0
  s_cbranch_scc1 L_qf_19
  v_mov_b32 v4, s62
  s_mov_b64 exec, 1
  buffer_store_dword v4, v0, s[4:7], s67 offen sc1
  s_mov_b64 exec, -1
L_qf_19:
  s_cmp_ge_u32 s52, 4
  s_cbranch_scc1 L_w_post
  s_cmp_ge_u32 s13, 20
  s_cbranch_scc1 L_w_post
  s_add_u32 s60, s52, 2
  v_lshrrev_b32 v2, 2, v0
  s_mul_i32 s58, s12, 160
  v_add_u32 v2, s58, v2
  v_lshlrev_b32 v3, 1, v2
  v_mul_u32_u24 v2, 7680, v2
  v_and_b32 v80, 3, v0
  v_lshl_add_u32 v2, v80, 4, v2
  s_mul_i32 s58, s60, 1280
  s_lshl_b32 s59, s13, 6
  s_add_u32 s58, s58, s59
  buffer_load_ushort v120, v3, s[20:23], 0 offen offset:0
  buffer_load_ushort v121, v3, s[20:23], 0 offen offset:32
  buffer_load_ushort v122, v3, s[20:23], 0 offen offset:64
  buffer_load_ushort v123, v3, s[20:23], 0 offen offset:96
  buffer_load_ushort v124, v3, s[20:23], 0 offen offset:128
  buffer_load_ushort v125, v3, s[20:23], 0 offen offset:160
  buffer_load_ushort v126, v3, s[20:23], 0 offen offset:192
  buffer_load_ushort v127, v3, s[20:23], 0 offen offset:224
  buffer_load_ushort v128, v3, s[20:23], 0 offen offset:256
  buffer_load_ushort v129, v3, s[20:23], 0 offen offset:288
  buffer_load_dwordx4 v[80:83], v2, s[24:27], s58 offen
  s_add_u32 s58, s58, 122880
  s_waitcnt vmcnt(3)
  buffer_load_dwordx4 v[84:87], v2, s[24:27], s58 offen
  s_add_u32 s58, s58, 122880
  s_waitcnt vmcnt(3)
  buffer_load_dwordx4 v[88:91], v2, s[24:27], s58 offen
  s_add_u32 s58, s58, 122880
  s_waitcnt vmcnt(3)
  buffer_load_dwordx4 v[92:95], v2, s[24:27], s58 offen
  s_add_u32 s58, s58, 122880
  s_waitcnt vmcnt(3)
  buffer_load_dwordx4 v[96:99], v2, s[24:27], s58 offen
  s_add_u32 s58, s58, 122880
  s_waitcnt vmcnt(3)
  buffer_load_dwordx4 v[100:103], v2, s[24:27], s58 offen
  s_add_u32 s58, s58, 122880
  s_waitcnt vmcnt(3)
  buffer_load_dwordx4 v[104:107], v2, s[24:27], s58 offen
  s_add_u32 s58, s58, 122880
  s_waitcnt vmcnt(3)
  buffer_load_dwordx4 v[108:111], v2, s[24:27], s58 offen
  s_add_u32 s58, s58, 122880
  s_waitcnt vmcnt(3)
  buffer_load_dwordx4 v[112:115], v2, s[24:27], s58 offen
  s_add_u32 s58, s58, 122880
  s_waitcnt vmcnt(3)
  buffer_load_dwordx4 v[116:119], v2, s[24:27], s58 offen
  s_add_u32 s58, s58, 122880
  s_waitcnt vmcnt(3)
  v_lshlrev_b32 v120, 16, v120
  v_mul_f32 v24, 0xbfb8aa3b, v120
  v_exp_f32 v24, v24
  s_nop 0
  v_add_f32 v24, 1.0, v24
  v_rcp_f32 v24, v24
  s_nop 0
  v_mul_f32 v120, v120, v24
  v_cvt_pk_bf16_f32 v120, v120, v120
  v_and_b32 v120, 0xffff0000, v120
  v_lshlrev_b32 v121, 16, v121
  v_mul_f32 v24, 0xbfb8aa3b, v121
  v_exp_f32 v24, v24
  s_nop 0
  v_add_f32 v24, 1.0, v24
  v_rcp_f32 v24, v24
  s_nop 0
  v_mul_f32 v121, v121, v24
  v_cvt_pk_bf16_f32 v121, v121, v121
  v_and_b32 v121, 0xffff0000, v121
  v_lshlrev_b32 v122, 16, v122
  v_mul_f32 v24, 0xbfb8aa3b, v122
  v_exp_f32 v24, v24
  s_nop 0
  v_add_f32 v24, 1.0, v24
  v_rcp_f32 v24, v24
  s_nop 0
  v_mul_f32 v122, v122, v24
  v_cvt_pk_bf16_f32 v122, v122, v122
  v_and_b32 v122, 0xffff0000, v122
  v_lshlrev_b32 v123, 16, v123
  v_mul_f32 v24, 0xbfb8aa3b, v123
  v_exp_f32 v24, v24
  s_nop 0
  v_add_f32 v24, 1.0, v24
  v_rcp_f32 v24, v24
  s_nop 0
  v_mul_f32 v123, v123, v24
  v_cvt_pk_bf16_f32 v123, v123, v123
  v_and_b32 v123, 0xffff0000, v123
  v_lshlrev_b32 v124, 16, v124
  v_mul_f32 v24, 0xbfb8aa3b, v124
  v_exp_f32 v24, v24
  s_nop 0
  v_add_f32 v24, 1.0, v24
  v_rcp_f32 v24, v24
  s_nop 0
  v_mul_f32_e64 v124, v124, v24
  v_cvt_pk_bf16_f32 v124, v124, v124
  v_and_b32 v124, 0xffff0000, v124
  v_lshlrev_b32 v125, 16, v125
  v_mul_f32 v24, 0xbfb8aa3b, v125
  v_exp_f32 v24, v24
  s_nop 0
  v_add_f32 v24, 1.0, v24
  v_rcp_f32 v24, v24
  s_nop 0
  v_mul_f32 v125, v125, v24
  v_cvt_pk_bf16_f32 v125, v125, v125
  v_and_b32 v125, 0xffff0000, v125
  v_lshlrev_b32 v126, 16, v126
  v_mul_f32 v24, 0xbfb8aa3b, v126
  v_exp_f32 v24, v24
  s_nop 0
  v_add_f32 v24, 1.0, v24
  v_rcp_f32 v24, v24
  s_nop 0
  v_mul_f32 v126, v126, v24
  v_cvt_pk_bf16_f32 v126, v126, v126
  v_and_b32 v126, 0xffff0000, v126
  v_lshlrev_b32 v127, 16, v127
  v_mul_f32 v24, 0xbfb8aa3b, v127
  v_exp_f32 v24, v24
  s_nop 0
  v_add_f32 v24, 1.0, v24
  v_rcp_f32 v24, v24
  s_nop 0
  v_mul_f32_e64 v127, v127, v24
  v_cvt_pk_bf16_f32 v127, v127, v127
  v_and_b32 v127, 0xffff0000, v127
  v_lshlrev_b32 v128, 16, v128
  v_mul_f32 v24, 0xbfb8aa3b, v128
  v_exp_f32 v24, v24
  s_nop 0
  v_add_f32 v24, 1.0, v24
  v_rcp_f32 v24, v24
  s_nop 0
  v_mul_f32 v128, v128, v24
  v_cvt_pk_bf16_f32 v128, v128, v128
  v_and_b32 v128, 0xffff0000, v128
  v_lshlrev_b32 v129, 16, v129
  v_mul_f32 v24, 0xbfb8aa3b, v129
  v_exp_f32 v24, v24
  s_nop 0
  v_add_f32 v24, 1.0, v24
  v_rcp_f32 v24, v24
  s_nop 0
  v_mul_f32 v129, v129, v24
  v_cvt_pk_bf16_f32 v129, v129, v129
  v_and_b32 v129, 0xffff0000, v129
  v_lshlrev_b32 v24, 16, v80
  v_and_b32 v25, 0xffff0000, v80
  v_mul_f32 v16, v24, v120
  v_mul_f32 v17, v25, v120
  v_lshlrev_b32 v24, 16, v81
  v_and_b32 v25, 0xffff0000, v81
  v_mul_f32 v18, v24, v120
  v_mul_f32 v19, v25, v120
  v_lshlrev_b32_e64 v24, 16, v82
  v_and_b32 v25, 0xffff0000, v82
  v_mul_f32 v20, v24, v120
  v_mul_f32 v21, v25, v120
  v_lshlrev_b32 v24, 16, v83
  v_and_b32 v25, 0xffff0000, v83
  v_mul_f32 v22, v24, v120
  v_mul_f32 v23, v25, v120
  v_lshlrev_b32 v24, 16, v84
  v_and_b32 v25, 0xffff0000, v84
  v_fmac_f32 v16, v24, v121
  v_fmac_f32 v17, v25, v121
  v_lshlrev_b32_e64 v24, 16, v85
  v_and_b32 v25, 0xffff0000, v85
  v_fmac_f32 v18, v24, v121
  v_fmac_f32 v19, v25, v121
  v_lshlrev_b32 v24, 16, v86
  v_and_b32 v25, 0xffff0000, v86
  v_fmac_f32 v20, v24, v121
  v_fmac_f32 v21, v25, v121
  v_lshlrev_b32 v24, 16, v87
  v_and_b32 v25, 0xffff0000, v87
  v_fmac_f32 v22, v24, v121
  v_fmac_f32 v23, v25, v121
  v_lshlrev_b32_e64 v24, 16, v88
  v_and_b32 v25, 0xffff0000, v88
  v_fmac_f32 v16, v24, v122
  v_fmac_f32 v17, v25, v122
  v_lshlrev_b32 v24, 16, v89
  v_and_b32 v25, 0xffff0000, v89
  v_fmac_f32 v18, v24, v122
  v_fmac_f32 v19, v25, v122
  v_lshlrev_b32 v24, 16, v90
  v_and_b32 v25, 0xffff0000, v90
  v_fmac_f32 v20, v24, v122
  v_fmac_f32 v21, v25, v122
  v_lshlrev_b32_e64 v24, 16, v91
  v_and_b32 v25, 0xffff0000, v91
  v_fmac_f32 v22, v24, v122
  v_fmac_f32 v23, v25, v122
  v_lshlrev_b32 v24, 16, v92
  v_and_b32 v25, 0xffff0000, v92
  v_fmac_f32 v16, v24, v123
  v_fmac_f32 v17, v25, v123
  v_lshlrev_b32 v24, 16, v93
  v_and_b32 v25, 0xffff0000, v93
  v_fmac_f32 v18, v24, v123
  v_fmac_f32 v19, v25, v123
  v_lshlrev_b32_e64 v24, 16, v94
  v_and_b32 v25, 0xffff0000, v94
  v_fmac_f32 v20, v24, v123
  v_fmac_f32 v21, v25, v123
  v_lshlrev_b32 v24, 16, v95
  v_and_b32 v25, 0xffff0000, v95
  v_fmac_f32 v22, v24, v123
  v_fmac_f32 v23, v25, v123
  v_lshlrev_b32 v24, 16, v96
  v_and_b32 v25, 0xffff0000, v96
  v_fmac_f32 v16, v24, v124
  v_fmac_f32 v17, v25, v124
  v_lshlrev_b32_e64 v24, 16, v97
  v_and_b32 v25, 0xffff0000, v97
  v_fmac_f32 v18, v24, v124
  v_fmac_f32 v19, v25, v124
  v_lshlrev_b32 v24, 16, v98
  v_and_b32 v25, 0xffff0000, v98
  v_fmac_f32 v20, v24, v124
  v_fmac_f32 v21, v25, v124
  v_lshlrev_b32 v24, 16, v99
  v_and_b32 v25, 0xffff0000, v99
  v_fmac_f32 v22, v24, v124
  v_fmac_f32 v23, v25, v124
  v_lshlrev_b32_e64 v24, 16, v100
  v_and_b32 v25, 0xffff0000, v100
  v_fmac_f32 v16, v24, v125
  v_fmac_f32 v17, v25, v125
  v_lshlrev_b32 v24, 16, v101
  v_and_b32 v25, 0xffff0000, v101
  v_fmac_f32 v18, v24, v125
  v_fmac_f32 v19, v25, v125
  v_lshlrev_b32 v24, 16, v102
  v_and_b32 v25, 0xffff0000, v102
  v_fmac_f32 v20, v24, v125
  v_fmac_f32 v21, v25, v125
  v_lshlrev_b32_e64 v24, 16, v103
  v_and_b32 v25, 0xffff0000, v103
  v_fmac_f32 v22, v24, v125
  v_fmac_f32 v23, v25, v125
  v_lshlrev_b32 v24, 16, v104
  v_and_b32 v25, 0xffff0000, v104
  v_fmac_f32 v16, v24, v126
  v_fmac_f32 v17, v25, v126
  v_lshlrev_b32 v24, 16, v105
  v_and_b32 v25, 0xffff0000, v105
  v_fmac_f32 v18, v24, v126
  v_fmac_f32 v19, v25, v126
  v_lshlrev_b32_e64 v24, 16, v106
  v_and_b32 v25, 0xffff0000, v106
  v_fmac_f32 v20, v24, v126
  v_fmac_f32 v21, v25, v126
  v_lshlrev_b32 v24, 16, v107
  v_and_b32 v25, 0xffff0000, v107
  v_fmac_f32 v22, v24, v126
  v_fmac_f32 v23, v25, v126
  s_waitcnt vmcnt(2)
  v_lshlrev_b32 v24, 16, v108
  v_and_b32 v25, 0xffff0000, v108
  v_fmac_f32 v16, v24, v127
  v_fmac_f32 v17, v25, v127
  v_lshlrev_b32 v24, 16, v109
  v_and_b32 v25, 0xffff0000, v109
  v_fmac_f32 v18, v24, v127
  v_fmac_f32 v19, v25, v127
  v_lshlrev_b32 v24, 16, v110
  v_and_b32 v25, 0xffff0000, v110
  v_fmac_f32 v20, v24, v127
  v_fmac_f32 v21, v25, v127
  v_lshlrev_b32 v24, 16, v111
  v_and_b32 v25, 0xffff0000, v111
  v_fmac_f32 v22, v24, v127
  v_fmac_f32 v23, v25, v127
  s_waitcnt vmcnt(1)
  v_lshlrev_b32 v24, 16, v112
  v_and_b32 v25, 0xffff0000, v112
  v_fmac_f32 v16, v24, v128
  v_fmac_f32 v17, v25, v128
  v_lshlrev_b32 v24, 16, v113
  v_and_b32 v25, 0xffff0000, v113
  v_fmac_f32 v18, v24, v128
  v_fmac_f32 v19, v25, v128
  v_lshlrev_b32 v24, 16, v114
  v_and_b32 v25, 0xffff0000, v114
  v_fmac_f32 v20, v24, v128
  v_fmac_f32 v21, v25, v128
  v_lshlrev_b32_e64 v24, 16, v115
  v_and_b32 v25, 0xffff0000, v115
  v_fmac_f32 v22, v24, v128
  v_fmac_f32 v23, v25, v128
  s_waitcnt vmcnt(0)
  v_lshlrev_b32 v24, 16, v116
  v_and_b32 v25, 0xffff0000, v116
  v_fmac_f32 v16, v24, v129
  v_fmac_f32 v17, v25, v129
  v_lshlrev_b32 v24, 16, v117
  v_and_b32 v25, 0xffff0000, v117
  v_fmac_f32 v18, v24, v129
  v_fmac_f32 v19, v25, v129
  v_lshlrev_b32 v24, 16, v118
  v_and_b32 v25, 0xffff0000, v118
  v_fmac_f32 v20, v24, v129
  v_fmac_f32 v21, v25, v129
  v_lshlrev_b32 v24, 16, v119
  v_and_b32 v25, 0xffff0000, v119
  v_fmac_f32 v22, v24, v129
  v_fmac_f32_e64 v23, v25, v129
  v_add_f32_dpp v16, v16, v16 row_ror:4 row_mask:0xf bank_mask:0xf
  v_add_f32_dpp v17, v17, v17 row_ror:4 row_mask:0xf bank_mask:0xf
  v_add_f32_dpp v18, v18, v18 row_ror:4 row_mask:0xf bank_mask:0xf
  v_add_f32_dpp v19, v19, v19 row_ror:4 row_mask:0xf bank_mask:0xf
  v_add_f32_dpp v20, v20, v20 row_ror:4 row_mask:0xf bank_mask:0xf
  v_add_f32_dpp v21, v21, v21 row_ror:4 row_mask:0xf bank_mask:0xf
  v_add_f32_dpp v22, v22, v22 row_ror:4 row_mask:0xf bank_mask:0xf
  v_add_f32_dpp v23, v23, v23 row_ror:4 row_mask:0xf bank_mask:0xf
  v_add_f32_dpp v16, v16, v16 row_ror:8 row_mask:0xf bank_mask:0xf
  v_add_f32_dpp v17, v17, v17 row_ror:8 row_mask:0xf bank_mask:0xf
  v_add_f32_dpp v18, v18, v18 row_ror:8 row_mask:0xf bank_mask:0xf
  v_add_f32_dpp v19, v19, v19 row_ror:8 row_mask:0xf bank_mask:0xf
  v_add_f32_dpp v20, v20, v20 row_ror:8 row_mask:0xf bank_mask:0xf
  v_add_f32_dpp v21, v21, v21 row_ror:8 row_mask:0xf bank_mask:0xf
  v_add_f32_dpp v22, v22, v22 row_ror:8 row_mask:0xf bank_mask:0xf
  v_add_f32_dpp v23, v23, v23 row_ror:8 row_mask:0xf bank_mask:0xf
  v_mov_b32 v24, v16
  s_nop 1
  v_permlane16_swap_b32 v16, v24
  v_add_f32 v16, v16, v24
  v_mov_b32 v24, v16
  s_nop 1
  v_permlane32_swap_b32 v16, v24
  v_add_f32 v16, v16, v24
  v_mov_b32 v24, v17
  s_nop 1
  v_permlane16_swap_b32 v17, v24
  v_add_f32 v17, v17, v24
  v_mov_b32 v24, v17
  s_nop 1
  v_permlane32_swap_b32 v17, v24
  v_add_f32 v17, v17, v24
  v_mov_b32 v24, v18
  s_nop 1
  v_permlane16_swap_b32 v18, v24
  v_add_f32 v18, v18, v24
  v_mov_b32 v24, v18
  s_nop 1
  v_permlane32_swap_b32 v18, v24
  v_add_f32 v18, v18, v24
  v_mov_b32 v24, v19
  s_nop 1
  v_permlane16_swap_b32 v19, v24
  v_add_f32 v19, v19, v24
  v_mov_b32 v24, v19
  s_nop 1
  v_permlane32_swap_b32 v19, v24
  v_add_f32 v19, v19, v24
  v_mov_b32 v24, v20
  s_nop 1
  v_permlane16_swap_b32 v20, v24
  v_add_f32 v20, v20, v24
  v_mov_b32 v24, v20
  s_nop 1
  v_permlane32_swap_b32 v20, v24
  v_add_f32 v20, v20, v24
  v_mov_b32 v24, v21
  s_nop 0
  s_nop 0
  v_permlane16_swap_b32 v21, v24
  v_add_f32 v21, v21, v24
  v_mov_b32 v24, v21
  s_nop 1
  v_permlane32_swap_b32 v21, v24
  v_add_f32 v21, v21, v24
  v_mov_b32 v24, v22
  s_nop 0
  s_nop 0
  v_permlane16_swap_b32 v22, v24
  v_add_f32 v22, v22, v24
  v_mov_b32 v24, v22
  s_nop 0
  s_nop 0
  v_permlane32_swap_b32 v22, v24
  v_add_f32 v22, v22, v24
  v_mov_b32 v24, v23
  s_nop 0
  s_nop 0
  v_permlane16_swap_b32 v23, v24
  v_add_f32 v23, v23, v24
  v_mov_b32 v24, v23
  s_nop 0
  s_nop 0
  v_permlane32_swap_b32 v23, v24
  v_add_f32 v23, v23, v24
  s_lshl_b32 s58, s12, 7
  v_lshlrev_b32 v2, 5, v0
  v_add_u32 v2, s58, v2
  s_mov_b64 exec, 15
  ds_write_b128 v2, v[16:19]
  ds_write_b128 v2, v[20:23] offset:16
  s_mov_b64 exec, -1
  s_waitcnt lgkmcnt(0)
  s_barrier
  v_and_b32 v2, 15, v0
  v_lshlrev_b32 v2, 3, v2
  ds_read_b64 v[16:17], v2 offset:0
  ds_read_b64 v[18:19], v2 offset:128
  ds_read_b64 v[20:21], v2 offset:256
  ds_read_b64 v[22:23], v2 offset:384
  s_waitcnt lgkmcnt(2)
  v_pk_add_f32 v[16:17], v[16:17], v[18:19]
  s_waitcnt lgkmcnt(0)
  v_pk_add_f32 v[20:21], v[20:21], v[22:23]
  v_pk_add_f32 v[16:17], v[16:17], v[20:21]
  v_cvt_pk_bf16_f32 v16, v16, v17
  v_min_u32 v16, -2, v16
  s_cmp_lg_u32 s12, 0
  s_cbranch_scc1 L_mst_20
  s_mul_i32 s58, s60, 1280
  s_lshl_b32 s59, s13, 6
  s_add_u32 s58, s58, s59
  s_add_u32 s58, s58, 16384
  v_lshlrev_b32 v2, 2, v0
  s_mov_b64 exec, 0xffff
  buffer_store_dword v16, v2, s[4:7], s58 offen sc1
  s_mov_b64 exec, -1
L_mst_20:
L_w_post:
  v_and_b32 v16, 15, v0
  v_lshrrev_b32_e64 v17, 4, v0
  s_mul_i32 s58, s12, 320
  v_lshrrev_b32 v18, 1, v17
  v_and_b32 v19, 1, v17
  v_lshl_add_u32 v18, v18, 2, v19
  v_mul_u32_u24 v18, 5120, v18
  s_mul_i32 s59, s13, 163840
  s_add_u32 s59, s59, s58
  v_add_u32 v18, s59, v18
  v_lshl_add_u32 v2, v16, 4, v18
  v_lshl_add_u32 v3, v16, 2, v18
  v_mul_u32_u24 v18, 20480, v17
  s_mul_i32 s59, s13, 81920
  s_add_u32 s59, s59, s58
  v_add_u32 v18, s59, v18
  v_lshl_add_u32 v4, v16, 4, v18
  v_lshl_add_u32 v5, v16, 2, v18
  v_mul_u32_u24 v18, 27648, v17
  s_lshl_b32 s59, s13, 7
  v_add_u32 v18, s59, v18
  v_lshl_add_u32 v6, v16, 3, v18
  s_mul_i32 s58, s12, 20480
  s_add_u32 s58, s58, 40960
  v_add_u32 v14, s58, v1
  s_mul_i32 s58, s12, 552960
  v_add_u32 v9, s58, v6
  s_mul_i32 s58, s12, 110592
  v_add_u32 v6, s58, v6
  s_lshl_b32 s58, s12, 11
  v_add_u32 v7, s58, v1
  s_lshl_b32 s58, s12, 13
  v_add_u32 v8, s58, v1
  s_cmp_lt_u32 s13, 27
  s_cbranch_scc1 L_p_wall
  s_mov_b32 s58, 0
  buffer_load_dwordx4 v[32:35], v2, s[32:35], s58 offen
  buffer_load_dword v64, v3, s[32:35], s58 offen offset:256
  s_waitcnt vmcnt(4)
  s_mov_b32 s58, 1280
  buffer_load_dwordx4 v[36:39], v2, s[32:35], s58 offen
  buffer_load_dword v65, v3, s[32:35], s58 offen offset:256
  s_waitcnt vmcnt(4)
  s_mov_b32 s58, 2560
  buffer_load_dwordx4 v[40:43], v2, s[32:35], s58 offen
  buffer_load_dword v66, v3, s[32:35], s58 offen offset:256
  s_waitcnt vmcnt(4)
  s_mov_b32 s58, 3840
  buffer_load_dwordx4 v[44:47], v2, s[32:35], s58 offen
  buffer_load_dword v67, v3, s[32:35], s58 offen offset:256
  s_waitcnt vmcnt(4)
  s_mov_b32 s58, 10240
  buffer_load_dwordx4 v[48:51], v2, s[32:35], s58 offen
  buffer_load_dword v68, v3, s[32:35], s58 offen offset:256
  s_waitcnt vmcnt(4)
  s_mov_b32 s58, 11520
  buffer_load_dwordx4 v[52:55], v2, s[32:35], s58 offen
  buffer_load_dword v69, v3, s[32:35], s58 offen offset:256
  s_waitcnt vmcnt(4)
  s_mov_b32 s58, 12800
  buffer_load_dwordx4 v[56:59], v2, s[32:35], s58 offen
  buffer_load_dword v70, v3, s[32:35], s58 offen offset:256
  s_waitcnt vmcnt(4)
  s_mov_b32 s58, 14080
  buffer_load_dwordx4 v[60:63], v2, s[32:35], s58 offen
  buffer_load_dword v71, v3, s[32:35], s58 offen offset:256
  s_waitcnt vmcnt(4)
  s_mov_b32 s58, 40960
  buffer_load_dwordx4 v[72:75], v2, s[32:35], s58 offen
  buffer_load_dword v104, v3, s[32:35], s58 offen offset:256
  s_waitcnt vmcnt(4)
  s_mov_b32 s58, 42240
  buffer_load_dwordx4 v[76:79], v2, s[32:35], s58 offen
  buffer_load_dword v105, v3, s[32:35], s58 offen offset:256
  s_waitcnt vmcnt(4)
  s_mov_b32 s58, 43520
  buffer_load_dwordx4 v[80:83], v2, s[32:35], s58 offen
  buffer_load_dword v106, v3, s[32:35], s58 offen offset:256
  s_waitcnt vmcnt(4)
  s_mov_b32 s58, 44800
  buffer_load_dwordx4 v[84:87], v2, s[32:35], s58 offen
  buffer_load_dword v107, v3, s[32:35], s58 offen offset:256
  s_waitcnt vmcnt(4)
  s_mov_b32 s58, 51200
  buffer_load_dwordx4 v[88:91], v2, s[32:35], s58 offen
  buffer_load_dword v108, v3, s[32:35], s58 offen offset:256
  s_waitcnt vmcnt(4)
  s_mov_b32 s58, 52480
  buffer_load_dwordx4 v[92:95], v2, s[32:35], s58 offen
  buffer_load_dword v109, v3, s[32:35], s58 offen offset:256
  s_waitcnt vmcnt(4)
  s_mov_b32 s58, 53760
  buffer_load_dwordx4 v[96:99], v2, s[32:35], s58 offen
  buffer_load_dword v110, v3, s[32:35], s58 offen offset:256
  s_waitcnt vmcnt(4)
  s_mov_b32 s58, 55040
  buffer_load_dwordx4 v[100:103], v2, s[32:35], s58 offen
  buffer_load_dword v111, v3, s[32:35], s58 offen offset:256
  s_waitcnt vmcnt(4)
  s_mov_b32 s58, 81920
  buffer_load_dwordx4 v[112:115], v2, s[32:35], s58 offen
  buffer_load_dword v144, v3, s[32:35], s58 offen offset:256
  s_waitcnt vmcnt(4)
  s_mov_b32 s58, 83200
  buffer_load_dwordx4 v[116:119], v2, s[32:35], s58 offen
  buffer_load_dword v145, v3, s[32:35], s58 offen offset:256
  s_waitcnt vmcnt(4)
  s_mov_b32 s58, 84480
  buffer_load_dwordx4 v[120:123], v2, s[32:35], s58 offen
  buffer_load_dword v146, v3, s[32:35], s58 offen offset:256
  s_waitcnt vmcnt(4)
  s_mov_b32 s58, 85760
  buffer_load_dwordx4 v[124:127], v2, s[32:35], s58 offen
  buffer_load_dword v147, v3, s[32:35], s58 offen offset:256
  s_waitcnt vmcnt(4)
  s_mov_b32 s58, 92160
  buffer_load_dwordx4 v[128:131], v2, s[32:35], s58 offen
  buffer_load_dword v148, v3, s[32:35], s58 offen offset:256
  s_waitcnt vmcnt(4)
  s_mov_b32 s58, 93440
  buffer_load_dwordx4 v[132:135], v2, s[32:35], s58 offen
  buffer_load_dword v149, v3, s[32:35], s58 offen offset:256
  s_waitcnt vmcnt(4)
  s_mov_b32 s58, 94720
  buffer_load_dwordx4 v[136:139], v2, s[32:35], s58 offen
  buffer_load_dword v150, v3, s[32:35], s58 offen offset:256
  s_waitcnt vmcnt(4)
  s_mov_b32 s58, 96000
  buffer_load_dwordx4 v[140:143], v2, s[32:35], s58 offen
  buffer_load_dword v151, v3, s[32:35], s58 offen offset:256
  s_waitcnt vmcnt(4)
  s_mov_b32 s58, 122880
  buffer_load_dwordx4 v[152:155], v2, s[32:35], s58 offen
  buffer_load_dword v184, v3, s[32:35], s58 offen offset:256
  s_waitcnt vmcnt(4)
  s_mov_b32 s58, 124160
  buffer_load_dwordx4 v[156:159], v2, s[32:35], s58 offen
  buffer_load_dword v185, v3, s[32:35], s58 offen offset:256
  s_waitcnt vmcnt(4)
  s_mov_b32 s58, 125440
  buffer_load_dwordx4 v[160:163], v2, s[32:35], s58 offen
  buffer_load_dword v186, v3, s[32:35], s58 offen offset:256
  s_waitcnt vmcnt(4)
  s_mov_b32 s58, 126720
  buffer_load_dwordx4 v[164:167], v2, s[32:35], s58 offen
  buffer_load_dword v187, v3, s[32:35], s58 offen offset:256
  s_waitcnt vmcnt(4)
  s_mov_b32 s58, 133120
  buffer_load_dwordx4 v[168:171], v2, s[32:35], s58 offen
  buffer_load_dword v188, v3, s[32:35], s58 offen offset:256
  s_waitcnt vmcnt(4)
  s_mov_b32 s58, 134400
  buffer_load_dwordx4 v[172:175], v2, s[32:35], s58 offen
  buffer_load_dword v189, v3, s[32:35], s58 offen offset:256
  s_waitcnt vmcnt(4)
  s_mov_b32 s58, 135680
  buffer_load_dwordx4 v[176:179], v2, s[32:35], s58 offen
  buffer_load_dword v190, v3, s[32:35], s58 offen offset:256
  s_waitcnt vmcnt(4)
  s_mov_b32 s58, 136960
  buffer_load_dwordx4 v[180:183], v2, s[32:35], s58 offen
  buffer_load_dword v191, v3, s[32:35], s58 offen offset:256
  s_waitcnt vmcnt(4)
  v_perm_b32 v16, v36, v32, s56
  v_accvgpr_write_b32 a0, v16
  v_perm_b32 v17, v44, v40, s56
  v_accvgpr_write_b32 a1, v17
  v_perm_b32 v18, v52, v48, s56
  v_accvgpr_write_b32 a2, v18
  v_perm_b32 v19, v60, v56, s56
  v_accvgpr_write_b32 a3, v19
  v_perm_b32 v16, v36, v32, s57
  v_accvgpr_write_b32 a16, v16
  v_perm_b32 v17, v44, v40, s57
  v_accvgpr_write_b32 a17, v17
  v_perm_b32 v18, v52, v48, s57
  v_accvgpr_write_b32 a18, v18
  v_perm_b32 v19, v60, v56, s57
  v_accvgpr_write_b32 a19, v19
  v_perm_b32 v16, v37, v33, s56
  v_accvgpr_write_b32 a32, v16
  v_perm_b32 v17, v45, v41, s56
  v_accvgpr_write_b32 a33, v17
  v_perm_b32 v18, v53, v49, s56
  v_accvgpr_write_b32 a34, v18
  v_perm_b32 v19, v61, v57, s56
  v_accvgpr_write_b32 a35, v19
  v_perm_b32 v16, v37, v33, s57
  v_accvgpr_write_b32 a48, v16
  v_perm_b32 v17, v45, v41, s57
  v_accvgpr_write_b32 a49, v17
  v_perm_b32 v18, v53, v49, s57
  v_accvgpr_write_b32 a50, v18
  v_perm_b32 v19, v61, v57, s57
  v_accvgpr_write_b32 a51, v19
  v_perm_b32 v16, v38, v34, s56
  v_accvgpr_write_b32 a64, v16
  v_perm_b32 v17, v46, v42, s56
  v_accvgpr_write_b32 a65, v17
  v_perm_b32 v18, v54, v50, s56
  v_accvgpr_write_b32 a66, v18
  v_perm_b32 v19, v62, v58, s56
  v_accvgpr_write_b32 a67, v19
  v_perm_b32 v16, v38, v34, s57
  v_accvgpr_write_b32 a80, v16
  v_perm_b32 v17, v46, v42, s57
  v_accvgpr_write_b32 a81, v17
  v_perm_b32 v18, v54, v50, s57
  v_accvgpr_write_b32 a82, v18
  v_perm_b32 v19, v62, v58, s57
  v_accvgpr_write_b32 a83, v19
  v_perm_b32 v16, v39, v35, s56
  v_accvgpr_write_b32 a96, v16
  v_perm_b32 v17, v47, v43, s56
  v_accvgpr_write_b32 a97, v17
  v_perm_b32 v18, v55, v51, s56
  v_accvgpr_write_b32 a98, v18
  v_perm_b32 v19, v63, v59, s56
  v_accvgpr_write_b32 a99, v19
  v_perm_b32 v16, v39, v35, s57
  v_accvgpr_write_b32 a112, v16
  v_perm_b32 v17, v47, v43, s57
  v_accvgpr_write_b32 a113, v17
  v_perm_b32 v18, v55, v51, s57
  v_accvgpr_write_b32 a114, v18
  v_perm_b32 v19, v63, v59, s57
  v_accvgpr_write_b32 a115, v19
  v_perm_b32 v16, v65, v64, s56
  v_accvgpr_write_b32 a128, v16
  v_perm_b32 v17, v67, v66, s56
  v_accvgpr_write_b32 a129, v17
  v_perm_b32 v18, v69, v68, s56
  v_accvgpr_write_b32 a130, v18
  v_perm_b32 v19, v71, v70, s56
  v_accvgpr_write_b32 a131, v19
  v_perm_b32 v16, v65, v64, s57
  v_accvgpr_write_b32 a144, v16
  v_perm_b32 v17, v67, v66, s57
  v_accvgpr_write_b32 a145, v17
  v_perm_b32 v18, v69, v68, s57
  v_accvgpr_write_b32 a146, v18
  v_perm_b32 v19, v71, v70, s57
  v_accvgpr_write_b32 a147, v19
  v_perm_b32 v16, v76, v72, s56
  v_accvgpr_write_b32 a4, v16
  v_perm_b32 v17, v84, v80, s56
  v_accvgpr_write_b32 a5, v17
  v_perm_b32 v18, v92, v88, s56
  v_accvgpr_write_b32 a6, v18
  v_perm_b32 v19, v100, v96, s56
  v_accvgpr_write_b32 a7, v19
  v_perm_b32 v16, v76, v72, s57
  v_accvgpr_write_b32 a20, v16
  v_perm_b32 v17, v84, v80, s57
  v_accvgpr_write_b32 a21, v17
  v_perm_b32 v18, v92, v88, s57
  v_accvgpr_write_b32 a22, v18
  v_perm_b32 v19, v100, v96, s57
  v_accvgpr_write_b32 a23, v19
  v_perm_b32 v16, v77, v73, s56
  v_accvgpr_write_b32 a36, v16
  v_perm_b32 v17, v85, v81, s56
  v_accvgpr_write_b32 a37, v17
  v_perm_b32 v18, v93, v89, s56
  v_accvgpr_write_b32 a38, v18
  v_perm_b32 v19, v101, v97, s56
  v_accvgpr_write_b32 a39, v19
  v_perm_b32 v16, v77, v73, s57
  v_accvgpr_write_b32 a52, v16
  v_perm_b32 v17, v85, v81, s57
  v_accvgpr_write_b32 a53, v17
  v_perm_b32 v18, v93, v89, s57
  v_accvgpr_write_b32 a54, v18
  v_perm_b32 v19, v101, v97, s57
  v_accvgpr_write_b32 a55, v19
  v_perm_b32 v16, v78, v74, s56
  v_accvgpr_write_b32 a68, v16
  v_perm_b32 v17, v86, v82, s56
  v_accvgpr_write_b32 a69, v17
  v_perm_b32 v18, v94, v90, s56
  v_accvgpr_write_b32 a70, v18
  v_perm_b32 v19, v102, v98, s56
  v_accvgpr_write_b32 a71, v19
  v_perm_b32 v16, v78, v74, s57
  v_accvgpr_write_b32 a84, v16
  v_perm_b32 v17, v86, v82, s57
  v_accvgpr_write_b32 a85, v17
  v_perm_b32 v18, v94, v90, s57
  v_accvgpr_write_b32 a86, v18
  v_perm_b32 v19, v102, v98, s57
  v_accvgpr_write_b32 a87, v19
  v_perm_b32 v16, v79, v75, s56
  v_accvgpr_write_b32 a100, v16
  v_perm_b32 v17, v87, v83, s56
  v_accvgpr_write_b32 a101, v17
  v_perm_b32 v18, v95, v91, s56
  v_accvgpr_write_b32 a102, v18
  v_perm_b32 v19, v103, v99, s56
  v_accvgpr_write_b32 a103, v19
  v_perm_b32 v16, v79, v75, s57
  v_accvgpr_write_b32 a116, v16
  v_perm_b32 v17, v87, v83, s57
  v_accvgpr_write_b32 a117, v17
  v_perm_b32 v18, v95, v91, s57
  v_accvgpr_write_b32 a118, v18
  v_perm_b32 v19, v103, v99, s57
  v_accvgpr_write_b32 a119, v19
  v_perm_b32 v16, v105, v104, s56
  v_accvgpr_write_b32 a132, v16
  v_perm_b32 v17, v107, v106, s56
  v_accvgpr_write_b32 a133, v17
  v_perm_b32 v18, v109, v108, s56
  v_accvgpr_write_b32 a134, v18
  v_perm_b32 v19, v111, v110, s56
  v_accvgpr_write_b32 a135, v19
  v_perm_b32 v16, v105, v104, s57
  v_accvgpr_write_b32 a148, v16
  v_perm_b32 v17, v107, v106, s57
  v_accvgpr_write_b32 a149, v17
  v_perm_b32 v18, v109, v108, s57
  v_accvgpr_write_b32 a150, v18
  v_perm_b32 v19, v111, v110, s57
  v_accvgpr_write_b32 a151, v19
  v_perm_b32 v16, v116, v112, s56
  v_accvgpr_write_b32 a8, v16
  v_perm_b32 v17, v124, v120, s56
  v_accvgpr_write_b32 a9, v17
  v_perm_b32 v18, v132, v128, s56
  v_accvgpr_write_b32 a10, v18
  v_perm_b32 v19, v140, v136, s56
  v_accvgpr_write_b32 a11, v19
  v_perm_b32 v16, v116, v112, s57
  v_accvgpr_write_b32 a24, v16
  v_perm_b32 v17, v124, v120, s57
  v_accvgpr_write_b32 a25, v17
  v_perm_b32 v18, v132, v128, s57
  v_accvgpr_write_b32 a26, v18
  v_perm_b32 v19, v140, v136, s57
  v_accvgpr_write_b32 a27, v19
  v_perm_b32 v16, v117, v113, s56
  v_accvgpr_write_b32 a40, v16
  v_perm_b32 v17, v125, v121, s56
  v_accvgpr_write_b32 a41, v17
  v_perm_b32 v18, v133, v129, s56
  v_accvgpr_write_b32 a42, v18
  v_perm_b32 v19, v141, v137, s56
  v_accvgpr_write_b32 a43, v19
  v_perm_b32 v16, v117, v113, s57
  v_accvgpr_write_b32 a56, v16
  v_perm_b32 v17, v125, v121, s57
  v_accvgpr_write_b32 a57, v17
  v_perm_b32 v18, v133, v129, s57
  v_accvgpr_write_b32 a58, v18
  v_perm_b32 v19, v141, v137, s57
  v_accvgpr_write_b32 a59, v19
  v_perm_b32 v16, v118, v114, s56
  v_accvgpr_write_b32 a72, v16
  v_perm_b32 v17, v126, v122, s56
  v_accvgpr_write_b32 a73, v17
  v_perm_b32 v18, v134, v130, s56
  v_accvgpr_write_b32 a74, v18
  v_perm_b32 v19, v142, v138, s56
  v_accvgpr_write_b32 a75, v19
  v_perm_b32 v16, v118, v114, s57
  v_accvgpr_write_b32 a88, v16
  v_perm_b32 v17, v126, v122, s57
  v_accvgpr_write_b32 a89, v17
  v_perm_b32 v18, v134, v130, s57
  v_accvgpr_write_b32 a90, v18
  v_perm_b32 v19, v142, v138, s57
  v_accvgpr_write_b32 a91, v19
  v_perm_b32 v16, v119, v115, s56
  v_accvgpr_write_b32 a104, v16
  v_perm_b32 v17, v127, v123, s56
  v_accvgpr_write_b32 a105, v17
  v_perm_b32 v18, v135, v131, s56
  v_accvgpr_write_b32 a106, v18
  v_perm_b32 v19, v143, v139, s56
  v_accvgpr_write_b32 a107, v19
  v_perm_b32 v16, v119, v115, s57
  v_accvgpr_write_b32 a120, v16
  v_perm_b32 v17, v127, v123, s57
  v_accvgpr_write_b32 a121, v17
  v_perm_b32 v18, v135, v131, s57
  v_accvgpr_write_b32 a122, v18
  v_perm_b32 v19, v143, v139, s57
  v_accvgpr_write_b32 a123, v19
  v_perm_b32 v16, v145, v144, s56
  v_accvgpr_write_b32 a136, v16
  v_perm_b32 v17, v147, v146, s56
  v_accvgpr_write_b32 a137, v17
  v_perm_b32 v18, v149, v148, s56
  v_accvgpr_write_b32 a138, v18
  v_perm_b32 v19, v151, v150, s56
  v_accvgpr_write_b32 a139, v19
  v_perm_b32 v16, v145, v144, s57
  v_accvgpr_write_b32 a152, v16
  v_perm_b32 v17, v147, v146, s57
  v_accvgpr_write_b32 a153, v17
  v_perm_b32 v18, v149, v148, s57
  v_accvgpr_write_b32 a154, v18
  v_perm_b32 v19, v151, v150, s57
  v_accvgpr_write_b32 a155, v19
  v_perm_b32 v16, v156, v152, s56
  v_accvgpr_write_b32 a12, v16
  v_perm_b32 v17, v164, v160, s56
  v_accvgpr_write_b32 a13, v17
  v_perm_b32 v18, v172, v168, s56
  v_accvgpr_write_b32 a14, v18
  s_waitcnt vmcnt(1)
  v_perm_b32 v19, v180, v176, s56
  v_accvgpr_write_b32 a15, v19
  v_perm_b32 v16, v156, v152, s57
  v_accvgpr_write_b32 a28, v16
  v_perm_b32 v17, v164, v160, s57
  v_accvgpr_write_b32 a29, v17
  v_perm_b32 v18, v172, v168, s57
  v_accvgpr_write_b32 a30, v18
  v_perm_b32 v19, v180, v176, s57
  v_accvgpr_write_b32 a31, v19
  v_perm_b32 v16, v157, v153, s56
  v_accvgpr_write_b32 a44, v16
  v_perm_b32 v17, v165, v161, s56
  v_accvgpr_write_b32 a45, v17
  v_perm_b32 v18, v173, v169, s56
  v_accvgpr_write_b32 a46, v18
  v_perm_b32 v19, v181, v177, s56
  v_accvgpr_write_b32 a47, v19
  v_perm_b32 v16, v157, v153, s57
  v_accvgpr_write_b32 a60, v16
  v_perm_b32 v17, v165, v161, s57
  v_accvgpr_write_b32 a61, v17
  v_perm_b32 v18, v173, v169, s57
  v_accvgpr_write_b32 a62, v18
  v_perm_b32 v19, v181, v177, s57
  v_accvgpr_write_b32 a63, v19
  v_perm_b32 v16, v158, v154, s56
  v_accvgpr_write_b32 a76, v16
  v_perm_b32 v17, v166, v162, s56
  v_accvgpr_write_b32 a77, v17
  v_perm_b32 v18, v174, v170, s56
  v_accvgpr_write_b32 a78, v18
  v_perm_b32 v19, v182, v178, s56
  v_accvgpr_write_b32 a79, v19
  v_perm_b32 v16, v158, v154, s57
  v_accvgpr_write_b32 a92, v16
  v_perm_b32 v17, v166, v162, s57
  v_accvgpr_write_b32 a93, v17
  v_perm_b32 v18, v174, v170, s57
  v_accvgpr_write_b32 a94, v18
  v_perm_b32 v19, v182, v178, s57
  v_accvgpr_write_b32 a95, v19
  v_perm_b32 v16, v159, v155, s56
  v_accvgpr_write_b32 a108, v16
  v_perm_b32 v17, v167, v163, s56
  v_accvgpr_write_b32 a109, v17
  v_perm_b32 v18, v175, v171, s56
  v_accvgpr_write_b32 a110, v18
  v_perm_b32 v19, v183, v179, s56
  v_accvgpr_write_b32 a111, v19
  v_perm_b32 v16, v159, v155, s57
  v_accvgpr_write_b32 a124, v16
  v_perm_b32 v17, v167, v163, s57
  v_accvgpr_write_b32 a125, v17
  v_perm_b32 v18, v175, v171, s57
  v_accvgpr_write_b32 a126, v18
  v_perm_b32 v19, v183, v179, s57
  v_accvgpr_write_b32 a127, v19
  v_perm_b32 v16, v185, v184, s56
  v_accvgpr_write_b32 a140, v16
  v_perm_b32 v17, v187, v186, s56
  v_accvgpr_write_b32 a141, v17
  v_perm_b32 v18, v189, v188, s56
  v_accvgpr_write_b32 a142, v18
  s_waitcnt vmcnt(0)
  v_perm_b32 v19, v191, v190, s56
  v_accvgpr_write_b32 a143, v19
  v_perm_b32 v16, v185, v184, s57
  v_accvgpr_write_b32 a156, v16
  v_perm_b32 v17, v187, v186, s57
  v_accvgpr_write_b32 a157, v17
  v_perm_b32 v18, v189, v188, s57
  v_accvgpr_write_b32 a158, v18
  v_perm_b32 v19, v191, v190, s57
  v_accvgpr_write_b32 a159, v19
  s_branch L_p_now
  s_nop 0
  s_nop 0
  s_nop 0
  s_nop 0
  s_nop 0
  s_nop 0
  s_nop 0
L_p_wall:
  s_mov_b32 s58, 0
  buffer_load_dwordx2 v[32:33], v6, s[36:39], s58 offen
  buffer_load_dwordx2 v[34:35], v6, s[36:39], s58 offen offset:3456
  s_waitcnt vmcnt(4)
  buffer_load_dwordx2 v[48:49], v6, s[40:43], s58 offen
  buffer_load_dwordx2 v[50:51], v6, s[40:43], s58 offen offset:3456
  s_waitcnt vmcnt(4)
  s_mov_b32 s58, 6912
  buffer_load_dwordx2 v[36:37], v6, s[36:39], s58 offen
  buffer_load_dwordx2 v[38:39], v6, s[36:39], s58 offen offset:3456
  s_waitcnt vmcnt(4)
  buffer_load_dwordx2 v[52:53], v6, s[40:43], s58 offen
  buffer_load_dwordx2 v[54:55], v6, s[40:43], s58 offen offset:3456
  s_waitcnt vmcnt(4)
  s_mov_b32 s58, 13824
  buffer_load_dwordx2 v[40:41], v6, s[36:39], s58 offen
  buffer_load_dwordx2 v[42:43], v6, s[36:39], s58 offen offset:3456
  s_waitcnt vmcnt(4)
  buffer_load_dwordx2 v[56:57], v6, s[40:43], s58 offen
  buffer_load_dwordx2 v[58:59], v6, s[40:43], s58 offen offset:3456
  s_waitcnt vmcnt(4)
  s_mov_b32 s58, 20736
  buffer_load_dwordx2 v[44:45], v6, s[36:39], s58 offen
  buffer_load_dwordx2 v[46:47], v6, s[36:39], s58 offen offset:3456
  s_waitcnt vmcnt(4)
  buffer_load_dwordx2 v[60:61], v6, s[40:43], s58 offen
  buffer_load_dwordx2 v[62:63], v6, s[40:43], s58 offen offset:3456
  s_waitcnt vmcnt(4)
  s_mov_b32 s58, 0
  buffer_load_dwordx4 v[72:75], v2, s[32:35], s58 offen
  buffer_load_dword v104, v3, s[32:35], s58 offen offset:256
  s_waitcnt vmcnt(4)
  s_mov_b32 s58, 1280
  buffer_load_dwordx4 v[76:79], v2, s[32:35], s58 offen
  buffer_load_dword v105, v3, s[32:35], s58 offen offset:256
  s_waitcnt vmcnt(4)
  s_mov_b32 s58, 2560
  buffer_load_dwordx4 v[80:83], v2, s[32:35], s58 offen
  buffer_load_dword v106, v3, s[32:35], s58 offen offset:256
  s_waitcnt vmcnt(4)
  s_mov_b32 s58, 3840
  buffer_load_dwordx4 v[84:87], v2, s[32:35], s58 offen
  buffer_load_dword v107, v3, s[32:35], s58 offen offset:256
  s_waitcnt vmcnt(4)
  s_mov_b32 s58, 10240
  buffer_load_dwordx4 v[88:91], v2, s[32:35], s58 offen
  buffer_load_dword v108, v3, s[32:35], s58 offen offset:256
  s_waitcnt vmcnt(4)
  s_mov_b32 s58, 11520
  buffer_load_dwordx4 v[92:95], v2, s[32:35], s58 offen
  buffer_load_dword v109, v3, s[32:35], s58 offen offset:256
  s_waitcnt vmcnt(4)
  s_mov_b32 s58, 12800
  buffer_load_dwordx4 v[96:99], v2, s[32:35], s58 offen
  buffer_load_dword v110, v3, s[32:35], s58 offen offset:256
  s_waitcnt vmcnt(4)
  s_mov_b32 s58, 14080
  buffer_load_dwordx4 v[100:103], v2, s[32:35], s58 offen
  buffer_load_dword v111, v3, s[32:35], s58 offen offset:256
  s_waitcnt vmcnt(4)
  v_perm_b32 v16, v34, v32, s56
  v_perm_b32 v17, v38, v36, s56
  v_perm_b32 v18, v42, v40, s56
  v_perm_b32 v19, v46, v44, s56
  v_perm_b32 v20, v34, v32, s57
  v_perm_b32 v21, v38, v36, s57
  v_perm_b32 v22, v42, v40, s57
  v_perm_b32 v23, v46, v44, s57
  v_perm_b32 v24, v35, v33, s56
  v_perm_b32 v25, v39, v37, s56
  v_perm_b32 v26, v43, v41, s56
  v_perm_b32 v27, v47, v45, s56
  v_perm_b32 v28, v35, v33, s57
  v_perm_b32 v29, v39, v37, s57
  v_perm_b32 v30, v43, v41, s57
  v_perm_b32 v31, v47, v45, s57
  s_barrier
  ds_write_b128 v7, v[16:19] offset:0
  ds_write_b128 v7, v[20:23] offset:8192
  ds_write_b128 v7, v[24:27] offset:16384
  ds_write_b128 v7, v[28:31] offset:24576
  s_waitcnt lgkmcnt(0)
  v_perm_b32 v16, v50, v48, s56
  v_perm_b32 v17, v54, v52, s56
  v_perm_b32 v18, v58, v56, s56
  v_perm_b32 v19, v62, v60, s56
  v_perm_b32 v20, v50, v48, s57
  v_perm_b32 v21, v54, v52, s57
  v_perm_b32 v22, v58, v56, s57
  v_perm_b32 v23, v62, v60, s57
  v_perm_b32 v24, v51, v49, s56
  v_perm_b32 v25, v55, v53, s56
  v_perm_b32 v26, v59, v57, s56
  v_perm_b32 v27, v63, v61, s56
  v_perm_b32 v28, v51, v49, s57
  v_perm_b32 v29, v55, v53, s57
  v_perm_b32 v30, v59, v57, s57
  v_perm_b32 v31, v63, v61, s57
  ds_write_b128 v7, v[16:19] offset:1024
  ds_write_b128 v7, v[20:23] offset:9216
  ds_write_b128 v7, v[24:27] offset:17408
  ds_write_b128 v7, v[28:31] offset:25600
  s_nop 0
  s_waitcnt lgkmcnt(0)
  s_barrier
  ds_read_b128 a[160:163], v8 offset:0
  ds_read_b128 a[164:167], v8 offset:1024
  ds_read_b128 a[168:171], v8 offset:2048
  ds_read_b128 a[172:175], v8 offset:3072
  ds_read_b128 a[176:179], v8 offset:4096
  ds_read_b128 a[180:183], v8 offset:5120
  ds_read_b128 a[184:187], v8 offset:6144
  ds_read_b128 a[188:191], v8 offset:7168
  s_waitcnt lgkmcnt(0)
  s_mov_b32 s58, 552960
  buffer_load_dwordx2 v[32:33], v6, s[36:39], s58 offen
  buffer_load_dwordx2 v[34:35], v6, s[36:39], s58 offen offset:3456
  s_waitcnt vmcnt(4)
  buffer_load_dwordx2 v[48:49], v6, s[40:43], s58 offen
  buffer_load_dwordx2 v[50:51], v6, s[40:43], s58 offen offset:3456
  s_waitcnt vmcnt(4)
  s_mov_b32 s58, 559872
  buffer_load_dwordx2 v[36:37], v6, s[36:39], s58 offen
  buffer_load_dwordx2 v[38:39], v6, s[36:39], s58 offen offset:3456
  s_waitcnt vmcnt(4)
  buffer_load_dwordx2 v[52:53], v6, s[40:43], s58 offen
  buffer_load_dwordx2 v[54:55], v6, s[40:43], s58 offen offset:3456
  s_waitcnt vmcnt(4)
  s_mov_b32 s58, 566784
  buffer_load_dwordx2 v[40:41], v6, s[36:39], s58 offen
  buffer_load_dwordx2 v[42:43], v6, s[36:39], s58 offen offset:3456
  s_waitcnt vmcnt(4)
  buffer_load_dwordx2 v[56:57], v6, s[40:43], s58 offen
  buffer_load_dwordx2 v[58:59], v6, s[40:43], s58 offen offset:3456
  s_waitcnt vmcnt(4)
  s_mov_b32 s58, 573696
  buffer_load_dwordx2 v[44:45], v6, s[36:39], s58 offen
  buffer_load_dwordx2 v[46:47], v6, s[36:39], s58 offen offset:3456
  s_waitcnt vmcnt(4)
  buffer_load_dwordx2 v[60:61], v6, s[40:43], s58 offen
  buffer_load_dwordx2 v[62:63], v6, s[40:43], s58 offen offset:3456
  s_waitcnt vmcnt(4)
  v_perm_b32 v16, v76, v72, s56
  v_accvgpr_write_b32 a0, v16
  v_perm_b32 v17, v84, v80, s56
  v_accvgpr_write_b32 a1, v17
  v_perm_b32 v18, v92, v88, s56
  v_accvgpr_write_b32 a2, v18
  v_perm_b32 v19, v100, v96, s56
  v_accvgpr_write_b32 a3, v19
  v_perm_b32 v16, v76, v72, s57
  v_accvgpr_write_b32 a16, v16
  v_perm_b32 v17, v84, v80, s57
  v_accvgpr_write_b32 a17, v17
  v_perm_b32 v18, v92, v88, s57
  v_accvgpr_write_b32 a18, v18
  v_perm_b32 v19, v100, v96, s57
  v_accvgpr_write_b32 a19, v19
  v_perm_b32 v16, v77, v73, s56
  v_accvgpr_write_b32 a32, v16
  v_perm_b32 v17, v85, v81, s56
  v_accvgpr_write_b32 a33, v17
  v_perm_b32 v18, v93, v89, s56
  v_accvgpr_write_b32 a34, v18
  v_perm_b32 v19, v101, v97, s56
  v_accvgpr_write_b32 a35, v19
  v_perm_b32 v16, v77, v73, s57
  v_accvgpr_write_b32 a48, v16
  v_perm_b32 v17, v85, v81, s57
  v_accvgpr_write_b32 a49, v17
  v_perm_b32 v18, v93, v89, s57
  v_accvgpr_write_b32 a50, v18
  v_perm_b32 v19, v101, v97, s57
  v_accvgpr_write_b32 a51, v19
  v_perm_b32 v16, v78, v74, s56
  v_accvgpr_write_b32 a64, v16
  v_perm_b32 v17, v86, v82, s56
  v_accvgpr_write_b32 a65, v17
  v_perm_b32 v18, v94, v90, s56
  v_accvgpr_write_b32 a66, v18
  v_perm_b32 v19, v102, v98, s56
  v_accvgpr_write_b32 a67, v19
  v_perm_b32 v16, v78, v74, s57
  v_accvgpr_write_b32 a80, v16
  v_perm_b32 v17, v86, v82, s57
  v_accvgpr_write_b32 a81, v17
  v_perm_b32 v18, v94, v90, s57
  v_accvgpr_write_b32 a82, v18
  v_perm_b32 v19, v102, v98, s57
  v_accvgpr_write_b32 a83, v19
  v_perm_b32 v16, v79, v75, s56
  v_accvgpr_write_b32 a96, v16
  v_perm_b32 v17, v87, v83, s56
  v_accvgpr_write_b32 a97, v17
  v_perm_b32 v18, v95, v91, s56
  v_accvgpr_write_b32 a98, v18
  v_perm_b32 v19, v103, v99, s56
  v_accvgpr_write_b32 a99, v19
  v_perm_b32 v16, v79, v75, s57
  v_accvgpr_write_b32 a112, v16
  v_perm_b32 v17, v87, v83, s57
  v_accvgpr_write_b32 a113, v17
  v_perm_b32 v18, v95, v91, s57
  v_accvgpr_write_b32 a114, v18
  v_perm_b32 v19, v103, v99, s57
  v_accvgpr_write_b32 a115, v19
  v_perm_b32 v16, v105, v104, s56
  v_accvgpr_write_b32 a128, v16
  v_perm_b32 v17, v107, v106, s56
  v_accvgpr_write_b32 a129, v17
  v_perm_b32 v18, v109, v108, s56
  v_accvgpr_write_b32 a130, v18
  v_perm_b32 v19, v111, v110, s56
  v_accvgpr_write_b32 a131, v19
  v_perm_b32 v16, v105, v104, s57
  v_accvgpr_write_b32 a144, v16
  v_perm_b32 v17, v107, v106, s57
  v_accvgpr_write_b32 a145, v17
  v_perm_b32 v18, v109, v108, s57
  v_accvgpr_write_b32 a146, v18
  v_perm_b32 v19, v111, v110, s57
  v_accvgpr_write_b32 a147, v19
  s_mov_b32 s58, 40960
  buffer_load_dwordx4 v[72:75], v2, s[32:35], s58 offen
  buffer_load_dword v104, v3, s[32:35], s58 offen offset:256
  s_waitcnt vmcnt(4)
  s_mov_b32 s58, 42240
  buffer_load_dwordx4 v[76:79], v2, s[32:35], s58 offen
  buffer_load_dword v105, v3, s[32:35], s58 offen offset:256
  s_waitcnt vmcnt(4)
  s_mov_b32 s58, 43520
  buffer_load_dwordx4 v[80:83], v2, s[32:35], s58 offen
  buffer_load_dword v106, v3, s[32:35], s58 offen offset:256
  s_waitcnt vmcnt(4)
  s_mov_b32 s58, 44800
  buffer_load_dwordx4 v[84:87], v2, s[32:35], s58 offen
  buffer_load_dword v107, v3, s[32:35], s58 offen offset:256
  s_waitcnt vmcnt(4)
  s_mov_b32 s58, 51200
  buffer_load_dwordx4 v[88:91], v2, s[32:35], s58 offen
  buffer_load_dword v108, v3, s[32:35], s58 offen offset:256
  s_waitcnt vmcnt(4)
  s_mov_b32 s58, 52480
  buffer_load_dwordx4 v[92:95], v2, s[32:35], s58 offen
  buffer_load_dword v109, v3, s[32:35], s58 offen offset:256
  s_waitcnt vmcnt(4)
  s_mov_b32 s58, 53760
  buffer_load_dwordx4 v[96:99], v2, s[32:35], s58 offen
  buffer_load_dword v110, v3, s[32:35], s58 offen offset:256
  s_waitcnt vmcnt(4)
  s_mov_b32 s58, 55040
  buffer_load_dwordx4 v[100:103], v2, s[32:35], s58 offen
  buffer_load_dword v111, v3, s[32:35], s58 offen offset:256
  s_waitcnt vmcnt(4)
  v_perm_b32 v16, v34, v32, s56
  v_perm_b32 v17, v38, v36, s56
  v_perm_b32 v18, v42, v40, s56
  v_perm_b32 v19, v46, v44, s56
  v_perm_b32 v20, v34, v32, s57
  v_perm_b32 v21, v38, v36, s57
  v_perm_b32 v22, v42, v40, s57
  v_perm_b32 v23, v46, v44, s57
  v_perm_b32 v24, v35, v33, s56
  v_perm_b32 v25, v39, v37, s56
  v_perm_b32 v26, v43, v41, s56
  v_perm_b32 v27, v47, v45, s56
  v_perm_b32 v28, v35, v33, s57
  v_perm_b32 v29, v39, v37, s57
  v_perm_b32 v30, v43, v41, s57
  v_perm_b32 v31, v47, v45, s57
  s_barrier
  ds_write_b128 v7, v[16:19] offset:0
  ds_write_b128 v7, v[20:23] offset:8192
  ds_write_b128 v7, v[24:27] offset:16384
  ds_write_b128 v7, v[28:31] offset:24576
  s_waitcnt lgkmcnt(0)
  v_perm_b32 v16, v50, v48, s56
  v_perm_b32 v17, v54, v52, s56
  v_perm_b32 v18, v58, v56, s56
  v_perm_b32 v19, v62, v60, s56
  v_perm_b32 v20, v50, v48, s57
  v_perm_b32 v21, v54, v52, s57
  v_perm_b32 v22, v58, v56, s57
  v_perm_b32 v23, v62, v60, s57
  v_perm_b32 v24, v51, v49, s56
  v_perm_b32 v25, v55, v53, s56
  v_perm_b32 v26, v59, v57, s56
  v_perm_b32 v27, v63, v61, s56
  v_perm_b32 v28, v51, v49, s57
  v_perm_b32 v29, v55, v53, s57
  v_perm_b32 v30, v59, v57, s57
  v_perm_b32 v31, v63, v61, s57
  ds_write_b128 v7, v[16:19] offset:1024
  ds_write_b128 v7, v[20:23] offset:9216
  ds_write_b128 v7, v[24:27] offset:17408
  ds_write_b128 v7, v[28:31] offset:25600
  s_nop 0
  s_waitcnt lgkmcnt(0)
  s_barrier
  ds_read_b128 a[192:195], v8 offset:0
  ds_read_b128 a[196:199], v8 offset:1024
  ds_read_b128 a[200:203], v8 offset:2048
  ds_read_b128 a[204:207], v8 offset:3072
  ds_read_b128 a[208:211], v8 offset:4096
  ds_read_b128 a[212:215], v8 offset:5120
  ds_read_b128 a[216:219], v8 offset:6144
  ds_read_b128 a[220:223], v8 offset:7168
  s_waitcnt lgkmcnt(0)
  s_mov_b32 s58, 1105920
  buffer_load_dwordx2 v[32:33], v6, s[36:39], s58 offen
  buffer_load_dwordx2 v[34:35], v6, s[36:39], s58 offen offset:3456
  s_waitcnt vmcnt(4)
  buffer_load_dwordx2 v[48:49], v6, s[40:43], s58 offen
  buffer_load_dwordx2 v[50:51], v6, s[40:43], s58 offen offset:3456
  s_waitcnt vmcnt(4)
  s_mov_b32 s58, 1112832
  buffer_load_dwordx2 v[36:37], v6, s[36:39], s58 offen
  buffer_load_dwordx2 v[38:39], v6, s[36:39], s58 offen offset:3456
  s_waitcnt vmcnt(4)
  buffer_load_dwordx2 v[52:53], v6, s[40:43], s58 offen
  buffer_load_dwordx2 v[54:55], v6, s[40:43], s58 offen offset:3456
  s_waitcnt vmcnt(4)
  s_mov_b32 s58, 1119744
  buffer_load_dwordx2 v[40:41], v6, s[36:39], s58 offen
  buffer_load_dwordx2 v[42:43], v6, s[36:39], s58 offen offset:3456
  s_waitcnt vmcnt(4)
  buffer_load_dwordx2 v[56:57], v6, s[40:43], s58 offen
  buffer_load_dwordx2 v[58:59], v6, s[40:43], s58 offen offset:3456
  s_waitcnt vmcnt(4)
  s_mov_b32 s58, 1126656
  buffer_load_dwordx2 v[44:45], v6, s[36:39], s58 offen
  buffer_load_dwordx2 v[46:47], v6, s[36:39], s58 offen offset:3456
  s_waitcnt vmcnt(4)
  buffer_load_dwordx2 v[60:61], v6, s[40:43], s58 offen
  buffer_load_dwordx2 v[62:63], v6, s[40:43], s58 offen offset:3456
  s_waitcnt vmcnt(4)
  v_perm_b32 v16, v76, v72, s56
  v_accvgpr_write_b32 a4, v16
  v_perm_b32 v17, v84, v80, s56
  v_accvgpr_write_b32 a5, v17
  v_perm_b32 v18, v92, v88, s56
  v_accvgpr_write_b32 a6, v18
  v_perm_b32 v19, v100, v96, s56
  v_accvgpr_write_b32 a7, v19
  v_perm_b32 v16, v76, v72, s57
  v_accvgpr_write_b32 a20, v16
  v_perm_b32 v17, v84, v80, s57
  v_accvgpr_write_b32 a21, v17
  v_perm_b32 v18, v92, v88, s57
  v_accvgpr_write_b32 a22, v18
  v_perm_b32 v19, v100, v96, s57
  v_accvgpr_write_b32 a23, v19
  v_perm_b32 v16, v77, v73, s56
  v_accvgpr_write_b32 a36, v16
  v_perm_b32 v17, v85, v81, s56
  v_accvgpr_write_b32 a37, v17
  v_perm_b32 v18, v93, v89, s56
  v_accvgpr_write_b32 a38, v18
  v_perm_b32 v19, v101, v97, s56
  v_accvgpr_write_b32 a39, v19
  v_perm_b32 v16, v77, v73, s57
  v_accvgpr_write_b32 a52, v16
  v_perm_b32 v17, v85, v81, s57
  v_accvgpr_write_b32 a53, v17
  v_perm_b32 v18, v93, v89, s57
  v_accvgpr_write_b32 a54, v18
  v_perm_b32 v19, v101, v97, s57
  v_accvgpr_write_b32 a55, v19
  v_perm_b32 v16, v78, v74, s56
  v_accvgpr_write_b32 a68, v16
  v_perm_b32 v17, v86, v82, s56
  v_accvgpr_write_b32 a69, v17
  v_perm_b32 v18, v94, v90, s56
  v_accvgpr_write_b32 a70, v18
  v_perm_b32 v19, v102, v98, s56
  v_accvgpr_write_b32 a71, v19
  v_perm_b32 v16, v78, v74, s57
  v_accvgpr_write_b32 a84, v16
  v_perm_b32 v17, v86, v82, s57
  v_accvgpr_write_b32 a85, v17
  v_perm_b32 v18, v94, v90, s57
  v_accvgpr_write_b32 a86, v18
  v_perm_b32 v19, v102, v98, s57
  v_accvgpr_write_b32 a87, v19
  v_perm_b32 v16, v79, v75, s56
  v_accvgpr_write_b32 a100, v16
  v_perm_b32 v17, v87, v83, s56
  v_accvgpr_write_b32 a101, v17
  v_perm_b32 v18, v95, v91, s56
  v_accvgpr_write_b32 a102, v18
  v_perm_b32 v19, v103, v99, s56
  v_accvgpr_write_b32 a103, v19
  v_perm_b32 v16, v79, v75, s57
  v_accvgpr_write_b32 a116, v16
  v_perm_b32 v17, v87, v83, s57
  v_accvgpr_write_b32 a117, v17
  v_perm_b32 v18, v95, v91, s57
  v_accvgpr_write_b32 a118, v18
  v_perm_b32 v19, v103, v99, s57
  v_accvgpr_write_b32 a119, v19
  v_perm_b32 v16, v105, v104, s56
  v_accvgpr_write_b32 a132, v16
  v_perm_b32 v17, v107, v106, s56
  v_accvgpr_write_b32 a133, v17
  v_perm_b32 v18, v109, v108, s56
  v_accvgpr_write_b32 a134, v18
  v_perm_b32 v19, v111, v110, s56
  v_accvgpr_write_b32 a135, v19
  v_perm_b32 v16, v105, v104, s57
  v_accvgpr_write_b32 a148, v16
  v_perm_b32 v17, v107, v106, s57
  v_accvgpr_write_b32 a149, v17
  v_perm_b32 v18, v109, v108, s57
  v_accvgpr_write_b32 a150, v18
  v_perm_b32 v19, v111, v110, s57
  v_accvgpr_write_b32 a151, v19
  s_mov_b32 s58, 81920
  buffer_load_dwordx4 v[72:75], v2, s[32:35], s58 offen
  buffer_load_dword v104, v3, s[32:35], s58 offen offset:256
  s_waitcnt vmcnt(4)
  s_mov_b32 s58, 83200
  buffer_load_dwordx4 v[76:79], v2, s[32:35], s58 offen
  buffer_load_dword v105, v3, s[32:35], s58 offen offset:256
  s_waitcnt vmcnt(4)
  s_mov_b32 s58, 84480
  buffer_load_dwordx4 v[80:83], v2, s[32:35], s58 offen
  buffer_load_dword v106, v3, s[32:35], s58 offen offset:256
  s_waitcnt vmcnt(4)
  s_mov_b32 s58, 85760
  buffer_load_dwordx4 v[84:87], v2, s[32:35], s58 offen
  buffer_load_dword v107, v3, s[32:35], s58 offen offset:256
  s_waitcnt vmcnt(4)
  s_mov_b32 s58, 92160
  buffer_load_dwordx4 v[88:91], v2, s[32:35], s58 offen
  buffer_load_dword v108, v3, s[32:35], s58 offen offset:256
  s_waitcnt vmcnt(4)
  s_mov_b32 s58, 93440
  buffer_load_dwordx4 v[92:95], v2, s[32:35], s58 offen
  buffer_load_dword v109, v3, s[32:35], s58 offen offset:256
  s_waitcnt vmcnt(4)
  s_mov_b32 s58, 94720
  buffer_load_dwordx4 v[96:99], v2, s[32:35], s58 offen
  buffer_load_dword v110, v3, s[32:35], s58 offen offset:256
  s_waitcnt vmcnt(4)
  s_mov_b32 s58, 96000
  buffer_load_dwordx4 v[100:103], v2, s[32:35], s58 offen
  buffer_load_dword v111, v3, s[32:35], s58 offen offset:256
  s_waitcnt vmcnt(4)
  v_perm_b32 v16, v34, v32, s56
  v_perm_b32 v17, v38, v36, s56
  v_perm_b32 v18, v42, v40, s56
  v_perm_b32 v19, v46, v44, s56
  v_perm_b32 v20, v34, v32, s57
  v_perm_b32 v21, v38, v36, s57
  v_perm_b32 v22, v42, v40, s57
  v_perm_b32 v23, v46, v44, s57
  v_perm_b32 v24, v35, v33, s56
  v_perm_b32 v25, v39, v37, s56
  v_perm_b32 v26, v43, v41, s56
  v_perm_b32 v27, v47, v45, s56
  v_perm_b32 v28, v35, v33, s57
  v_perm_b32 v29, v39, v37, s57
  v_perm_b32 v30, v43, v41, s57
  v_perm_b32 v31, v47, v45, s57
  s_barrier
  ds_write_b128 v7, v[16:19] offset:0
  ds_write_b128 v7, v[20:23] offset:8192
  ds_write_b128 v7, v[24:27] offset:16384
  ds_write_b128 v7, v[28:31] offset:24576
  s_waitcnt lgkmcnt(0)
  v_perm_b32 v16, v50, v48, s56
  v_perm_b32 v17, v54, v52, s56
  v_perm_b32 v18, v58, v56, s56
  v_perm_b32 v19, v62, v60, s56
  v_perm_b32 v20, v50, v48, s57
  v_perm_b32 v21, v54, v52, s57
  v_perm_b32 v22, v58, v56, s57
  v_perm_b32 v23, v62, v60, s57
  v_perm_b32 v24, v51, v49, s56
  v_perm_b32 v25, v55, v53, s56
  v_perm_b32 v26, v59, v57, s56
  v_perm_b32 v27, v63, v61, s56
  v_perm_b32 v28, v51, v49, s57
  v_perm_b32 v29, v55, v53, s57
  v_perm_b32 v30, v59, v57, s57
  v_perm_b32 v31, v63, v61, s57
  ds_write_b128 v7, v[16:19] offset:1024
  ds_write_b128 v7, v[20:23] offset:9216
  ds_write_b128 v7, v[24:27] offset:17408
  ds_write_b128 v7, v[28:31] offset:25600
  s_nop 0
  s_waitcnt lgkmcnt(0)
  s_barrier
  ds_read_b128 a[224:227], v8 offset:0
  ds_read_b128 a[228:231], v8 offset:1024
  ds_read_b128 a[232:235], v8 offset:2048
  ds_read_b128 a[236:239], v8 offset:3072
  ds_read_b128 a[240:243], v8 offset:4096
  ds_read_b128 a[244:247], v8 offset:5120
  ds_read_b128 a[248:251], v8 offset:6144
  ds_read_b128 a[252:255], v8 offset:7168
  s_waitcnt lgkmcnt(0)
  s_mov_b32 s58, 1658880
  buffer_load_dwordx2 v[32:33], v6, s[36:39], s58 offen
  buffer_load_dwordx2 v[34:35], v6, s[36:39], s58 offen offset:3456
  s_waitcnt vmcnt(4)
  buffer_load_dwordx2 v[48:49], v6, s[40:43], s58 offen
  buffer_load_dwordx2 v[50:51], v6, s[40:43], s58 offen offset:3456
  s_waitcnt vmcnt(4)
  s_mov_b32 s58, 1665792
  buffer_load_dwordx2 v[36:37], v6, s[36:39], s58 offen
  buffer_load_dwordx2 v[38:39], v6, s[36:39], s58 offen offset:3456
  s_waitcnt vmcnt(4)
  buffer_load_dwordx2 v[52:53], v6, s[40:43], s58 offen
  buffer_load_dwordx2 v[54:55], v6, s[40:43], s58 offen offset:3456
  s_waitcnt vmcnt(4)
  s_mov_b32 s58, 1672704
  buffer_load_dwordx2 v[40:41], v6, s[36:39], s58 offen
  buffer_load_dwordx2 v[42:43], v6, s[36:39], s58 offen offset:3456
  s_waitcnt vmcnt(4)
  buffer_load_dwordx2 v[56:57], v6, s[40:43], s58 offen
  buffer_load_dwordx2 v[58:59], v6, s[40:43], s58 offen offset:3456
  s_waitcnt vmcnt(4)
  s_mov_b32 s58, 1679616
  buffer_load_dwordx2 v[44:45], v6, s[36:39], s58 offen
  buffer_load_dwordx2 v[46:47], v6, s[36:39], s58 offen offset:3456
  s_waitcnt vmcnt(4)
  buffer_load_dwordx2 v[60:61], v6, s[40:43], s58 offen
  buffer_load_dwordx2 v[62:63], v6, s[40:43], s58 offen offset:3456
  s_waitcnt vmcnt(4)
  v_perm_b32 v16, v76, v72, s56
  v_accvgpr_write_b32 a8, v16
  v_perm_b32 v17, v84, v80, s56
  v_accvgpr_write_b32 a9, v17
  v_perm_b32 v18, v92, v88, s56
  v_accvgpr_write_b32 a10, v18
  v_perm_b32 v19, v100, v96, s56
  v_accvgpr_write_b32 a11, v19
  v_perm_b32 v16, v76, v72, s57
  v_accvgpr_write_b32 a24, v16
  v_perm_b32 v17, v84, v80, s57
  v_accvgpr_write_b32 a25, v17
  v_perm_b32 v18, v92, v88, s57
  v_accvgpr_write_b32 a26, v18
  v_perm_b32 v19, v100, v96, s57
  v_accvgpr_write_b32 a27, v19
  v_perm_b32 v16, v77, v73, s56
  v_accvgpr_write_b32 a40, v16
  v_perm_b32 v17, v85, v81, s56
  v_accvgpr_write_b32 a41, v17
  v_perm_b32 v18, v93, v89, s56
  v_accvgpr_write_b32 a42, v18
  v_perm_b32 v19, v101, v97, s56
  v_accvgpr_write_b32 a43, v19
  v_perm_b32 v16, v77, v73, s57
  v_accvgpr_write_b32 a56, v16
  v_perm_b32 v17, v85, v81, s57
  v_accvgpr_write_b32 a57, v17
  v_perm_b32 v18, v93, v89, s57
  v_accvgpr_write_b32 a58, v18
  v_perm_b32 v19, v101, v97, s57
  v_accvgpr_write_b32 a59, v19
  v_perm_b32 v16, v78, v74, s56
  v_accvgpr_write_b32 a72, v16
  v_perm_b32 v17, v86, v82, s56
  v_accvgpr_write_b32 a73, v17
  v_perm_b32 v18, v94, v90, s56
  v_accvgpr_write_b32 a74, v18
  v_perm_b32 v19, v102, v98, s56
  v_accvgpr_write_b32 a75, v19
  v_perm_b32 v16, v78, v74, s57
  v_accvgpr_write_b32 a88, v16
  v_perm_b32 v17, v86, v82, s57
  v_accvgpr_write_b32 a89, v17
  v_perm_b32 v18, v94, v90, s57
  v_accvgpr_write_b32 a90, v18
  v_perm_b32 v19, v102, v98, s57
  v_accvgpr_write_b32 a91, v19
  v_perm_b32 v16, v79, v75, s56
  v_accvgpr_write_b32 a104, v16
  v_perm_b32 v17, v87, v83, s56
  v_accvgpr_write_b32 a105, v17
  v_perm_b32 v18, v95, v91, s56
  v_accvgpr_write_b32 a106, v18
  v_perm_b32 v19, v103, v99, s56
  v_accvgpr_write_b32 a107, v19
  v_perm_b32 v16, v79, v75, s57
  v_accvgpr_write_b32 a120, v16
  v_perm_b32 v17, v87, v83, s57
  v_accvgpr_write_b32 a121, v17
  v_perm_b32 v18, v95, v91, s57
  v_accvgpr_write_b32 a122, v18
  v_perm_b32 v19, v103, v99, s57
  v_accvgpr_write_b32 a123, v19
  v_perm_b32 v16, v105, v104, s56
  v_accvgpr_write_b32 a136, v16
  v_perm_b32 v17, v107, v106, s56
  v_accvgpr_write_b32 a137, v17
  v_perm_b32 v18, v109, v108, s56
  v_accvgpr_write_b32 a138, v18
  v_perm_b32 v19, v111, v110, s56
  v_accvgpr_write_b32 a139, v19
  v_perm_b32 v16, v105, v104, s57
  v_accvgpr_write_b32 a152, v16
  v_perm_b32 v17, v107, v106, s57
  v_accvgpr_write_b32 a153, v17
  v_perm_b32 v18, v109, v108, s57
  v_accvgpr_write_b32 a154, v18
  v_perm_b32 v19, v111, v110, s57
  v_accvgpr_write_b32 a155, v19
  s_mov_b32 s58, 122880
  buffer_load_dwordx4 v[72:75], v2, s[32:35], s58 offen
  buffer_load_dword v104, v3, s[32:35], s58 offen offset:256
  s_waitcnt vmcnt(4)
  s_mov_b32 s58, 124160
  buffer_load_dwordx4 v[76:79], v2, s[32:35], s58 offen
  buffer_load_dword v105, v3, s[32:35], s58 offen offset:256
  s_waitcnt vmcnt(4)
  s_mov_b32 s58, 125440
  buffer_load_dwordx4 v[80:83], v2, s[32:35], s58 offen
  buffer_load_dword v106, v3, s[32:35], s58 offen offset:256
  s_waitcnt vmcnt(4)
  s_mov_b32 s58, 126720
  buffer_load_dwordx4 v[84:87], v2, s[32:35], s58 offen
  buffer_load_dword v107, v3, s[32:35], s58 offen offset:256
  s_waitcnt vmcnt(4)
  s_mov_b32 s58, 133120
  buffer_load_dwordx4 v[88:91], v2, s[32:35], s58 offen
  buffer_load_dword v108, v3, s[32:35], s58 offen offset:256
  s_waitcnt vmcnt(4)
  s_mov_b32 s58, 134400
  buffer_load_dwordx4 v[92:95], v2, s[32:35], s58 offen
  buffer_load_dword v109, v3, s[32:35], s58 offen offset:256
  s_waitcnt vmcnt(4)
  s_mov_b32 s58, 135680
  buffer_load_dwordx4 v[96:99], v2, s[32:35], s58 offen
  buffer_load_dword v110, v3, s[32:35], s58 offen offset:256
  s_waitcnt vmcnt(4)
  s_mov_b32 s58, 136960
  buffer_load_dwordx4 v[100:103], v2, s[32:35], s58 offen
  buffer_load_dword v111, v3, s[32:35], s58 offen offset:256
  s_waitcnt vmcnt(4)
  v_perm_b32 v16, v34, v32, s56
  v_perm_b32 v17, v38, v36, s56
  v_perm_b32 v18, v42, v40, s56
  v_perm_b32 v19, v46, v44, s56
  v_perm_b32 v20, v34, v32, s57
  v_perm_b32 v21, v38, v36, s57
  v_perm_b32 v22, v42, v40, s57
  v_perm_b32 v23, v46, v44, s57
  v_perm_b32 v24, v35, v33, s56
  v_perm_b32 v25, v39, v37, s56
  v_perm_b32 v26, v43, v41, s56
  v_perm_b32 v27, v47, v45, s56
  v_perm_b32 v28, v35, v33, s57
  v_perm_b32 v29, v39, v37, s57
  v_perm_b32 v30, v43, v41, s57
  v_perm_b32 v31, v47, v45, s57
  s_barrier
  ds_write_b128 v7, v[16:19] offset:0
  ds_write_b128 v7, v[20:23] offset:8192
  ds_write_b128 v7, v[24:27] offset:16384
  ds_write_b128 v7, v[28:31] offset:24576
  s_waitcnt lgkmcnt(0)
  v_perm_b32 v16, v50, v48, s56
  v_perm_b32 v17, v54, v52, s56
  v_perm_b32 v18, v58, v56, s56
  v_perm_b32 v19, v62, v60, s56
  v_perm_b32 v20, v50, v48, s57
  v_perm_b32 v21, v54, v52, s57
  v_perm_b32 v22, v58, v56, s57
  v_perm_b32 v23, v62, v60, s57
  v_perm_b32 v24, v51, v49, s56
  v_perm_b32 v25, v55, v53, s56
  v_perm_b32 v26, v59, v57, s56
  v_perm_b32 v27, v63, v61, s56
  v_perm_b32 v28, v51, v49, s57
  v_perm_b32 v29, v55, v53, s57
  v_perm_b32 v30, v59, v57, s57
  v_perm_b32 v31, v63, v61, s57
  ds_write_b128 v7, v[16:19] offset:1024
  ds_write_b128 v7, v[20:23] offset:9216
  ds_write_b128 v7, v[24:27] offset:17408
  ds_write_b128 v7, v[28:31] offset:25600
  s_nop 0
  s_waitcnt lgkmcnt(0)
  s_barrier
  ds_read_b128 v[192:195], v8 offset:0
  ds_read_b128 v[196:199], v8 offset:1024
  ds_read_b128 v[200:203], v8 offset:2048
  ds_read_b128 v[204:207], v8 offset:3072
  ds_read_b128 v[208:211], v8 offset:4096
  ds_read_b128 v[212:215], v8 offset:5120
  ds_read_b128 v[216:219], v8 offset:6144
  ds_read_b128 v[220:223], v8 offset:7168
  s_waitcnt lgkmcnt(0)
  s_mov_b32 s58, 442368
  buffer_load_dwordx2 v[32:33], v9, s[36:39], s58 offen
  buffer_load_dwordx2 v[34:35], v9, s[36:39], s58 offen offset:3456
  s_waitcnt vmcnt(4)
  buffer_load_dwordx2 v[48:49], v9, s[40:43], s58 offen
  buffer_load_dwordx2 v[50:51], v9, s[40:43], s58 offen offset:3456
  s_waitcnt vmcnt(4)
  s_mov_b32 s58, 449280
  buffer_load_dwordx2 v[36:37], v9, s[36:39], s58 offen
  buffer_load_dwordx2 v[38:39], v9, s[36:39], s58 offen offset:3456
  s_waitcnt vmcnt(4)
  buffer_load_dwordx2 v[52:53], v9, s[40:43], s58 offen
  buffer_load_dwordx2 v[54:55], v9, s[40:43], s58 offen offset:3456
  s_waitcnt vmcnt(4)
  s_mov_b32 s58, 456192
  buffer_load_dwordx2 v[40:41], v9, s[36:39], s58 offen
  buffer_load_dwordx2 v[42:43], v9, s[36:39], s58 offen offset:3456
  s_waitcnt vmcnt(4)
  buffer_load_dwordx2 v[56:57], v9, s[40:43], s58 offen
  buffer_load_dwordx2 v[58:59], v9, s[40:43], s58 offen offset:3456
  s_waitcnt vmcnt(4)
  s_mov_b32 s58, 463104
  buffer_load_dwordx2 v[44:45], v9, s[36:39], s58 offen
  buffer_load_dwordx2 v[46:47], v9, s[36:39], s58 offen offset:3456
  s_waitcnt vmcnt(4)
  buffer_load_dwordx2 v[60:61], v9, s[40:43], s58 offen
  buffer_load_dwordx2 v[62:63], v9, s[40:43], s58 offen offset:3456
  s_waitcnt vmcnt(4)
  v_perm_b32 v16, v76, v72, s56
  v_accvgpr_write_b32 a12, v16
  v_perm_b32 v17, v84, v80, s56
  v_accvgpr_write_b32 a13, v17
  v_perm_b32 v18, v92, v88, s56
  v_accvgpr_write_b32 a14, v18
  v_perm_b32 v19, v100, v96, s56
  v_accvgpr_write_b32 a15, v19
  v_perm_b32 v16, v76, v72, s57
  v_accvgpr_write_b32 a28, v16
  v_perm_b32 v17, v84, v80, s57
  v_accvgpr_write_b32 a29, v17
  v_perm_b32 v18, v92, v88, s57
  v_accvgpr_write_b32 a30, v18
  v_perm_b32 v19, v100, v96, s57
  v_accvgpr_write_b32 a31, v19
  v_perm_b32 v16, v77, v73, s56
  v_accvgpr_write_b32 a44, v16
  v_perm_b32 v17, v85, v81, s56
  v_accvgpr_write_b32 a45, v17
  v_perm_b32 v18, v93, v89, s56
  v_accvgpr_write_b32 a46, v18
  v_perm_b32 v19, v101, v97, s56
  v_accvgpr_write_b32 a47, v19
  v_perm_b32 v16, v77, v73, s57
  v_accvgpr_write_b32 a60, v16
  v_perm_b32 v17, v85, v81, s57
  v_accvgpr_write_b32 a61, v17
  v_perm_b32 v18, v93, v89, s57
  v_accvgpr_write_b32 a62, v18
  v_perm_b32 v19, v101, v97, s57
  v_accvgpr_write_b32 a63, v19
  v_perm_b32 v16, v78, v74, s56
  v_accvgpr_write_b32 a76, v16
  v_perm_b32 v17, v86, v82, s56
  v_accvgpr_write_b32 a77, v17
  v_perm_b32 v18, v94, v90, s56
  v_accvgpr_write_b32 a78, v18
  v_perm_b32 v19, v102, v98, s56
  v_accvgpr_write_b32 a79, v19
  v_perm_b32 v16, v78, v74, s57
  v_accvgpr_write_b32 a92, v16
  v_perm_b32 v17, v86, v82, s57
  v_accvgpr_write_b32 a93, v17
  v_perm_b32 v18, v94, v90, s57
  v_accvgpr_write_b32 a94, v18
  v_perm_b32 v19, v102, v98, s57
  v_accvgpr_write_b32 a95, v19
  v_perm_b32 v16, v79, v75, s56
  v_accvgpr_write_b32 a108, v16
  v_perm_b32 v17, v87, v83, s56
  v_accvgpr_write_b32 a109, v17
  v_perm_b32 v18, v95, v91, s56
  v_accvgpr_write_b32 a110, v18
  v_perm_b32 v19, v103, v99, s56
  v_accvgpr_write_b32 a111, v19
  v_perm_b32 v16, v79, v75, s57
  v_accvgpr_write_b32 a124, v16
  v_perm_b32 v17, v87, v83, s57
  v_accvgpr_write_b32 a125, v17
  v_perm_b32 v18, v95, v91, s57
  v_accvgpr_write_b32 a126, v18
  v_perm_b32 v19, v103, v99, s57
  v_accvgpr_write_b32 a127, v19
  v_perm_b32 v16, v105, v104, s56
  v_accvgpr_write_b32 a140, v16
  v_perm_b32 v17, v107, v106, s56
  v_accvgpr_write_b32 a141, v17
  v_perm_b32 v18, v109, v108, s56
  v_accvgpr_write_b32 a142, v18
  v_perm_b32 v19, v111, v110, s56
  v_accvgpr_write_b32 a143, v19
  v_perm_b32 v16, v105, v104, s57
  v_accvgpr_write_b32 a156, v16
  v_perm_b32 v17, v107, v106, s57
  v_accvgpr_write_b32 a157, v17
  v_perm_b32 v18, v109, v108, s57
  v_accvgpr_write_b32 a158, v18
  v_perm_b32 v19, v111, v110, s57
  v_accvgpr_write_b32 a159, v19
  s_mov_b32 s58, 0
  buffer_load_dwordx4 v[72:75], v4, s[44:47], s58 offen
  buffer_load_dword v104, v5, s[44:47], s58 offen offset:256
  s_waitcnt vmcnt(4)
  s_mov_b32 s58, 5120
  buffer_load_dwordx4 v[76:79], v4, s[44:47], s58 offen
  buffer_load_dword v105, v5, s[44:47], s58 offen offset:256
  s_waitcnt vmcnt(4)
  s_mov_b32 s58, 10240
  buffer_load_dwordx4 v[80:83], v4, s[44:47], s58 offen
  buffer_load_dword v106, v5, s[44:47], s58 offen offset:256
  s_waitcnt vmcnt(4)
  s_mov_b32 s58, 15360
  buffer_load_dwordx4 v[84:87], v4, s[44:47], s58 offen
  buffer_load_dword v107, v5, s[44:47], s58 offen offset:256
  s_waitcnt vmcnt(4)
  s_mov_b32 s58, 1280
  buffer_load_dwordx4 v[88:91], v4, s[44:47], s58 offen
  buffer_load_dword v108, v5, s[44:47], s58 offen offset:256
  s_waitcnt vmcnt(4)
  s_mov_b32 s58, 6400
  buffer_load_dwordx4 v[92:95], v4, s[44:47], s58 offen
  buffer_load_dword v109, v5, s[44:47], s58 offen offset:256
  s_waitcnt vmcnt(4)
  s_mov_b32 s58, 11520
  buffer_load_dwordx4 v[96:99], v4, s[44:47], s58 offen
  buffer_load_dword v110, v5, s[44:47], s58 offen offset:256
  s_waitcnt vmcnt(4)
  s_mov_b32 s58, 16640
  buffer_load_dwordx4 v[100:103], v4, s[44:47], s58 offen
  buffer_load_dword v111, v5, s[44:47], s58 offen offset:256
  s_waitcnt vmcnt(4)
  v_perm_b32 v16, v34, v32, s56
  v_perm_b32 v17, v38, v36, s56
  v_perm_b32 v18, v42, v40, s56
  v_perm_b32 v19, v46, v44, s56
  v_perm_b32 v20, v34, v32, s57
  v_perm_b32 v21, v38, v36, s57
  v_perm_b32 v22, v42, v40, s57
  v_perm_b32 v23, v46, v44, s57
  v_perm_b32 v24, v35, v33, s56
  v_perm_b32 v25, v39, v37, s56
  v_perm_b32 v26, v43, v41, s56
  v_perm_b32 v27, v47, v45, s56
  v_perm_b32 v28, v35, v33, s57
  v_perm_b32 v29, v39, v37, s57
  v_perm_b32 v30, v43, v41, s57
  v_perm_b32 v31, v47, v45, s57
  s_barrier
  ds_write_b128 v7, v[16:19] offset:0
  ds_write_b128 v7, v[20:23] offset:8192
  ds_write_b128 v7, v[24:27] offset:16384
  ds_write_b128 v7, v[28:31] offset:24576
  s_waitcnt lgkmcnt(0)
  v_perm_b32 v16, v50, v48, s56
  v_perm_b32 v17, v54, v52, s56
  v_perm_b32 v18, v58, v56, s56
  v_perm_b32 v19, v62, v60, s56
  v_perm_b32 v20, v50, v48, s57
  v_perm_b32 v21, v54, v52, s57
  v_perm_b32 v22, v58, v56, s57
  v_perm_b32 v23, v62, v60, s57
  v_perm_b32 v24, v51, v49, s56
  v_perm_b32 v25, v55, v53, s56
  v_perm_b32 v26, v59, v57, s56
  v_perm_b32 v27, v63, v61, s56
  v_perm_b32 v28, v51, v49, s57
  v_perm_b32 v29, v55, v53, s57
  v_perm_b32 v30, v59, v57, s57
  v_perm_b32 v31, v63, v61, s57
  ds_write_b128 v7, v[16:19] offset:1024
  ds_write_b128 v7, v[20:23] offset:9216
  ds_write_b128 v7, v[24:27] offset:17408
  ds_write_b128 v7, v[28:31] offset:25600
  s_waitcnt lgkmcnt(0)
  s_barrier
  ds_read_b128 v[224:227], v8 offset:0
  ds_read_b128 v[228:231], v8 offset:1024
  ds_read_b128 v[232:235], v8 offset:2048
  ds_read_b128 v[236:239], v8 offset:3072
  ds_read_b128 v[240:243], v8 offset:4096
  ds_read_b128 v[244:247], v8 offset:5120
  ds_read_b128 v[248:251], v8 offset:6144
  ds_read_b128 v[252:255], v8 offset:7168
  s_waitcnt lgkmcnt(0)
  s_mov_b32 s58, 2560
  buffer_load_dwordx4 v[32:35], v4, s[44:47], s58 offen
  buffer_load_dword v64, v5, s[44:47], s58 offen offset:256
  s_waitcnt vmcnt(4)
  s_mov_b32 s58, 7680
  buffer_load_dwordx4 v[36:39], v4, s[44:47], s58 offen
  buffer_load_dword v65, v5, s[44:47], s58 offen offset:256
  s_waitcnt vmcnt(4)
  s_mov_b32 s58, 12800
  buffer_load_dwordx4 v[40:43], v4, s[44:47], s58 offen
  buffer_load_dword v66, v5, s[44:47], s58 offen offset:256
  s_waitcnt vmcnt(4)
  s_mov_b32 s58, 17920
  buffer_load_dwordx4 v[44:47], v4, s[44:47], s58 offen
  buffer_load_dword v67, v5, s[44:47], s58 offen offset:256
  s_waitcnt vmcnt(4)
  s_mov_b32 s58, 3840
  buffer_load_dwordx4 v[48:51], v4, s[44:47], s58 offen
  buffer_load_dword v68, v5, s[44:47], s58 offen offset:256
  s_waitcnt vmcnt(4)
  s_mov_b32 s58, 8960
  buffer_load_dwordx4 v[52:55], v4, s[44:47], s58 offen
  buffer_load_dword v69, v5, s[44:47], s58 offen offset:256
  s_waitcnt vmcnt(4)
  s_mov_b32 s58, 14080
  buffer_load_dwordx4 v[56:59], v4, s[44:47], s58 offen
  buffer_load_dword v70, v5, s[44:47], s58 offen offset:256
  s_waitcnt vmcnt(4)
  s_mov_b32 s58, 19200
  buffer_load_dwordx4 v[60:63], v4, s[44:47], s58 offen
  buffer_load_dword v71, v5, s[44:47], s58 offen offset:256
  s_waitcnt vmcnt(4)
  v_perm_b32 v16, v76, v72, s56
  v_perm_b32 v17, v84, v80, s56
  v_perm_b32 v18, v92, v88, s56
  v_perm_b32 v19, v100, v96, s56
  ds_write_b128 v14, v[16:19] offset:0
  v_perm_b32 v20, v76, v72, s57
  v_perm_b32 v21, v84, v80, s57
  v_perm_b32 v22, v92, v88, s57
  v_perm_b32 v23, v100, v96, s57
  ds_write_b128 v14, v[20:23] offset:2048
  s_waitcnt lgkmcnt(0)
  v_perm_b32 v16, v77, v73, s56
  v_perm_b32 v17, v85, v81, s56
  v_perm_b32 v18, v93, v89, s56
  v_perm_b32 v19, v101, v97, s56
  ds_write_b128 v14, v[16:19] offset:4096
  v_perm_b32 v20, v77, v73, s57
  v_perm_b32 v21, v85, v81, s57
  v_perm_b32 v22, v93, v89, s57
  v_perm_b32 v23, v101, v97, s57
  ds_write_b128 v14, v[20:23] offset:6144
  s_waitcnt lgkmcnt(0)
  v_perm_b32 v16, v78, v74, s56
  v_perm_b32 v17, v86, v82, s56
  v_perm_b32 v18, v94, v90, s56
  v_perm_b32 v19, v102, v98, s56
  ds_write_b128 v14, v[16:19] offset:8192
  v_perm_b32 v20, v78, v74, s57
  v_perm_b32 v21, v86, v82, s57
  v_perm_b32 v22, v94, v90, s57
  v_perm_b32 v23, v102, v98, s57
  ds_write_b128 v14, v[20:23] offset:10240
  s_waitcnt lgkmcnt(0)
  v_perm_b32 v16, v79, v75, s56
  v_perm_b32 v17, v87, v83, s56
  v_perm_b32 v18, v95, v91, s56
  v_perm_b32 v19, v103, v99, s56
  ds_write_b128 v14, v[16:19] offset:12288
  v_perm_b32 v20, v79, v75, s57
  v_perm_b32 v21, v87, v83, s57
  v_perm_b32 v22, v95, v91, s57
  v_perm_b32 v23, v103, v99, s57
  ds_write_b128 v14, v[20:23] offset:14336
  s_waitcnt lgkmcnt(0)
  v_perm_b32 v16, v105, v104, s56
  v_perm_b32 v17, v107, v106, s56
  v_perm_b32 v18, v109, v108, s56
  v_perm_b32 v19, v111, v110, s56
  ds_write_b128 v14, v[16:19] offset:16384
  v_perm_b32 v20, v105, v104, s57
  v_perm_b32 v21, v107, v106, s57
  v_perm_b32 v22, v109, v108, s57
  v_perm_b32 v23, v111, v110, s57
  ds_write_b128 v14, v[20:23] offset:18432
  s_waitcnt lgkmcnt(0)
  v_perm_b32 v16, v36, v32, s56
  v_perm_b32 v17, v44, v40, s56
  v_perm_b32 v18, v52, v48, s56
  s_waitcnt vmcnt(1)
  v_perm_b32 v19, v60, v56, s56
  ds_write_b128 v14, v[16:19] offset:1024
  v_perm_b32 v20, v36, v32, s57
  v_perm_b32 v21, v44, v40, s57
  v_perm_b32 v22, v52, v48, s57
  v_perm_b32 v23, v60, v56, s57
  ds_write_b128 v14, v[20:23] offset:3072
  s_waitcnt lgkmcnt(0)
  v_perm_b32 v16, v37, v33, s56
  v_perm_b32 v17, v45, v41, s56
  v_perm_b32 v18, v53, v49, s56
  v_perm_b32 v19, v61, v57, s56
  ds_write_b128 v14, v[16:19] offset:5120
  v_perm_b32 v20, v37, v33, s57
  v_perm_b32 v21, v45, v41, s57
  v_perm_b32 v22, v53, v49, s57
  v_perm_b32 v23, v61, v57, s57
  ds_write_b128 v14, v[20:23] offset:7168
  s_waitcnt lgkmcnt(0)
  v_perm_b32 v16, v38, v34, s56
  v_perm_b32 v17, v46, v42, s56
  v_perm_b32 v18, v54, v50, s56
  v_perm_b32 v19, v62, v58, s56
  ds_write_b128 v14, v[16:19] offset:9216
  v_perm_b32 v20, v38, v34, s57
  v_perm_b32 v21, v46, v42, s57
  v_perm_b32 v22, v54, v50, s57
  v_perm_b32 v23, v62, v58, s57
  ds_write_b128 v14, v[20:23] offset:11264
  s_waitcnt lgkmcnt(0)
  v_perm_b32 v16, v39, v35, s56
  v_perm_b32 v17, v47, v43, s56
  v_perm_b32 v18, v55, v51, s56
  v_perm_b32 v19, v63, v59, s56
  ds_write_b128 v14, v[16:19] offset:13312
  v_perm_b32 v20, v39, v35, s57
  v_perm_b32 v21, v47, v43, s57
  v_perm_b32 v22, v55, v51, s57
  v_perm_b32 v23, v63, v59, s57
  ds_write_b128 v14, v[20:23] offset:15360
  s_waitcnt lgkmcnt(0)
  v_perm_b32 v16, v65, v64, s56
  v_perm_b32 v17, v67, v66, s56
  v_perm_b32 v18, v69, v68, s56
  s_waitcnt vmcnt(0)
  v_perm_b32 v19, v71, v70, s56
  ds_write_b128 v14, v[16:19] offset:17408
  v_perm_b32 v20, v65, v64, s57
  v_perm_b32 v21, v67, v66, s57
  v_perm_b32 v22, v69, v68, s57
  v_perm_b32 v23, v71, v70, s57
  ds_write_b128 v14, v[20:23] offset:19456
  s_waitcnt lgkmcnt(0)
L_p_now:
  v_lshlrev_b32_e64 v5, 2, v0
L_tk_21:
  buffer_load_dword v4, v5, s[8:11], 0 offen sc1
  s_sub_u32 s54, s54, 1
  s_cbranch_scc1 L_end
  s_waitcnt vmcnt(0)
  s_add_u32 s92, s14, 30
  v_readlane_b32 s92, v4, s92
  s_nop 0
  s_cmp_ge_u32 s92, 32
  s_cbranch_scc1 L_tk_21x
  s_mov_b32 s94, 0
  v_readlane_b32 s95, v4, 0
  s_nop 0
  s_add_u32 s94, s94, s95
  v_readlane_b32 s95, v4, 16
  s_nop 0
  s_add_u32 s94, s94, s95
  v_readlane_b32 s95, v4, 32
  s_nop 0
  s_add_u32 s94, s94, s95
  v_readlane_b32 s95, v4, 33
  s_nop 0
  s_add_u32 s94, s94, s95
  v_readlane_b32 s95, v4, 34
  s_nop 0
  s_add_u32 s94, s94, s95
  v_readlane_b32 s95, v4, 35
  s_nop 0
  s_add_u32 s94, s94, s95
  v_readlane_b32 s95, v4, 36
  s_nop 0
  s_add_u32 s94, s94, s95
  v_readlane_b32 s95, v4, 37
  s_nop 0
  s_add_u32 s94, s94, s95
  v_readlane_b32 s95, v4, 38
  s_nop 0
  s_add_u32 s94, s94, s95
  s_sleep 4
  s_cmp_lt_u32 s94, 256
  s_cbranch_scc1 L_tk_21
L_tk_21x:
  s_waitcnt vmcnt(0) lgkmcnt(0)
  v_and_b32 v60, 15, v0
  v_lshrrev_b32 v61, 4, v0
  v_lshlrev_b32 v11, 2, v0
  v_lshrrev_b32 v62, 1, v1
  v_and_b32 v62, 0x1e0, v62
  v_and_or_b32 v4, v1, 16, v62
  s_and_b32 s58, s12, 1
  s_lshl_b32 s58, s58, 12
  s_lshr_b32 s59, s12, 1
  s_lshl_b32 s59, s59, 8
  s_add_u32 s58, s58, s59
  s_add_u32 s58, s58, 122880
  v_lshlrev_b32_e64 v62, 10, v61
  v_lshl_add_u32 v62, v60, 4, v62
  v_add_u32 v5, s58, v62
  s_mul_i32 s58, s13, 1280
  v_mul_u32_u24 v62, 164864, v61
  v_add_u32 v62, s58, v62
  s_lshl_b32 s59, s12, 4
  v_add_u32 v63, s59, v60
  v_lshl_add_u32 v6, v63, 4, v62
  v_lshl_add_u32 v7, v63, 2, v62
  v_mul_u32_u24 v62, 1280, v61
  v_lshl_add_u32 v8, v63, 4, v62
  v_and_b32 v64, 12, v60
  v_add_u32 v64, v64, v61
  v_cmp_gt_u32 s[70:71], 11, v64
  v_cmp_gt_u32 s[100:101], 3, v61
  v_mul_u32_u24 v64, 1280, v64
  v_and_b32 v65, 3, v60
  v_lshl_add_u32 v64, v65, 4, v64
  s_lshl_b32 s59, s12, 6
  v_add_u32 v9, s59, v64
  v_lshrrev_b32 v64, 1, v61
  v_and_b32 v65, 1, v61
  v_lshlrev_b32 v65, 3, v65
  v_lshl_add_u32 v66, v60, 4, v65
  v_lshl_add_u32 v66, v64, 8, v66
  s_mul_i32 s59, s12, 320
  v_add_u32 v66, s59, v66
  s_mov_b32 s98, -1
  s_mov_b32 s99, 0x000f000f
  v_mov_b32 v67, 0x7f000000
  v_cndmask_b32 v10, v67, v66, s[98:99]
  s_lshl_b32 s59, s12, 2
  s_add_u32 s59, s59, 64
  v_add_u32 v66, s59, v60
  v_cmp_eq_u32 vcc, 0, v64
  s_nop 0
  s_nop 0
  v_cndmask_b32 v66, v66, v63, vcc
  v_lshrrev_b32 v62, 2, v66
  v_lshl_add_u32 v62, v62, 11, v65
  v_and_b32 v66, 3, v66
  v_lshl_add_u32 v62, v66, 8, v62
  v_cndmask_b32 v62, v67, v62, s[98:99]
  s_lshr_b32 s58, s13, 4
  s_lshl_b32 s58, s58, 10
  s_and_b32 s59, s13, 15
  s_lshl_b32 s59, s59, 4
  s_add_u32 s58, s58, s59
  v_add_u32 v12, s58, v62
  s_lshr_b32 s58, s12, 1
  s_lshl_b32 s58, s58, 10
  s_and_b32 s59, s12, 1
  s_lshl_b32 s59, s59, 3
  s_add_u32 s58, s58, s59
  s_add_u32 s58, s58, 131072
  v_add_u32 v13, s58, v1
  v_and_b32_e64 v62, 16, v1
  s_movk_i32 s58, 0x3f80
  v_lshlrev_b32_e64 v62, v62, s58
  v_lshrrev_b32 v63, 1, v60
  v_cmp_eq_u32 vcc, 0, v63
  s_nop 1
  v_cndmask_b32 v16, 0, v62, vcc
  v_cmp_eq_u32 vcc, 1, v63
  s_nop 1
  v_cndmask_b32 v17, 0, v62, vcc
  v_cmp_eq_u32 vcc, 2, v63
  s_nop 1
  v_cndmask_b32 v18, 0, v62, vcc
  v_cmp_eq_u32 vcc, 3, v63
  s_nop 1
  v_cndmask_b32 v19, 0, v62, vcc
  v_cmp_eq_u32 vcc, 4, v63
  s_nop 1
  v_cndmask_b32 v20, 0, v62, vcc
  v_cmp_eq_u32 vcc, 5, v63
  s_nop 1
  v_cndmask_b32 v21, 0, v62, vcc
  v_cmp_eq_u32 vcc, 6, v63
  s_nop 0
  s_nop 0
  v_cndmask_b32 v22, 0, v62, vcc
  v_cmp_eq_u32 vcc, 7, v63
  s_nop 0
  s_nop 0
  v_cndmask_b32 v23, 0, v62, vcc
  s_and_b32 s58, s12, 1
  s_lshl_b32 s58, s58, 4
  v_add_u32 v62, s58, v60
  v_lshlrev_b32 v63, 2, v61
  v_sub_u32 v62, v62, v63
  v_cmp_le_i32 s[76:77], 0, v62
  v_cmp_le_i32 s[78:79], 1, v62
  v_cmp_le_i32 s[80:81], 2, v62
  v_cmp_le_i32 s[82:83], 3, v62
  v_cmp_le_i32 s[84:85], 16, v62
  v_cmp_le_i32 s[86:87], 17, v62
  v_cmp_le_i32 s[88:89], 18, v62
  v_cmp_le_i32 s[90:91], 19, v62
  s_lshl_b32 s58, s52, 22
  s_add_u32 s63, s58, 68157440
  s_add_u32 s64, s63, 1572864
  s_add_u32 s65, s63, 3145728
  s_mul_i32 s58, s13, 41216
  s_add_u32 s72, s63, s58
  s_add_u32 s73, s64, s58
  s_lshl_b32 s58, s52, 9
  s_add_u32 s66, s58, 8192
  s_mov_b32 s61, s52
  s_mov_b32 s62, 1
  s_mov_b32 s3, 0
  s_mov_b32 s15, 0
  s_mov_b32 s97, 0x3e0293ee
  s_lshr_b32 s58, s13, 1
  s_lshl_b32 s58, s58, 8
  s_add_u32 s58, s58, 0
  s_mov_b32 s59, 18944
L_p_w0:
  s_mov_b64 exec, 0x7777
  buffer_load_dword v60, v1, s[4:7], s58 offen sc1
  s_mov_b64 exec, -1
  buffer_load_dwordx2 v[62:63], v10, s[4:7], s59 offen offset:0 sc1
  buffer_load_dwordx2 v[64:65], v10, s[4:7], s59 offen offset:1280 sc1
  buffer_load_dwordx2 v[66:67], v10, s[4:7], s59 offen offset:2560 sc1
  buffer_load_dwordx2 v[68:69], v10, s[4:7], s59 offen offset:3840 sc1
  s_sub_u32 s54, s54, 1
  s_cbranch_scc1 L_end
  s_waitcnt vmcnt(0)
  v_max_u32 v61, v62, v63
  v_max3_u32 v61, v61, v64, v65
  v_max3_u32 v61, v61, v66, v67
  v_max3_u32 v61, v61, v68, v69
  v_cmp_eq_u32 vcc, -1, v61
  s_cbranch_vccnz L_p_w0
  v_cmp_ne_u32 vcc, 16, v60
  s_nop 0
  s_and_b32 s60, vcc_lo, 0x7777
  s_cbranch_scc1 L_p_w0
  v_lshlrev_b32 v40, 16, v62
  v_and_b32 v41, 0xffff0000, v62
  v_lshlrev_b32 v42, 16, v63
  v_and_b32 v43, 0xffff0000, v63
  v_lshlrev_b32 v44, 16, v64
  v_and_b32 v45, 0xffff0000, v64
  v_lshlrev_b32 v46, 16, v65
  v_and_b32 v47, 0xffff0000, v65
  v_lshlrev_b32 v48, 16, v66
  v_and_b32 v49, 0xffff0000, v66
  v_lshlrev_b32 v50, 16, v67
  v_and_b32 v51, 0xffff0000, v67
  v_lshlrev_b32 v52, 16, v68
  v_and_b32 v53, 0xffff0000, v68
  v_lshlrev_b32_e64 v54, 16, v69
  v_and_b32 v55, 0xffff0000, v69
  v_add_f32 v48, 1.0, v48
  v_add_f32 v49, 1.0, v49
  v_add_f32 v50, 1.0, v50
  v_add_f32 v51, 1.0, v51
  s_cmp_lt_u32 s92, 32
  s_cbranch_scc1 L_p_run_s
L_p_run:
  s_lshl_b32 s58, s61, 5
  s_add_u32 s58, s58, s13
  s_and_b32 s59, s52, s15
  s_lshl_b32 s59, s59, 4
  s_add_u32 s59, s59, s58
  s_mul_i32 s74, s59, 1280
  s_lshl_b32 s67, s58, 13
  s_and_b32 s59, s12, 1
  s_lshl_b32 s59, s59, 10
  s_add_u32 s67, s67, s59
  s_add_u32 s67, s67, 16777216
  s_lshl_b32 s68, s58, 14
  s_add_u32 s68, s68, 33554432
  s_lshr_b32 s69, s58, 2
  s_lshl_b32 s69, s69, 14
  s_and_b32 s59, s13, 3
  s_lshl_b32 s59, s59, 11
  s_add_u32 s69, s69, s59
  s_add_u32 s69, s69, 8388608
  s_lshr_b32 s59, s12, 1
  s_lshl_b32 s59, s59, 10
  s_add_u32 s55, s69, s59
  s_add_u32 s55, s55, 0x2000
  s_lshl_b32 s59, s59, 3
  s_add_u32 s75, s68, s59
  buffer_load_dwordx4 v[60:63], v1, s[4:7], s67 offen offset:0 sc1
  buffer_load_dwordx4 v[64:67], v1, s[4:7], s67 offen offset:2048 sc1
  s_add_u32 s67, s67, 4096
  buffer_load_dwordx4 v[68:71], v1, s[4:7], s67 offen offset:0 sc1
  buffer_load_dwordx4 v[72:75], v1, s[4:7], s67 offen offset:2048 sc1
  buffer_load_dwordx4 v[76:79], v1, s[4:7], s68 offen offset:0 sc1
  buffer_load_dwordx4 v[80:83], v1, s[4:7], s68 offen offset:1024 sc1
  buffer_load_dwordx4 v[108:111], v1, s[4:7], s75 offen offset:2048 sc1
  s_add_u32 s68, s68, 4096
  buffer_load_dwordx4 v[84:87], v1, s[4:7], s68 offen offset:0 sc1
  buffer_load_dwordx4 v[88:91], v1, s[4:7], s68 offen offset:1024 sc1
  buffer_load_dwordx4 v[112:115], v1, s[4:7], s75 offen offset:3072 sc1
  s_add_u32 s68, s68, 4096
  s_add_u32 s75, s75, 4096
  buffer_load_dwordx4 v[92:95], v1, s[4:7], s68 offen offset:0 sc1
  buffer_load_dwordx4 v[96:99], v1, s[4:7], s68 offen offset:1024 sc1
  buffer_load_dwordx4 v[116:119], v1, s[4:7], s75 offen offset:2048 sc1
  s_add_u32 s68, s68, 4096
  buffer_load_dwordx4 v[100:103], v1, s[4:7], s68 offen offset:0 sc1
  buffer_load_dwordx4 v[104:107], v1, s[4:7], s68 offen offset:1024 sc1
  buffer_load_dwordx4 v[120:123], v1, s[4:7], s75 offen offset:3072 sc1
  v_lshlrev_b32 v190, 1, v11
  buffer_load_dwordx4 v[168:171], v4, s[4:7], s69 offen offset:0 sc1
  buffer_load_dwordx2 v[184:185], v190, s[4:7], s55 offen offset:0 sc1
  buffer_load_dwordx4 v[172:175], v4, s[4:7], s69 offen offset:512 sc1
  buffer_load_dwordx2 v[186:187], v190, s[4:7], s55 offen offset:512 sc1
  buffer_load_dwordx4 v[176:179], v4, s[4:7], s69 offen offset:1024 sc1
  buffer_load_dwordx4 v[180:183], v4, s[4:7], s69 offen offset:1536 sc1
  s_waitcnt vmcnt(6)
L_p_loop:
  v_mfma_f32_16x16x32_bf16 v[124:127], v[76:79], v[60:63], 0
  v_mfma_f32_16x16x32_bf16 v[124:127], v[84:87], v[64:67], v[124:127]
  v_mfma_f32_16x16x32_bf16 v[124:127], v[92:95], v[68:71], v[124:127]
  v_mfma_f32_16x16x32_bf16 v[124:127], v[100:103], v[72:75], v[124:127]
  v_mfma_f32_16x16x32_bf16 v[128:131], v[80:83], v[60:63], 0
  v_mfma_f32_16x16x32_bf16 v[128:131], v[88:91], v[64:67], v[128:131]
  v_mfma_f32_16x16x32_bf16 v[128:131], v[96:99], v[68:71], v[128:131]
  v_mfma_f32_16x16x32_bf16 v[128:131], v[104:107], v[72:75], v[128:131]
  v_mov_b32 v3, 0xff800000
  v_cndmask_b32 v124, v3, v124, s[76:77]
  v_cndmask_b32 v125, v3, v125, s[78:79]
  v_cndmask_b32 v126, v3, v126, s[80:81]
  v_cndmask_b32 v127, v3, v127, s[82:83]
  s_nop 0
  s_nop 1
  v_cndmask_b32 v128, v3, v128, s[84:85]
  v_cndmask_b32 v129, v3, v129, s[86:87]
  v_cndmask_b32 v130, v3, v130, s[88:89]
  v_cndmask_b32 v131, v3, v131, s[90:91]
  v_max_f32_e64 v136, v124, v125
  v_max3_f32 v136, v136, v126, v127
  v_max3_f32 v136, v136, v128, v129
  v_max3_f32 v136, v136, v130, v131
  s_branch L_p_km1
  s_nop 0
  s_nop 0
  s_nop 0
  s_nop 0
  s_nop 0
  s_nop 0
  s_nop 0
L_p_pr:
  s_cmp_ge_u32 s61, 58
  s_cbranch_scc1 L_p_km
  s_sleep 2
  v_lshlrev_b32 v190, 1, v11
  s_mov_b32 exec_lo, 1
  s_mov_b32 exec_hi, 1
  buffer_load_dword v188, v190, s[4:7], s55 offen offset:512 sc1
  s_mov_b64 exec, -1
  s_sub_u32 s54, s54, 1
  s_cbranch_scc1 L_end
  s_waitcnt vmcnt(0)
  v_cmp_eq_u32 vcc, -1, v188
  s_nop 0
  s_or_b32 s58, vcc_lo, vcc_hi
  s_bitcmp1_b32 s58, 0
  s_cbranch_scc1 L_p_pr
L_p_km:
  v_lshlrev_b32 v190, 1, v11
  buffer_load_dwordx4 v[168:171], v4, s[4:7], s69 offen offset:0 sc1
  buffer_load_dwordx2 v[184:185], v190, s[4:7], s55 offen offset:0 sc1
  buffer_load_dwordx4 v[172:175], v4, s[4:7], s69 offen offset:512 sc1
  buffer_load_dwordx2 v[186:187], v190, s[4:7], s55 offen offset:512 sc1
  buffer_load_dwordx4 v[176:179], v4, s[4:7], s69 offen offset:1024 sc1
  buffer_load_dwordx4 v[180:183], v4, s[4:7], s69 offen offset:1536 sc1
L_p_km1:
  s_sub_u32 s54, s54, 1
  s_cbranch_scc1 L_end
  s_waitcnt vmcnt(0)
  v_max3_u32 v2, v168, v172, v176
  v_max3_u32 v2, v2, v180, v184
  v_max_u32 v2, v2, v186
  v_cmp_eq_u32 vcc, -1, v2
  s_cbranch_vccnz L_p_pr
  buffer_load_dwordx2 v[56:57], v10, s[16:19], s74 offen
  v_mfma_f32_16x16x32_bf16 v[132:135], v[168:171], v[60:63], 0
  v_mfma_f32_16x16x32_bf16 v[132:135], v[172:175], v[64:67], v[132:135]
  v_mfma_f32_16x16x32_bf16 v[132:135], v[176:179], v[68:71], v[132:135]
  v_mfma_f32_16x16x32_bf16 v[132:135], v[180:183], v[72:75], v[132:135]
  s_nop 7
  v_max3_f32 v136, v136, v132, v133
  v_mov_b32 v137, v136
  s_nop 1
  v_permlane16_swap_b32 v136, v137
  v_max_f32 v136, v136, v137
  v_mov_b32 v137, v136
  s_nop 1
  v_permlane32_swap_b32 v136, v137
  v_max_f32 v136, v136, v137
  v_mul_f32 v136, s97, v136
  v_fma_f32 v124, v124, s97, -v136
  v_fma_f32 v125, v125, s97, -v136
  v_fma_f32 v126, v126, s97, -v136
  v_fma_f32 v127, v127, s97, -v136
  v_fma_f32 v128, v128, s97, -v136
  v_fma_f32 v129, v129, s97, -v136
  v_fma_f32 v130, v130, s97, -v136
  v_fma_f32 v131, v131, s97, -v136
  v_fma_f32 v132, v132, s97, -v136
  v_fma_f32 v133, v133, s97, -v136
  v_exp_f32 v124, v124
  v_exp_f32 v125, v125
  v_exp_f32 v126, v126
  v_exp_f32 v127, v127
  v_exp_f32 v128, v128
  v_exp_f32 v129, v129
  v_exp_f32 v130, v130
  v_exp_f32 v131, v131
  v_exp_f32 v132, v132
  v_exp_f32 v133, v133
  v_cvt_pk_bf16_f32 v138, v124, v125
  v_cvt_pk_bf16_f32 v139, v126, v127
  v_cvt_pk_bf16_f32 v140, v128, v129
  v_cvt_pk_bf16_f32 v141, v130, v131
  v_cvt_pk_bf16_f32 v142, v132, v133
  v_mov_b32 v143, 0
  v_mov_b32 v144, 0
  v_mov_b32_e64 v145, v142
  v_mfma_f32_16x16x32_bf16 v[168:171], v[108:111], v[138:141], 0
  v_mfma_f32_16x16x32_bf16 v[172:175], v[112:115], v[138:141], 0
  v_mfma_f32_16x16x32_bf16 v[176:179], v[116:119], v[138:141], 0
  v_mfma_f32_16x16x32_bf16 v[180:183], v[120:123], v[138:141], 0
  v_mfma_f32_16x16x16_bf16 v[168:171], v[184:185], v[142:143], v[168:171]
  v_mfma_f32_16x16x16_bf16 v[172:175], v[184:185], v[144:145], v[172:175]
  v_mfma_f32_16x16x16_bf16 v[176:179], v[186:187], v[142:143], v[176:179]
  v_mfma_f32_16x16x16_bf16 v[180:183], v[186:187], v[144:145], v[180:183]
  v_add_f32 v124, v124, v125
  v_add_f32 v124, v124, v126
  v_add_f32 v124, v124, v127
  v_add_f32 v124, v124, v128
  v_add_f32 v124, v124, v129
  v_add_f32 v124, v124, v130
  v_add_f32 v124, v124, v131
  v_add_f32 v124, v124, v132
  v_add_f32 v124, v124, v133
  v_mov_b32 v137, v124
  s_nop 1
  v_permlane16_swap_b32 v124, v137
  v_add_f32 v124, v124, v137
  v_mov_b32 v137, v124
  s_nop 0
  s_nop 0
  v_permlane32_swap_b32 v124, v137
  v_add_f32 v124, v124, v137
  v_rcp_f32 v124, v124
  s_nop 0
  v_pk_mul_f32 v[168:169], v[168:169], v[124:125] op_sel_hi:[1,0]
  v_pk_mul_f32 v[170:171], v[170:171], v[124:125] op_sel_hi:[1,0]
  v_pk_mul_f32 v[172:173], v[172:173], v[124:125] op_sel_hi:[1,0]
  v_pk_mul_f32 v[174:175], v[174:175], v[124:125] op_sel_hi:[1,0]
  v_pk_mul_f32 v[176:177], v[176:177], v[124:125] op_sel_hi:[1,0]
  v_pk_mul_f32 v[178:179], v[178:179], v[124:125] op_sel_hi:[1,0]
  v_pk_mul_f32 v[180:181], v[180:181], v[124:125] op_sel_hi:[1,0]
  v_pk_mul_f32 v[182:183], v[182:183], v[124:125] op_sel_hi:[1,0]
  v_cvt_pk_bf16_f32 v128, v168, v172
  v_cvt_pk_bf16_f32 v129, v176, v180
  v_cvt_pk_bf16_f32 v130, v169, v173
  v_cvt_pk_bf16_f32 v131, v177, v181
  v_cvt_pk_bf16_f32 v132, v170, v174
  v_cvt_pk_bf16_f32 v133, v178, v182
  v_cvt_pk_bf16_f32 v134, v171, v175
  v_cvt_pk_bf16_f32 v135, v179, v183
  ds_write_b128 v5, v[128:131]
  ds_write_b128 v5, v[132:135] offset:512
  s_and_b32 s58, s52, s3
  s_lshl_b32 s58, s58, 12
  s_add_u32 s58, s58, 122880
  v_add_u32_e64 v2, s58, v1
  s_waitcnt lgkmcnt(0)
  s_barrier
  ds_read_b128 v[76:79], v2 offset:0
  ds_read_b128 v[80:83], v2 offset:1024
  ds_read_b128 v[84:87], v2 offset:2048
  ds_read_b128 v[88:91], v2 offset:3072
  ds_read_b128 v[92:95], v2 offset:4096
  ds_read_b128 v[96:99], v2 offset:5120
  ds_read_b128 v[100:103], v2 offset:6144
  ds_read_b128 v[104:107], v2 offset:7168
  s_waitcnt lgkmcnt(7)
  v_mfma_f32_16x16x32_bf16 v[124:127], v[76:79], a[0:3], 0
  s_waitcnt lgkmcnt(6)
  v_mfma_f32_16x16x32_bf16 v[124:127], v[80:83], a[4:7], v[124:127]
  s_waitcnt lgkmcnt(5)
  v_mfma_f32_16x16x32_bf16 v[124:127], v[84:87], a[8:11], v[124:127]
  s_waitcnt lgkmcnt(4)
  v_mfma_f32_16x16x32_bf16 v[124:127], v[88:91], a[12:15], v[124:127]
  v_mfma_f32_16x16x32_bf16 v[128:131], v[76:79], a[16:19], 0
  v_mfma_f32_16x16x32_bf16 v[128:131], v[80:83], a[20:23], v[128:131]
  v_mfma_f32_16x16x32_bf16 v[128:131], v[84:87], a[24:27], v[128:131]
  v_mfma_f32_16x16x32_bf16 v[128:131], v[88:91], a[28:31], v[128:131]
  v_mfma_f32_16x16x32_bf16 v[132:135], v[76:79], a[32:35], 0
  v_mfma_f32_16x16x32_bf16 v[132:135], v[80:83], a[36:39], v[132:135]
  v_mfma_f32_16x16x32_bf16 v[132:135], v[84:87], a[40:43], v[132:135]
  v_mfma_f32_16x16x32_bf16 v[132:135], v[88:91], a[44:47], v[132:135]
  v_mfma_f32_16x16x32_bf16 v[136:139], v[76:79], a[48:51], 0
  v_mfma_f32_16x16x32_bf16 v[136:139], v[80:83], a[52:55], v[136:139]
  v_mfma_f32_16x16x32_bf16 v[136:139], v[84:87], a[56:59], v[136:139]
  v_mfma_f32_16x16x32_bf16 v[136:139], v[88:91], a[60:63], v[136:139]
  v_mfma_f32_16x16x32_bf16 v[140:143], v[76:79], a[64:67], 0
  v_mfma_f32_16x16x32_bf16 v[140:143], v[80:83], a[68:71], v[140:143]
  v_mfma_f32_16x16x32_bf16 v[140:143], v[84:87], a[72:75], v[140:143]
  v_mfma_f32_16x16x32_bf16 v[140:143], v[88:91], a[76:79], v[140:143]
  v_mfma_f32_16x16x32_bf16 v[144:147], v[76:79], a[80:83], 0
  v_mfma_f32_16x16x32_bf16 v[144:147], v[80:83], a[84:87], v[144:147]
  v_mfma_f32_16x16x32_bf16 v[144:147], v[84:87], a[88:91], v[144:147]
  v_mfma_f32_16x16x32_bf16 v[144:147], v[88:91], a[92:95], v[144:147]
  v_mfma_f32_16x16x32_bf16 v[148:151], v[76:79], a[96:99], 0
  v_mfma_f32_16x16x32_bf16 v[148:151], v[80:83], a[100:103], v[148:151]
  v_mfma_f32_16x16x32_bf16 v[148:151], v[84:87], a[104:107], v[148:151]
  v_mfma_f32_16x16x32_bf16 v[148:151], v[88:91], a[108:111], v[148:151]
  v_mfma_f32_16x16x32_bf16 v[152:155], v[76:79], a[112:115], 0
  v_mfma_f32_16x16x32_bf16 v[152:155], v[80:83], a[116:119], v[152:155]
  v_mfma_f32_16x16x32_bf16 v[152:155], v[84:87], a[120:123], v[152:155]
  v_mfma_f32_16x16x32_bf16 v[152:155], v[88:91], a[124:127], v[152:155]
  v_mfma_f32_16x16x32_bf16 v[156:159], v[76:79], a[128:131], 0
  v_mfma_f32_16x16x32_bf16 v[156:159], v[80:83], a[132:135], v[156:159]
  v_mfma_f32_16x16x32_bf16 v[156:159], v[84:87], a[136:139], v[156:159]
  v_mfma_f32_16x16x32_bf16 v[156:159], v[88:91], a[140:143], v[156:159]
  v_mfma_f32_16x16x32_bf16 v[160:163], v[76:79], a[144:147], 0
  v_mfma_f32_16x16x32_bf16 v[160:163], v[80:83], a[148:151], v[160:163]
  v_mfma_f32_16x16x32_bf16 v[160:163], v[84:87], a[152:155], v[160:163]
  v_mfma_f32_16x16x32_bf16 v[160:163], v[88:91], a[156:159], v[160:163]
  v_cvt_pk_bf16_f32 v164, v124, v128
  v_cvt_pk_bf16_f32 v165, v132, v136
  v_cvt_pk_bf16_f32 v166, v140, v144
  v_cvt_pk_bf16_f32 v167, v148, v152
  s_nop 0
  s_nop 2
  v_cvt_pk_bf16_f32 v180, v156, v160
  v_cvt_pk_bf16_f32 v168, v125, v129
  v_cvt_pk_bf16_f32 v169, v133, v137
  v_cvt_pk_bf16_f32 v170, v141, v145
  v_cvt_pk_bf16_f32 v171, v149, v153
  v_cvt_pk_bf16_f32 v181, v157, v161
  v_cvt_pk_bf16_f32 v172, v126, v130
  v_cvt_pk_bf16_f32 v173, v134, v138
  v_cvt_pk_bf16_f32 v174, v142, v146
  v_cvt_pk_bf16_f32 v175, v150, v154
  v_cvt_pk_bf16_f32 v182, v158, v162
  v_cvt_pk_bf16_f32 v176, v127, v131
  v_cvt_pk_bf16_f32 v177, v135, v139
  v_cvt_pk_bf16_f32 v178, v143, v147
  v_cvt_pk_bf16_f32 v179, v151, v155
  v_cvt_pk_bf16_f32 v183, v159, v163
  s_cmp_lg_u32 s3, 0
  s_cbranch_scc1 L_ph_22
  s_waitcnt lgkmcnt(3)
  v_mfma_f32_16x16x32_bf16 v[124:127], v[92:95], a[0:3], 0
  s_waitcnt lgkmcnt(2)
  v_mfma_f32_16x16x32_bf16 v[124:127], v[96:99], a[4:7], v[124:127]
  s_waitcnt lgkmcnt(1)
  v_mfma_f32_16x16x32_bf16 v[124:127], v[100:103], a[8:11], v[124:127]
  s_waitcnt lgkmcnt(0)
  v_mfma_f32_16x16x32_bf16 v[124:127], v[104:107], a[12:15], v[124:127]
  s_add_u32 s58, s63, 0
  buffer_store_dwordx4 v[164:167], v6, s[4:7], s58 offen
  v_mfma_f32_16x16x32_bf16 v[128:131], v[92:95], a[16:19], 0
  v_mfma_f32_16x16x32_bf16 v[128:131], v[96:99], a[20:23], v[128:131]
  s_nop 0
  v_mfma_f32_16x16x32_bf16 v[128:131], v[100:103], a[24:27], v[128:131]
  v_mfma_f32_16x16x32_bf16 v[128:131], v[104:107], a[28:31], v[128:131]
  buffer_store_dword v180, v7, s[4:7], s58 offen offset:1024
  v_mfma_f32_16x16x32_bf16 v[132:135], v[92:95], a[32:35], 0
  v_mfma_f32_16x16x32_bf16 v[132:135], v[96:99], a[36:39], v[132:135]
  v_mfma_f32_16x16x32_bf16 v[132:135], v[100:103], a[40:43], v[132:135]
  v_mfma_f32_16x16x32_bf16 v[132:135], v[104:107], a[44:47], v[132:135]
  s_add_u32 s58, s63, 41216
  buffer_store_dwordx4 v[168:171], v6, s[4:7], s58 offen
  v_mfma_f32_16x16x32_bf16 v[136:139], v[92:95], a[48:51], 0
  v_mfma_f32_16x16x32_bf16 v[136:139], v[96:99], a[52:55], v[136:139]
  v_mfma_f32_16x16x32_bf16 v[136:139], v[100:103], a[56:59], v[136:139]
  v_mfma_f32_16x16x32_bf16 v[136:139], v[104:107], a[60:63], v[136:139]
  buffer_store_dword v181, v7, s[4:7], s58 offen offset:1024
  v_mfma_f32_16x16x32_bf16 v[140:143], v[92:95], a[64:67], 0
  v_mfma_f32_16x16x32_bf16 v[140:143], v[96:99], a[68:71], v[140:143]
  v_mfma_f32_16x16x32_bf16 v[140:143], v[100:103], a[72:75], v[140:143]
  v_mfma_f32_16x16x32_bf16 v[140:143], v[104:107], a[76:79], v[140:143]
  s_add_u32 s58, s63, 82432
  buffer_store_dwordx4 v[172:175], v6, s[4:7], s58 offen
  v_mfma_f32_16x16x32_bf16 v[144:147], v[92:95], a[80:83], 0
  v_mfma_f32_16x16x32_bf16 v[144:147], v[96:99], a[84:87], v[144:147]
  v_mfma_f32_16x16x32_bf16 v[144:147], v[100:103], a[88:91], v[144:147]
  v_mfma_f32_16x16x32_bf16 v[144:147], v[104:107], a[92:95], v[144:147]
  buffer_store_dword v182, v7, s[4:7], s58 offen offset:1024
  v_mfma_f32_16x16x32_bf16 v[148:151], v[92:95], a[96:99], 0
  v_mfma_f32_16x16x32_bf16 v[148:151], v[96:99], a[100:103], v[148:151]
  v_mfma_f32_16x16x32_bf16 v[148:151], v[100:103], a[104:107], v[148:151]
  v_mfma_f32_16x16x32_bf16 v[148:151], v[104:107], a[108:111], v[148:151]
  s_add_u32 s58, s63, 123648
  buffer_store_dwordx4 v[176:179], v6, s[4:7], s58 offen
  v_mfma_f32_16x16x32_bf16 v[152:155], v[92:95], a[112:115], 0
  v_mfma_f32_16x16x32_bf16 v[152:155], v[96:99], a[116:119], v[152:155]
  v_mfma_f32_16x16x32_bf16 v[152:155], v[100:103], a[120:123], v[152:155]
  v_mfma_f32_16x16x32_bf16 v[152:155], v[104:107], a[124:127], v[152:155]
  buffer_store_dword v183, v7, s[4:7], s58 offen offset:1024
  v_mfma_f32_16x16x32_bf16 v[156:159], v[92:95], a[128:131], 0
  v_mfma_f32_16x16x32_bf16 v[156:159], v[96:99], a[132:135], v[156:159]
  v_mfma_f32_16x16x32_bf16 v[156:159], v[100:103], a[136:139], v[156:159]
  v_mfma_f32_16x16x32_bf16 v[156:159], v[104:107], a[140:143], v[156:159]
  v_mfma_f32_16x16x32_bf16 v[160:163], v[92:95], a[144:147], 0
  v_mfma_f32_16x16x32_bf16 v[160:163], v[96:99], a[148:151], v[160:163]
  v_mfma_f32_16x16x32_bf16 v[160:163], v[100:103], a[152:155], v[160:163]
  v_mfma_f32_16x16x32_bf16 v[160:163], v[104:107], a[156:159], v[160:163]
  v_cvt_pk_bf16_f32 v164, v124, v128
  v_cvt_pk_bf16_f32 v165, v132, v136
  v_cvt_pk_bf16_f32 v166, v140, v144
  v_cvt_pk_bf16_f32 v167, v148, v152
  s_nop 0
  s_nop 2
  v_cvt_pk_bf16_f32 v180, v156, v160
  s_add_u32 s58, s63, 659456
  buffer_store_dwordx4 v[164:167], v6, s[4:7], s58 offen
  buffer_store_dword v180, v7, s[4:7], s58 offen offset:1024
  v_cvt_pk_bf16_f32 v168, v125, v129
  v_cvt_pk_bf16_f32 v169, v133, v137
  v_cvt_pk_bf16_f32 v170, v141, v145
  v_cvt_pk_bf16_f32 v171, v149, v153
  v_cvt_pk_bf16_f32 v181, v157, v161
  s_add_u32 s58, s63, 700672
  buffer_store_dwordx4 v[168:171], v6, s[4:7], s58 offen
  buffer_store_dword v181, v7, s[4:7], s58 offen offset:1024
  v_cvt_pk_bf16_f32 v172, v126, v130
  v_cvt_pk_bf16_f32 v173, v134, v138
  v_cvt_pk_bf16_f32 v174, v142, v146
  v_cvt_pk_bf16_f32 v175, v150, v154
  v_cvt_pk_bf16_f32 v182, v158, v162
  s_add_u32 s58, s63, 741888
  buffer_store_dwordx4 v[172:175], v6, s[4:7], s58 offen
  buffer_store_dword v182, v7, s[4:7], s58 offen offset:1024
  v_cvt_pk_bf16_f32 v176, v127, v131
  v_cvt_pk_bf16_f32 v177, v135, v139
  v_cvt_pk_bf16_f32 v178, v143, v147
  v_cvt_pk_bf16_f32 v179, v151, v155
  v_cvt_pk_bf16_f32 v183, v159, v163
  s_add_u32 s58, s63, 783104
  buffer_store_dwordx4 v[176:179], v6, s[4:7], s58 offen
  buffer_store_dword v183, v7, s[4:7], s58 offen offset:1024
L_ph_22x:
  s_waitcnt vmcnt(0)
  s_barrier
  s_cmp_lg_u32 s12, 0
  s_cbranch_scc1 L_ps_23
  s_lshl_b32 s58, s13, 2
  s_add_u32 s58, s58, s66
  v_mov_b32 v2, s62
  s_mov_b64 exec, 1
  buffer_store_dword v2, v0, s[4:7], s58 offen offset:0
  s_mov_b64 exec, -1
L_ps_23:
  s_lshr_b32 s58, s13, 4
  s_and_b32 s58, s58, s3
  s_cbranch_scc1 L_p_noln
  s_cmp_lg_u32 s12, 0
  s_cbranch_scc1 L_pw_24x
  s_mov_b32 exec_lo, 0xffffffff
  s_mov_b32 exec_hi, 0
L_pw_24:
  buffer_load_dword v2, v11, s[4:7], s66 offen offset:0 sc1
  s_sub_u32 s54, s54, 1
  s_cbranch_scc1 L_end
  s_waitcnt vmcnt(0)
  v_cmp_gt_u32_e64 vcc, s62, v2
  s_cbranch_vccnz L_pw_24
L_pw_24y:
  s_mov_b64 exec, -1
L_pw_24x:
  s_barrier
  s_cmp_lt_u32 s61, 6
  s_cbranch_scc1 L_q_in
  buffer_load_dwordx4 v[156:159], v9, s[4:7], s72 offen offset:1024 sc1
  s_add_u32 s58, s72, 20480
  buffer_load_dwordx4 v[160:163], v9, s[4:7], s58 offen offset:1024 sc1
  buffer_load_dwordx4 v[124:127], v8, s[4:7], s72 offen sc1
  s_add_u32 s58, s72, 5120
  buffer_load_dwordx4 v[128:131], v8, s[4:7], s58 offen sc1
  s_add_u32 s58, s72, 10240
  buffer_load_dwordx4 v[132:135], v8, s[4:7], s58 offen sc1
  s_add_u32 s58, s72, 15360
  buffer_load_dwordx4 v[136:139], v8, s[4:7], s58 offen sc1
  s_add_u32 s58, s72, 20480
  buffer_load_dwordx4 v[140:143], v8, s[4:7], s58 offen sc1
  s_add_u32 s58, s72, 25600
  buffer_load_dwordx4 v[144:147], v8, s[4:7], s58 offen sc1
  s_add_u32 s58, s72, 30720
  buffer_load_dwordx4 v[148:151], v8, s[4:7], s58 offen sc1
  s_add_u32 s58, s72, 35840
  buffer_load_dwordx4 v[152:155], v8, s[4:7], s58 offen sc1
  v_lshlrev_b32 v168, 16, v56
  v_and_b32 v169, 0xffff0000, v56
  v_lshlrev_b32 v170, 16, v57
  v_and_b32 v171, 0xffff0000, v57
  s_lshl_b32 s58, s12, 3
  s_add_u32 s58, s58, 135168
  v_mov_b32 v2, s58
  v_mov_b32 v3, 135168
  s_waitcnt vmcnt(9)
  v_mfma_f32_16x16x32_bf16 v[164:167], v[20:23], v[156:159], 0
  s_waitcnt vmcnt(8)
  v_mfma_f32_16x16x32_bf16 v[164:167], v[20:23], v[160:163], v[164:167]
  s_nop 0
  s_nop 6
  v_add_f32_dpp v164, v164, v164 row_ror:4 row_mask:0xf bank_mask:0xf
  v_add_f32_dpp v165, v165, v165 row_ror:4 row_mask:0xf bank_mask:0xf
  v_add_f32_dpp v166, v166, v166 row_ror:4 row_mask:0xf bank_mask:0xf
  v_add_f32_dpp v167, v167, v167 row_ror:4 row_mask:0xf bank_mask:0xf
  v_add_f32_dpp v164, v164, v164 row_ror:8 row_mask:0xf bank_mask:0xf
  v_add_f32_dpp v165, v165, v165 row_ror:8 row_mask:0xf bank_mask:0xf
  v_add_f32_dpp v166, v166, v166 row_ror:8 row_mask:0xf bank_mask:0xf
  v_add_f32_dpp v167, v167, v167 row_ror:8 row_mask:0xf bank_mask:0xf
  s_waitcnt vmcnt(7)
  s_nop 0
  v_mfma_f32_16x16x32_bf16 v[164:167], v[16:19], v[124:127], v[164:167]
  s_waitcnt vmcnt(6)
  v_mfma_f32_16x16x32_bf16 v[164:167], v[16:19], v[128:131], v[164:167]
  s_waitcnt vmcnt(5)
  v_mfma_f32_16x16x32_bf16 v[164:167], v[16:19], v[132:135], v[164:167]
  s_waitcnt vmcnt(4)
  v_mfma_f32_16x16x32_bf16 v[164:167], v[16:19], v[136:139], v[164:167]
  s_waitcnt vmcnt(3)
  v_mfma_f32_16x16x32_bf16 v[164:167], v[16:19], v[140:143], v[164:167]
  s_waitcnt vmcnt(2)
  v_mfma_f32_16x16x32_bf16 v[164:167], v[16:19], v[144:147], v[164:167]
  s_waitcnt vmcnt(1)
  v_mfma_f32_16x16x32_bf16 v[164:167], v[16:19], v[148:151], v[164:167]
  s_nop 0
  s_waitcnt vmcnt(0)
  v_mfma_f32_16x16x32_bf16 v[164:167], v[16:19], v[152:155], v[164:167]
  s_nop 7
  v_cvt_pk_bf16_f32 v165, v164, v165
  v_lshlrev_b32 v164, 16, v165
  v_and_b32 v165, 0xffff0000, v165
  v_pk_fma_f32 v[180:181], v[164:165], v[40:41], v[168:169]
  v_cvt_pk_bf16_f32 v56, v180, v181
  v_lshlrev_b32_e64 v180, 16, v56
  v_and_b32 v181, 0xffff0000, v56
  v_cvt_pk_bf16_f32 v167, v166, v167
  v_lshlrev_b32_e64 v166, 16, v167
  v_and_b32 v167, 0xffff0000, v167
  v_pk_fma_f32 v[182:183], v[166:167], v[42:43], v[170:171]
  v_cvt_pk_bf16_f32 v57, v182, v183
  v_lshlrev_b32 v182, 16, v57
  v_and_b32 v183, 0xffff0000, v57
  v_readfirstlane_b32 s58, v180
  s_nop 0
  s_nop 0
  v_subrev_f32 v164, s58, v180
  v_subrev_f32 v165, s58, v181
  v_subrev_f32 v166, s58, v182
  v_subrev_f32 v167, s58, v183
  v_pk_add_f32 v[168:169], v[164:165], v[166:167]
  v_pk_mul_f32 v[170:171], v[164:165], v[164:165]
  v_pk_fma_f32 v[170:171], v[166:167], v[166:167], v[170:171]
  v_add_f32 v168, v168, v169
  v_add_f32 v169, v170, v171
  v_cndmask_b32 v168, 0, v168, s[98:99]
  v_cndmask_b32 v169, 0, v169, s[98:99]
  s_nop 0
  v_add_f32_dpp v168, v168, v168 quad_perm:[1,0,3,2] row_mask:0xf bank_mask:0xf
  v_add_f32_dpp v169, v169, v169 quad_perm:[1,0,3,2] row_mask:0xf bank_mask:0xf
  s_nop 0
  v_add_f32_dpp v168, v168, v168 quad_perm:[2,3,0,1] row_mask:0xf bank_mask:0xf
  v_add_f32_dpp v169, v169, v169 quad_perm:[2,3,0,1] row_mask:0xf bank_mask:0xf
  s_nop 0
  v_add_f32_dpp v168, v168, v168 row_ror:4 row_mask:0xf bank_mask:0xf
  v_add_f32_dpp v169, v169, v169 row_ror:4 row_mask:0xf bank_mask:0xf
  s_nop 0
  v_add_f32_dpp v168, v168, v168 row_ror:8 row_mask:0xf bank_mask:0xf
  v_add_f32_dpp v169, v169, v169 row_ror:8 row_mask:0xf bank_mask:0xf
  v_mov_b64 v[170:171], v[168:169]
  s_nop 0
  s_nop 0
  v_permlane16_swap_b32 v168, v170
  v_permlane16_swap_b32 v169, v171
  v_pk_add_f32 v[168:169], v[168:169], v[170:171]
  v_mov_b64 v[170:171], v[168:169]
  s_nop 0
  s_nop 0
  v_permlane32_swap_b32 v168, v170
  v_permlane32_swap_b32 v169, v171
  v_pk_add_f32 v[168:169], v[168:169], v[170:171]
  v_mul_f32 v170, 0x3bcccccd, v168
  v_fma_f32 v169, -v170, v168, v169
  v_add_f32_e64 v168, s58, v170
  s_mov_b64 exec, 1
  ds_write_b64 v2, v[168:169]
  s_mov_b64 exec, -1
  s_waitcnt lgkmcnt(0)
  s_barrier
  ds_read_b128 v[168:171], v3
  ds_read_b128 v[172:175], v3 offset:16
  s_waitcnt lgkmcnt(1)
  v_pk_add_f32 v[176:177], v[168:169], v[170:171]
  s_waitcnt lgkmcnt(0)
  v_pk_add_f32 v[178:179], v[172:173], v[174:175]
  v_pk_add_f32 v[176:177], v[176:177], v[178:179]
  v_mul_f32 v176, 0x3e800000, v176
  v_sub_f32 v168, v168, v176
  v_sub_f32 v170, v170, v176
  v_sub_f32 v172, v172, v176
  v_sub_f32 v174, v174, v176
  v_mul_f32 v168, v168, v168
  v_fmac_f32 v168, v170, v170
  v_fmac_f32_e64 v168, v172, v172
  v_fmac_f32_e64 v168, v174, v174
  v_fmac_f32 v177, 0x43200000, v168
  v_mov_b32 v168, 0x3727c5ac
  v_fmac_f32 v168, 0x3acccccd, v177
  v_rsq_f32_e64 v168, v168
  v_pk_add_f32 v[164:165], v[180:181], v[176:177] op_sel_hi:[1,0] neg_lo:[0,1] neg_hi:[0,1]
  v_pk_add_f32 v[166:167], v[182:183], v[176:177] op_sel_hi:[1,0] neg_lo:[0,1] neg_hi:[0,1]
  v_pk_mul_f32 v[164:165], v[164:165], v[168:169] op_sel_hi:[1,0]
  v_pk_mul_f32 v[166:167], v[166:167], v[168:169] op_sel_hi:[1,0]
  v_pk_fma_f32 v[164:165], v[164:165], v[48:49], v[44:45]
  v_pk_fma_f32 v[166:167], v[166:167], v[50:51], v[46:47]
  v_cvt_pk_bf16_f32 v164, v164, v165
  v_cvt_pk_bf16_f32 v165, v166, v167
  buffer_store_dwordx2 v[164:165], v12, s[4:7], s65 offen
L_p_noln:
  s_waitcnt vmcnt(0)
  s_barrier
  s_cmp_lg_u32 s12, 0
  s_cbranch_scc1 L_ps_25
  s_lshl_b32 s58, s13, 2
  s_add_u32 s58, s58, s66
  v_mov_b32_e64 v2, s62
  s_mov_b64 exec, 1
  buffer_store_dword v2, v0, s[4:7], s58 offen offset:128
  s_mov_b64 exec, -1
L_ps_25:
  s_mov_b32 s92, s74
  v_mov_b64_e64 v[58:59], v[56:57]
  s_add_u32 s61, s61, 6
  s_lshr_b32 s58, s52, 1
  s_add_u32 s58, s58, 61
  s_sub_u32 s59, s61, 62
  s_cmp_lt_u32 s59, 4
  s_cselect_b32 s15, 1, 0
  s_cselect_b32 s61, s58, s61
L_p_join:
  s_lshl_b32 s58, s61, 5
  s_add_u32 s58, s58, s13
  s_and_b32 s59, s52, s15
  s_lshl_b32 s59, s59, 4
  s_add_u32 s59, s59, s58
  s_mul_i32 s74, s59, 1280
  s_lshl_b32 s67, s58, 13
  s_and_b32 s59, s12, 1
  s_lshl_b32 s59, s59, 10
  s_add_u32 s67, s67, s59
  s_add_u32 s67, s67, 16777216
  s_lshl_b32 s68, s58, 14
  s_add_u32 s68, s68, 33554432
  s_lshr_b32 s69, s58, 2
  s_lshl_b32 s69, s69, 14
  s_and_b32 s59, s13, 3
  s_lshl_b32 s59, s59, 11
  s_add_u32 s69, s69, s59
  s_add_u32 s69, s69, 8388608
  s_lshr_b32 s59, s12, 1
  s_lshl_b32 s59, s59, 10
  s_add_u32 s55, s69, s59
  s_add_u32 s55, s55, 0x2000
  s_lshl_b32 s59, s59, 3
  s_add_u32 s75, s68, s59
  s_cmp_ge_u32 s13, 27
  s_cbranch_scc1 L_p_noffn
  s_cmp_lg_u32 s12, 0
  s_cbranch_scc1 L_pw_26x
  s_mov_b32 exec_lo, 0xffffffff
  s_mov_b32 exec_hi, 0
L_pw_26:
  buffer_load_dword v2, v11, s[4:7], s66 offen offset:128 sc1
  s_sub_u32 s54, s54, 1
  s_cbranch_scc1 L_end
  s_waitcnt vmcnt(0)
  v_cmp_gt_u32 vcc, s62, v2
  s_cbranch_vccnz L_pw_26
L_pw_26y:
  s_mov_b64 exec, -1
L_pw_26x:
  s_barrier
  s_lshl_b32 s60, s12, 11
  s_add_u32 m0, s60, 0
  s_add_u32 s60, s65, m0
  buffer_load_dwordx4 v1, s[4:7], s60 offen sc1 lds
  s_lshl_b32 s60, s12, 11
  s_add_u32 m0, s60, 8192
  s_add_u32 s60, s65, m0
  buffer_load_dwordx4 v1, s[4:7], s60 offen sc1 lds
  s_lshl_b32 s60, s12, 11
  s_add_u32 m0, s60, 16384
  s_add_u32 s60, s65, m0
  buffer_load_dwordx4 v1, s[4:7], s60 offen sc1 lds
  s_lshl_b32 s60, s12, 11
  s_add_u32 m0, s60, 24576
  s_add_u32 s60, s65, m0
  buffer_load_dwordx4 v1, s[4:7], s60 offen sc1 lds
  s_lshl_b32 s60, s12, 11
  s_add_u32 m0, s60, 32768
  s_add_u32 s60, s65, m0
  buffer_load_dwordx4 v1, s[4:7], s60 offen sc1 lds
  s_cmp_lg_u32 s3, 0
  s_cbranch_scc1 L_p_hd
  s_lshl_b32 s60, s12, 11
  s_add_u32 m0, s60, 1024
  s_add_u32 s60, s65, m0
  buffer_load_dwordx4 v1, s[4:7], s60 offen sc1 lds
  s_lshl_b32 s60, s12, 11
  s_add_u32 m0, s60, 9216
  s_add_u32 s60, s65, m0
  buffer_load_dwordx4 v1, s[4:7], s60 offen sc1 lds
  s_lshl_b32 s60, s12, 11
  s_add_u32 m0, s60, 17408
  s_add_u32 s60, s65, m0
  buffer_load_dwordx4 v1, s[4:7], s60 offen sc1 lds
  s_lshl_b32 s60, s12, 11
  s_add_u32 m0, s60, 25600
  s_add_u32 s60, s65, m0
  buffer_load_dwordx4 v1, s[4:7], s60 offen sc1 lds
  s_lshl_b32 s60, s12, 11
  s_add_u32 m0, s60, 33792
  s_add_u32 s60, s65, m0
  buffer_load_dwordx4 v1, s[4:7], s60 offen sc1 lds
  s_waitcnt vmcnt(5)
L_p_hdx:
  s_barrier
  ds_read_b128 v[124:127], v1 offset:0
  ds_read_b128 v[128:131], v1 offset:2048
  ds_read_b128 v[132:135], v1 offset:4096
  ds_read_b128 v[136:139], v1 offset:6144
  s_waitcnt lgkmcnt(3)
  v_mfma_f32_16x16x32_bf16 v[148:151], a[160:163], v[124:127], 0
  ds_read_b128 v[140:143], v1 offset:8192
  v_mfma_f32_16x16x32_bf16 v[152:155], a[164:167], v[124:127], 0
  s_waitcnt lgkmcnt(3)
  v_mfma_f32_16x16x32_bf16 v[148:151], a[168:171], v[128:131], v[148:151]
  ds_read_b128 v[144:147], v1 offset:10240
  v_mfma_f32_16x16x32_bf16 v[152:155], a[172:175], v[128:131], v[152:155]
  s_waitcnt lgkmcnt(3)
  v_mfma_f32_16x16x32_bf16 v[148:151], a[176:179], v[132:135], v[148:151]
  ds_read_b128 v[124:127], v1 offset:12288
  v_mfma_f32_16x16x32_bf16 v[152:155], a[180:183], v[132:135], v[152:155]
  s_waitcnt lgkmcnt(3)
  v_mfma_f32_16x16x32_bf16 v[148:151], a[184:187], v[136:139], v[148:151]
  ds_read_b128 v[128:131], v1 offset:14336
  v_mfma_f32_16x16x32_bf16 v[152:155], a[188:191], v[136:139], v[152:155]
  s_nop 0
  s_waitcnt lgkmcnt(3)
  v_mfma_f32_16x16x32_bf16 v[148:151], a[192:195], v[140:143], v[148:151]
  ds_read_b128 v[132:135], v1 offset:16384
  v_mfma_f32_16x16x32_bf16 v[152:155], a[196:199], v[140:143], v[152:155]
  s_nop 0
  s_waitcnt lgkmcnt(3)
  v_mfma_f32_16x16x32_bf16 v[148:151], a[200:203], v[144:147], v[148:151]
  ds_read_b128 v[136:139], v1 offset:18432
  v_mfma_f32_16x16x32_bf16 v[152:155], a[204:207], v[144:147], v[152:155]
  s_nop 0
  s_waitcnt lgkmcnt(3)
  v_mfma_f32_16x16x32_bf16 v[148:151], a[208:211], v[124:127], v[148:151]
  ds_read_b128 v[140:143], v1 offset:20480
  v_mfma_f32_16x16x32_bf16 v[152:155], a[212:215], v[124:127], v[152:155]
  s_nop 0
  s_waitcnt lgkmcnt(3)
  v_mfma_f32_16x16x32_bf16 v[148:151], a[216:219], v[128:131], v[148:151]
  ds_read_b128 v[144:147], v1 offset:22528
  v_mfma_f32_16x16x32_bf16 v[152:155], a[220:223], v[128:131], v[152:155]
  s_nop 0
  s_waitcnt lgkmcnt(3)
  v_mfma_f32_16x16x32_bf16 v[148:151], a[224:227], v[132:135], v[148:151]
  ds_read_b128 v[124:127], v1 offset:24576
  v_mfma_f32_16x16x32_bf16 v[152:155], a[228:231], v[132:135], v[152:155]
  s_nop 0
  s_waitcnt lgkmcnt(3)
  v_mfma_f32_16x16x32_bf16 v[148:151], a[232:235], v[136:139], v[148:151]
  ds_read_b128 v[128:131], v1 offset:26624
  v_mfma_f32_16x16x32_bf16 v[152:155], a[236:239], v[136:139], v[152:155]
  s_waitcnt vmcnt(0)
  s_barrier
  s_waitcnt lgkmcnt(3)
  v_mfma_f32_16x16x32_bf16 v[148:151], a[240:243], v[140:143], v[148:151]
  s_nop 0
  ds_read_b128 v[132:135], v1 offset:28672
  v_mfma_f32_16x16x32_bf16 v[152:155], a[244:247], v[140:143], v[152:155]
  buffer_load_dwordx4 v[60:63], v1, s[4:7], s67 offen offset:0 sc1
  s_waitcnt lgkmcnt(3)
  v_mfma_f32_16x16x32_bf16 v[148:151], a[248:251], v[144:147], v[148:151]
  s_nop 0
  ds_read_b128 v[136:139], v1 offset:30720
  v_mfma_f32_16x16x32_bf16 v[152:155], a[252:255], v[144:147], v[152:155]
  s_waitcnt lgkmcnt(3)
  v_mfma_f32_16x16x32_bf16 v[148:151], v[192:195], v[124:127], v[148:151]
  s_nop 0
  ds_read_b128 v[140:143], v1 offset:32768
  v_mfma_f32_16x16x32_bf16 v[152:155], v[196:199], v[124:127], v[152:155]
  buffer_load_dwordx4 v[64:67], v1, s[4:7], s67 offen offset:2048 sc1
  s_waitcnt lgkmcnt(3)
  v_mfma_f32_16x16x32_bf16 v[148:151], v[200:203], v[128:131], v[148:151]
  s_nop 0
  ds_read_b128 v[144:147], v1 offset:34816
  v_mfma_f32_16x16x32_bf16 v[152:155], v[204:207], v[128:131], v[152:155]
  s_waitcnt lgkmcnt(3)
  v_mfma_f32_16x16x32_bf16 v[148:151], v[208:211], v[132:135], v[148:151]
  s_nop 0
  ds_read_b128 v[124:127], v1 offset:36864
  v_mfma_f32_16x16x32_bf16 v[152:155], v[212:215], v[132:135], v[152:155]
  s_add_u32 s67, s67, 4096
  buffer_load_dwordx4 v[68:71], v1, s[4:7], s67 offen offset:0 sc1
  s_waitcnt lgkmcnt(3)
  v_mfma_f32_16x16x32_bf16 v[148:151], v[216:219], v[136:139], v[148:151]
  ds_read_b128 v[128:131], v1 offset:38912
  v_mfma_f32_16x16x32_bf16 v[152:155], v[220:223], v[136:139], v[152:155]
  s_waitcnt lgkmcnt(3)
  v_mfma_f32_16x16x32_bf16 v[148:151], v[224:227], v[140:143], v[148:151]
  ds_read_b128 v[132:135], v1 offset:1024
  v_mfma_f32_16x16x32_bf16 v[152:155], v[228:231], v[140:143], v[152:155]
  buffer_load_dwordx4 v[72:75], v1, s[4:7], s67 offen offset:2048 sc1
  s_waitcnt lgkmcnt(3)
  v_mfma_f32_16x16x32_bf16 v[148:151], v[232:235], v[144:147], v[148:151]
  ds_read_b128 v[136:139], v1 offset:3072
  v_mfma_f32_16x16x32_bf16 v[152:155], v[236:239], v[144:147], v[152:155]
  s_waitcnt lgkmcnt(3)
  v_mfma_f32_16x16x32_bf16 v[148:151], v[240:243], v[124:127], v[148:151]
  ds_read_b128 v[140:143], v1 offset:5120
  v_mfma_f32_16x16x32_bf16 v[152:155], v[244:247], v[124:127], v[152:155]
  buffer_load_dwordx4 v[76:79], v1, s[4:7], s68 offen offset:0 sc1
  s_waitcnt lgkmcnt(3)
  v_mfma_f32_16x16x32_bf16 v[148:151], v[248:251], v[128:131], v[148:151]
  ds_read_b128 v[144:147], v1 offset:7168
  v_mfma_f32_16x16x32_bf16 v[152:155], v[252:255], v[128:131], v[152:155]
  s_cmp_lg_u32 s3, 0
  s_cbranch_scc1 L_p_hg
  s_waitcnt lgkmcnt(3)
  v_mfma_f32_16x16x32_bf16 v[156:159], a[160:163], v[132:135], 0
  ds_read_b128 v[124:127], v1 offset:9216
  v_mfma_f32_16x16x32_bf16 v[160:163], a[164:167], v[132:135], 0
  buffer_load_dwordx4 v[80:83], v1, s[4:7], s68 offen offset:1024 sc1
  s_waitcnt lgkmcnt(3)
  v_mfma_f32_16x16x32_bf16 v[156:159], a[168:171], v[136:139], v[156:159]
  s_nop 0
  ds_read_b128 v[128:131], v1 offset:11264
  v_mfma_f32_16x16x32_bf16 v[160:163], a[172:175], v[136:139], v[160:163]
  s_waitcnt lgkmcnt(3)
  v_mfma_f32_16x16x32_bf16 v[156:159], a[176:179], v[140:143], v[156:159]
  s_nop 0
  ds_read_b128 v[132:135], v1 offset:13312
  v_cvt_pk_bf16_f32 v149, v148, v149
  v_mfma_f32_16x16x32_bf16 v[160:163], a[180:183], v[140:143], v[160:163]
  buffer_load_dwordx4 v[108:111], v1, s[4:7], s75 offen offset:2048 sc1
  v_lshlrev_b32 v148, 16, v149
  s_waitcnt lgkmcnt(3)
  v_mfma_f32_16x16x32_bf16 v[156:159], a[184:187], v[144:147], v[156:159]
  ds_read_b128 v[136:139], v1 offset:15360
  v_and_b32 v149, 0xffff0000, v149
  v_mfma_f32_16x16x32_bf16 v[160:163], a[188:191], v[144:147], v[160:163]
  v_cvt_pk_bf16_f32 v151, v150, v151
  s_waitcnt lgkmcnt(3)
  v_mfma_f32_16x16x32_bf16 v[156:159], a[192:195], v[124:127], v[156:159]
  ds_read_b128 v[140:143], v1 offset:17408
  v_lshlrev_b32 v150, 16, v151
  v_mfma_f32_16x16x32_bf16 v[160:163], a[196:199], v[124:127], v[160:163]
  s_add_u32 s68, s68, 4096
  buffer_load_dwordx4 v[84:87], v1, s[4:7], s68 offen offset:0 sc1
  v_and_b32 v151, 0xffff0000, v151
  s_waitcnt lgkmcnt(3)
  v_mfma_f32_16x16x32_bf16 v[156:159], a[200:203], v[128:131], v[156:159]
  s_nop 0
  ds_read_b128 v[144:147], v1 offset:19456
  v_cvt_pk_bf16_f32 v153, v152, v153
  v_mfma_f32_16x16x32_bf16 v[160:163], a[204:207], v[128:131], v[160:163]
  v_lshlrev_b32 v152, 16, v153
  s_waitcnt lgkmcnt(3)
  v_mfma_f32_16x16x32_bf16 v[156:159], a[208:211], v[132:135], v[156:159]
  ds_read_b128 v[124:127], v1 offset:21504
  v_and_b32 v153, 0xffff0000, v153
  v_mfma_f32_16x16x32_bf16 v[160:163], a[212:215], v[132:135], v[160:163]
  buffer_load_dwordx4 v[88:91], v1, s[4:7], s68 offen offset:1024 sc1
  v_cvt_pk_bf16_f32 v155, v154, v155
  s_waitcnt lgkmcnt(3)
  v_mfma_f32_16x16x32_bf16 v[156:159], a[216:219], v[136:139], v[156:159]
  ds_read_b128 v[128:131], v1 offset:23552
  v_lshlrev_b32 v154, 16, v155
  v_mfma_f32_16x16x32_bf16 v[160:163], a[220:223], v[136:139], v[160:163]
  v_and_b32 v155, 0xffff0000, v155
  s_waitcnt lgkmcnt(3)
  v_mfma_f32_16x16x32_bf16 v[156:159], a[224:227], v[140:143], v[156:159]
  ds_read_b128 v[132:135], v1 offset:25600
  v_max_f32 v148, 0, v148
  v_mfma_f32_16x16x32_bf16 v[160:163], a[228:231], v[140:143], v[160:163]
  buffer_load_dwordx4 v[112:115], v1, s[4:7], s75 offen offset:3072 sc1
  v_mul_f32 v148, v148, v152
  s_waitcnt lgkmcnt(3)
  v_mfma_f32_16x16x32_bf16 v[156:159], a[232:235], v[144:147], v[156:159]
  ds_read_b128 v[136:139], v1 offset:27648
  v_max_f32 v149, 0, v149
  v_mfma_f32_16x16x32_bf16 v[160:163], a[236:239], v[144:147], v[160:163]
  v_mul_f32_e64 v149, v149, v153
  s_waitcnt lgkmcnt(3)
  v_mfma_f32_16x16x32_bf16 v[156:159], a[240:243], v[124:127], v[156:159]
  ds_read_b128 v[140:143], v1 offset:29696
  v_max_f32_e64 v150, 0, v150
  v_mfma_f32_16x16x32_bf16 v[160:163], a[244:247], v[124:127], v[160:163]
  s_add_u32 s68, s68, 4096
  s_add_u32 s75, s75, 4096
  buffer_load_dwordx4 v[92:95], v1, s[4:7], s68 offen offset:0 sc1
  v_mul_f32 v150, v150, v154
  s_waitcnt lgkmcnt(3)
  v_mfma_f32_16x16x32_bf16 v[156:159], a[248:251], v[128:131], v[156:159]
  ds_read_b128 v[144:147], v1 offset:31744
  v_max_f32_e64 v151, 0, v151
  v_mfma_f32_16x16x32_bf16 v[160:163], a[252:255], v[128:131], v[160:163]
  v_mul_f32 v151, v151, v155
  s_waitcnt lgkmcnt(3)
  v_mfma_f32_16x16x32_bf16 v[156:159], v[192:195], v[132:135], v[156:159]
  ds_read_b128 v[124:127], v1 offset:33792
  v_cvt_pk_bf16_f32 v148, v148, v149
  v_mfma_f32_16x16x32_bf16 v[160:163], v[196:199], v[132:135], v[160:163]
  buffer_load_dwordx4 v[96:99], v1, s[4:7], s68 offen offset:1024 sc1
  v_cvt_pk_bf16_f32 v149, v150, v151
  s_waitcnt lgkmcnt(3)
  v_mfma_f32_16x16x32_bf16 v[156:159], v[200:203], v[136:139], v[156:159]
  ds_read_b128 v[128:131], v1 offset:35840
  ds_write_b64 v13, v[148:149] offset:0
  v_mfma_f32_16x16x32_bf16 v[160:163], v[204:207], v[136:139], v[160:163]
  s_waitcnt lgkmcnt(4)
  v_mfma_f32_16x16x32_bf16 v[156:159], v[208:211], v[140:143], v[156:159]
  ds_read_b128 v[132:135], v1 offset:37888
  v_mfma_f32_16x16x32_bf16 v[160:163], v[212:215], v[140:143], v[160:163]
  buffer_load_dwordx4 v[116:119], v1, s[4:7], s75 offen offset:2048 sc1
  s_waitcnt lgkmcnt(4)
  v_mfma_f32_16x16x32_bf16 v[156:159], v[216:219], v[144:147], v[156:159]
  ds_read_b128 v[136:139], v1 offset:39936
  v_mfma_f32_16x16x32_bf16 v[160:163], v[220:223], v[144:147], v[160:163]
  s_waitcnt lgkmcnt(4)
  v_mfma_f32_16x16x32_bf16 v[156:159], v[224:227], v[124:127], v[156:159]
  v_mfma_f32_16x16x32_bf16 v[160:163], v[228:231], v[124:127], v[160:163]
  s_add_u32 s68, s68, 4096
  buffer_load_dwordx4 v[100:103], v1, s[4:7], s68 offen offset:0 sc1
  s_waitcnt lgkmcnt(3)
  v_mfma_f32_16x16x32_bf16 v[156:159], v[232:235], v[128:131], v[156:159]
  v_mfma_f32_16x16x32_bf16 v[160:163], v[236:239], v[128:131], v[160:163]
  s_waitcnt lgkmcnt(1)
  v_mfma_f32_16x16x32_bf16 v[156:159], v[240:243], v[132:135], v[156:159]
  v_mfma_f32_16x16x32_bf16 v[160:163], v[244:247], v[132:135], v[160:163]
  buffer_load_dwordx4 v[104:107], v1, s[4:7], s68 offen offset:1024 sc1
  s_waitcnt lgkmcnt(0)
  v_mfma_f32_16x16x32_bf16 v[156:159], v[248:251], v[136:139], v[156:159]
  s_nop 0
  v_mfma_f32_16x16x32_bf16 v[160:163], v[252:255], v[136:139], v[160:163]
  buffer_load_dwordx4 v[120:123], v1, s[4:7], s75 offen offset:3072 sc1
  s_nop 0
  s_nop 1
  v_cvt_pk_bf16_f32 v157, v156, v157
  v_lshlrev_b32 v156, 16, v157
  v_and_b32 v157, 0xffff0000, v157
  v_cvt_pk_bf16_f32 v159, v158, v159
  v_lshlrev_b32 v158, 16, v159
  v_and_b32 v159, 0xffff0000, v159
  v_cvt_pk_bf16_f32 v161, v160, v161
  v_lshlrev_b32 v160, 16, v161
  v_and_b32 v161, 0xffff0000, v161
  v_cvt_pk_bf16_f32 v163, v162, v163
  v_lshlrev_b32 v162, 16, v163
  v_and_b32 v163, 0xffff0000, v163
  v_max_f32 v156, 0, v156
  v_mul_f32 v156, v156, v160
  v_max_f32 v157, 0, v157
  v_mul_f32 v157, v157, v161
  v_max_f32_e64 v158, 0, v158
  v_mul_f32_e64 v158, v158, v162
  v_max_f32_e64 v159, 0, v159
  v_mul_f32_e64 v159, v159, v163
  v_cvt_pk_bf16_f32 v156, v156, v157
  v_cvt_pk_bf16_f32 v157, v158, v159
  ds_write_b64 v13, v[156:157] offset:2048
L_p_hgx:
  v_add_u32 v2, 131072, v1
  s_nop 0
  s_waitcnt lgkmcnt(0)
  s_barrier
  ds_read_b128 v[184:187], v2 offset:0
  ds_read_b128 v[188:191], v2 offset:1024
  ds_read_b128 v[24:27], v14 offset:0
  ds_read_b128 v[28:31], v14 offset:1024
  ds_read_b128 v[32:35], v14 offset:2048
  ds_read_b128 v[36:39], v14 offset:3072
  s_waitcnt lgkmcnt(3)
  v_mfma_f32_16x16x32_bf16 v[124:127], v[184:187], v[24:27], 0
  ds_read_b128 v[24:27], v14 offset:4096
  s_waitcnt lgkmcnt(3)
  v_mfma_f32_16x16x32_bf16 v[124:127], v[188:191], v[28:31], v[124:127]
  ds_read_b128 v[28:31], v14 offset:5120
  s_waitcnt lgkmcnt(3)
  v_mfma_f32_16x16x32_bf16 v[128:131], v[184:187], v[32:35], 0
  ds_read_b128 v[32:35], v14 offset:6144
  s_waitcnt lgkmcnt(3)
  v_mfma_f32_16x16x32_bf16 v[128:131], v[188:191], v[36:39], v[128:131]
  ds_read_b128 v[36:39], v14 offset:7168
  s_waitcnt lgkmcnt(3)
  v_mfma_f32_16x16x32_bf16 v[132:135], v[184:187], v[24:27], 0
  ds_read_b128 v[24:27], v14 offset:8192
  s_waitcnt lgkmcnt(3)
  v_mfma_f32_16x16x32_bf16 v[132:135], v[188:191], v[28:31], v[132:135]
  ds_read_b128 v[28:31], v14 offset:9216
  s_waitcnt lgkmcnt(3)
  v_mfma_f32_16x16x32_bf16 v[136:139], v[184:187], v[32:35], 0
  ds_read_b128 v[32:35], v14 offset:10240
  s_waitcnt lgkmcnt(3)
  v_mfma_f32_16x16x32_bf16 v[136:139], v[188:191], v[36:39], v[136:139]
  ds_read_b128 v[36:39], v14 offset:11264
  s_waitcnt lgkmcnt(3)
  v_mfma_f32_16x16x32_bf16 v[140:143], v[184:187], v[24:27], 0
  ds_read_b128 v[24:27], v14 offset:12288
  s_waitcnt lgkmcnt(3)
  v_mfma_f32_16x16x32_bf16 v[140:143], v[188:191], v[28:31], v[140:143]
  ds_read_b128 v[28:31], v14 offset:13312
  s_waitcnt lgkmcnt(3)
  v_mfma_f32_16x16x32_bf16 v[144:147], v[184:187], v[32:35], 0
  ds_read_b128 v[32:35], v14 offset:14336
  s_waitcnt lgkmcnt(3)
  v_mfma_f32_16x16x32_bf16 v[144:147], v[188:191], v[36:39], v[144:147]
  ds_read_b128 v[36:39], v14 offset:15360
  s_waitcnt lgkmcnt(3)
  v_mfma_f32_16x16x32_bf16 v[148:151], v[184:187], v[24:27], 0
  ds_read_b128 v[24:27], v14 offset:16384
  s_waitcnt lgkmcnt(3)
  v_mfma_f32_16x16x32_bf16 v[148:151], v[188:191], v[28:31], v[148:151]
  ds_read_b128 v[28:31], v14 offset:17408
  s_waitcnt lgkmcnt(3)
  v_mfma_f32_16x16x32_bf16 v[152:155], v[184:187], v[32:35], 0
  ds_read_b128 v[32:35], v14 offset:18432
  s_waitcnt lgkmcnt(3)
  v_mfma_f32_16x16x32_bf16 v[152:155], v[188:191], v[36:39], v[152:155]
  ds_read_b128 v[36:39], v14 offset:19456
  s_waitcnt lgkmcnt(3)
  v_mfma_f32_16x16x32_bf16 v[156:159], v[184:187], v[24:27], 0
  ds_read_b128 v[24:27], v14 offset:0
  s_waitcnt lgkmcnt(3)
  v_mfma_f32_16x16x32_bf16 v[156:159], v[188:191], v[28:31], v[156:159]
  ds_read_b128 v[28:31], v14 offset:1024
  s_waitcnt lgkmcnt(3)
  v_mfma_f32_16x16x32_bf16 v[160:163], v[184:187], v[32:35], 0
  ds_read_b128 v[32:35], v14 offset:2048
  s_waitcnt lgkmcnt(3)
  v_mfma_f32_16x16x32_bf16 v[160:163], v[188:191], v[36:39], v[160:163]
  ds_read_b128 v[36:39], v14 offset:3072
  ds_read_b128 v[184:187], v2 offset:2048
  ds_read_b128 v[188:191], v2 offset:3072
  v_cvt_pk_bf16_f32 v164, v124, v128
  v_cvt_pk_bf16_f32 v165, v132, v136
  v_cvt_pk_bf16_f32 v166, v140, v144
  v_cvt_pk_bf16_f32 v167, v148, v152
  s_nop 0
  v_cvt_pk_bf16_f32 v180, v156, v160
  v_cvt_pk_bf16_f32 v168, v125, v129
  v_cvt_pk_bf16_f32 v169, v133, v137
  v_cvt_pk_bf16_f32 v170, v141, v145
  v_cvt_pk_bf16_f32 v171, v149, v153
  v_cvt_pk_bf16_f32 v181, v157, v161
  v_cvt_pk_bf16_f32 v172, v126, v130
  v_cvt_pk_bf16_f32 v173, v134, v138
  v_cvt_pk_bf16_f32 v174, v142, v146
  v_cvt_pk_bf16_f32 v175, v150, v154
  v_cvt_pk_bf16_f32 v182, v158, v162
  v_cvt_pk_bf16_f32 v176, v127, v131
  v_cvt_pk_bf16_f32 v177, v135, v139
  v_cvt_pk_bf16_f32 v178, v143, v147
  v_cvt_pk_bf16_f32 v179, v151, v155
  v_cvt_pk_bf16_f32 v183, v159, v163
  s_cmp_lg_u32 s3, 0
  s_cbranch_scc1 L_ph_27
  s_waitcnt lgkmcnt(1)
  v_mfma_f32_16x16x32_bf16 v[124:127], v[184:187], v[24:27], 0
  ds_read_b128 v[24:27], v14 offset:4096
  s_waitcnt lgkmcnt(1)
  v_mfma_f32_16x16x32_bf16 v[124:127], v[188:191], v[28:31], v[124:127]
  ds_read_b128 v[28:31], v14 offset:5120
  s_add_u32 s58, s64, 0
  buffer_store_dwordx4 v[164:167], v6, s[4:7], s58 offen
  v_mfma_f32_16x16x32_bf16 v[128:131], v[184:187], v[32:35], 0
  s_nop 0
  ds_read_b128 v[32:35], v14 offset:6144
  v_mfma_f32_16x16x32_bf16 v[128:131], v[188:191], v[36:39], v[128:131]
  ds_read_b128 v[36:39], v14 offset:7168
  buffer_store_dword v180, v7, s[4:7], s58 offen offset:1024
  s_waitcnt lgkmcnt(3)
  v_mfma_f32_16x16x32_bf16 v[132:135], v[184:187], v[24:27], 0
  ds_read_b128 v[24:27], v14 offset:8192
  s_waitcnt lgkmcnt(3)
  v_mfma_f32_16x16x32_bf16 v[132:135], v[188:191], v[28:31], v[132:135]
  ds_read_b128 v[28:31], v14 offset:9216
  s_add_u32 s58, s64, 41216
  buffer_store_dwordx4 v[168:171], v6, s[4:7], s58 offen
  s_waitcnt lgkmcnt(3)
  v_mfma_f32_16x16x32_bf16 v[136:139], v[184:187], v[32:35], 0
  ds_read_b128 v[32:35], v14 offset:10240
  s_waitcnt lgkmcnt(3)
  v_mfma_f32_16x16x32_bf16 v[136:139], v[188:191], v[36:39], v[136:139]
  ds_read_b128 v[36:39], v14 offset:11264
  buffer_store_dword v181, v7, s[4:7], s58 offen offset:1024
  s_waitcnt lgkmcnt(3)
  v_mfma_f32_16x16x32_bf16 v[140:143], v[184:187], v[24:27], 0
  ds_read_b128 v[24:27], v14 offset:12288
  s_waitcnt lgkmcnt(3)
  v_mfma_f32_16x16x32_bf16 v[140:143], v[188:191], v[28:31], v[140:143]
  ds_read_b128 v[28:31], v14 offset:13312
  s_add_u32 s58, s64, 82432
  buffer_store_dwordx4 v[172:175], v6, s[4:7], s58 offen
  s_waitcnt lgkmcnt(3)
  v_mfma_f32_16x16x32_bf16 v[144:147], v[184:187], v[32:35], 0
  ds_read_b128 v[32:35], v14 offset:14336
  s_waitcnt lgkmcnt(3)
  v_mfma_f32_16x16x32_bf16 v[144:147], v[188:191], v[36:39], v[144:147]
  ds_read_b128 v[36:39], v14 offset:15360
  buffer_store_dword v182, v7, s[4:7], s58 offen offset:1024
  s_waitcnt lgkmcnt(3)
  v_mfma_f32_16x16x32_bf16 v[148:151], v[184:187], v[24:27], 0
  ds_read_b128 v[24:27], v14 offset:16384
  s_waitcnt lgkmcnt(3)
  v_mfma_f32_16x16x32_bf16 v[148:151], v[188:191], v[28:31], v[148:151]
  ds_read_b128 v[28:31], v14 offset:17408
  s_add_u32 s58, s64, 123648
  buffer_store_dwordx4 v[176:179], v6, s[4:7], s58 offen
  s_waitcnt lgkmcnt(3)
  v_mfma_f32_16x16x32_bf16 v[152:155], v[184:187], v[32:35], 0
  ds_read_b128 v[32:35], v14 offset:18432
  s_waitcnt lgkmcnt(3)
  v_mfma_f32_16x16x32_bf16 v[152:155], v[188:191], v[36:39], v[152:155]
  ds_read_b128 v[36:39], v14 offset:19456
  buffer_store_dword v183, v7, s[4:7], s58 offen offset:1024
  s_waitcnt lgkmcnt(3)
  v_mfma_f32_16x16x32_bf16 v[156:159], v[184:187], v[24:27], 0
  s_waitcnt lgkmcnt(2)
  v_mfma_f32_16x16x32_bf16 v[156:159], v[188:191], v[28:31], v[156:159]
  s_waitcnt lgkmcnt(1)
  v_mfma_f32_16x16x32_bf16 v[160:163], v[184:187], v[32:35], 0
  s_waitcnt lgkmcnt(0)
  v_mfma_f32_16x16x32_bf16 v[160:163], v[188:191], v[36:39], v[160:163]
  v_cvt_pk_bf16_f32 v164, v124, v128
  v_cvt_pk_bf16_f32 v165, v132, v136
  v_cvt_pk_bf16_f32 v166, v140, v144
  v_cvt_pk_bf16_f32 v167, v148, v152
  s_nop 0
  s_nop 2
  v_cvt_pk_bf16_f32 v180, v156, v160
  s_add_u32 s58, s64, 659456
  buffer_store_dwordx4 v[164:167], v6, s[4:7], s58 offen
  buffer_store_dword v180, v7, s[4:7], s58 offen offset:1024
  v_cvt_pk_bf16_f32 v168, v125, v129
  v_cvt_pk_bf16_f32 v169, v133, v137
  v_cvt_pk_bf16_f32 v170, v141, v145
  v_cvt_pk_bf16_f32 v171, v149, v153
  v_cvt_pk_bf16_f32 v181, v157, v161
  s_add_u32 s58, s64, 700672
  buffer_store_dwordx4 v[168:171], v6, s[4:7], s58 offen
  buffer_store_dword v181, v7, s[4:7], s58 offen offset:1024
  v_cvt_pk_bf16_f32 v172, v126, v130
  v_cvt_pk_bf16_f32 v173, v134, v138
  v_cvt_pk_bf16_f32 v174, v142, v146
  v_cvt_pk_bf16_f32 v175, v150, v154
  v_cvt_pk_bf16_f32 v182, v158, v162
  s_add_u32 s58, s64, 741888
  buffer_store_dwordx4 v[172:175], v6, s[4:7], s58 offen
  buffer_store_dword v182, v7, s[4:7], s58 offen offset:1024
  v_cvt_pk_bf16_f32 v176, v127, v131
  v_cvt_pk_bf16_f32 v177, v135, v139
  v_cvt_pk_bf16_f32 v178, v143, v147
  v_cvt_pk_bf16_f32 v179, v151, v155
  v_cvt_pk_bf16_f32 v183, v159, v163
  s_add_u32 s58, s64, 783104
  buffer_store_dwordx4 v[176:179], v6, s[4:7], s58 offen
  buffer_store_dword v183, v7, s[4:7], s58 offen offset:1024
L_ph_27x:
  s_branch L_p_fin
  s_nop 0
L_p_noffn:
  buffer_load_dwordx4 v[60:63], v1, s[4:7], s67 offen offset:0 sc1
  buffer_load_dwordx4 v[64:67], v1, s[4:7], s67 offen offset:2048 sc1
  s_add_u32 s67, s67, 4096
  buffer_load_dwordx4 v[68:71], v1, s[4:7], s67 offen offset:0 sc1
  buffer_load_dwordx4 v[72:75], v1, s[4:7], s67 offen offset:2048 sc1
  buffer_load_dwordx4 v[76:79], v1, s[4:7], s68 offen offset:0 sc1
  buffer_load_dwordx4 v[80:83], v1, s[4:7], s68 offen offset:1024 sc1
  buffer_load_dwordx4 v[108:111], v1, s[4:7], s75 offen offset:2048 sc1
  s_add_u32 s68, s68, 4096
  buffer_load_dwordx4 v[84:87], v1, s[4:7], s68 offen offset:0 sc1
  buffer_load_dwordx4 v[88:91], v1, s[4:7], s68 offen offset:1024 sc1
  buffer_load_dwordx4 v[112:115], v1, s[4:7], s75 offen offset:3072 sc1
  s_add_u32 s68, s68, 4096
  s_add_u32 s75, s75, 4096
  buffer_load_dwordx4 v[92:95], v1, s[4:7], s68 offen offset:0 sc1
  buffer_load_dwordx4 v[96:99], v1, s[4:7], s68 offen offset:1024 sc1
  buffer_load_dwordx4 v[116:119], v1, s[4:7], s75 offen offset:2048 sc1
  s_add_u32 s68, s68, 4096
  buffer_load_dwordx4 v[100:103], v1, s[4:7], s68 offen offset:0 sc1
  buffer_load_dwordx4 v[104:107], v1, s[4:7], s68 offen offset:1024 sc1
  buffer_load_dwordx4 v[120:123], v1, s[4:7], s75 offen offset:3072 sc1
L_p_fin:
  s_waitcnt vmcnt(0)
  s_barrier
  s_cmp_lg_u32 s12, 0
  s_cbranch_scc1 L_ps_28
  s_lshl_b32 s58, s13, 2
  s_add_u32 s58, s58, s66
  v_mov_b32 v2, s62
  s_mov_b64 exec, 1
  buffer_store_dword v2, v0, s[4:7], s58 offen offset:256
  s_mov_b64 exec, -1
L_ps_28:
  s_lshr_b32 s58, s13, 4
  s_and_b32 s58, s58, s3
  s_cbranch_scc1 L_p_out
  s_cmp_lg_u32 s12, 0
  s_cbranch_scc1 L_pw_29x
  s_mov_b32 exec_lo, 0x7ffffff
  s_mov_b32 exec_hi, 0
L_pw_29:
  buffer_load_dword v2, v11, s[4:7], s66 offen offset:256 sc1
  s_sub_u32 s54, s54, 1
  s_cbranch_scc1 L_end
  s_waitcnt vmcnt(0)
  v_cmp_gt_u32 vcc, s62, v2
  s_cbranch_vccnz L_pw_29
L_pw_29y:
  s_mov_b64 exec, -1
L_pw_29x:
  s_barrier
  v_mov_b32 v3, 0x7f000000
  v_cndmask_b32 v2, v3, v8, s[100:101]
  v_cndmask_b32 v3, v3, v9, s[70:71]
  buffer_load_dwordx4 v[156:159], v9, s[4:7], s73 offen offset:1024 sc1
  s_add_u32 s58, s73, 20480
  buffer_load_dwordx4 v[160:163], v3, s[4:7], s58 offen offset:1024 sc1
  buffer_load_dwordx4 v[124:127], v8, s[4:7], s73 offen sc1
  s_add_u32 s58, s73, 5120
  buffer_load_dwordx4 v[128:131], v8, s[4:7], s58 offen sc1
  s_add_u32 s58, s73, 10240
  buffer_load_dwordx4 v[132:135], v8, s[4:7], s58 offen sc1
  s_add_u32 s58, s73, 15360
  buffer_load_dwordx4 v[136:139], v8, s[4:7], s58 offen sc1
  s_add_u32 s58, s73, 20480
  buffer_load_dwordx4 v[140:143], v8, s[4:7], s58 offen sc1
  s_add_u32 s58, s73, 25600
  buffer_load_dwordx4 v[144:147], v8, s[4:7], s58 offen sc1
  s_add_u32 s58, s73, 30720
  buffer_load_dwordx4 v[148:151], v2, s[4:7], s58 offen sc1
  v_lshlrev_b32_e64 v190, 1, v11
  buffer_load_dwordx4 v[168:171], v4, s[4:7], s69 offen offset:0 sc1
  buffer_load_dwordx2 v[184:185], v190, s[4:7], s55 offen offset:0 sc1
  buffer_load_dwordx4 v[172:175], v4, s[4:7], s69 offen offset:512 sc1
  buffer_load_dwordx2 v[186:187], v190, s[4:7], s55 offen offset:512 sc1
  buffer_load_dwordx4 v[176:179], v4, s[4:7], s69 offen offset:1024 sc1
  buffer_load_dwordx4 v[180:183], v4, s[4:7], s69 offen offset:1536 sc1
  s_waitcnt vmcnt(14)
  v_mfma_f32_16x16x32_bf16 v[164:167], v[20:23], v[156:159], 0
  s_waitcnt vmcnt(13)
  v_mfma_f32_16x16x32_bf16 v[164:167], v[20:23], v[160:163], v[164:167]
  s_nop 0
  s_nop 6
  v_add_f32_dpp v164, v164, v164 row_ror:4 row_mask:0xf bank_mask:0xf
  v_add_f32_dpp v165, v165, v165 row_ror:4 row_mask:0xf bank_mask:0xf
  v_add_f32_dpp v166, v166, v166 row_ror:4 row_mask:0xf bank_mask:0xf
  v_add_f32_dpp v167, v167, v167 row_ror:4 row_mask:0xf bank_mask:0xf
  v_add_f32_dpp v164, v164, v164 row_ror:8 row_mask:0xf bank_mask:0xf
  v_add_f32_dpp v165, v165, v165 row_ror:8 row_mask:0xf bank_mask:0xf
  v_add_f32_dpp v166, v166, v166 row_ror:8 row_mask:0xf bank_mask:0xf
  v_add_f32_dpp v167, v167, v167 row_ror:8 row_mask:0xf bank_mask:0xf
  s_waitcnt vmcnt(12)
  s_nop 0
  v_mfma_f32_16x16x32_bf16 v[164:167], v[16:19], v[124:127], v[164:167]
  s_waitcnt vmcnt(11)
  v_mfma_f32_16x16x32_bf16 v[164:167], v[16:19], v[128:131], v[164:167]
  s_waitcnt vmcnt(10)
  v_mfma_f32_16x16x32_bf16 v[164:167], v[16:19], v[132:135], v[164:167]
  s_waitcnt vmcnt(9)
  v_mfma_f32_16x16x32_bf16 v[164:167], v[16:19], v[136:139], v[164:167]
  s_waitcnt vmcnt(8)
  v_mfma_f32_16x16x32_bf16 v[164:167], v[16:19], v[140:143], v[164:167]
  s_waitcnt vmcnt(7)
  v_mfma_f32_16x16x32_bf16 v[164:167], v[16:19], v[144:147], v[164:167]
  s_waitcnt vmcnt(6)
  v_mfma_f32_16x16x32_bf16 v[164:167], v[16:19], v[148:151], v[164:167]
  v_lshlrev_b32_e64 v160, 16, v58
  v_and_b32 v161, 0xffff0000, v58
  v_lshlrev_b32 v162, 16, v59
  v_and_b32 v163, 0xffff0000, v59
  s_nop 3
  v_cvt_pk_bf16_f32 v165, v164, v165
  v_lshlrev_b32 v164, 16, v165
  v_and_b32 v165, 0xffff0000, v165
  v_pk_fma_f32 v[164:165], v[164:165], v[52:53], v[160:161]
  v_cvt_pk_bf16_f32 v167, v166, v167
  v_lshlrev_b32 v166, 16, v167
  v_and_b32 v167, 0xffff0000, v167
  v_pk_fma_f32 v[166:167], v[166:167], v[54:55], v[162:163]
  v_cvt_pk_bf16_f32 v164, v164, v165
  v_cvt_pk_bf16_f32 v165, v166, v167
  buffer_store_dwordx2 v[164:165], v10, s[48:51], s92 offen
  s_mov_b32 s3, s15
  s_add_u32 s62, s62, 1
  s_cmp_lt_u32 s61, 64
  s_cbranch_scc1 L_p_loop
L_p_out:
  s_branch L_end
L_ph_22:
  s_add_u32 s58, s63, 0
  buffer_store_dwordx4 v[164:167], v6, s[4:7], s58 offen
  buffer_store_dword v180, v7, s[4:7], s58 offen offset:1024
  s_add_u32 s58, s63, 41216
  buffer_store_dwordx4 v[168:171], v6, s[4:7], s58 offen
  buffer_store_dword v181, v7, s[4:7], s58 offen offset:1024
  s_add_u32 s58, s63, 82432
  buffer_store_dwordx4 v[172:175], v6, s[4:7], s58 offen
  buffer_store_dword v182, v7, s[4:7], s58 offen offset:1024
  s_add_u32 s58, s63, 123648
  buffer_store_dwordx4 v[176:179], v6, s[4:7], s58 offen
  buffer_store_dword v183, v7, s[4:7], s58 offen offset:1024
  s_waitcnt lgkmcnt(0)
  s_branch L_ph_22x
L_p_hd:
  s_waitcnt vmcnt(0)
  s_branch L_p_hdx
  s_nop 0
  s_nop 0
  s_nop 0
L_p_hg:
  s_nop 7
  v_cvt_pk_bf16_f32 v149, v148, v149
  v_lshlrev_b32 v148, 16, v149
  v_and_b32 v149, 0xffff0000, v149
  v_cvt_pk_bf16_f32 v151, v150, v151
  v_lshlrev_b32 v150, 16, v151
  v_and_b32 v151, 0xffff0000, v151
  v_cvt_pk_bf16_f32 v153, v152, v153
  v_lshlrev_b32 v152, 16, v153
  v_and_b32 v153, 0xffff0000, v153
  v_cvt_pk_bf16_f32 v155, v154, v155
  v_lshlrev_b32 v154, 16, v155
  v_and_b32 v155, 0xffff0000, v155
  v_max_f32 v148, 0, v148
  v_mul_f32 v148, v148, v152
  v_max_f32 v149, 0, v149
  v_mul_f32 v149, v149, v153
  v_max_f32 v150, 0, v150
  v_mul_f32 v150, v150, v154
  v_max_f32 v151, 0, v151
  v_mul_f32 v151, v151, v155
  v_cvt_pk_bf16_f32 v148, v148, v149
  v_cvt_pk_bf16_f32 v149, v150, v151
  ds_write_b64 v13, v[148:149] offset:0
  s_branch L_p_hgx
L_ph_27:
  s_add_u32 s58, s64, 0
  buffer_store_dwordx4 v[164:167], v6, s[4:7], s58 offen
  buffer_store_dword v180, v7, s[4:7], s58 offen offset:1024
  s_add_u32 s58, s64, 41216
  buffer_store_dwordx4 v[168:171], v6, s[4:7], s58 offen
  buffer_store_dword v181, v7, s[4:7], s58 offen offset:1024
  s_add_u32 s58, s64, 82432
  buffer_store_dwordx4 v[172:175], v6, s[4:7], s58 offen
  buffer_store_dword v182, v7, s[4:7], s58 offen offset:1024
  s_add_u32 s58, s64, 123648
  buffer_store_dwordx4 v[176:179], v6, s[4:7], s58 offen
  buffer_store_dword v183, v7, s[4:7], s58 offen offset:1024
  s_waitcnt lgkmcnt(0)
  s_branch L_ph_27x
  s_nop 0
  s_nop 0
  s_nop 0
  s_nop 0
  s_nop 0
  s_nop 0
L_q_in:
  s_mov_b32 s2, s74
  s_add_u32 s61, s61, 6
  s_lshr_b32 s58, s52, 1
  s_add_u32 s58, s58, 61
  s_sub_u32 s59, s61, 62
  s_cmp_lt_u32 s59, 4
  s_cselect_b32 s15, 1, 0
  s_cselect_b32 s61, s58, s61
  s_lshl_b32 s58, s61, 5
  s_add_u32 s58, s58, s13
  s_and_b32 s59, s52, s15
  s_lshl_b32 s59, s59, 4
  s_add_u32 s59, s59, s58
  s_mul_i32 s74, s59, 1280
  s_lshl_b32 s67, s58, 13
  s_and_b32 s59, s12, 1
  s_lshl_b32 s59, s59, 10
  s_add_u32 s67, s67, s59
  s_add_u32 s67, s67, 16777216
  s_lshl_b32 s68, s58, 14
  s_add_u32 s68, s68, 33554432
  s_lshr_b32 s69, s58, 2
  s_lshl_b32 s69, s69, 14
  s_and_b32 s59, s13, 3
  s_lshl_b32 s59, s59, 11
  s_add_u32 s69, s69, s59
  s_add_u32 s69, s69, 8388608
  s_lshr_b32 s59, s12, 1
  s_lshl_b32 s59, s59, 10
  s_add_u32 s55, s69, s59
  s_add_u32 s55, s55, 0x2000
  s_lshl_b32 s59, s59, 3
  s_add_u32 s75, s68, s59
  buffer_load_dwordx4 v[156:159], v9, s[4:7], s72 offen offset:1024 sc1
  s_add_u32 s58, s72, 20480
  buffer_load_dwordx4 v[160:163], v9, s[4:7], s58 offen offset:1024 sc1
  buffer_load_dwordx4 v[124:127], v8, s[4:7], s72 offen sc1
  s_add_u32 s58, s72, 5120
  buffer_load_dwordx4 v[128:131], v8, s[4:7], s58 offen sc1
  s_add_u32 s58, s72, 10240
  buffer_load_dwordx4 v[132:135], v8, s[4:7], s58 offen sc1
  s_add_u32 s58, s72, 15360
  buffer_load_dwordx4 v[136:139], v8, s[4:7], s58 offen sc1
  s_add_u32 s58, s72, 20480
  buffer_load_dwordx4 v[140:143], v8, s[4:7], s58 offen sc1
  s_add_u32 s58, s72, 25600
  buffer_load_dwordx4 v[144:147], v8, s[4:7], s58 offen sc1
  s_add_u32 s58, s72, 30720
  buffer_load_dwordx4 v[148:151], v8, s[4:7], s58 offen sc1
  s_add_u32 s58, s72, 35840
  buffer_load_dwordx4 v[152:155], v8, s[4:7], s58 offen sc1
  buffer_load_dwordx4 v[60:63], v1, s[4:7], s67 offen offset:0 sc1
  buffer_load_dwordx4 v[64:67], v1, s[4:7], s67 offen offset:2048 sc1
  s_add_u32 s67, s67, 4096
  buffer_load_dwordx4 v[68:71], v1, s[4:7], s67 offen offset:0 sc1
  buffer_load_dwordx4 v[72:75], v1, s[4:7], s67 offen offset:2048 sc1
  buffer_load_dwordx4 v[76:79], v1, s[4:7], s68 offen offset:0 sc1
  buffer_load_dwordx4 v[80:83], v1, s[4:7], s68 offen offset:1024 sc1
  buffer_load_dwordx4 v[108:111], v1, s[4:7], s75 offen offset:2048 sc1
  s_add_u32 s68, s68, 4096
  buffer_load_dwordx4 v[84:87], v1, s[4:7], s68 offen offset:0 sc1
  buffer_load_dwordx4 v[88:91], v1, s[4:7], s68 offen offset:1024 sc1
  buffer_load_dwordx4 v[112:115], v1, s[4:7], s75 offen offset:3072 sc1
  s_add_u32 s68, s68, 4096
  s_add_u32 s75, s75, 4096
  buffer_load_dwordx4 v[92:95], v1, s[4:7], s68 offen offset:0 sc1
  buffer_load_dwordx4 v[96:99], v1, s[4:7], s68 offen offset:1024 sc1
  buffer_load_dwordx4 v[116:119], v1, s[4:7], s75 offen offset:2048 sc1
  s_add_u32 s68, s68, 4096
  buffer_load_dwordx4 v[100:103], v1, s[4:7], s68 offen offset:0 sc1
  buffer_load_dwordx4 v[104:107], v1, s[4:7], s68 offen offset:1024 sc1
  buffer_load_dwordx4 v[120:123], v1, s[4:7], s75 offen offset:3072 sc1
  v_lshlrev_b32 v168, 16, v56
  v_and_b32 v169, 0xffff0000, v56
  v_lshlrev_b32 v170, 16, v57
  v_and_b32 v171, 0xffff0000, v57
  s_lshl_b32 s58, s12, 3
  s_add_u32 s58, s58, 135168
  v_mov_b32 v2, s58
  v_mov_b32 v3, 135168
  s_waitcnt vmcnt(25)
  v_mfma_f32_16x16x32_bf16 v[164:167], v[20:23], v[156:159], 0
  s_waitcnt vmcnt(24)
  v_mfma_f32_16x16x32_bf16 v[164:167], v[20:23], v[160:163], v[164:167]
  s_nop 0
  s_nop 6
  v_add_f32_dpp v164, v164, v164 row_ror:4 row_mask:0xf bank_mask:0xf
  v_add_f32_dpp v165, v165, v165 row_ror:4 row_mask:0xf bank_mask:0xf
  v_add_f32_dpp v166, v166, v166 row_ror:4 row_mask:0xf bank_mask:0xf
  v_add_f32_dpp v167, v167, v167 row_ror:4 row_mask:0xf bank_mask:0xf
  v_add_f32_dpp v164, v164, v164 row_ror:8 row_mask:0xf bank_mask:0xf
  v_add_f32_dpp v165, v165, v165 row_ror:8 row_mask:0xf bank_mask:0xf
  v_add_f32_dpp v166, v166, v166 row_ror:8 row_mask:0xf bank_mask:0xf
  v_add_f32_dpp v167, v167, v167 row_ror:8 row_mask:0xf bank_mask:0xf
  s_waitcnt vmcnt(23)
  s_nop 0
  v_mfma_f32_16x16x32_bf16 v[164:167], v[16:19], v[124:127], v[164:167]
  s_waitcnt vmcnt(22)
  v_mfma_f32_16x16x32_bf16 v[164:167], v[16:19], v[128:131], v[164:167]
  s_waitcnt vmcnt(21)
  v_mfma_f32_16x16x32_bf16 v[164:167], v[16:19], v[132:135], v[164:167]
  s_waitcnt vmcnt(20)
  v_mfma_f32_16x16x32_bf16 v[164:167], v[16:19], v[136:139], v[164:167]
  s_waitcnt vmcnt(19)
  v_mfma_f32_16x16x32_bf16 v[164:167], v[16:19], v[140:143], v[164:167]
  s_waitcnt vmcnt(18)
  v_mfma_f32_16x16x32_bf16 v[164:167], v[16:19], v[144:147], v[164:167]
  s_waitcnt vmcnt(17)
  v_mfma_f32_16x16x32_bf16 v[164:167], v[16:19], v[148:151], v[164:167]
  s_nop 0
  s_waitcnt vmcnt(16)
  v_mfma_f32_16x16x32_bf16 v[164:167], v[16:19], v[152:155], v[164:167]
  s_nop 7
  v_cvt_pk_bf16_f32 v165, v164, v165
  v_lshlrev_b32 v164, 16, v165
  v_and_b32 v165, 0xffff0000, v165
  v_pk_fma_f32 v[180:181], v[164:165], v[40:41], v[168:169]
  v_cvt_pk_bf16_f32 v56, v180, v181
  v_lshlrev_b32_e64 v180, 16, v56
  v_and_b32 v181, 0xffff0000, v56
  v_cvt_pk_bf16_f32 v167, v166, v167
  v_lshlrev_b32_e64 v166, 16, v167
  v_and_b32 v167, 0xffff0000, v167
  v_pk_fma_f32 v[182:183], v[166:167], v[42:43], v[170:171]
  v_cvt_pk_bf16_f32 v57, v182, v183
  v_lshlrev_b32 v182, 16, v57
  v_and_b32 v183, 0xffff0000, v57
  v_readfirstlane_b32 s58, v180
  s_nop 0
  s_nop 0
  v_subrev_f32 v164, s58, v180
  v_subrev_f32 v165, s58, v181
  v_subrev_f32 v166, s58, v182
  v_subrev_f32 v167, s58, v183
  v_pk_add_f32 v[168:169], v[164:165], v[166:167]
  v_pk_mul_f32 v[170:171], v[164:165], v[164:165]
  v_pk_fma_f32 v[170:171], v[166:167], v[166:167], v[170:171]
  v_add_f32 v168, v168, v169
  v_add_f32 v169, v170, v171
  v_cndmask_b32 v168, 0, v168, s[98:99]
  v_cndmask_b32 v169, 0, v169, s[98:99]
  s_nop 0
  v_add_f32_dpp v168, v168, v168 quad_perm:[1,0,3,2] row_mask:0xf bank_mask:0xf
  v_add_f32_dpp v169, v169, v169 quad_perm:[1,0,3,2] row_mask:0xf bank_mask:0xf
  s_nop 0
  v_add_f32_dpp v168, v168, v168 quad_perm:[2,3,0,1] row_mask:0xf bank_mask:0xf
  v_add_f32_dpp v169, v169, v169 quad_perm:[2,3,0,1] row_mask:0xf bank_mask:0xf
  s_nop 0
  v_add_f32_dpp v168, v168, v168 row_ror:4 row_mask:0xf bank_mask:0xf
  v_add_f32_dpp v169, v169, v169 row_ror:4 row_mask:0xf bank_mask:0xf
  s_nop 0
  v_add_f32_dpp v168, v168, v168 row_ror:8 row_mask:0xf bank_mask:0xf
  v_add_f32_dpp v169, v169, v169 row_ror:8 row_mask:0xf bank_mask:0xf
  v_mov_b64 v[170:171], v[168:169]
  s_nop 0
  s_nop 0
  v_permlane16_swap_b32 v168, v170
  v_permlane16_swap_b32 v169, v171
  v_pk_add_f32 v[168:169], v[168:169], v[170:171]
  v_mov_b64 v[170:171], v[168:169]
  s_nop 0
  s_nop 0
  v_permlane32_swap_b32 v168, v170
  v_permlane32_swap_b32 v169, v171
  v_pk_add_f32 v[168:169], v[168:169], v[170:171]
  v_mul_f32 v170, 0x3bcccccd, v168
  v_fma_f32 v169, -v170, v168, v169
  v_add_f32_e64 v168, s58, v170
  s_mov_b64 exec, 1
  ds_write_b64 v2, v[168:169]
  s_mov_b64 exec, -1
  s_waitcnt lgkmcnt(0)
  s_barrier
  ds_read_b128 v[168:171], v3
  ds_read_b128 v[172:175], v3 offset:16
  s_waitcnt lgkmcnt(1)
  v_pk_add_f32 v[176:177], v[168:169], v[170:171]
  s_waitcnt lgkmcnt(0)
  v_pk_add_f32 v[178:179], v[172:173], v[174:175]
  v_pk_add_f32 v[176:177], v[176:177], v[178:179]
  v_mul_f32 v176, 0x3e800000, v176
  v_sub_f32 v168, v168, v176
  v_sub_f32 v170, v170, v176
  v_sub_f32 v172, v172, v176
  v_sub_f32 v174, v174, v176
  v_mul_f32 v168, v168, v168
  v_fmac_f32 v168, v170, v170
  v_fmac_f32 v168, v172, v172
  v_fmac_f32 v168, v174, v174
  v_fmac_f32 v177, 0x43200000, v168
  v_mov_b32 v168, 0x3727c5ac
  v_fmac_f32 v168, 0x3acccccd, v177
  v_rsq_f32_e64 v168, v168
  v_pk_add_f32 v[164:165], v[180:181], v[176:177] op_sel_hi:[1,0] neg_lo:[0,1] neg_hi:[0,1]
  v_pk_add_f32 v[166:167], v[182:183], v[176:177] op_sel_hi:[1,0] neg_lo:[0,1] neg_hi:[0,1]
  v_pk_mul_f32 v[164:165], v[164:165], v[168:169] op_sel_hi:[1,0]
  v_pk_mul_f32 v[166:167], v[166:167], v[168:169] op_sel_hi:[1,0]
  v_pk_fma_f32 v[164:165], v[164:165], v[48:49], v[44:45]
  v_pk_fma_f32 v[166:167], v[166:167], v[50:51], v[46:47]
  v_cvt_pk_bf16_f32 v164, v164, v165
  v_cvt_pk_bf16_f32 v165, v166, v167
  buffer_store_dwordx2 v[164:165], v12, s[4:7], s65 offen
  v_lshlrev_b32_e64 v190, 1, v11
  buffer_load_dwordx4 v[168:171], v4, s[4:7], s69 offen offset:0 sc1
  buffer_load_dwordx2 v[184:185], v190, s[4:7], s55 offen offset:0 sc1
  buffer_load_dwordx4 v[172:175], v4, s[4:7], s69 offen offset:512 sc1
  buffer_load_dwordx2 v[186:187], v190, s[4:7], s55 offen offset:512 sc1
  buffer_load_dwordx4 v[176:179], v4, s[4:7], s69 offen offset:1024 sc1
  buffer_load_dwordx4 v[180:183], v4, s[4:7], s69 offen offset:1536 sc1
  s_waitcnt vmcnt(6)
  s_barrier
  s_cmp_lg_u32 s12, 0
  s_cbranch_scc1 L_ps_30
  s_lshl_b32 s58, s13, 2
  s_add_u32 s58, s58, s66
  v_mov_b32 v2, s62
  s_mov_b64 exec, 1
  buffer_store_dword v2, v0, s[4:7], s58 offen offset:128
  s_mov_b64 exec, -1
L_ps_30:
  s_branch L_q_att
  s_nop 0
L_q_loop:
  s_sub_u32 s93, s62, 1
  buffer_load_dwordx4 v[156:159], v9, s[4:7], s72 offen offset:1024 sc1
  s_add_u32 s58, s72, 20480
  buffer_load_dwordx4 v[160:163], v9, s[4:7], s58 offen offset:1024 sc1
  buffer_load_dwordx4 v[124:127], v8, s[4:7], s72 offen sc1
  s_add_u32 s58, s72, 5120
  buffer_load_dwordx4 v[128:131], v8, s[4:7], s58 offen sc1
  s_add_u32 s58, s72, 10240
  buffer_load_dwordx4 v[132:135], v8, s[4:7], s58 offen sc1
  s_add_u32 s58, s72, 15360
  buffer_load_dwordx4 v[136:139], v8, s[4:7], s58 offen sc1
  s_add_u32 s58, s72, 20480
  buffer_load_dwordx4 v[140:143], v8, s[4:7], s58 offen sc1
  s_add_u32 s58, s72, 25600
  buffer_load_dwordx4 v[144:147], v8, s[4:7], s58 offen sc1
  s_add_u32 s58, s72, 30720
  buffer_load_dwordx4 v[148:151], v8, s[4:7], s58 offen sc1
  s_add_u32 s58, s72, 35840
  buffer_load_dwordx4 v[152:155], v8, s[4:7], s58 offen sc1
  s_waitcnt vmcnt(10)
  s_barrier
  s_cmp_lg_u32 s12, 0
  s_cbranch_scc1 L_ps_31
  s_lshl_b32 s58, s13, 2
  s_add_u32 s58, s58, s66
  v_mov_b32 v2, s93
  s_mov_b64 exec, 1
  buffer_store_dword v2, v0, s[4:7], s58 offen offset:256
  s_mov_b64 exec, -1
L_ps_31:
  v_lshlrev_b32 v168, 16, v56
  v_and_b32 v169, 0xffff0000, v56
  v_lshlrev_b32 v170, 16, v57
  v_and_b32 v171, 0xffff0000, v57
  s_lshl_b32 s58, s12, 3
  s_add_u32 s58, s58, 135168
  v_mov_b32 v2, s58
  v_mov_b32 v3, 135168
  s_waitcnt vmcnt(9)
  v_mfma_f32_16x16x32_bf16 v[164:167], v[20:23], v[156:159], 0
  s_waitcnt vmcnt(8)
  v_mfma_f32_16x16x32_bf16 v[164:167], v[20:23], v[160:163], v[164:167]
  s_nop 0
  s_nop 0
  s_nop 5
  v_add_f32_dpp v164, v164, v164 row_ror:4 row_mask:0xf bank_mask:0xf
  v_add_f32_dpp v165, v165, v165 row_ror:4 row_mask:0xf bank_mask:0xf
  v_add_f32_dpp v166, v166, v166 row_ror:4 row_mask:0xf bank_mask:0xf
  v_add_f32_dpp v167, v167, v167 row_ror:4 row_mask:0xf bank_mask:0xf
  v_add_f32_dpp v164, v164, v164 row_ror:8 row_mask:0xf bank_mask:0xf
  v_add_f32_dpp v165, v165, v165 row_ror:8 row_mask:0xf bank_mask:0xf
  v_add_f32_dpp v166, v166, v166 row_ror:8 row_mask:0xf bank_mask:0xf
  v_add_f32_dpp v167, v167, v167 row_ror:8 row_mask:0xf bank_mask:0xf
  s_waitcnt vmcnt(7)
  s_nop 0
  v_mfma_f32_16x16x32_bf16 v[164:167], v[16:19], v[124:127], v[164:167]
  s_waitcnt vmcnt(6)
  v_mfma_f32_16x16x32_bf16 v[164:167], v[16:19], v[128:131], v[164:167]
  s_waitcnt vmcnt(5)
  v_mfma_f32_16x16x32_bf16 v[164:167], v[16:19], v[132:135], v[164:167]
  s_waitcnt vmcnt(4)
  v_mfma_f32_16x16x32_bf16 v[164:167], v[16:19], v[136:139], v[164:167]
  s_waitcnt vmcnt(3)
  v_mfma_f32_16x16x32_bf16 v[164:167], v[16:19], v[140:143], v[164:167]
  s_nop 0
  s_waitcnt vmcnt(2)
  v_mfma_f32_16x16x32_bf16 v[164:167], v[16:19], v[144:147], v[164:167]
  s_waitcnt vmcnt(1)
  v_mfma_f32_16x16x32_bf16 v[164:167], v[16:19], v[148:151], v[164:167]
  s_waitcnt vmcnt(0)
  v_mfma_f32_16x16x32_bf16 v[164:167], v[16:19], v[152:155], v[164:167]
  s_nop 0
  s_nop 0
  s_nop 5
  v_cvt_pk_bf16_f32 v165, v164, v165
  v_lshlrev_b32 v164, 16, v165
  v_and_b32 v165, 0xffff0000, v165
  v_pk_fma_f32 v[180:181], v[164:165], v[40:41], v[168:169]
  v_cvt_pk_bf16_f32 v56, v180, v181
  v_lshlrev_b32_e64 v180, 16, v56
  v_and_b32 v181, 0xffff0000, v56
  v_cvt_pk_bf16_f32 v167, v166, v167
  v_lshlrev_b32_e64 v166, 16, v167
  v_and_b32 v167, 0xffff0000, v167
  v_pk_fma_f32 v[182:183], v[166:167], v[42:43], v[170:171]
  v_cvt_pk_bf16_f32 v57, v182, v183
  v_lshlrev_b32 v182, 16, v57
  v_and_b32 v183, 0xffff0000, v57
  v_readfirstlane_b32 s58, v180
  s_nop 0
  s_nop 0
  v_subrev_f32 v164, s58, v180
  v_subrev_f32 v165, s58, v181
  v_subrev_f32 v166, s58, v182
  v_subrev_f32 v167, s58, v183
  v_pk_add_f32 v[168:169], v[164:165], v[166:167]
  v_pk_mul_f32 v[170:171], v[164:165], v[164:165]
  v_pk_fma_f32 v[170:171], v[166:167], v[166:167], v[170:171]
  v_add_f32 v168, v168, v169
  v_add_f32 v169, v170, v171
  v_cndmask_b32 v168, 0, v168, s[98:99]
  v_cndmask_b32 v169, 0, v169, s[98:99]
  s_nop 0
  v_add_f32_dpp v168, v168, v168 quad_perm:[1,0,3,2] row_mask:0xf bank_mask:0xf
  v_add_f32_dpp v169, v169, v169 quad_perm:[1,0,3,2] row_mask:0xf bank_mask:0xf
  s_nop 0
  v_add_f32_dpp v168, v168, v168 quad_perm:[2,3,0,1] row_mask:0xf bank_mask:0xf
  v_add_f32_dpp v169, v169, v169 quad_perm:[2,3,0,1] row_mask:0xf bank_mask:0xf
  s_nop 0
  v_add_f32_dpp v168, v168, v168 row_ror:4 row_mask:0xf bank_mask:0xf
  v_add_f32_dpp v169, v169, v169 row_ror:4 row_mask:0xf bank_mask:0xf
  s_nop 0
  v_add_f32_dpp v168, v168, v168 row_ror:8 row_mask:0xf bank_mask:0xf
  v_add_f32_dpp v169, v169, v169 row_ror:8 row_mask:0xf bank_mask:0xf
  buffer_load_dword v24, v11, s[4:7], s66 offen offset:256 sc1
  v_mov_b64 v[170:171], v[168:169]
  s_nop 1
  v_permlane16_swap_b32 v168, v170
  v_permlane16_swap_b32 v169, v171
  v_pk_add_f32 v[168:169], v[168:169], v[170:171]
  v_mov_b64 v[170:171], v[168:169]
  s_nop 0
  s_nop 0
  v_permlane32_swap_b32 v168, v170
  v_permlane32_swap_b32 v169, v171
  v_pk_add_f32 v[168:169], v[168:169], v[170:171]
  v_mul_f32 v170, 0x3bcccccd, v168
  v_fma_f32 v169, -v170, v168, v169
  v_add_f32 v168, s58, v170
  s_mov_b64 exec, 1
  ds_write_b64 v2, v[168:169]
  s_mov_b64 exec, -1
  s_waitcnt lgkmcnt(0)
  s_barrier
  ds_read_b128 v[168:171], v3
  ds_read_b128 v[172:175], v3 offset:16
  s_waitcnt lgkmcnt(1)
  v_pk_add_f32 v[176:177], v[168:169], v[170:171]
  s_waitcnt lgkmcnt(0)
  v_pk_add_f32 v[178:179], v[172:173], v[174:175]
  v_pk_add_f32 v[176:177], v[176:177], v[178:179]
  v_mul_f32 v176, 0x3e800000, v176
  v_sub_f32 v168, v168, v176
  v_sub_f32 v170, v170, v176
  v_sub_f32 v172, v172, v176
  v_sub_f32 v174, v174, v176
  v_mul_f32 v168, v168, v168
  v_fmac_f32 v168, v170, v170
  v_fmac_f32 v168, v172, v172
  v_fmac_f32 v168, v174, v174
  v_fmac_f32 v177, 0x43200000, v168
  v_mov_b32 v168, 0x3727c5ac
  v_fmac_f32 v168, 0x3acccccd, v177
  v_rsq_f32_e64 v168, v168
  v_pk_add_f32 v[164:165], v[180:181], v[176:177] op_sel_hi:[1,0] neg_lo:[0,1] neg_hi:[0,1]
  v_pk_add_f32 v[166:167], v[182:183], v[176:177] op_sel_hi:[1,0] neg_lo:[0,1] neg_hi:[0,1]
  v_pk_mul_f32 v[164:165], v[164:165], v[168:169] op_sel_hi:[1,0]
  v_pk_mul_f32 v[166:167], v[166:167], v[168:169] op_sel_hi:[1,0]
  v_pk_fma_f32 v[164:165], v[164:165], v[48:49], v[44:45]
  v_pk_fma_f32 v[166:167], v[166:167], v[50:51], v[46:47]
  v_cvt_pk_bf16_f32 v164, v164, v165
  v_cvt_pk_bf16_f32 v165, v166, v167
  buffer_store_dwordx2 v[164:165], v12, s[4:7], s65 offen
  s_mov_b32 exec_lo, 0x7ffffff
  s_mov_b32 exec_hi, 0
  s_waitcnt vmcnt(1)
  v_cmp_gt_u32 vcc, s93, v24
  s_cbranch_vccz L_pw_32y
L_pw_32:
  buffer_load_dword v2, v11, s[4:7], s66 offen offset:256 sc1
  s_sub_u32 s54, s54, 1
  s_cbranch_scc1 L_end
  s_waitcnt vmcnt(0)
  v_cmp_gt_u32 vcc, s93, v2
  s_cbranch_vccnz L_pw_32
L_pw_32y:
  s_mov_b64 exec, -1
L_pw_32x:
  v_mov_b32 v3, 0x7f000000
  v_cndmask_b32 v2, v3, v8, s[100:101]
  v_cndmask_b32 v3, v3, v9, s[70:71]
  buffer_load_dwordx4 v[156:159], v9, s[4:7], s73 offen offset:1024 sc1
  s_add_u32 s58, s73, 20480
  buffer_load_dwordx4 v[160:163], v3, s[4:7], s58 offen offset:1024 sc1
  buffer_load_dwordx4 v[124:127], v8, s[4:7], s73 offen sc1
  s_add_u32 s58, s73, 5120
  buffer_load_dwordx4 v[128:131], v8, s[4:7], s58 offen sc1
  s_add_u32 s58, s73, 10240
  buffer_load_dwordx4 v[132:135], v8, s[4:7], s58 offen sc1
  s_add_u32 s58, s73, 15360
  buffer_load_dwordx4 v[136:139], v8, s[4:7], s58 offen sc1
  s_add_u32 s58, s73, 20480
  buffer_load_dwordx4 v[140:143], v8, s[4:7], s58 offen sc1
  s_add_u32 s58, s73, 25600
  buffer_load_dwordx4 v[144:147], v8, s[4:7], s58 offen sc1
  s_add_u32 s58, s73, 30720
  buffer_load_dwordx4 v[148:151], v2, s[4:7], s58 offen sc1
  s_waitcnt vmcnt(9)
  s_barrier
  s_cmp_lg_u32 s12, 0
  s_cbranch_scc1 L_ps_33
  s_lshl_b32 s58, s13, 2
  s_add_u32 s58, s58, s66
  v_mov_b32 v2, s62
  s_mov_b64 exec, 1
  buffer_store_dword v2, v0, s[4:7], s58 offen offset:128
  s_mov_b64 exec, -1
L_ps_33:
  v_lshlrev_b32 v190, 1, v11
  buffer_load_dwordx4 v[168:171], v4, s[4:7], s69 offen offset:0 sc1
  buffer_load_dwordx2 v[184:185], v190, s[4:7], s55 offen offset:0 sc1
  buffer_load_dwordx4 v[172:175], v4, s[4:7], s69 offen offset:512 sc1
  buffer_load_dwordx2 v[186:187], v190, s[4:7], s55 offen offset:512 sc1
  buffer_load_dwordx4 v[176:179], v4, s[4:7], s69 offen offset:1024 sc1
  buffer_load_dwordx4 v[180:183], v4, s[4:7], s69 offen offset:1536 sc1
  s_waitcnt vmcnt(14)
  v_mfma_f32_16x16x32_bf16 v[164:167], v[20:23], v[156:159], 0
  s_waitcnt vmcnt(13)
  v_mfma_f32_16x16x32_bf16 v[164:167], v[20:23], v[160:163], v[164:167]
  s_nop 0
  s_nop 0
  s_nop 0
  s_nop 4
  v_add_f32_dpp v164, v164, v164 row_ror:4 row_mask:0xf bank_mask:0xf
  v_add_f32_dpp v165, v165, v165 row_ror:4 row_mask:0xf bank_mask:0xf
  v_add_f32_dpp v166, v166, v166 row_ror:4 row_mask:0xf bank_mask:0xf
  v_add_f32_dpp v167, v167, v167 row_ror:4 row_mask:0xf bank_mask:0xf
  v_add_f32_dpp v164, v164, v164 row_ror:8 row_mask:0xf bank_mask:0xf
  v_add_f32_dpp v165, v165, v165 row_ror:8 row_mask:0xf bank_mask:0xf
  v_add_f32_dpp v166, v166, v166 row_ror:8 row_mask:0xf bank_mask:0xf
  v_add_f32_dpp v167, v167, v167 row_ror:8 row_mask:0xf bank_mask:0xf
  s_waitcnt vmcnt(12)
  s_nop 0
  v_mfma_f32_16x16x32_bf16 v[164:167], v[16:19], v[124:127], v[164:167]
  s_waitcnt vmcnt(11)
  v_mfma_f32_16x16x32_bf16 v[164:167], v[16:19], v[128:131], v[164:167]
  s_waitcnt vmcnt(10)
  v_mfma_f32_16x16x32_bf16 v[164:167], v[16:19], v[132:135], v[164:167]
  s_nop 0
  s_waitcnt vmcnt(9)
  v_mfma_f32_16x16x32_bf16 v[164:167], v[16:19], v[136:139], v[164:167]
  s_waitcnt vmcnt(8)
  v_mfma_f32_16x16x32_bf16 v[164:167], v[16:19], v[140:143], v[164:167]
  s_waitcnt vmcnt(7)
  v_mfma_f32_16x16x32_bf16 v[164:167], v[16:19], v[144:147], v[164:167]
  s_waitcnt vmcnt(6)
  v_mfma_f32_16x16x32_bf16 v[164:167], v[16:19], v[148:151], v[164:167]
  v_lshlrev_b32 v160, 16, v58
  v_and_b32 v161, 0xffff0000, v58
  v_lshlrev_b32_e64 v162, 16, v59
  v_and_b32 v163, 0xffff0000, v59
  s_nop 0
  s_nop 0
  s_nop 0
  s_nop 0
  v_cvt_pk_bf16_f32 v165, v164, v165
  v_lshlrev_b32 v164, 16, v165
  v_and_b32 v165, 0xffff0000, v165
  v_pk_fma_f32 v[164:165], v[164:165], v[52:53], v[160:161]
  v_cvt_pk_bf16_f32 v167, v166, v167
  v_lshlrev_b32 v166, 16, v167
  v_and_b32 v167, 0xffff0000, v167
  v_pk_fma_f32 v[166:167], v[166:167], v[54:55], v[162:163]
  v_cvt_pk_bf16_f32 v164, v164, v165
  v_cvt_pk_bf16_f32 v165, v166, v167
  buffer_store_dwordx2 v[164:165], v10, s[48:51], s92 offen
  s_waitcnt vmcnt(63)
  s_barrier
  s_cmp_lg_u32 s12, 0
  s_cbranch_scc1 L_ps_34
  s_lshl_b32 s58, s13, 2
  s_add_u32 s58, s58, s66
  v_mov_b32 v2, s93
  s_mov_b64 exec, 1
  buffer_store_dword v2, v0, s[4:7], s58 offen offset:384
  s_mov_b64 exec, -1
L_ps_34:
L_q_att:
  s_mov_b32 s92, s2
  v_mov_b64 v[58:59], v[56:57]
  s_cmp_lt_u32 s61, 56
  s_cbranch_scc1 L_q_go
  s_sub_u32 s93, s62, 1
  s_cmp_lg_u32 s12, 0
  s_cbranch_scc1 L_pw_35x
  s_mov_b32 exec_lo, 0xffffffff
  s_mov_b32 exec_hi, 0
L_pw_35:
  buffer_load_dword v2, v11, s[4:7], s66 offen offset:384 sc1
  s_sub_u32 s54, s54, 1
  s_cbranch_scc1 L_end
  s_waitcnt vmcnt(0)
  v_cmp_gt_u32 vcc, s93, v2
  s_cbranch_vccnz L_pw_35
L_pw_35y:
  s_mov_b64 exec, -1
L_pw_35x:
  s_barrier
  s_waitcnt vmcnt(0)
  s_branch L_p_join
  s_nop 0
L_q_go:
  s_add_u32 s96, s62, 1
  s_sub_u32 s93, s62, 1
  v_mfma_f32_16x16x32_bf16 v[124:127], v[76:79], v[60:63], 0
  v_mfma_f32_16x16x32_bf16 v[124:127], v[84:87], v[64:67], v[124:127]
  v_mfma_f32_16x16x32_bf16 v[124:127], v[92:95], v[68:71], v[124:127]
  v_mfma_f32_16x16x32_bf16 v[124:127], v[100:103], v[72:75], v[124:127]
  v_mfma_f32_16x16x32_bf16 v[128:131], v[80:83], v[60:63], 0
  v_mfma_f32_16x16x32_bf16 v[128:131], v[88:91], v[64:67], v[128:131]
  v_mfma_f32_16x16x32_bf16 v[128:131], v[96:99], v[68:71], v[128:131]
  v_mfma_f32_16x16x32_bf16 v[128:131], v[104:107], v[72:75], v[128:131]
  v_mov_b32 v3, 0xff800000
  v_cndmask_b32 v124, v3, v124, s[76:77]
  v_cndmask_b32 v125, v3, v125, s[78:79]
  v_cndmask_b32 v126, v3, v126, s[80:81]
  v_cndmask_b32 v127, v3, v127, s[82:83]
  s_nop 0
  s_nop 1
  v_cndmask_b32 v128, v3, v128, s[84:85]
  v_cndmask_b32 v129, v3, v129, s[86:87]
  v_cndmask_b32 v130, v3, v130, s[88:89]
  v_cndmask_b32 v131, v3, v131, s[90:91]
  v_max_f32 v136, v124, v125
  v_max3_f32 v136, v136, v126, v127
  v_max3_f32 v136, v136, v128, v129
  v_max3_f32 v136, v136, v130, v131
  s_branch L_p_km1q
L_p_prq:
  s_cmp_ge_u32 s61, 58
  s_cbranch_scc1 L_p_kmq
  s_sleep 2
  v_lshlrev_b32 v190, 1, v11
  s_mov_b32 exec_lo, 1
  s_mov_b32 exec_hi, 1
  buffer_load_dword v188, v190, s[4:7], s55 offen offset:512 sc1
  s_mov_b64 exec, -1
  s_sub_u32 s54, s54, 1
  s_cbranch_scc1 L_end
  s_waitcnt vmcnt(0)
  v_cmp_eq_u32 vcc, -1, v188
  s_nop 0
  s_or_b32 s58, vcc_lo, vcc_hi
  s_bitcmp1_b32 s58, 0
  s_cbranch_scc1 L_p_prq
L_p_kmq:
  v_lshlrev_b32 v190, 1, v11
  buffer_load_dwordx4 v[168:171], v4, s[4:7], s69 offen offset:0 sc1
  buffer_load_dwordx2 v[184:185], v190, s[4:7], s55 offen offset:0 sc1
  buffer_load_dwordx4 v[172:175], v4, s[4:7], s69 offen offset:512 sc1
  buffer_load_dwordx2 v[186:187], v190, s[4:7], s55 offen offset:512 sc1
  buffer_load_dwordx4 v[176:179], v4, s[4:7], s69 offen offset:1024 sc1
  buffer_load_dwordx4 v[180:183], v4, s[4:7], s69 offen offset:1536 sc1
L_p_km1q:
  s_sub_u32 s54, s54, 1
  s_cbranch_scc1 L_end
  s_waitcnt vmcnt(0)
  v_max3_u32 v2, v168, v172, v176
  v_max3_u32 v2, v2, v180, v184
  v_max_u32 v2, v2, v186
  v_cmp_eq_u32 vcc, -1, v2
  s_cbranch_vccnz L_p_prq
  buffer_load_dword v24, v11, s[4:7], s66 offen offset:128 sc1
  buffer_load_dwordx2 v[56:57], v10, s[16:19], s74 offen
  v_mfma_f32_16x16x32_bf16 v[132:135], v[168:171], v[60:63], 0
  v_mfma_f32_16x16x32_bf16 v[132:135], v[172:175], v[64:67], v[132:135]
  v_mfma_f32_16x16x32_bf16 v[132:135], v[176:179], v[68:71], v[132:135]
  v_mfma_f32_16x16x32_bf16 v[132:135], v[180:183], v[72:75], v[132:135]
  s_nop 7
  v_max3_f32 v136, v136, v132, v133
  v_mov_b32 v137, v136
  s_nop 1
  v_permlane16_swap_b32 v136, v137
  v_max_f32 v136, v136, v137
  v_mov_b32 v137, v136
  s_nop 1
  v_permlane32_swap_b32 v136, v137
  v_max_f32 v136, v136, v137
  v_mul_f32 v136, s97, v136
  v_fma_f32 v124, v124, s97, -v136
  v_fma_f32 v125, v125, s97, -v136
  v_fma_f32 v126, v126, s97, -v136
  v_fma_f32 v127, v127, s97, -v136
  v_fma_f32 v128, v128, s97, -v136
  v_fma_f32 v129, v129, s97, -v136
  v_fma_f32 v130, v130, s97, -v136
  v_fma_f32 v131, v131, s97, -v136
  v_fma_f32 v132, v132, s97, -v136
  v_fma_f32 v133, v133, s97, -v136
  v_exp_f32 v124, v124
  v_exp_f32 v125, v125
  v_exp_f32 v126, v126
  v_exp_f32 v127, v127
  v_exp_f32 v128, v128
  v_exp_f32 v129, v129
  v_exp_f32 v130, v130
  v_exp_f32 v131, v131
  v_exp_f32 v132, v132
  v_exp_f32 v133, v133
  v_cvt_pk_bf16_f32 v138, v124, v125
  v_cvt_pk_bf16_f32 v139, v126, v127
  v_cvt_pk_bf16_f32 v140, v128, v129
  v_cvt_pk_bf16_f32 v141, v130, v131
  v_cvt_pk_bf16_f32 v142, v132, v133
  v_mov_b32 v143, 0
  v_mov_b32 v144, 0
  v_mov_b32_e64 v145, v142
  v_mfma_f32_16x16x32_bf16 v[168:171], v[108:111], v[138:141], 0
  v_mfma_f32_16x16x32_bf16 v[172:175], v[112:115], v[138:141], 0
  v_mfma_f32_16x16x32_bf16 v[176:179], v[116:119], v[138:141], 0
  v_mfma_f32_16x16x32_bf16 v[180:183], v[120:123], v[138:141], 0
  v_mfma_f32_16x16x16_bf16 v[168:171], v[184:185], v[142:143], v[168:171]
  v_mfma_f32_16x16x16_bf16 v[172:175], v[184:185], v[144:145], v[172:175]
  v_mfma_f32_16x16x16_bf16 v[176:179], v[186:187], v[142:143], v[176:179]
  v_mfma_f32_16x16x16_bf16 v[180:183], v[186:187], v[144:145], v[180:183]
  v_add_f32 v124, v124, v125
  v_add_f32 v124, v124, v126
  v_add_f32 v124, v124, v127
  v_add_f32 v124, v124, v128
  v_add_f32 v124, v124, v129
  v_add_f32 v124, v124, v130
  v_add_f32 v124, v124, v131
  v_add_f32 v124, v124, v132
  v_add_f32 v124, v124, v133
  v_mov_b32 v137, v124
  s_nop 1
  v_permlane16_swap_b32 v124, v137
  v_add_f32 v124, v124, v137
  v_mov_b32 v137, v124
  s_nop 0
  s_nop 0
  v_permlane32_swap_b32 v124, v137
  v_add_f32 v124, v124, v137
  v_rcp_f32 v124, v124
  s_nop 0
  v_pk_mul_f32 v[168:169], v[168:169], v[124:125] op_sel_hi:[1,0]
  v_pk_mul_f32 v[170:171], v[170:171], v[124:125] op_sel_hi:[1,0]
  v_pk_mul_f32 v[172:173], v[172:173], v[124:125] op_sel_hi:[1,0]
  v_pk_mul_f32 v[174:175], v[174:175], v[124:125] op_sel_hi:[1,0]
  v_pk_mul_f32 v[176:177], v[176:177], v[124:125] op_sel_hi:[1,0]
  v_pk_mul_f32 v[178:179], v[178:179], v[124:125] op_sel_hi:[1,0]
  v_pk_mul_f32 v[180:181], v[180:181], v[124:125] op_sel_hi:[1,0]
  v_pk_mul_f32 v[182:183], v[182:183], v[124:125] op_sel_hi:[1,0]
  v_cvt_pk_bf16_f32 v128, v168, v172
  v_cvt_pk_bf16_f32 v129, v176, v180
  v_cvt_pk_bf16_f32 v130, v169, v173
  v_cvt_pk_bf16_f32 v131, v177, v181
  v_cvt_pk_bf16_f32 v132, v170, v174
  v_cvt_pk_bf16_f32 v133, v178, v182
  v_cvt_pk_bf16_f32 v134, v171, v175
  v_cvt_pk_bf16_f32 v135, v179, v183
  ds_write_b128 v5, v[128:131]
  ds_write_b128 v5, v[132:135] offset:512
  s_mov_b32 exec_lo, 0xffffffff
  s_mov_b32 exec_hi, 0
  s_waitcnt vmcnt(1)
  v_cmp_gt_u32 vcc, s62, v24
  s_cbranch_vccz L_pw_36y
L_pw_36:
  buffer_load_dword v2, v11, s[4:7], s66 offen offset:128 sc1
  s_sub_u32 s54, s54, 1
  s_cbranch_scc1 L_end
  s_waitcnt vmcnt(0)
  v_cmp_gt_u32 vcc, s62, v2
  s_cbranch_vccnz L_pw_36
L_pw_36y:
  s_mov_b64 exec, -1
L_pw_36x:
  s_and_b32 s58, s52, s3
  s_lshl_b32 s58, s58, 12
  s_add_u32 s58, s58, 122880
  v_add_u32 v2, s58, v1
  s_waitcnt lgkmcnt(0)
  s_barrier
  ds_read_b128 v[76:79], v2 offset:0
  ds_read_b128 v[80:83], v2 offset:1024
  ds_read_b128 v[84:87], v2 offset:2048
  ds_read_b128 v[88:91], v2 offset:3072
  ds_read_b128 v[92:95], v2 offset:4096
  ds_read_b128 v[96:99], v2 offset:5120
  ds_read_b128 v[100:103], v2 offset:6144
  ds_read_b128 v[104:107], v2 offset:7168
  s_waitcnt lgkmcnt(7)
  v_mfma_f32_16x16x32_bf16 v[124:127], v[76:79], a[0:3], 0
  s_waitcnt lgkmcnt(6)
  v_mfma_f32_16x16x32_bf16 v[124:127], v[80:83], a[4:7], v[124:127]
  s_nop 0
  s_waitcnt lgkmcnt(5)
  v_mfma_f32_16x16x32_bf16 v[124:127], v[84:87], a[8:11], v[124:127]
  s_waitcnt lgkmcnt(4)
  v_mfma_f32_16x16x32_bf16 v[124:127], v[88:91], a[12:15], v[124:127]
  s_lshl_b32 s60, s12, 11
  s_add_u32 m0, s60, 0
  s_add_u32 s60, s65, m0
  buffer_load_dwordx4 v1, s[4:7], s60 offen sc1 lds
  v_mfma_f32_16x16x32_bf16 v[128:131], v[76:79], a[16:19], 0
  v_mfma_f32_16x16x32_bf16 v[128:131], v[80:83], a[20:23], v[128:131]
  v_mfma_f32_16x16x32_bf16 v[128:131], v[84:87], a[24:27], v[128:131]
  v_mfma_f32_16x16x32_bf16 v[128:131], v[88:91], a[28:31], v[128:131]
  s_lshl_b32 s60, s12, 11
  s_add_u32 m0, s60, 8192
  s_add_u32 s60, s65, m0
  buffer_load_dwordx4 v1, s[4:7], s60 offen sc1 lds
  v_mfma_f32_16x16x32_bf16 v[132:135], v[76:79], a[32:35], 0
  v_mfma_f32_16x16x32_bf16 v[132:135], v[80:83], a[36:39], v[132:135]
  v_mfma_f32_16x16x32_bf16 v[132:135], v[84:87], a[40:43], v[132:135]
  v_mfma_f32_16x16x32_bf16 v[132:135], v[88:91], a[44:47], v[132:135]
  s_lshl_b32 s60, s12, 11
  s_add_u32 m0, s60, 16384
  s_add_u32 s60, s65, m0
  buffer_load_dwordx4 v1, s[4:7], s60 offen sc1 lds
  v_mfma_f32_16x16x32_bf16 v[136:139], v[76:79], a[48:51], 0
  v_mfma_f32_16x16x32_bf16 v[136:139], v[80:83], a[52:55], v[136:139]
  v_mfma_f32_16x16x32_bf16 v[136:139], v[84:87], a[56:59], v[136:139]
  v_mfma_f32_16x16x32_bf16 v[136:139], v[88:91], a[60:63], v[136:139]
  s_lshl_b32 s60, s12, 11
  s_add_u32 m0, s60, 24576
  s_add_u32 s60, s65, m0
  buffer_load_dwordx4 v1, s[4:7], s60 offen sc1 lds
  v_mfma_f32_16x16x32_bf16 v[140:143], v[76:79], a[64:67], 0
  v_mfma_f32_16x16x32_bf16 v[140:143], v[80:83], a[68:71], v[140:143]
  v_mfma_f32_16x16x32_bf16 v[140:143], v[84:87], a[72:75], v[140:143]
  v_mfma_f32_16x16x32_bf16 v[140:143], v[88:91], a[76:79], v[140:143]
  s_lshl_b32 s60, s12, 11
  s_add_u32 m0, s60, 32768
  s_add_u32 s60, s65, m0
  buffer_load_dwordx4 v1, s[4:7], s60 offen sc1 lds
  v_mfma_f32_16x16x32_bf16 v[144:147], v[76:79], a[80:83], 0
  v_mfma_f32_16x16x32_bf16 v[144:147], v[80:83], a[84:87], v[144:147]
  v_mfma_f32_16x16x32_bf16 v[144:147], v[84:87], a[88:91], v[144:147]
  v_mfma_f32_16x16x32_bf16 v[144:147], v[88:91], a[92:95], v[144:147]
  s_lshl_b32 s60, s12, 11
  s_add_u32 m0, s60, 1024
  s_add_u32 s60, s65, m0
  buffer_load_dwordx4 v1, s[4:7], s60 offen sc1 lds
  v_mfma_f32_16x16x32_bf16 v[148:151], v[76:79], a[96:99], 0
  v_mfma_f32_16x16x32_bf16 v[148:151], v[80:83], a[100:103], v[148:151]
  v_mfma_f32_16x16x32_bf16 v[148:151], v[84:87], a[104:107], v[148:151]
  v_mfma_f32_16x16x32_bf16 v[148:151], v[88:91], a[108:111], v[148:151]
  s_lshl_b32 s60, s12, 11
  s_add_u32 m0, s60, 9216
  s_add_u32 s60, s65, m0
  buffer_load_dwordx4 v1, s[4:7], s60 offen sc1 lds
  v_mfma_f32_16x16x32_bf16 v[152:155], v[76:79], a[112:115], 0
  v_mfma_f32_16x16x32_bf16 v[152:155], v[80:83], a[116:119], v[152:155]
  v_mfma_f32_16x16x32_bf16 v[152:155], v[84:87], a[120:123], v[152:155]
  v_mfma_f32_16x16x32_bf16 v[152:155], v[88:91], a[124:127], v[152:155]
  s_lshl_b32 s60, s12, 11
  s_add_u32 m0, s60, 17408
  s_add_u32 s60, s65, m0
  buffer_load_dwordx4 v1, s[4:7], s60 offen sc1 lds
  v_mfma_f32_16x16x32_bf16 v[156:159], v[76:79], a[128:131], 0
  v_mfma_f32_16x16x32_bf16 v[156:159], v[80:83], a[132:135], v[156:159]
  v_mfma_f32_16x16x32_bf16 v[156:159], v[84:87], a[136:139], v[156:159]
  v_mfma_f32_16x16x32_bf16 v[156:159], v[88:91], a[140:143], v[156:159]
  s_lshl_b32 s60, s12, 11
  s_add_u32 m0, s60, 25600
  s_add_u32 s60, s65, m0
  buffer_load_dwordx4 v1, s[4:7], s60 offen sc1 lds
  v_mfma_f32_16x16x32_bf16 v[160:163], v[76:79], a[144:147], 0
  v_mfma_f32_16x16x32_bf16 v[160:163], v[80:83], a[148:151], v[160:163]
  v_mfma_f32_16x16x32_bf16 v[160:163], v[84:87], a[152:155], v[160:163]
  v_mfma_f32_16x16x32_bf16 v[160:163], v[88:91], a[156:159], v[160:163]
  s_lshl_b32 s60, s12, 11
  s_add_u32 m0, s60, 33792
  s_add_u32 s60, s65, m0
  buffer_load_dwordx4 v1, s[4:7], s60 offen sc1 lds
  v_cvt_pk_bf16_f32 v164, v124, v128
  v_cvt_pk_bf16_f32 v165, v132, v136
  v_cvt_pk_bf16_f32 v166, v140, v144
  v_cvt_pk_bf16_f32 v167, v148, v152
  v_cvt_pk_bf16_f32 v180, v156, v160
  v_cvt_pk_bf16_f32 v168, v125, v129
  v_cvt_pk_bf16_f32 v169, v133, v137
  v_cvt_pk_bf16_f32 v170, v141, v145
  v_cvt_pk_bf16_f32 v171, v149, v153
  v_cvt_pk_bf16_f32 v181, v157, v161
  v_cvt_pk_bf16_f32 v172, v126, v130
  v_cvt_pk_bf16_f32 v173, v134, v138
  v_cvt_pk_bf16_f32 v174, v142, v146
  v_cvt_pk_bf16_f32 v175, v150, v154
  v_cvt_pk_bf16_f32 v182, v158, v162
  v_cvt_pk_bf16_f32 v176, v127, v131
  v_cvt_pk_bf16_f32 v177, v135, v139
  v_cvt_pk_bf16_f32 v178, v143, v147
  v_cvt_pk_bf16_f32 v179, v151, v155
  v_cvt_pk_bf16_f32 v183, v159, v163
  s_waitcnt lgkmcnt(3)
  v_mfma_f32_16x16x32_bf16 v[124:127], v[92:95], a[0:3], 0
  s_waitcnt lgkmcnt(2)
  v_mfma_f32_16x16x32_bf16 v[124:127], v[96:99], a[4:7], v[124:127]
  s_nop 0
  s_waitcnt lgkmcnt(1)
  v_mfma_f32_16x16x32_bf16 v[124:127], v[100:103], a[8:11], v[124:127]
  s_waitcnt lgkmcnt(0)
  v_mfma_f32_16x16x32_bf16 v[124:127], v[104:107], a[12:15], v[124:127]
  s_add_u32 s58, s63, 0
  buffer_store_dwordx4 v[164:167], v6, s[4:7], s58 offen
  v_mfma_f32_16x16x32_bf16 v[128:131], v[92:95], a[16:19], 0
  v_mfma_f32_16x16x32_bf16 v[128:131], v[96:99], a[20:23], v[128:131]
  v_mfma_f32_16x16x32_bf16 v[128:131], v[100:103], a[24:27], v[128:131]
  v_mfma_f32_16x16x32_bf16 v[128:131], v[104:107], a[28:31], v[128:131]
  buffer_store_dword v180, v7, s[4:7], s58 offen offset:1024
  v_mfma_f32_16x16x32_bf16 v[132:135], v[92:95], a[32:35], 0
  v_mfma_f32_16x16x32_bf16 v[132:135], v[96:99], a[36:39], v[132:135]
  v_mfma_f32_16x16x32_bf16 v[132:135], v[100:103], a[40:43], v[132:135]
  v_mfma_f32_16x16x32_bf16 v[132:135], v[104:107], a[44:47], v[132:135]
  s_add_u32 s58, s63, 41216
  buffer_store_dwordx4 v[168:171], v6, s[4:7], s58 offen
  v_mfma_f32_16x16x32_bf16 v[136:139], v[92:95], a[48:51], 0
  v_mfma_f32_16x16x32_bf16 v[136:139], v[96:99], a[52:55], v[136:139]
  v_mfma_f32_16x16x32_bf16 v[136:139], v[100:103], a[56:59], v[136:139]
  v_mfma_f32_16x16x32_bf16 v[136:139], v[104:107], a[60:63], v[136:139]
  buffer_store_dword v181, v7, s[4:7], s58 offen offset:1024
  v_mfma_f32_16x16x32_bf16 v[140:143], v[92:95], a[64:67], 0
  v_mfma_f32_16x16x32_bf16 v[140:143], v[96:99], a[68:71], v[140:143]
  v_mfma_f32_16x16x32_bf16 v[140:143], v[100:103], a[72:75], v[140:143]
  v_mfma_f32_16x16x32_bf16 v[140:143], v[104:107], a[76:79], v[140:143]
  s_add_u32 s58, s63, 82432
  buffer_store_dwordx4 v[172:175], v6, s[4:7], s58 offen
  v_mfma_f32_16x16x32_bf16 v[144:147], v[92:95], a[80:83], 0
  v_mfma_f32_16x16x32_bf16 v[144:147], v[96:99], a[84:87], v[144:147]
  v_mfma_f32_16x16x32_bf16 v[144:147], v[100:103], a[88:91], v[144:147]
  v_mfma_f32_16x16x32_bf16 v[144:147], v[104:107], a[92:95], v[144:147]
  buffer_store_dword v182, v7, s[4:7], s58 offen offset:1024
  v_mfma_f32_16x16x32_bf16 v[148:151], v[92:95], a[96:99], 0
  v_mfma_f32_16x16x32_bf16 v[148:151], v[96:99], a[100:103], v[148:151]
  v_mfma_f32_16x16x32_bf16 v[148:151], v[100:103], a[104:107], v[148:151]
  v_mfma_f32_16x16x32_bf16 v[148:151], v[104:107], a[108:111], v[148:151]
  s_add_u32 s58, s63, 123648
  buffer_store_dwordx4 v[176:179], v6, s[4:7], s58 offen
  v_mfma_f32_16x16x32_bf16 v[152:155], v[92:95], a[112:115], 0
  v_mfma_f32_16x16x32_bf16 v[152:155], v[96:99], a[116:119], v[152:155]
  v_mfma_f32_16x16x32_bf16 v[152:155], v[100:103], a[120:123], v[152:155]
  v_mfma_f32_16x16x32_bf16 v[152:155], v[104:107], a[124:127], v[152:155]
  buffer_store_dword v183, v7, s[4:7], s58 offen offset:1024
  v_mfma_f32_16x16x32_bf16 v[156:159], v[92:95], a[128:131], 0
  v_mfma_f32_16x16x32_bf16 v[156:159], v[96:99], a[132:135], v[156:159]
  v_mfma_f32_16x16x32_bf16 v[156:159], v[100:103], a[136:139], v[156:159]
  v_mfma_f32_16x16x32_bf16 v[156:159], v[104:107], a[140:143], v[156:159]
  v_mfma_f32_16x16x32_bf16 v[160:163], v[92:95], a[144:147], 0
  v_mfma_f32_16x16x32_bf16 v[160:163], v[96:99], a[148:151], v[160:163]
  v_mfma_f32_16x16x32_bf16 v[160:163], v[100:103], a[152:155], v[160:163]
  v_mfma_f32_16x16x32_bf16 v[160:163], v[104:107], a[156:159], v[160:163]
  v_cvt_pk_bf16_f32 v164, v124, v128
  v_cvt_pk_bf16_f32 v165, v132, v136
  v_cvt_pk_bf16_f32 v166, v140, v144
  v_cvt_pk_bf16_f32 v167, v148, v152
  s_nop 0
  s_nop 2
  v_cvt_pk_bf16_f32 v180, v156, v160
  s_add_u32 s58, s63, 659456
  buffer_store_dwordx4 v[164:167], v6, s[4:7], s58 offen
  buffer_store_dword v180, v7, s[4:7], s58 offen offset:1024
  v_cvt_pk_bf16_f32 v168, v125, v129
  v_cvt_pk_bf16_f32 v169, v133, v137
  v_cvt_pk_bf16_f32 v170, v141, v145
  v_cvt_pk_bf16_f32 v171, v149, v153
  v_cvt_pk_bf16_f32 v181, v157, v161
  s_add_u32 s58, s63, 700672
  buffer_store_dwordx4 v[168:171], v6, s[4:7], s58 offen
  buffer_store_dword v181, v7, s[4:7], s58 offen offset:1024
  v_cvt_pk_bf16_f32 v172, v126, v130
  v_cvt_pk_bf16_f32 v173, v134, v138
  v_cvt_pk_bf16_f32 v174, v142, v146
  v_cvt_pk_bf16_f32 v175, v150, v154
  v_cvt_pk_bf16_f32 v182, v158, v162
  s_add_u32 s58, s63, 741888
  buffer_store_dwordx4 v[172:175], v6, s[4:7], s58 offen
  buffer_store_dword v182, v7, s[4:7], s58 offen offset:1024
  v_cvt_pk_bf16_f32 v176, v127, v131
  v_cvt_pk_bf16_f32 v177, v135, v139
  v_cvt_pk_bf16_f32 v178, v143, v147
  v_cvt_pk_bf16_f32 v179, v151, v155
  v_cvt_pk_bf16_f32 v183, v159, v163
  s_add_u32 s58, s63, 783104
  buffer_store_dwordx4 v[176:179], v6, s[4:7], s58 offen
  buffer_store_dword v183, v7, s[4:7], s58 offen offset:1024
L_ph_37x:
  s_mov_b32 s2, s74
  s_add_u32 s61, s61, 6
  s_lshr_b32 s58, s52, 1
  s_add_u32 s58, s58, 61
  s_sub_u32 s59, s61, 62
  s_cmp_lt_u32 s59, 4
  s_cselect_b32 s15, 1, 0
  s_cselect_b32 s61, s58, s61
  s_lshl_b32 s58, s61, 5
  s_add_u32 s58, s58, s13
  s_and_b32 s59, s52, s15
  s_lshl_b32 s59, s59, 4
  s_add_u32 s59, s59, s58
  s_mul_i32 s74, s59, 1280
  s_lshl_b32 s67, s58, 13
  s_and_b32 s59, s12, 1
  s_lshl_b32 s59, s59, 10
  s_add_u32 s67, s67, s59
  s_add_u32 s67, s67, 16777216
  s_lshl_b32 s68, s58, 14
  s_add_u32 s68, s68, 33554432
  s_lshr_b32 s69, s58, 2
  s_lshl_b32 s69, s69, 14
  s_and_b32 s59, s13, 3
  s_lshl_b32 s59, s59, 11
  s_add_u32 s69, s69, s59
  s_add_u32 s69, s69, 8388608
  s_lshr_b32 s59, s12, 1
  s_lshl_b32 s59, s59, 10
  s_add_u32 s55, s69, s59
  s_add_u32 s55, s55, 0x2000
  s_lshl_b32 s59, s59, 3
  s_add_u32 s75, s68, s59
  s_cmp_ge_u32 s13, 27
  s_cbranch_scc1 L_q_noffn
  s_waitcnt vmcnt(16)
  s_barrier
  buffer_load_dword v3, v11, s[4:7], s66 offen offset:384 sc1
  ds_read_b128 v[124:127], v1 offset:0
  ds_read_b128 v[128:131], v1 offset:2048
  ds_read_b128 v[132:135], v1 offset:4096
  ds_read_b128 v[136:139], v1 offset:6144
  s_waitcnt lgkmcnt(3)
  v_mfma_f32_16x16x32_bf16 v[148:151], a[160:163], v[124:127], 0
  ds_read_b128 v[140:143], v1 offset:8192
  v_mfma_f32_16x16x32_bf16 v[152:155], a[164:167], v[124:127], 0
  s_waitcnt lgkmcnt(3)
  v_mfma_f32_16x16x32_bf16 v[148:151], a[168:171], v[128:131], v[148:151]
  ds_read_b128 v[144:147], v1 offset:10240
  v_mfma_f32_16x16x32_bf16 v[152:155], a[172:175], v[128:131], v[152:155]
  buffer_load_dwordx4 v[60:63], v1, s[4:7], s67 offen offset:0 sc1
  s_waitcnt lgkmcnt(3)
  v_mfma_f32_16x16x32_bf16 v[148:151], a[176:179], v[132:135], v[148:151]
  s_nop 0
  ds_read_b128 v[124:127], v1 offset:12288
  v_mfma_f32_16x16x32_bf16 v[152:155], a[180:183], v[132:135], v[152:155]
  s_waitcnt lgkmcnt(3)
  v_mfma_f32_16x16x32_bf16 v[148:151], a[184:187], v[136:139], v[148:151]
  s_nop 0
  ds_read_b128 v[128:131], v1 offset:14336
  v_mfma_f32_16x16x32_bf16 v[152:155], a[188:191], v[136:139], v[152:155]
  buffer_load_dwordx4 v[64:67], v1, s[4:7], s67 offen offset:2048 sc1
  s_waitcnt lgkmcnt(3)
  v_mfma_f32_16x16x32_bf16 v[148:151], a[192:195], v[140:143], v[148:151]
  s_nop 0
  ds_read_b128 v[132:135], v1 offset:16384
  v_mfma_f32_16x16x32_bf16 v[152:155], a[196:199], v[140:143], v[152:155]
  s_waitcnt lgkmcnt(3)
  v_mfma_f32_16x16x32_bf16 v[148:151], a[200:203], v[144:147], v[148:151]
  s_nop 0
  ds_read_b128 v[136:139], v1 offset:18432
  v_mfma_f32_16x16x32_bf16 v[152:155], a[204:207], v[144:147], v[152:155]
  s_waitcnt lgkmcnt(3)
  v_mfma_f32_16x16x32_bf16 v[148:151], a[208:211], v[124:127], v[148:151]
  s_nop 0
  ds_read_b128 v[140:143], v1 offset:20480
  v_mfma_f32_16x16x32_bf16 v[152:155], a[212:215], v[124:127], v[152:155]
  s_add_u32 s67, s67, 4096
  buffer_load_dwordx4 v[68:71], v1, s[4:7], s67 offen offset:0 sc1
  s_waitcnt lgkmcnt(3)
  v_mfma_f32_16x16x32_bf16 v[148:151], a[216:219], v[128:131], v[148:151]
  ds_read_b128 v[144:147], v1 offset:22528
  v_mfma_f32_16x16x32_bf16 v[152:155], a[220:223], v[128:131], v[152:155]
  s_waitcnt lgkmcnt(3)
  v_mfma_f32_16x16x32_bf16 v[148:151], a[224:227], v[132:135], v[148:151]
  ds_read_b128 v[124:127], v1 offset:24576
  v_mfma_f32_16x16x32_bf16 v[152:155], a[228:231], v[132:135], v[152:155]
  buffer_load_dwordx4 v[72:75], v1, s[4:7], s67 offen offset:2048 sc1
  s_waitcnt lgkmcnt(3)
  v_mfma_f32_16x16x32_bf16 v[148:151], a[232:235], v[136:139], v[148:151]
  ds_read_b128 v[128:131], v1 offset:26624
  v_mfma_f32_16x16x32_bf16 v[152:155], a[236:239], v[136:139], v[152:155]
  s_waitcnt lgkmcnt(3)
  v_mfma_f32_16x16x32_bf16 v[148:151], a[240:243], v[140:143], v[148:151]
  ds_read_b128 v[132:135], v1 offset:28672
  v_mfma_f32_16x16x32_bf16 v[152:155], a[244:247], v[140:143], v[152:155]
  s_nop 0
  s_waitcnt lgkmcnt(3)
  v_mfma_f32_16x16x32_bf16 v[148:151], a[248:251], v[144:147], v[148:151]
  ds_read_b128 v[136:139], v1 offset:30720
  v_mfma_f32_16x16x32_bf16 v[152:155], a[252:255], v[144:147], v[152:155]
  buffer_load_dwordx4 v[76:79], v1, s[4:7], s68 offen offset:0 sc1
  s_waitcnt lgkmcnt(3)
  v_mfma_f32_16x16x32_bf16 v[148:151], v[192:195], v[124:127], v[148:151]
  ds_read_b128 v[140:143], v1 offset:32768
  v_mfma_f32_16x16x32_bf16 v[152:155], v[196:199], v[124:127], v[152:155]
  s_waitcnt lgkmcnt(3)
  v_mfma_f32_16x16x32_bf16 v[148:151], v[200:203], v[128:131], v[148:151]
  ds_read_b128 v[144:147], v1 offset:34816
  v_mfma_f32_16x16x32_bf16 v[152:155], v[204:207], v[128:131], v[152:155]
  buffer_load_dwordx4 v[80:83], v1, s[4:7], s68 offen offset:1024 sc1
  s_waitcnt lgkmcnt(3)
  v_mfma_f32_16x16x32_bf16 v[148:151], v[208:211], v[132:135], v[148:151]
  ds_read_b128 v[124:127], v1 offset:36864
  v_mfma_f32_16x16x32_bf16 v[152:155], v[212:215], v[132:135], v[152:155]
  s_waitcnt lgkmcnt(3)
  v_mfma_f32_16x16x32_bf16 v[148:151], v[216:219], v[136:139], v[148:151]
  ds_read_b128 v[128:131], v1 offset:38912
  v_mfma_f32_16x16x32_bf16 v[152:155], v[220:223], v[136:139], v[152:155]
  s_nop 0
  s_waitcnt lgkmcnt(3)
  v_mfma_f32_16x16x32_bf16 v[148:151], v[224:227], v[140:143], v[148:151]
  ds_read_b128 v[132:135], v1 offset:1024
  v_mfma_f32_16x16x32_bf16 v[152:155], v[228:231], v[140:143], v[152:155]
  buffer_load_dwordx4 v[108:111], v1, s[4:7], s75 offen offset:2048 sc1
  s_waitcnt lgkmcnt(3)
  v_mfma_f32_16x16x32_bf16 v[148:151], v[232:235], v[144:147], v[148:151]
  ds_read_b128 v[136:139], v1 offset:3072
  v_mfma_f32_16x16x32_bf16 v[152:155], v[236:239], v[144:147], v[152:155]
  s_waitcnt lgkmcnt(3)
  v_mfma_f32_16x16x32_bf16 v[148:151], v[240:243], v[124:127], v[148:151]
  ds_read_b128 v[140:143], v1 offset:5120
  v_mfma_f32_16x16x32_bf16 v[152:155], v[244:247], v[124:127], v[152:155]
  s_add_u32 s68, s68, 4096
  buffer_load_dwordx4 v[84:87], v1, s[4:7], s68 offen offset:0 sc1
  s_waitcnt lgkmcnt(3)
  v_mfma_f32_16x16x32_bf16 v[148:151], v[248:251], v[128:131], v[148:151]
  ds_read_b128 v[144:147], v1 offset:7168
  v_mfma_f32_16x16x32_bf16 v[152:155], v[252:255], v[128:131], v[152:155]
  s_waitcnt lgkmcnt(3)
  v_mfma_f32_16x16x32_bf16 v[156:159], a[160:163], v[132:135], 0
  ds_read_b128 v[124:127], v1 offset:9216
  v_mfma_f32_16x16x32_bf16 v[160:163], a[164:167], v[132:135], 0
  s_waitcnt lgkmcnt(3)
  v_mfma_f32_16x16x32_bf16 v[156:159], a[168:171], v[136:139], v[156:159]
  s_nop 0
  ds_read_b128 v[128:131], v1 offset:11264
  v_mfma_f32_16x16x32_bf16 v[160:163], a[172:175], v[136:139], v[160:163]
  buffer_load_dwordx4 v[88:91], v1, s[4:7], s68 offen offset:1024 sc1
  s_waitcnt lgkmcnt(3)
  v_mfma_f32_16x16x32_bf16 v[156:159], a[176:179], v[140:143], v[156:159]
  s_nop 0
  ds_read_b128 v[132:135], v1 offset:13312
  v_cvt_pk_bf16_f32 v149, v148, v149
  v_mfma_f32_16x16x32_bf16 v[160:163], a[180:183], v[140:143], v[160:163]
  v_lshlrev_b32 v148, 16, v149
  s_waitcnt lgkmcnt(3)
  v_mfma_f32_16x16x32_bf16 v[156:159], a[184:187], v[144:147], v[156:159]
  ds_read_b128 v[136:139], v1 offset:15360
  v_and_b32 v149, 0xffff0000, v149
  v_mfma_f32_16x16x32_bf16 v[160:163], a[188:191], v[144:147], v[160:163]
  buffer_load_dwordx4 v[112:115], v1, s[4:7], s75 offen offset:3072 sc1
  v_cvt_pk_bf16_f32 v151, v150, v151
  s_waitcnt vmcnt(11)
  s_barrier
  s_cmp_lg_u32 s12, 0
  s_cbranch_scc1 L_ps_38
  s_lshl_b32 s58, s13, 2
  s_add_u32 s58, s58, s66
  v_mov_b32 v2, s96
  s_mov_b64 exec, 1
  buffer_store_dword v2, v0, s[4:7], s58 offen offset:0
  s_mov_b64 exec, -1
L_ps_38:
  s_waitcnt lgkmcnt(3)
  v_mfma_f32_16x16x32_bf16 v[156:159], a[192:195], v[124:127], v[156:159]
  ds_read_b128 v[140:143], v1 offset:17408
  v_lshlrev_b32 v150, 16, v151
  v_mfma_f32_16x16x32_bf16 v[160:163], a[196:199], v[124:127], v[160:163]
  v_and_b32 v151, 0xffff0000, v151
  s_waitcnt lgkmcnt(3)
  v_mfma_f32_16x16x32_bf16 v[156:159], a[200:203], v[128:131], v[156:159]
  ds_read_b128 v[144:147], v1 offset:19456
  v_cvt_pk_bf16_f32 v153, v152, v153
  v_mfma_f32_16x16x32_bf16 v[160:163], a[204:207], v[128:131], v[160:163]
  v_lshlrev_b32 v152, 16, v153
  s_waitcnt lgkmcnt(3)
  v_mfma_f32_16x16x32_bf16 v[156:159], a[208:211], v[132:135], v[156:159]
  ds_read_b128 v[124:127], v1 offset:21504
  v_and_b32 v153, 0xffff0000, v153
  v_mfma_f32_16x16x32_bf16 v[160:163], a[212:215], v[132:135], v[160:163]
  s_add_u32 s68, s68, 4096
  s_add_u32 s75, s75, 4096
  buffer_load_dwordx4 v[92:95], v1, s[4:7], s68 offen offset:0 sc1
  v_cvt_pk_bf16_f32 v155, v154, v155
  s_waitcnt lgkmcnt(3)
  v_mfma_f32_16x16x32_bf16 v[156:159], a[216:219], v[136:139], v[156:159]
  ds_read_b128 v[128:131], v1 offset:23552
  v_lshlrev_b32 v154, 16, v155
  v_mfma_f32_16x16x32_bf16 v[160:163], a[220:223], v[136:139], v[160:163]
  v_and_b32 v155, 0xffff0000, v155
  s_waitcnt lgkmcnt(3)
  v_mfma_f32_16x16x32_bf16 v[156:159], a[224:227], v[140:143], v[156:159]
  s_nop 0
  ds_read_b128 v[132:135], v1 offset:25600
  v_max_f32 v148, 0, v148
  v_mfma_f32_16x16x32_bf16 v[160:163], a[228:231], v[140:143], v[160:163]
  buffer_load_dwordx4 v[96:99], v1, s[4:7], s68 offen offset:1024 sc1
  v_mul_f32 v148, v148, v152
  s_waitcnt lgkmcnt(3)
  v_mfma_f32_16x16x32_bf16 v[156:159], a[232:235], v[144:147], v[156:159]
  ds_read_b128 v[136:139], v1 offset:27648
  v_max_f32 v149, 0, v149
  v_mfma_f32_16x16x32_bf16 v[160:163], a[236:239], v[144:147], v[160:163]
  v_mul_f32 v149, v149, v153
  s_waitcnt lgkmcnt(3)
  v_mfma_f32_16x16x32_bf16 v[156:159], a[240:243], v[124:127], v[156:159]
  ds_read_b128 v[140:143], v1 offset:29696
  v_max_f32_e64 v150, 0, v150
  v_mfma_f32_16x16x32_bf16 v[160:163], a[244:247], v[124:127], v[160:163]
  v_mul_f32 v150, v150, v154
  s_waitcnt lgkmcnt(3)
  v_mfma_f32_16x16x32_bf16 v[156:159], a[248:251], v[128:131], v[156:159]
  ds_read_b128 v[144:147], v1 offset:31744
  v_max_f32_e64 v151, 0, v151
  v_mfma_f32_16x16x32_bf16 v[160:163], a[252:255], v[128:131], v[160:163]
  buffer_load_dwordx4 v[116:119], v1, s[4:7], s75 offen offset:2048 sc1
  v_mul_f32_e64 v151, v151, v155
  s_waitcnt lgkmcnt(3)
  v_mfma_f32_16x16x32_bf16 v[156:159], v[192:195], v[132:135], v[156:159]
  ds_read_b128 v[124:127], v1 offset:33792
  v_cvt_pk_bf16_f32 v148, v148, v149
  v_mfma_f32_16x16x32_bf16 v[160:163], v[196:199], v[132:135], v[160:163]
  v_cvt_pk_bf16_f32 v149, v150, v151
  s_waitcnt lgkmcnt(3)
  v_mfma_f32_16x16x32_bf16 v[156:159], v[200:203], v[136:139], v[156:159]
  ds_read_b128 v[128:131], v1 offset:35840
  ds_write_b64 v13, v[148:149] offset:0
  v_mfma_f32_16x16x32_bf16 v[160:163], v[204:207], v[136:139], v[160:163]
  s_add_u32 s68, s68, 4096
  buffer_load_dwordx4 v[100:103], v1, s[4:7], s68 offen offset:0 sc1
  s_waitcnt lgkmcnt(4)
  v_mfma_f32_16x16x32_bf16 v[156:159], v[208:211], v[140:143], v[156:159]
  ds_read_b128 v[132:135], v1 offset:37888
  v_mfma_f32_16x16x32_bf16 v[160:163], v[212:215], v[140:143], v[160:163]
  s_waitcnt lgkmcnt(4)
  v_mfma_f32_16x16x32_bf16 v[156:159], v[216:219], v[144:147], v[156:159]
  ds_read_b128 v[136:139], v1 offset:39936
  v_mfma_f32_16x16x32_bf16 v[160:163], v[220:223], v[144:147], v[160:163]
  buffer_load_dwordx4 v[104:107], v1, s[4:7], s68 offen offset:1024 sc1
  s_waitcnt lgkmcnt(4)
  v_mfma_f32_16x16x32_bf16 v[156:159], v[224:227], v[124:127], v[156:159]
  v_mfma_f32_16x16x32_bf16 v[160:163], v[228:231], v[124:127], v[160:163]
  s_waitcnt lgkmcnt(3)
  v_mfma_f32_16x16x32_bf16 v[156:159], v[232:235], v[128:131], v[156:159]
  v_mfma_f32_16x16x32_bf16 v[160:163], v[236:239], v[128:131], v[160:163]
  buffer_load_dwordx4 v[120:123], v1, s[4:7], s75 offen offset:3072 sc1
  s_waitcnt lgkmcnt(1)
  v_mfma_f32_16x16x32_bf16 v[156:159], v[240:243], v[132:135], v[156:159]
  s_nop 0
  v_mfma_f32_16x16x32_bf16 v[160:163], v[244:247], v[132:135], v[160:163]
  s_waitcnt lgkmcnt(0)
  v_mfma_f32_16x16x32_bf16 v[156:159], v[248:251], v[136:139], v[156:159]
  v_mfma_f32_16x16x32_bf16 v[160:163], v[252:255], v[136:139], v[160:163]
  s_nop 0
  s_nop 0
  s_nop 0
  s_nop 0
  v_cvt_pk_bf16_f32 v157, v156, v157
  v_lshlrev_b32 v156, 16, v157
  v_and_b32 v157, 0xffff0000, v157
  v_cvt_pk_bf16_f32 v159, v158, v159
  v_lshlrev_b32 v158, 16, v159
  v_and_b32 v159, 0xffff0000, v159
  v_cvt_pk_bf16_f32 v161, v160, v161
  v_lshlrev_b32 v160, 16, v161
  v_and_b32 v161, 0xffff0000, v161
  v_cvt_pk_bf16_f32 v163, v162, v163
  v_lshlrev_b32 v162, 16, v163
  v_and_b32 v163, 0xffff0000, v163
  v_max_f32 v156, 0, v156
  v_mul_f32 v156, v156, v160
  v_max_f32 v157, 0, v157
  v_mul_f32 v157, v157, v161
  v_max_f32 v158, 0, v158
  v_mul_f32 v158, v158, v162
  v_max_f32 v159, 0, v159
  v_mul_f32_e64 v159, v159, v163
  v_cvt_pk_bf16_f32 v156, v156, v157
  v_cvt_pk_bf16_f32 v157, v158, v159
  ds_write_b64 v13, v[156:157] offset:2048
  s_mov_b32 exec_lo, 0xffffffff
  s_mov_b32 exec_hi, 0
  s_waitcnt vmcnt(16)
  v_cmp_gt_u32_e64 vcc, s93, v3
  s_cbranch_vccz L_pw_39y
L_pw_39:
  buffer_load_dword v2, v11, s[4:7], s66 offen offset:384 sc1
  s_sub_u32 s54, s54, 1
  s_cbranch_scc1 L_end
  s_waitcnt vmcnt(0)
  v_cmp_gt_u32_e64 vcc, s93, v2
  s_cbranch_vccnz L_pw_39
L_pw_39y:
  s_mov_b64 exec, -1
L_pw_39x:
  v_add_u32 v2, 131072, v1
  s_waitcnt lgkmcnt(0)
  s_barrier
  ds_read_b128 v[184:187], v2 offset:0
  ds_read_b128 v[188:191], v2 offset:1024
  ds_read_b128 v[24:27], v14 offset:0
  ds_read_b128 v[28:31], v14 offset:1024
  ds_read_b128 v[32:35], v14 offset:2048
  ds_read_b128 v[36:39], v14 offset:3072
  s_waitcnt lgkmcnt(3)
  v_mfma_f32_16x16x32_bf16 v[124:127], v[184:187], v[24:27], 0
  ds_read_b128 v[24:27], v14 offset:4096
  s_waitcnt lgkmcnt(3)
  v_mfma_f32_16x16x32_bf16 v[124:127], v[188:191], v[28:31], v[124:127]
  ds_read_b128 v[28:31], v14 offset:5120
  s_waitcnt lgkmcnt(3)
  v_mfma_f32_16x16x32_bf16 v[128:131], v[184:187], v[32:35], 0
  ds_read_b128 v[32:35], v14 offset:6144
  s_waitcnt lgkmcnt(3)
  v_mfma_f32_16x16x32_bf16 v[128:131], v[188:191], v[36:39], v[128:131]
  ds_read_b128 v[36:39], v14 offset:7168
  s_waitcnt lgkmcnt(3)
  v_mfma_f32_16x16x32_bf16 v[132:135], v[184:187], v[24:27], 0
  ds_read_b128 v[24:27], v14 offset:8192
  s_waitcnt lgkmcnt(3)
  v_mfma_f32_16x16x32_bf16 v[132:135], v[188:191], v[28:31], v[132:135]
  ds_read_b128 v[28:31], v14 offset:9216
  s_waitcnt lgkmcnt(3)
  v_mfma_f32_16x16x32_bf16 v[136:139], v[184:187], v[32:35], 0
  ds_read_b128 v[32:35], v14 offset:10240
  s_waitcnt lgkmcnt(3)
  v_mfma_f32_16x16x32_bf16 v[136:139], v[188:191], v[36:39], v[136:139]
  ds_read_b128 v[36:39], v14 offset:11264
  s_waitcnt lgkmcnt(3)
  v_mfma_f32_16x16x32_bf16 v[140:143], v[184:187], v[24:27], 0
  ds_read_b128 v[24:27], v14 offset:12288
  s_waitcnt lgkmcnt(3)
  v_mfma_f32_16x16x32_bf16 v[140:143], v[188:191], v[28:31], v[140:143]
  ds_read_b128 v[28:31], v14 offset:13312
  s_waitcnt lgkmcnt(3)
  v_mfma_f32_16x16x32_bf16 v[144:147], v[184:187], v[32:35], 0
  ds_read_b128 v[32:35], v14 offset:14336
  s_waitcnt lgkmcnt(3)
  v_mfma_f32_16x16x32_bf16 v[144:147], v[188:191], v[36:39], v[144:147]
  ds_read_b128 v[36:39], v14 offset:15360
  s_waitcnt lgkmcnt(3)
  v_mfma_f32_16x16x32_bf16 v[148:151], v[184:187], v[24:27], 0
  ds_read_b128 v[24:27], v14 offset:16384
  s_waitcnt lgkmcnt(3)
  v_mfma_f32_16x16x32_bf16 v[148:151], v[188:191], v[28:31], v[148:151]
  ds_read_b128 v[28:31], v14 offset:17408
  s_waitcnt lgkmcnt(3)
  v_mfma_f32_16x16x32_bf16 v[152:155], v[184:187], v[32:35], 0
  ds_read_b128 v[32:35], v14 offset:18432
  s_waitcnt lgkmcnt(3)
  v_mfma_f32_16x16x32_bf16 v[152:155], v[188:191], v[36:39], v[152:155]
  ds_read_b128 v[36:39], v14 offset:19456
  s_waitcnt lgkmcnt(3)
  v_mfma_f32_16x16x32_bf16 v[156:159], v[184:187], v[24:27], 0
  ds_read_b128 v[24:27], v14 offset:0
  s_waitcnt lgkmcnt(3)
  v_mfma_f32_16x16x32_bf16 v[156:159], v[188:191], v[28:31], v[156:159]
  ds_read_b128 v[28:31], v14 offset:1024
  buffer_load_dword v3, v11, s[4:7], s66 offen sc1
  s_waitcnt lgkmcnt(3)
  v_mfma_f32_16x16x32_bf16 v[160:163], v[184:187], v[32:35], 0
  ds_read_b128 v[32:35], v14 offset:2048
  s_waitcnt lgkmcnt(3)
  v_mfma_f32_16x16x32_bf16 v[160:163], v[188:191], v[36:39], v[160:163]
  ds_read_b128 v[36:39], v14 offset:3072
  ds_read_b128 v[184:187], v2 offset:2048
  ds_read_b128 v[188:191], v2 offset:3072
  v_cvt_pk_bf16_f32 v164, v124, v128
  v_cvt_pk_bf16_f32 v165, v132, v136
  v_cvt_pk_bf16_f32 v166, v140, v144
  v_cvt_pk_bf16_f32 v167, v148, v152
  s_nop 0
  v_cvt_pk_bf16_f32 v180, v156, v160
  v_cvt_pk_bf16_f32 v168, v125, v129
  v_cvt_pk_bf16_f32 v169, v133, v137
  v_cvt_pk_bf16_f32 v170, v141, v145
  v_cvt_pk_bf16_f32 v171, v149, v153
  v_cvt_pk_bf16_f32 v181, v157, v161
  v_cvt_pk_bf16_f32 v172, v126, v130
  v_cvt_pk_bf16_f32 v173, v134, v138
  v_cvt_pk_bf16_f32 v174, v142, v146
  v_cvt_pk_bf16_f32 v175, v150, v154
  v_cvt_pk_bf16_f32 v182, v158, v162
  v_cvt_pk_bf16_f32 v176, v127, v131
  v_cvt_pk_bf16_f32 v177, v135, v139
  v_cvt_pk_bf16_f32 v178, v143, v147
  v_cvt_pk_bf16_f32 v179, v151, v155
  v_cvt_pk_bf16_f32 v183, v159, v163
  s_waitcnt lgkmcnt(1)
  v_mfma_f32_16x16x32_bf16 v[124:127], v[184:187], v[24:27], 0
  ds_read_b128 v[24:27], v14 offset:4096
  s_waitcnt lgkmcnt(1)
  v_mfma_f32_16x16x32_bf16 v[124:127], v[188:191], v[28:31], v[124:127]
  ds_read_b128 v[28:31], v14 offset:5120
  s_add_u32 s58, s64, 0
  buffer_store_dwordx4 v[164:167], v6, s[4:7], s58 offen
  v_mfma_f32_16x16x32_bf16 v[128:131], v[184:187], v[32:35], 0
  s_nop 0
  ds_read_b128 v[32:35], v14 offset:6144
  v_mfma_f32_16x16x32_bf16 v[128:131], v[188:191], v[36:39], v[128:131]
  ds_read_b128 v[36:39], v14 offset:7168
  buffer_store_dword v180, v7, s[4:7], s58 offen offset:1024
  s_waitcnt lgkmcnt(3)
  v_mfma_f32_16x16x32_bf16 v[132:135], v[184:187], v[24:27], 0
  ds_read_b128 v[24:27], v14 offset:8192
  s_waitcnt lgkmcnt(3)
  v_mfma_f32_16x16x32_bf16 v[132:135], v[188:191], v[28:31], v[132:135]
  ds_read_b128 v[28:31], v14 offset:9216
  s_add_u32 s58, s64, 41216
  buffer_store_dwordx4 v[168:171], v6, s[4:7], s58 offen
  s_waitcnt lgkmcnt(3)
  v_mfma_f32_16x16x32_bf16 v[136:139], v[184:187], v[32:35], 0
  ds_read_b128 v[32:35], v14 offset:10240
  s_waitcnt lgkmcnt(3)
  v_mfma_f32_16x16x32_bf16 v[136:139], v[188:191], v[36:39], v[136:139]
  ds_read_b128 v[36:39], v14 offset:11264
  buffer_store_dword v181, v7, s[4:7], s58 offen offset:1024
  s_waitcnt lgkmcnt(3)
  v_mfma_f32_16x16x32_bf16 v[140:143], v[184:187], v[24:27], 0
  ds_read_b128 v[24:27], v14 offset:12288
  s_waitcnt lgkmcnt(3)
  v_mfma_f32_16x16x32_bf16 v[140:143], v[188:191], v[28:31], v[140:143]
  ds_read_b128 v[28:31], v14 offset:13312
  s_add_u32 s58, s64, 82432
  buffer_store_dwordx4 v[172:175], v6, s[4:7], s58 offen
  s_waitcnt lgkmcnt(3)
  v_mfma_f32_16x16x32_bf16 v[144:147], v[184:187], v[32:35], 0
  ds_read_b128 v[32:35], v14 offset:14336
  s_waitcnt lgkmcnt(3)
  v_mfma_f32_16x16x32_bf16 v[144:147], v[188:191], v[36:39], v[144:147]
  ds_read_b128 v[36:39], v14 offset:15360
  buffer_store_dword v182, v7, s[4:7], s58 offen offset:1024
  s_waitcnt lgkmcnt(3)
  v_mfma_f32_16x16x32_bf16 v[148:151], v[184:187], v[24:27], 0
  ds_read_b128 v[24:27], v14 offset:16384
  s_waitcnt lgkmcnt(3)
  v_mfma_f32_16x16x32_bf16 v[148:151], v[188:191], v[28:31], v[148:151]
  ds_read_b128 v[28:31], v14 offset:17408
  s_add_u32 s58, s64, 123648
  buffer_store_dwordx4 v[176:179], v6, s[4:7], s58 offen
  s_waitcnt lgkmcnt(3)
  v_mfma_f32_16x16x32_bf16 v[152:155], v[184:187], v[32:35], 0
  ds_read_b128 v[32:35], v14 offset:18432
  s_waitcnt lgkmcnt(3)
  v_mfma_f32_16x16x32_bf16 v[152:155], v[188:191], v[36:39], v[152:155]
  ds_read_b128 v[36:39], v14 offset:19456
  buffer_store_dword v183, v7, s[4:7], s58 offen offset:1024
  s_waitcnt lgkmcnt(3)
  v_mfma_f32_16x16x32_bf16 v[156:159], v[184:187], v[24:27], 0
  s_waitcnt lgkmcnt(2)
  v_mfma_f32_16x16x32_bf16 v[156:159], v[188:191], v[28:31], v[156:159]
  s_waitcnt lgkmcnt(1)
  v_mfma_f32_16x16x32_bf16 v[160:163], v[184:187], v[32:35], 0
  s_waitcnt lgkmcnt(0)
  v_mfma_f32_16x16x32_bf16 v[160:163], v[188:191], v[36:39], v[160:163]
  v_cvt_pk_bf16_f32 v164, v124, v128
  v_cvt_pk_bf16_f32 v165, v132, v136
  v_cvt_pk_bf16_f32 v166, v140, v144
  v_cvt_pk_bf16_f32 v167, v148, v152
  s_nop 0
  s_nop 2
  v_cvt_pk_bf16_f32 v180, v156, v160
  s_add_u32 s58, s64, 659456
  buffer_store_dwordx4 v[164:167], v6, s[4:7], s58 offen
  buffer_store_dword v180, v7, s[4:7], s58 offen offset:1024
  v_cvt_pk_bf16_f32 v168, v125, v129
  v_cvt_pk_bf16_f32 v169, v133, v137
  v_cvt_pk_bf16_f32 v170, v141, v145
  v_cvt_pk_bf16_f32 v171, v149, v153
  v_cvt_pk_bf16_f32 v181, v157, v161
  s_add_u32 s58, s64, 700672
  buffer_store_dwordx4 v[168:171], v6, s[4:7], s58 offen
  buffer_store_dword v181, v7, s[4:7], s58 offen offset:1024
  v_cvt_pk_bf16_f32 v172, v126, v130
  v_cvt_pk_bf16_f32 v173, v134, v138
  v_cvt_pk_bf16_f32 v174, v142, v146
  v_cvt_pk_bf16_f32 v175, v150, v154
  v_cvt_pk_bf16_f32 v182, v158, v162
  s_add_u32 s58, s64, 741888
  buffer_store_dwordx4 v[172:175], v6, s[4:7], s58 offen
  buffer_store_dword v182, v7, s[4:7], s58 offen offset:1024
  v_cvt_pk_bf16_f32 v176, v127, v131
  v_cvt_pk_bf16_f32 v177, v135, v139
  v_cvt_pk_bf16_f32 v178, v143, v147
  v_cvt_pk_bf16_f32 v179, v151, v155
  v_cvt_pk_bf16_f32 v183, v159, v163
  s_add_u32 s58, s64, 783104
  buffer_store_dwordx4 v[176:179], v6, s[4:7], s58 offen
  buffer_store_dword v183, v7, s[4:7], s58 offen offset:1024
L_ph_40x:
  s_mov_b32 exec_lo, 0xffffffff
  s_mov_b32 exec_hi, 0
  s_waitcnt vmcnt(16)
  v_cmp_gt_u32 vcc, s96, v3
  s_cbranch_vccz L_pw_41y
L_pw_41:
  buffer_load_dword v2, v11, s[4:7], s66 offen offset:0 sc1
  s_sub_u32 s54, s54, 1
  s_cbranch_scc1 L_end
  s_waitcnt vmcnt(0)
  v_cmp_gt_u32 vcc, s96, v2
  s_cbranch_vccnz L_pw_41
L_pw_41y:
  s_mov_b64 exec, -1
L_pw_41x:
  s_branch L_q_fin
  s_nop 0
L_q_noffn:
  s_waitcnt vmcnt(0)
  s_barrier
  s_cmp_lg_u32 s12, 0
  s_cbranch_scc1 L_ps_42
  s_lshl_b32 s58, s13, 2
  s_add_u32 s58, s58, s66
  v_mov_b32 v2, s96
  s_mov_b64 exec, 1
  buffer_store_dword v2, v0, s[4:7], s58 offen offset:0
  s_mov_b64 exec, -1
L_ps_42:
  buffer_load_dwordx4 v[60:63], v1, s[4:7], s67 offen offset:0 sc1
  buffer_load_dwordx4 v[64:67], v1, s[4:7], s67 offen offset:2048 sc1
  s_add_u32 s67, s67, 4096
  buffer_load_dwordx4 v[68:71], v1, s[4:7], s67 offen offset:0 sc1
  buffer_load_dwordx4 v[72:75], v1, s[4:7], s67 offen offset:2048 sc1
  buffer_load_dwordx4 v[76:79], v1, s[4:7], s68 offen offset:0 sc1
  buffer_load_dwordx4 v[80:83], v1, s[4:7], s68 offen offset:1024 sc1
  buffer_load_dwordx4 v[108:111], v1, s[4:7], s75 offen offset:2048 sc1
  s_add_u32 s68, s68, 4096
  buffer_load_dwordx4 v[84:87], v1, s[4:7], s68 offen offset:0 sc1
  buffer_load_dwordx4 v[88:91], v1, s[4:7], s68 offen offset:1024 sc1
  buffer_load_dwordx4 v[112:115], v1, s[4:7], s75 offen offset:3072 sc1
  s_add_u32 s68, s68, 4096
  s_add_u32 s75, s75, 4096
  buffer_load_dwordx4 v[92:95], v1, s[4:7], s68 offen offset:0 sc1
  buffer_load_dwordx4 v[96:99], v1, s[4:7], s68 offen offset:1024 sc1
  buffer_load_dwordx4 v[116:119], v1, s[4:7], s75 offen offset:2048 sc1
  s_add_u32 s68, s68, 4096
  buffer_load_dwordx4 v[100:103], v1, s[4:7], s68 offen offset:0 sc1
  buffer_load_dwordx4 v[104:107], v1, s[4:7], s68 offen offset:1024 sc1
  buffer_load_dwordx4 v[120:123], v1, s[4:7], s75 offen offset:3072 sc1
  s_cmp_lg_u32 s12, 0
  s_cbranch_scc1 L_pw_43x
  s_mov_b32 exec_lo, 0xffffffff
  s_mov_b32 exec_hi, 0
L_pw_43:
  buffer_load_dword v2, v11, s[4:7], s66 offen offset:0 sc1
  s_sub_u32 s54, s54, 1
  s_cbranch_scc1 L_end
  s_waitcnt vmcnt(0)
  v_cmp_gt_u32 vcc, s96, v2
  s_cbranch_vccnz L_pw_43
L_pw_43y:
  s_mov_b64 exec, -1
L_pw_43x:
  s_barrier
L_q_fin:
  s_add_u32 s62, s62, 1
  s_branch L_q_loop
L_end:
  s_waitcnt vmcnt(0) lgkmcnt(0)
L_exit:
  s_endpgm
  s_nop 0
L_spare:
  v_mov_b32 v3, 1
  s_cmp_lg_u32 s12, 0
  s_cbranch_scc1 L_sp1
  s_mov_b64 exec, 1
  buffer_atomic_add v3, v2, s[8:11], 0 offen offset:156 sc0
  s_waitcnt vmcnt(0)
  ds_write_b32 v2, v3
  s_waitcnt lgkmcnt(0)
  s_mov_b64 exec, -1
L_sp1:
  s_barrier
  ds_read_b32 v3, v2
  s_waitcnt lgkmcnt(0)
  v_readfirstlane_b32 s13, v3
  s_barrier
  s_mov_b32 s30, 1000000
  v_lshlrev_b32 v5, 2, v0
L_tk_44:
  buffer_load_dword v4, v5, s[8:11], 0 offen sc1
  s_sub_u32 s30, s30, 1
  s_cbranch_scc1 L_end
  s_waitcnt vmcnt(0)
  s_mov_b32 s94, 0
  v_readlane_b32 s95, v4, 0
  s_nop 0
  s_add_u32 s94, s94, s95
  v_readlane_b32 s95, v4, 16
  s_nop 0
  s_add_u32 s94, s94, s95
  v_readlane_b32 s95, v4, 32
  s_nop 0
  s_add_u32 s94, s94, s95
  v_readlane_b32 s95, v4, 33
  s_nop 0
  s_add_u32 s94, s94, s95
  v_readlane_b32 s95, v4, 34
  s_nop 0
  s_add_u32 s94, s94, s95
  v_readlane_b32 s95, v4, 35
  s_nop 0
  s_add_u32 s94, s94, s95
  v_readlane_b32 s95, v4, 36
  s_nop 0
  s_add_u32 s94, s94, s95
  v_readlane_b32 s95, v4, 37
  s_nop 0
  s_add_u32 s94, s94, s95
  v_readlane_b32 s95, v4, 38
  s_nop 0
  s_add_u32 s94, s94, s95
  s_sleep 4
  s_cmp_lt_u32 s94, 256
  s_cbranch_scc1 L_tk_44
L_tk_44x:
  s_mov_b32 s14, 0
  v_readlane_b32 s20, v4, 0
  s_nop 0
  s_min_u32 s20, s20, 32
  s_add_u32 s13, s13, s20
  s_cmp_lt_u32 s13, 32
  s_cbranch_scc1 L_placed
  s_sub_u32 s13, s13, 32
  s_mov_b32 s14, 1
  v_readlane_b32 s20, v4, 16
  s_nop 0
  s_min_u32 s20, s20, 32
  s_add_u32 s13, s13, s20
  s_cmp_lt_u32 s13, 32
  s_cbranch_scc1 L_placed
  s_sub_u32 s13, s13, 32
  s_mov_b32 s14, 2
  v_readlane_b32 s20, v4, 32
  s_nop 0
  s_min_u32 s20, s20, 32
  s_add_u32 s13, s13, s20
  s_cmp_lt_u32 s13, 32
  s_cbranch_scc1 L_placed
  s_sub_u32 s13, s13, 32
  s_mov_b32 s14, 3
  v_readlane_b32 s20, v4, 33
  s_nop 0
  s_min_u32 s20, s20, 32
  s_add_u32 s13, s13, s20
  s_cmp_lt_u32 s13, 32
  s_cbranch_scc1 L_placed
  s_sub_u32 s13, s13, 32
  s_mov_b32 s14, 4
  v_readlane_b32 s20, v4, 34
  s_nop 0
  s_min_u32 s20, s20, 32
  s_add_u32 s13, s13, s20
  s_cmp_lt_u32 s13, 32
  s_cbranch_scc1 L_placed
  s_sub_u32 s13, s13, 32
  s_mov_b32 s14, 5
  v_readlane_b32 s20, v4, 35
  s_nop 0
  s_min_u32 s20, s20, 32
  s_add_u32 s13, s13, s20
  s_cmp_lt_u32 s13, 32
  s_cbranch_scc1 L_placed
  s_sub_u32 s13, s13, 32
  s_mov_b32 s14, 6
  v_readlane_b32 s20, v4, 36
  s_nop 0
  s_min_u32 s20, s20, 32
  s_add_u32 s13, s13, s20
  s_cmp_lt_u32 s13, 32
  s_cbranch_scc1 L_placed
  s_sub_u32 s13, s13, 32
  s_mov_b32 s14, 7
  v_readlane_b32 s20, v4, 37
  s_nop 0
  s_min_u32 s20, s20, 32
  s_add_u32 s13, s13, s20
  s_cmp_lt_u32 s13, 32
  s_cbranch_scc1 L_placed
  s_sub_u32 s13, s13, 32
  s_branch L_exit
  s_nop 0
L_chain:
  s_load_dwordx2 s[16:17], s[0:1], 16
  s_load_dwordx2 s[20:21], s[0:1], 24
  s_load_dwordx2 s[24:25], s[0:1], 32
  s_load_dwordx2 s[28:29], s[0:1], 40
  v_and_b32 v16, 15, v0
  v_lshrrev_b32 v17, 4, v0
  v_lshlrev_b32 v5, 16, v17
  v_lshl_add_u32 v5, v16, 4, v5
  s_lshl_b32 s40, s13, 8
  v_add_u32 v5, s40, v5
  v_lshrrev_b32 v18, 1, v17
  v_and_b32_e64 v19, 1, v17
  v_lshl_add_u32 v18, v18, 5, v19
  v_mul_u32_u24 v18, 1280, v18
  s_mul_i32 s40, s13, 163840
  s_mul_i32 s41, s14, 640
  s_add_u32 s40, s40, s41
  v_add_u32 v18, s40, v18
  s_lshl_b32 s41, s12, 7
  v_lshl_add_u32 v6, v16, 3, v18
  v_add_u32 v6, s41, v6
  s_and_b32 s41, s12, 1
  s_lshl_b32 s41, s41, 6
  s_add_u32 s41, s41, 512
  v_lshl_add_u32 v7, v16, 2, v18
  v_add_u32 v7, s41, v7
  v_lshlrev_b32 v0, 4, v0
  s_lshl_b32 s40, s12, 10
  v_add_u32 v2, s40, v0
  s_xor_b32 s41, s12, 2
  s_lshl_b32 s41, s41, 15
  s_cmp_eq_u32 s12, 1
  s_cselect_b32 s40, 8192, 0
  s_add_u32 s40, s40, s41
  s_add_u32 s40, s40, 16384
  v_add_u32 v4, s40, v0
  s_lshl_b32 s40, s12, 12
  v_add_u32 v8, s40, v0
  v_add_u32_e64 v12, s40, v2
  v_xor_b32 v13, 1024, v12
  v_xor_b32 v14, 2048, v12
  v_xor_b32 v15, 3072, v12
  s_mov_b32 s60, 0x05040100
  s_mov_b32 s65, 0x07060302
  s_mul_i32 s40, s14, 5
  s_add_u32 s36, s40, s12
  s_lshl_b32 s36, s36, 19
  s_sub_u32 s41, 5, s40
  s_add_u32 s37, s41, s12
  s_lshl_b32 s37, s37, 19
  s_cmp_lt_u32 s12, 2
  s_cselect_b32 s38, s40, s41
  s_add_u32 s38, s38, 4
  s_lshl_b32 s38, s38, 1
  s_and_b32 s40, s12, 1
  s_add_u32 s38, s38, s40
  s_lshl_b32 s38, s38, 18
  s_mov_b32 s66, 1000000
  s_waitcnt lgkmcnt(0)
  s_mov_b32 s18, 5242880
  s_mov_b32 s19, 0x20000
  s_mov_b32 s22, 5242880
  s_mov_b32 s23, 0x20000
  s_mov_b32 s26, 5242880
  s_mov_b32 s27, 0x20000
  s_mov_b32 s30, 5242880
  s_mov_b32 s31, 0x20000
  s_xor_b32 s40, s12, 0
  s_mul_i32 s42, s40, 2560
  s_xor_b32 s40, s12, 1
  s_mul_i32 s43, s40, 2560
  s_xor_b32 s40, s12, 2
  s_mul_i32 s44, s40, 2560
  s_xor_b32 s40, s12, 3
  s_mul_i32 s45, s40, 2560
  s_add_u32 s40, s36, 0
  buffer_load_dwordx4 v[224:227], v5, s[16:19], s40 offen
  s_add_u32 s40, s36, 8192
  buffer_load_dwordx4 v[228:231], v5, s[16:19], s40 offen
  s_add_u32 s40, s36, 32768
  buffer_load_dwordx4 v[232:235], v5, s[16:19], s40 offen
  s_add_u32 s40, s36, 40960
  buffer_load_dwordx4 v[236:239], v5, s[16:19], s40 offen
  s_add_u32 s40, s36, 16384
  buffer_load_dwordx4 v[240:243], v5, s[16:19], s40 offen
  s_add_u32 s40, s36, 24576
  buffer_load_dwordx4 v[244:247], v5, s[16:19], s40 offen
  s_add_u32 s40, s36, 49152
  buffer_load_dwordx4 v[248:251], v5, s[16:19], s40 offen
  s_add_u32 s40, s36, 57344
  buffer_load_dwordx4 v[252:255], v5, s[16:19], s40 offen
  s_add_u32 s40, s36, 262144
  buffer_load_dwordx4 v[16:19], v5, s[16:19], s40 offen
  s_add_u32 s40, s36, 270336
  buffer_load_dwordx4 v[20:23], v5, s[16:19], s40 offen
  s_add_u32 s40, s36, 294912
  buffer_load_dwordx4 v[24:27], v5, s[16:19], s40 offen
  s_add_u32 s40, s36, 303104
  buffer_load_dwordx4 v[28:31], v5, s[16:19], s40 offen
  s_add_u32 s40, s36, 278528
  buffer_load_dwordx4 v[32:35], v5, s[16:19], s40 offen
  s_add_u32 s40, s36, 286720
  buffer_load_dwordx4 v[36:39], v5, s[16:19], s40 offen
  s_add_u32 s40, s36, 311296
  buffer_load_dwordx4 v[40:43], v5, s[16:19], s40 offen
  s_add_u32 s40, s36, 319488
  buffer_load_dwordx4 v[44:47], v5, s[16:19], s40 offen
  s_waitcnt vmcnt(8)
  s_add_u32 s40, s37, 0
  buffer_load_dwordx4 v[48:51], v5, s[16:19], s40 offen
  s_add_u32 s40, s37, 8192
  buffer_load_dwordx4 v[52:55], v5, s[16:19], s40 offen
  s_add_u32 s40, s37, 32768
  buffer_load_dwordx4 v[56:59], v5, s[16:19], s40 offen
  s_add_u32 s40, s37, 40960
  buffer_load_dwordx4 v[60:63], v5, s[16:19], s40 offen
  s_add_u32 s40, s37, 16384
  buffer_load_dwordx4 v[64:67], v5, s[16:19], s40 offen
  s_add_u32 s40, s37, 24576
  buffer_load_dwordx4 v[68:71], v5, s[16:19], s40 offen
  s_add_u32 s40, s37, 49152
  buffer_load_dwordx4 v[72:75], v5, s[16:19], s40 offen
  s_add_u32 s40, s37, 57344
  buffer_load_dwordx4 v[76:79], v5, s[16:19], s40 offen
  v_perm_b32 v80, v228, v224, s60
  v_perm_b32 v81, v236, v232, s60
  v_perm_b32 v82, v244, v240, s60
  v_perm_b32 v83, v252, v248, s60
  v_perm_b32 v84, v229, v225, s60
  v_perm_b32 v85, v237, v233, s60
  v_perm_b32 v86, v245, v241, s60
  v_perm_b32 v87, v253, v249, s60
  v_perm_b32 v88, v230, v226, s60
  v_perm_b32 v89, v238, v234, s60
  v_perm_b32 v90, v246, v242, s60
  v_perm_b32 v91, v254, v250, s60
  v_perm_b32 v92, v231, v227, s60
  v_perm_b32 v93, v239, v235, s60
  v_perm_b32 v94, v247, v243, s60
  v_perm_b32 v95, v255, v251, s60
  s_barrier
  ds_write_b128 v2, v[80:83] offset:0
  ds_write_b128 v2, v[84:87] offset:4096
  ds_write_b128 v2, v[88:91] offset:8192
  ds_write_b128 v2, v[92:95] offset:12288
  s_waitcnt lgkmcnt(0)
  s_barrier
  ds_read_b128 v[80:83], v12
  ds_read_b128 a[136:139], v13
  ds_read_b128 v[88:91], v14
  ds_read_b128 a[192:195], v15
  s_waitcnt lgkmcnt(3)
  ds_write_b128 v4, v[80:83] offset:0
  s_waitcnt lgkmcnt(2)
  ds_write_b128 v4, v[88:91] offset:10240
  s_waitcnt lgkmcnt(0)
  v_perm_b32 v80, v228, v224, s65
  v_perm_b32 v81, v236, v232, s65
  v_perm_b32 v82, v244, v240, s65
  v_perm_b32 v83, v252, v248, s65
  v_perm_b32 v84, v229, v225, s65
  v_perm_b32 v85, v237, v233, s65
  v_perm_b32 v86, v245, v241, s65
  v_perm_b32 v87, v253, v249, s65
  v_perm_b32 v88, v230, v226, s65
  v_perm_b32 v89, v238, v234, s65
  v_perm_b32 v90, v246, v242, s65
  v_perm_b32 v91, v254, v250, s65
  v_perm_b32 v92, v231, v227, s65
  v_perm_b32 v93, v239, v235, s65
  v_perm_b32 v94, v247, v243, s65
  v_perm_b32 v95, v255, v251, s65
  s_barrier
  ds_write_b128 v2, v[80:83] offset:0
  ds_write_b128 v2, v[84:87] offset:4096
  ds_write_b128 v2, v[88:91] offset:8192
  ds_write_b128 v2, v[92:95] offset:12288
  s_nop 0
  s_waitcnt lgkmcnt(0)
  s_barrier
  ds_read_b128 a[64:67], v12
  ds_read_b128 a[144:147], v13
  ds_read_b128 a[176:179], v14
  ds_read_b128 a[208:211], v15
  s_waitcnt lgkmcnt(0)
  v_lshrrev_b32_e64 v10, 2, v0
  buffer_load_dword v10, v10, s[8:11], 0 offen sc1
  s_waitcnt vmcnt(8)
  s_add_u32 s40, s37, 262144
  buffer_load_dwordx4 v[192:195], v5, s[16:19], s40 offen
  s_add_u32 s40, s37, 270336
  buffer_load_dwordx4 v[196:199], v5, s[16:19], s40 offen
  s_add_u32 s40, s37, 294912
  buffer_load_dwordx4 v[200:203], v5, s[16:19], s40 offen
  s_add_u32 s40, s37, 303104
  buffer_load_dwordx4 v[204:207], v5, s[16:19], s40 offen
  s_add_u32 s40, s37, 278528
  buffer_load_dwordx4 v[208:211], v5, s[16:19], s40 offen
  s_add_u32 s40, s37, 286720
  buffer_load_dwordx4 v[212:215], v5, s[16:19], s40 offen
  s_add_u32 s40, s37, 311296
  buffer_load_dwordx4 v[216:219], v5, s[16:19], s40 offen
  s_add_u32 s40, s37, 319488
  buffer_load_dwordx4 v[220:223], v5, s[16:19], s40 offen
  v_perm_b32 v80, v20, v16, s60
  v_perm_b32 v81, v28, v24, s60
  v_perm_b32 v82, v36, v32, s60
  v_perm_b32 v83, v44, v40, s60
  v_perm_b32 v84, v21, v17, s60
  v_perm_b32 v85, v29, v25, s60
  v_perm_b32 v86, v37, v33, s60
  v_perm_b32 v87, v45, v41, s60
  v_perm_b32 v88, v22, v18, s60
  v_perm_b32 v89, v30, v26, s60
  v_perm_b32 v90, v38, v34, s60
  v_perm_b32 v91, v46, v42, s60
  v_perm_b32 v92, v23, v19, s60
  v_perm_b32 v93, v31, v27, s60
  v_perm_b32 v94, v39, v35, s60
  v_perm_b32 v95, v47, v43, s60
  s_barrier
  ds_write_b128 v2, v[80:83] offset:0
  ds_write_b128 v2, v[84:87] offset:4096
  ds_write_b128 v2, v[88:91] offset:8192
  ds_write_b128 v2, v[92:95] offset:12288
  s_waitcnt lgkmcnt(0)
  s_barrier
  ds_read_b128 v[80:83], v12
  ds_read_b128 a[140:143], v13
  ds_read_b128 v[88:91], v14
  ds_read_b128 a[196:199], v15
  s_waitcnt lgkmcnt(3)
  ds_write_b128 v4, v[80:83] offset:1024
  s_waitcnt lgkmcnt(2)
  ds_write_b128 v4, v[88:91] offset:11264
  s_waitcnt lgkmcnt(0)
  v_perm_b32 v80, v20, v16, s65
  v_perm_b32 v81, v28, v24, s65
  v_perm_b32 v82, v36, v32, s65
  v_perm_b32 v83, v44, v40, s65
  v_perm_b32 v84, v21, v17, s65
  v_perm_b32 v85, v29, v25, s65
  v_perm_b32 v86, v37, v33, s65
  v_perm_b32 v87, v45, v41, s65
  v_perm_b32 v88, v22, v18, s65
  v_perm_b32 v89, v30, v26, s65
  v_perm_b32 v90, v38, v34, s65
  v_perm_b32 v91, v46, v42, s65
  v_perm_b32 v92, v23, v19, s65
  v_perm_b32 v93, v31, v27, s65
  v_perm_b32 v94, v39, v35, s65
  v_perm_b32 v95, v47, v43, s65
  s_barrier
  ds_write_b128 v2, v[80:83] offset:0
  ds_write_b128 v2, v[84:87] offset:4096
  ds_write_b128 v2, v[88:91] offset:8192
  ds_write_b128 v2, v[92:95] offset:12288
  s_waitcnt lgkmcnt(0)
  s_barrier
  ds_read_b128 a[68:71], v12
  ds_read_b128 a[148:151], v13
  ds_read_b128 a[180:183], v14
  ds_read_b128 a[212:215], v15
  s_waitcnt lgkmcnt(0)
  s_waitcnt vmcnt(8)
  s_add_u32 s40, s38, 0
  buffer_load_dwordx4 v[224:227], v5, s[16:19], s40 offen
  s_add_u32 s40, s38, 8192
  buffer_load_dwordx4 v[228:231], v5, s[16:19], s40 offen
  s_add_u32 s40, s38, 32768
  buffer_load_dwordx4 v[232:235], v5, s[16:19], s40 offen
  s_add_u32 s40, s38, 40960
  buffer_load_dwordx4 v[236:239], v5, s[16:19], s40 offen
  s_add_u32 s40, s38, 16384
  buffer_load_dwordx4 v[240:243], v5, s[16:19], s40 offen
  s_add_u32 s40, s38, 24576
  buffer_load_dwordx4 v[244:247], v5, s[16:19], s40 offen
  s_add_u32 s40, s38, 49152
  buffer_load_dwordx4 v[248:251], v5, s[16:19], s40 offen
  s_add_u32 s40, s38, 57344
  buffer_load_dwordx4 v[252:255], v5, s[16:19], s40 offen
  v_perm_b32 v80, v52, v48, s60
  v_perm_b32 v81, v60, v56, s60
  v_perm_b32 v82, v68, v64, s60
  v_perm_b32 v83, v76, v72, s60
  v_perm_b32 v84, v53, v49, s60
  v_perm_b32 v85, v61, v57, s60
  v_perm_b32 v86, v69, v65, s60
  v_perm_b32 v87, v77, v73, s60
  v_perm_b32 v88, v54, v50, s60
  v_perm_b32 v89, v62, v58, s60
  v_perm_b32 v90, v70, v66, s60
  v_perm_b32 v91, v78, v74, s60
  v_perm_b32 v92, v55, v51, s60
  v_perm_b32 v93, v63, v59, s60
  v_perm_b32 v94, v71, v67, s60
  v_perm_b32 v95, v79, v75, s60
  s_barrier
  ds_write_b128 v2, v[80:83] offset:0
  ds_write_b128 v2, v[84:87] offset:4096
  ds_write_b128 v2, v[88:91] offset:8192
  ds_write_b128 v2, v[92:95] offset:12288
  s_waitcnt lgkmcnt(0)
  s_barrier
  ds_read_b128 a[224:227], v12
  ds_read_b128 v[84:87], v13
  ds_read_b128 v[120:123], v14
  ds_read_b128 v[92:95], v15
  s_waitcnt lgkmcnt(2)
  ds_write_b128 v4, v[84:87] offset:22528
  s_waitcnt lgkmcnt(1)
  ds_write_b128 v4, v[92:95] offset:24576
  s_waitcnt lgkmcnt(0)
  v_perm_b32 v80, v52, v48, s65
  v_perm_b32 v81, v60, v56, s65
  v_perm_b32 v82, v68, v64, s65
  v_perm_b32 v83, v76, v72, s65
  v_perm_b32 v84, v53, v49, s65
  v_perm_b32 v85, v61, v57, s65
  v_perm_b32 v86, v69, v65, s65
  v_perm_b32 v87, v77, v73, s65
  v_perm_b32 v88, v54, v50, s65
  v_perm_b32 v89, v62, v58, s65
  v_perm_b32 v90, v70, v66, s65
  v_perm_b32 v91, v78, v74, s65
  v_perm_b32 v92, v55, v51, s65
  v_perm_b32 v93, v63, v59, s65
  v_perm_b32 v94, v71, v67, s65
  v_perm_b32 v95, v79, v75, s65
  s_barrier
  ds_write_b128 v2, v[80:83] offset:0
  ds_write_b128 v2, v[84:87] offset:4096
  ds_write_b128 v2, v[88:91] offset:8192
  ds_write_b128 v2, v[92:95] offset:12288
  s_nop 0
  s_waitcnt lgkmcnt(0)
  s_barrier
  ds_read_b128 v[80:83], v12
  ds_read_b128 v[144:147], v13
  ds_read_b128 v[152:155], v14
  ds_read_b128 v[160:163], v15
  s_waitcnt lgkmcnt(3)
  ds_write_b128 v4, v[80:83] offset:20480
  s_waitcnt lgkmcnt(0)
  s_lshl_b32 s40, s13, 2
  s_add_u32 s40, s40, s12
  s_mul_i32 s41, s14, 524288
  s_lshl_b32 s46, s40, 8
  s_add_u32 s46, s46, s41
  s_add_u32 s46, s46, 458752
  s_lshl_b32 s40, s40, 11
  s_add_u32 s40, s40, s41
  s_add_u32 s40, s40, 65536
  v_mov_b64 v[80:81], 0
  v_mov_b64 v[82:83], 0
  v_mov_b64 v[84:85], -1
  v_mov_b64 v[86:87], -1
  v_lshrrev_b32 v88, 2, v0
  s_lshl_b32 s41, s14, 4
  v_readlane_b32 s41, v10, s41
  s_nop 0
  s_cmp_ge_u32 s41, 32
  s_cbranch_scc1 L_c_clrf
  buffer_store_dwordx4 v[80:83], v0, s[4:7], s40 offen sc1
  buffer_store_dwordx4 v[80:83], v0, s[4:7], s40 offen offset:1024 sc1
  buffer_store_dword v84, v88, s[4:7], s46 offen sc1
  s_cbranch_scc0 L_c_clrx
L_c_clrf:
  buffer_store_dwordx4 v[80:83], v0, s[4:7], s40 offen
  buffer_store_dwordx4 v[80:83], v0, s[4:7], s40 offen offset:1024
  buffer_store_dword v84, v88, s[4:7], s46 offen
L_c_clrx:
  s_waitcnt vmcnt(8)
  s_add_u32 s40, s36, 0
  buffer_load_dwordx4 v[16:19], v5, s[20:23], s40 offen
  s_add_u32 s40, s36, 8192
  buffer_load_dwordx4 v[20:23], v5, s[20:23], s40 offen
  s_add_u32 s40, s36, 32768
  buffer_load_dwordx4 v[24:27], v5, s[20:23], s40 offen
  s_add_u32 s40, s36, 40960
  buffer_load_dwordx4 v[28:31], v5, s[20:23], s40 offen
  s_add_u32 s40, s36, 16384
  buffer_load_dwordx4 v[32:35], v5, s[20:23], s40 offen
  s_add_u32 s40, s36, 24576
  buffer_load_dwordx4 v[36:39], v5, s[20:23], s40 offen
  s_add_u32 s40, s36, 49152
  buffer_load_dwordx4 v[40:43], v5, s[20:23], s40 offen
  s_add_u32 s40, s36, 57344
  buffer_load_dwordx4 v[44:47], v5, s[20:23], s40 offen
  v_perm_b32 v80, v196, v192, s60
  v_perm_b32 v81, v204, v200, s60
  v_perm_b32 v82, v212, v208, s60
  v_perm_b32 v83, v220, v216, s60
  v_perm_b32 v84, v197, v193, s60
  v_perm_b32 v85, v205, v201, s60
  v_perm_b32 v86, v213, v209, s60
  v_perm_b32 v87, v221, v217, s60
  v_perm_b32 v88, v198, v194, s60
  v_perm_b32 v89, v206, v202, s60
  v_perm_b32 v90, v214, v210, s60
  v_perm_b32 v91, v222, v218, s60
  v_perm_b32 v92, v199, v195, s60
  v_perm_b32 v93, v207, v203, s60
  v_perm_b32 v94, v215, v211, s60
  v_perm_b32 v95, v223, v219, s60
  s_barrier
  ds_write_b128 v2, v[80:83] offset:0
  ds_write_b128 v2, v[84:87] offset:4096
  ds_write_b128 v2, v[88:91] offset:8192
  ds_write_b128 v2, v[92:95] offset:12288
  s_waitcnt lgkmcnt(0)
  s_barrier
  ds_read_b128 a[228:231], v12
  ds_read_b128 v[84:87], v13
  ds_read_b128 v[124:127], v14
  ds_read_b128 v[92:95], v15
  s_waitcnt lgkmcnt(2)
  ds_write_b128 v4, v[84:87] offset:23552
  s_waitcnt lgkmcnt(1)
  ds_write_b128 v4, v[92:95] offset:25600
  s_waitcnt lgkmcnt(0)
  v_perm_b32 v80, v196, v192, s65
  v_perm_b32 v81, v204, v200, s65
  v_perm_b32 v82, v212, v208, s65
  v_perm_b32 v83, v220, v216, s65
  v_perm_b32 v84, v197, v193, s65
  v_perm_b32 v85, v205, v201, s65
  v_perm_b32 v86, v213, v209, s65
  v_perm_b32 v87, v221, v217, s65
  v_perm_b32 v88, v198, v194, s65
  v_perm_b32 v89, v206, v202, s65
  v_perm_b32 v90, v214, v210, s65
  v_perm_b32 v91, v222, v218, s65
  v_perm_b32 v92, v199, v195, s65
  v_perm_b32 v93, v207, v203, s65
  v_perm_b32 v94, v215, v211, s65
  v_perm_b32 v95, v223, v219, s65
  s_barrier
  ds_write_b128 v2, v[80:83] offset:0
  ds_write_b128 v2, v[84:87] offset:4096
  ds_write_b128 v2, v[88:91] offset:8192
  ds_write_b128 v2, v[92:95] offset:12288
  s_waitcnt lgkmcnt(0)
  s_barrier
  ds_read_b128 v[80:83], v12
  ds_read_b128 v[148:151], v13
  ds_read_b128 v[156:159], v14
  ds_read_b128 v[164:167], v15
  s_waitcnt lgkmcnt(3)
  ds_write_b128 v4, v[80:83] offset:21504
  s_waitcnt lgkmcnt(0)
  s_waitcnt vmcnt(8)
  s_add_u32 s40, s36, 262144
  buffer_load_dwordx4 v[48:51], v5, s[20:23], s40 offen
  s_add_u32 s40, s36, 270336
  buffer_load_dwordx4 v[52:55], v5, s[20:23], s40 offen
  s_add_u32 s40, s36, 294912
  buffer_load_dwordx4 v[56:59], v5, s[20:23], s40 offen
  s_add_u32 s40, s36, 303104
  buffer_load_dwordx4 v[60:63], v5, s[20:23], s40 offen
  s_add_u32 s40, s36, 278528
  buffer_load_dwordx4 v[64:67], v5, s[20:23], s40 offen
  s_add_u32 s40, s36, 286720
  buffer_load_dwordx4 v[68:71], v5, s[20:23], s40 offen
  s_add_u32 s40, s36, 311296
  buffer_load_dwordx4 v[72:75], v5, s[20:23], s40 offen
  s_add_u32 s40, s36, 319488
  buffer_load_dwordx4 v[76:79], v5, s[20:23], s40 offen
  v_perm_b32 v80, v228, v224, s60
  v_perm_b32 v81, v236, v232, s60
  v_perm_b32 v82, v244, v240, s60
  v_perm_b32 v83, v252, v248, s60
  v_perm_b32 v84, v229, v225, s60
  v_perm_b32 v85, v237, v233, s60
  v_perm_b32 v86, v245, v241, s60
  v_perm_b32 v87, v253, v249, s60
  v_perm_b32 v88, v230, v226, s60
  v_perm_b32 v89, v238, v234, s60
  v_perm_b32 v90, v246, v242, s60
  v_perm_b32 v91, v254, v250, s60
  v_perm_b32 v92, v231, v227, s60
  v_perm_b32 v93, v239, v235, s60
  v_perm_b32 v94, v247, v243, s60
  v_perm_b32 v95, v255, v251, s60
  s_barrier
  ds_write_b128 v2, v[80:83] offset:0
  ds_write_b128 v2, v[84:87] offset:4096
  ds_write_b128 v2, v[88:91] offset:8192
  ds_write_b128 v2, v[92:95] offset:12288
  s_waitcnt lgkmcnt(0)
  s_barrier
  ds_read_b128 a[96:99], v8 offset:0
  ds_read_b128 a[100:103], v8 offset:1024
  ds_read_b128 a[248:251], v8 offset:2048
  ds_read_b128 a[252:255], v8 offset:3072
  s_waitcnt lgkmcnt(0)
  v_perm_b32 v80, v228, v224, s65
  v_perm_b32 v81, v236, v232, s65
  v_perm_b32 v82, v244, v240, s65
  v_perm_b32 v83, v252, v248, s65
  v_perm_b32 v84, v229, v225, s65
  v_perm_b32 v85, v237, v233, s65
  v_perm_b32 v86, v245, v241, s65
  v_perm_b32 v87, v253, v249, s65
  v_perm_b32 v88, v230, v226, s65
  v_perm_b32 v89, v238, v234, s65
  v_perm_b32 v90, v246, v242, s65
  v_perm_b32 v91, v254, v250, s65
  v_perm_b32 v92, v231, v227, s65
  v_perm_b32 v93, v239, v235, s65
  v_perm_b32 v94, v247, v243, s65
  v_perm_b32 v95, v255, v251, s65
  s_barrier
  ds_write_b128 v2, v[80:83] offset:0
  ds_write_b128 v2, v[84:87] offset:4096
  ds_write_b128 v2, v[88:91] offset:8192
  ds_write_b128 v2, v[92:95] offset:12288
  s_waitcnt lgkmcnt(0)
  s_barrier
  ds_read_b128 a[112:115], v8 offset:0
  ds_read_b128 a[116:119], v8 offset:1024
  ds_read_b128 v[104:107], v8 offset:2048
  ds_read_b128 v[108:111], v8 offset:3072
  s_waitcnt lgkmcnt(0)
  s_waitcnt vmcnt(8)
  s_add_u32 s40, s37, 0
  buffer_load_dwordx4 v[192:195], v5, s[20:23], s40 offen
  s_add_u32 s40, s37, 8192
  buffer_load_dwordx4 v[196:199], v5, s[20:23], s40 offen
  s_add_u32 s40, s37, 32768
  buffer_load_dwordx4 v[200:203], v5, s[20:23], s40 offen
  s_add_u32 s40, s37, 40960
  buffer_load_dwordx4 v[204:207], v5, s[20:23], s40 offen
  s_add_u32 s40, s37, 16384
  buffer_load_dwordx4 v[208:211], v5, s[20:23], s40 offen
  s_add_u32 s40, s37, 24576
  buffer_load_dwordx4 v[212:215], v5, s[20:23], s40 offen
  s_add_u32 s40, s37, 49152
  buffer_load_dwordx4 v[216:219], v5, s[20:23], s40 offen
  s_add_u32 s40, s37, 57344
  buffer_load_dwordx4 v[220:223], v5, s[20:23], s40 offen
  v_perm_b32 v80, v20, v16, s60
  v_perm_b32 v81, v28, v24, s60
  v_perm_b32 v82, v36, v32, s60
  v_perm_b32 v83, v44, v40, s60
  v_perm_b32 v84, v21, v17, s60
  v_perm_b32 v85, v29, v25, s60
  v_perm_b32 v86, v37, v33, s60
  v_perm_b32 v87, v45, v41, s60
  v_perm_b32 v88, v22, v18, s60
  v_perm_b32 v89, v30, v26, s60
  v_perm_b32 v90, v38, v34, s60
  v_perm_b32 v91, v46, v42, s60
  v_perm_b32 v92, v23, v19, s60
  v_perm_b32 v93, v31, v27, s60
  v_perm_b32 v94, v39, v35, s60
  v_perm_b32 v95, v47, v43, s60
  s_barrier
  ds_write_b128 v2, v[80:83] offset:0
  ds_write_b128 v2, v[84:87] offset:4096
  ds_write_b128 v2, v[88:91] offset:8192
  ds_write_b128 v2, v[92:95] offset:12288
  s_waitcnt lgkmcnt(0)
  s_barrier
  ds_read_b128 v[80:83], v12
  ds_read_b128 v[84:87], v13
  ds_read_b128 a[168:171], v14
  ds_read_b128 a[200:203], v15
  s_waitcnt lgkmcnt(3)
  ds_write_b128 v4, v[80:83] offset:2048
  s_waitcnt lgkmcnt(3)
  ds_write_b128 v4, v[84:87] offset:6144
  s_waitcnt lgkmcnt(0)
  v_perm_b32 v80, v20, v16, s65
  v_perm_b32 v81, v28, v24, s65
  v_perm_b32 v82, v36, v32, s65
  v_perm_b32 v83, v44, v40, s65
  v_perm_b32 v84, v21, v17, s65
  v_perm_b32 v85, v29, v25, s65
  v_perm_b32 v86, v37, v33, s65
  v_perm_b32 v87, v45, v41, s65
  v_perm_b32 v88, v22, v18, s65
  v_perm_b32 v89, v30, v26, s65
  v_perm_b32 v90, v38, v34, s65
  v_perm_b32 v91, v46, v42, s65
  v_perm_b32 v92, v23, v19, s65
  v_perm_b32 v93, v31, v27, s65
  v_perm_b32 v94, v39, v35, s65
  v_perm_b32 v95, v47, v43, s65
  s_barrier
  ds_write_b128 v2, v[80:83] offset:0
  ds_write_b128 v2, v[84:87] offset:4096
  ds_write_b128 v2, v[88:91] offset:8192
  ds_write_b128 v2, v[92:95] offset:12288
  s_waitcnt lgkmcnt(0)
  s_barrier
  ds_read_b128 a[72:75], v12
  ds_read_b128 v[84:87], v13
  ds_read_b128 v[88:91], v14
  ds_read_b128 v[92:95], v15
  s_waitcnt lgkmcnt(2)
  ds_write_b128 v4, v[84:87] offset:8192
  s_waitcnt lgkmcnt(2)
  ds_write_b128 v4, v[88:91] offset:12288
  s_waitcnt lgkmcnt(2)
  ds_write_b128 v4, v[92:95] offset:16384
  s_waitcnt lgkmcnt(0)
  s_waitcnt vmcnt(8)
  s_add_u32 s40, s37, 262144
  buffer_load_dwordx4 v[224:227], v5, s[20:23], s40 offen
  s_add_u32 s40, s37, 270336
  buffer_load_dwordx4 v[228:231], v5, s[20:23], s40 offen
  s_add_u32 s40, s37, 294912
  buffer_load_dwordx4 v[232:235], v5, s[20:23], s40 offen
  s_add_u32 s40, s37, 303104
  buffer_load_dwordx4 v[236:239], v5, s[20:23], s40 offen
  s_add_u32 s40, s37, 278528
  buffer_load_dwordx4 v[240:243], v5, s[20:23], s40 offen
  s_add_u32 s40, s37, 286720
  buffer_load_dwordx4 v[244:247], v5, s[20:23], s40 offen
  s_add_u32 s40, s37, 311296
  buffer_load_dwordx4 v[248:251], v5, s[20:23], s40 offen
  s_add_u32 s40, s37, 319488
  buffer_load_dwordx4 v[252:255], v5, s[20:23], s40 offen
  v_perm_b32 v80, v52, v48, s60
  v_perm_b32 v81, v60, v56, s60
  v_perm_b32 v82, v68, v64, s60
  v_perm_b32 v83, v76, v72, s60
  v_perm_b32 v84, v53, v49, s60
  v_perm_b32 v85, v61, v57, s60
  v_perm_b32 v86, v69, v65, s60
  v_perm_b32 v87, v77, v73, s60
  v_perm_b32 v88, v54, v50, s60
  v_perm_b32 v89, v62, v58, s60
  v_perm_b32 v90, v70, v66, s60
  v_perm_b32 v91, v78, v74, s60
  v_perm_b32 v92, v55, v51, s60
  v_perm_b32 v93, v63, v59, s60
  v_perm_b32 v94, v71, v67, s60
  v_perm_b32 v95, v79, v75, s60
  s_barrier
  ds_write_b128 v2, v[80:83] offset:0
  ds_write_b128 v2, v[84:87] offset:4096
  ds_write_b128 v2, v[88:91] offset:8192
  ds_write_b128 v2, v[92:95] offset:12288
  s_waitcnt lgkmcnt(0)
  s_barrier
  ds_read_b128 v[80:83], v12
  ds_read_b128 v[84:87], v13
  ds_read_b128 a[172:175], v14
  ds_read_b128 a[204:207], v15
  s_waitcnt lgkmcnt(3)
  ds_write_b128 v4, v[80:83] offset:3072
  s_waitcnt lgkmcnt(3)
  ds_write_b128 v4, v[84:87] offset:7168
  s_waitcnt lgkmcnt(0)
  v_perm_b32 v80, v52, v48, s65
  v_perm_b32 v81, v60, v56, s65
  v_perm_b32 v82, v68, v64, s65
  v_perm_b32 v83, v76, v72, s65
  v_perm_b32 v84, v53, v49, s65
  v_perm_b32 v85, v61, v57, s65
  v_perm_b32 v86, v69, v65, s65
  v_perm_b32 v87, v77, v73, s65
  v_perm_b32 v88, v54, v50, s65
  v_perm_b32 v89, v62, v58, s65
  v_perm_b32 v90, v70, v66, s65
  v_perm_b32 v91, v78, v74, s65
  v_perm_b32 v92, v55, v51, s65
  v_perm_b32 v93, v63, v59, s65
  v_perm_b32 v94, v71, v67, s65
  v_perm_b32 v95, v79, v75, s65
  s_barrier
  ds_write_b128 v2, v[80:83] offset:0
  ds_write_b128 v2, v[84:87] offset:4096
  ds_write_b128 v2, v[88:91] offset:8192
  ds_write_b128 v2, v[92:95] offset:12288
  s_nop 0
  s_waitcnt lgkmcnt(0)
  s_barrier
  ds_read_b128 a[76:79], v12
  ds_read_b128 v[84:87], v13
  ds_read_b128 v[88:91], v14
  ds_read_b128 v[92:95], v15
  s_waitcnt lgkmcnt(2)
  ds_write_b128 v4, v[84:87] offset:9216
  s_waitcnt lgkmcnt(2)
  ds_write_b128 v4, v[88:91] offset:13312
  s_waitcnt lgkmcnt(2)
  ds_write_b128 v4, v[92:95] offset:17408
  s_waitcnt lgkmcnt(0)
  s_waitcnt vmcnt(8)
  s_add_u32 s40, s38, 0
  buffer_load_dwordx4 v[16:19], v5, s[20:23], s40 offen
  s_add_u32 s40, s38, 8192
  buffer_load_dwordx4 v[20:23], v5, s[20:23], s40 offen
  s_add_u32 s40, s38, 32768
  buffer_load_dwordx4 v[24:27], v5, s[20:23], s40 offen
  s_add_u32 s40, s38, 40960
  buffer_load_dwordx4 v[28:31], v5, s[20:23], s40 offen
  s_add_u32 s40, s38, 16384
  buffer_load_dwordx4 v[32:35], v5, s[20:23], s40 offen
  s_add_u32 s40, s38, 24576
  buffer_load_dwordx4 v[36:39], v5, s[20:23], s40 offen
  s_add_u32 s40, s38, 49152
  buffer_load_dwordx4 v[40:43], v5, s[20:23], s40 offen
  s_add_u32 s40, s38, 57344
  buffer_load_dwordx4 v[44:47], v5, s[20:23], s40 offen
  v_perm_b32 v80, v196, v192, s60
  v_perm_b32 v81, v204, v200, s60
  v_perm_b32 v82, v212, v208, s60
  v_perm_b32 v83, v220, v216, s60
  v_perm_b32 v84, v197, v193, s60
  v_perm_b32 v85, v205, v201, s60
  v_perm_b32 v86, v213, v209, s60
  v_perm_b32 v87, v221, v217, s60
  v_perm_b32 v88, v198, v194, s60
  v_perm_b32 v89, v206, v202, s60
  v_perm_b32 v90, v214, v210, s60
  v_perm_b32 v91, v222, v218, s60
  v_perm_b32 v92, v199, v195, s60
  v_perm_b32 v93, v207, v203, s60
  v_perm_b32 v94, v215, v211, s60
  v_perm_b32 v95, v223, v219, s60
  s_barrier
  ds_write_b128 v2, v[80:83] offset:0
  ds_write_b128 v2, v[84:87] offset:4096
  ds_write_b128 v2, v[88:91] offset:8192
  ds_write_b128 v2, v[92:95] offset:12288
  s_nop 0
  s_waitcnt lgkmcnt(0)
  s_barrier
  ds_read_b128 a[232:235], v12
  ds_read_b128 v[128:131], v13
  ds_read_b128 v[136:139], v14
  ds_read_b128 v[92:95], v15
  s_waitcnt lgkmcnt(0)
  ds_write_b128 v4, v[92:95] offset:26624
  s_waitcnt lgkmcnt(0)
  v_perm_b32 v80, v196, v192, s65
  v_perm_b32 v81, v204, v200, s65
  v_perm_b32 v82, v212, v208, s65
  v_perm_b32 v83, v220, v216, s65
  v_perm_b32 v84, v197, v193, s65
  v_perm_b32 v85, v205, v201, s65
  v_perm_b32 v86, v213, v209, s65
  v_perm_b32 v87, v221, v217, s65
  v_perm_b32 v88, v198, v194, s65
  v_perm_b32 v89, v206, v202, s65
  v_perm_b32 v90, v214, v210, s65
  v_perm_b32 v91, v222, v218, s65
  v_perm_b32 v92, v199, v195, s65
  v_perm_b32 v93, v207, v203, s65
  v_perm_b32 v94, v215, v211, s65
  v_perm_b32 v95, v223, v219, s65
  s_barrier
  ds_write_b128 v2, v[80:83] offset:0
  ds_write_b128 v2, v[84:87] offset:4096
  ds_write_b128 v2, v[88:91] offset:8192
  ds_write_b128 v2, v[92:95] offset:12288
  s_nop 0
  s_waitcnt lgkmcnt(0)
  s_barrier
  ds_read_b128 a[240:243], v12
  ds_read_b128 v[168:171], v13
  ds_read_b128 v[176:179], v14
  ds_read_b128 v[184:187], v15
  s_waitcnt lgkmcnt(0)
  s_barrier
  s_cmp_lg_u32 s12, 0
  s_cbranch_scc1 L_arr_45
  v_mov_b32_e64 v10, 1
  v_mov_b32 v11, 96
  s_mov_b64 exec, 1
  buffer_atomic_add v10, v11, s[8:11], 0 offen
  s_mov_b64 exec, -1
L_arr_45:
  s_waitcnt vmcnt(8)
  s_add_u32 s40, s36, 0
  buffer_load_dwordx4 v[48:51], v5, s[24:27], s40 offen
  s_add_u32 s40, s36, 8192
  buffer_load_dwordx4 v[52:55], v5, s[24:27], s40 offen
  s_add_u32 s40, s36, 32768
  buffer_load_dwordx4 v[56:59], v5, s[24:27], s40 offen
  s_add_u32 s40, s36, 40960
  buffer_load_dwordx4 v[60:63], v5, s[24:27], s40 offen
  s_add_u32 s40, s36, 16384
  buffer_load_dwordx4 v[64:67], v5, s[24:27], s40 offen
  s_add_u32 s40, s36, 24576
  buffer_load_dwordx4 v[68:71], v5, s[24:27], s40 offen
  s_add_u32 s40, s36, 49152
  buffer_load_dwordx4 v[72:75], v5, s[24:27], s40 offen
  s_add_u32 s40, s36, 57344
  buffer_load_dwordx4 v[76:79], v5, s[24:27], s40 offen
  v_perm_b32 v80, v228, v224, s60
  v_perm_b32 v81, v236, v232, s60
  v_perm_b32 v82, v244, v240, s60
  v_perm_b32 v83, v252, v248, s60
  v_perm_b32 v84, v229, v225, s60
  v_perm_b32 v85, v237, v233, s60
  v_perm_b32 v86, v245, v241, s60
  v_perm_b32 v87, v253, v249, s60
  v_perm_b32 v88, v230, v226, s60
  v_perm_b32 v89, v238, v234, s60
  v_perm_b32 v90, v246, v242, s60
  v_perm_b32 v91, v254, v250, s60
  v_perm_b32 v92, v231, v227, s60
  v_perm_b32 v93, v239, v235, s60
  v_perm_b32 v94, v247, v243, s60
  v_perm_b32 v95, v255, v251, s60
  s_barrier
  ds_write_b128 v2, v[80:83] offset:0
  ds_write_b128 v2, v[84:87] offset:4096
  ds_write_b128 v2, v[88:91] offset:8192
  ds_write_b128 v2, v[92:95] offset:12288
  s_nop 0
  s_waitcnt lgkmcnt(0)
  s_barrier
  ds_read_b128 a[236:239], v12
  ds_read_b128 v[132:135], v13
  ds_read_b128 v[140:143], v14
  ds_read_b128 v[92:95], v15
  s_waitcnt lgkmcnt(0)
  ds_write_b128 v4, v[92:95] offset:27648
  s_waitcnt lgkmcnt(0)
  v_perm_b32 v80, v228, v224, s65
  v_perm_b32 v81, v236, v232, s65
  v_perm_b32 v82, v244, v240, s65
  v_perm_b32 v83, v252, v248, s65
  v_perm_b32 v84, v229, v225, s65
  v_perm_b32 v85, v237, v233, s65
  v_perm_b32 v86, v245, v241, s65
  v_perm_b32 v87, v253, v249, s65
  v_perm_b32 v88, v230, v226, s65
  v_perm_b32 v89, v238, v234, s65
  v_perm_b32 v90, v246, v242, s65
  v_perm_b32 v91, v254, v250, s65
  v_perm_b32 v92, v231, v227, s65
  v_perm_b32 v93, v239, v235, s65
  v_perm_b32 v94, v247, v243, s65
  v_perm_b32 v95, v255, v251, s65
  s_barrier
  ds_write_b128 v2, v[80:83] offset:0
  ds_write_b128 v2, v[84:87] offset:4096
  ds_write_b128 v2, v[88:91] offset:8192
  ds_write_b128 v2, v[92:95] offset:12288
  s_nop 0
  s_waitcnt lgkmcnt(0)
  s_barrier
  ds_read_b128 a[244:247], v12
  ds_read_b128 v[172:175], v13
  ds_read_b128 v[180:183], v14
  ds_read_b128 v[188:191], v15
  s_waitcnt lgkmcnt(0)
  s_waitcnt vmcnt(8)
  s_add_u32 s40, s36, 262144
  buffer_load_dwordx4 v[192:195], v5, s[24:27], s40 offen
  s_add_u32 s40, s36, 270336
  buffer_load_dwordx4 v[196:199], v5, s[24:27], s40 offen
  s_add_u32 s40, s36, 294912
  buffer_load_dwordx4 v[200:203], v5, s[24:27], s40 offen
  s_add_u32 s40, s36, 303104
  buffer_load_dwordx4 v[204:207], v5, s[24:27], s40 offen
  s_add_u32 s40, s36, 278528
  buffer_load_dwordx4 v[208:211], v5, s[24:27], s40 offen
  s_add_u32 s40, s36, 286720
  buffer_load_dwordx4 v[212:215], v5, s[24:27], s40 offen
  s_add_u32 s40, s36, 311296
  buffer_load_dwordx4 v[216:219], v5, s[24:27], s40 offen
  s_add_u32 s40, s36, 319488
  buffer_load_dwordx4 v[220:223], v5, s[24:27], s40 offen
  v_perm_b32 v80, v20, v16, s60
  v_perm_b32 v81, v28, v24, s60
  v_perm_b32 v82, v36, v32, s60
  v_perm_b32 v83, v44, v40, s60
  v_perm_b32 v84, v21, v17, s60
  v_perm_b32 v85, v29, v25, s60
  v_perm_b32 v86, v37, v33, s60
  v_perm_b32 v87, v45, v41, s60
  v_perm_b32 v88, v22, v18, s60
  v_perm_b32 v89, v30, v26, s60
  v_perm_b32 v90, v38, v34, s60
  v_perm_b32 v91, v46, v42, s60
  v_perm_b32 v92, v23, v19, s60
  v_perm_b32 v93, v31, v27, s60
  v_perm_b32 v94, v39, v35, s60
  v_perm_b32 v95, v47, v43, s60
  s_barrier
  ds_write_b128 v2, v[80:83] offset:0
  ds_write_b128 v2, v[84:87] offset:4096
  ds_write_b128 v2, v[88:91] offset:8192
  ds_write_b128 v2, v[92:95] offset:12288
  s_waitcnt lgkmcnt(0)
  s_barrier
  ds_read_b128 a[104:107], v8 offset:0
  ds_read_b128 a[108:111], v8 offset:1024
  ds_read_b128 v[96:99], v8 offset:2048
  ds_read_b128 v[100:103], v8 offset:3072
  s_waitcnt lgkmcnt(0)
  v_perm_b32 v80, v20, v16, s65
  v_perm_b32 v81, v28, v24, s65
  v_perm_b32 v82, v36, v32, s65
  v_perm_b32 v83, v44, v40, s65
  v_perm_b32 v84, v21, v17, s65
  v_perm_b32 v85, v29, v25, s65
  v_perm_b32 v86, v37, v33, s65
  v_perm_b32 v87, v45, v41, s65
  v_perm_b32 v88, v22, v18, s65
  v_perm_b32 v89, v30, v26, s65
  v_perm_b32 v90, v38, v34, s65
  v_perm_b32 v91, v46, v42, s65
  v_perm_b32 v92, v23, v19, s65
  v_perm_b32 v93, v31, v27, s65
  v_perm_b32 v94, v39, v35, s65
  v_perm_b32 v95, v47, v43, s65
  s_barrier
  ds_write_b128 v2, v[80:83] offset:0
  ds_write_b128 v2, v[84:87] offset:4096
  ds_write_b128 v2, v[88:91] offset:8192
  ds_write_b128 v2, v[92:95] offset:12288
  s_waitcnt lgkmcnt(0)
  s_barrier
  ds_read_b128 a[120:123], v8 offset:0
  ds_read_b128 a[124:127], v8 offset:1024
  ds_read_b128 v[112:115], v8 offset:2048
  ds_read_b128 v[116:119], v8 offset:3072
  s_waitcnt lgkmcnt(0)
  s_waitcnt vmcnt(8)
  s_add_u32 s40, s38, 0
  buffer_load_dwordx4 v[224:227], v5, s[24:27], s40 offen
  s_add_u32 s40, s38, 8192
  buffer_load_dwordx4 v[228:231], v5, s[24:27], s40 offen
  s_add_u32 s40, s38, 32768
  buffer_load_dwordx4 v[232:235], v5, s[24:27], s40 offen
  s_add_u32 s40, s38, 40960
  buffer_load_dwordx4 v[236:239], v5, s[24:27], s40 offen
  s_add_u32 s40, s38, 16384
  buffer_load_dwordx4 v[240:243], v5, s[24:27], s40 offen
  s_add_u32 s40, s38, 24576
  buffer_load_dwordx4 v[244:247], v5, s[24:27], s40 offen
  s_add_u32 s40, s38, 49152
  buffer_load_dwordx4 v[248:251], v5, s[24:27], s40 offen
  s_add_u32 s40, s38, 57344
  buffer_load_dwordx4 v[252:255], v5, s[24:27], s40 offen
  v_perm_b32 v80, v52, v48, s60
  v_perm_b32 v81, v60, v56, s60
  v_perm_b32 v82, v68, v64, s60
  v_perm_b32 v83, v76, v72, s60
  v_perm_b32 v84, v53, v49, s60
  v_perm_b32 v85, v61, v57, s60
  v_perm_b32 v86, v69, v65, s60
  v_perm_b32 v87, v77, v73, s60
  v_perm_b32 v88, v54, v50, s60
  v_perm_b32 v89, v62, v58, s60
  v_perm_b32 v90, v70, v66, s60
  v_perm_b32 v91, v78, v74, s60
  v_perm_b32 v92, v55, v51, s60
  v_perm_b32 v93, v63, v59, s60
  v_perm_b32 v94, v71, v67, s60
  v_perm_b32 v95, v79, v75, s60
  s_barrier
  ds_write_b128 v2, v[80:83] offset:0
  ds_write_b128 v2, v[84:87] offset:4096
  ds_write_b128 v2, v[88:91] offset:8192
  ds_write_b128 v2, v[92:95] offset:12288
  s_waitcnt lgkmcnt(0)
  s_barrier
  ds_read_b128 a[80:83], v12
  ds_read_b128 a[152:155], v13
  ds_read_b128 a[184:187], v14
  ds_read_b128 a[216:219], v15
  s_waitcnt lgkmcnt(0)
  v_perm_b32 v80, v52, v48, s65
  v_perm_b32 v81, v60, v56, s65
  v_perm_b32 v82, v68, v64, s65
  v_perm_b32 v83, v76, v72, s65
  v_perm_b32 v84, v53, v49, s65
  v_perm_b32 v85, v61, v57, s65
  v_perm_b32 v86, v69, v65, s65
  v_perm_b32 v87, v77, v73, s65
  v_perm_b32 v88, v54, v50, s65
  v_perm_b32 v89, v62, v58, s65
  v_perm_b32 v90, v70, v66, s65
  v_perm_b32 v91, v78, v74, s65
  v_perm_b32 v92, v55, v51, s65
  v_perm_b32 v93, v63, v59, s65
  v_perm_b32 v94, v71, v67, s65
  v_perm_b32 v95, v79, v75, s65
  s_barrier
  ds_write_b128 v2, v[80:83] offset:0
  ds_write_b128 v2, v[84:87] offset:4096
  ds_write_b128 v2, v[88:91] offset:8192
  ds_write_b128 v2, v[92:95] offset:12288
  s_waitcnt lgkmcnt(0)
  s_barrier
  ds_read_b128 a[88:91], v12
  ds_read_b128 a[160:163], v13
  ds_read_b128 v[88:91], v14
  ds_read_b128 v[92:95], v15
  s_waitcnt lgkmcnt(1)
  ds_write_b128 v4, v[88:91] offset:14336
  s_waitcnt lgkmcnt(1)
  ds_write_b128 v4, v[92:95] offset:18432
  s_waitcnt lgkmcnt(0)
  s_waitcnt vmcnt(8)
  s_add_u32 s40, s42, 0
  buffer_load_dwordx2 v[16:17], v6, s[28:31], s40 offen
  buffer_load_dword v32, v7, s[28:31], s40 offen
  s_add_u32 s40, s42, 10240
  buffer_load_dwordx2 v[18:19], v6, s[28:31], s40 offen
  buffer_load_dword v33, v7, s[28:31], s40 offen
  s_add_u32 s40, s42, 20480
  buffer_load_dwordx2 v[20:21], v6, s[28:31], s40 offen
  buffer_load_dword v34, v7, s[28:31], s40 offen
  s_add_u32 s40, s42, 30720
  buffer_load_dwordx2 v[22:23], v6, s[28:31], s40 offen
  buffer_load_dword v35, v7, s[28:31], s40 offen
  s_add_u32 s40, s42, 81920
  buffer_load_dwordx2 v[24:25], v6, s[28:31], s40 offen
  buffer_load_dword v36, v7, s[28:31], s40 offen
  s_add_u32 s40, s42, 92160
  buffer_load_dwordx2 v[26:27], v6, s[28:31], s40 offen
  buffer_load_dword v37, v7, s[28:31], s40 offen
  s_add_u32 s40, s42, 102400
  buffer_load_dwordx2 v[28:29], v6, s[28:31], s40 offen
  buffer_load_dword v38, v7, s[28:31], s40 offen
  s_add_u32 s40, s42, 112640
  buffer_load_dwordx2 v[30:31], v6, s[28:31], s40 offen
  buffer_load_dword v39, v7, s[28:31], s40 offen
  v_perm_b32 v80, v196, v192, s60
  v_perm_b32 v81, v204, v200, s60
  v_perm_b32 v82, v212, v208, s60
  v_perm_b32 v83, v220, v216, s60
  v_perm_b32 v84, v197, v193, s60
  v_perm_b32 v85, v205, v201, s60
  v_perm_b32 v86, v213, v209, s60
  v_perm_b32 v87, v221, v217, s60
  v_perm_b32 v88, v198, v194, s60
  v_perm_b32 v89, v206, v202, s60
  v_perm_b32 v90, v214, v210, s60
  v_perm_b32 v91, v222, v218, s60
  v_perm_b32 v92, v199, v195, s60
  v_perm_b32 v93, v207, v203, s60
  v_perm_b32 v94, v215, v211, s60
  v_perm_b32 v95, v223, v219, s60
  s_barrier
  ds_write_b128 v2, v[80:83] offset:0
  ds_write_b128 v2, v[84:87] offset:4096
  ds_write_b128 v2, v[88:91] offset:8192
  ds_write_b128 v2, v[92:95] offset:12288
  s_waitcnt lgkmcnt(0)
  s_barrier
  ds_read_b128 a[84:87], v12
  ds_read_b128 a[156:159], v13
  ds_read_b128 a[188:191], v14
  ds_read_b128 a[220:223], v15
  s_waitcnt lgkmcnt(0)
  v_perm_b32 v80, v196, v192, s65
  v_perm_b32 v81, v204, v200, s65
  v_perm_b32 v82, v212, v208, s65
  v_perm_b32 v83, v220, v216, s65
  v_perm_b32 v84, v197, v193, s65
  v_perm_b32 v85, v205, v201, s65
  v_perm_b32 v86, v213, v209, s65
  v_perm_b32 v87, v221, v217, s65
  v_perm_b32 v88, v198, v194, s65
  v_perm_b32 v89, v206, v202, s65
  v_perm_b32 v90, v214, v210, s65
  v_perm_b32 v91, v222, v218, s65
  v_perm_b32 v92, v199, v195, s65
  v_perm_b32 v93, v207, v203, s65
  v_perm_b32 v94, v215, v211, s65
  v_perm_b32 v95, v223, v219, s65
  s_barrier
  ds_write_b128 v2, v[80:83] offset:0
  ds_write_b128 v2, v[84:87] offset:4096
  ds_write_b128 v2, v[88:91] offset:8192
  ds_write_b128 v2, v[92:95] offset:12288
  s_waitcnt lgkmcnt(0)
  s_barrier
  ds_read_b128 a[92:95], v12
  ds_read_b128 a[164:167], v13
  ds_read_b128 v[88:91], v14
  ds_read_b128 v[92:95], v15
  s_waitcnt lgkmcnt(1)
  ds_write_b128 v4, v[88:91] offset:15360
  s_waitcnt lgkmcnt(1)
  ds_write_b128 v4, v[92:95] offset:19456
  s_waitcnt lgkmcnt(0)
  s_waitcnt vmcnt(16)
  s_add_u32 s40, s43, 0
  buffer_load_dwordx2 v[48:49], v6, s[28:31], s40 offen
  buffer_load_dword v64, v7, s[28:31], s40 offen
  s_add_u32 s40, s43, 10240
  buffer_load_dwordx2 v[50:51], v6, s[28:31], s40 offen
  buffer_load_dword v65, v7, s[28:31], s40 offen
  s_add_u32 s40, s43, 20480
  buffer_load_dwordx2 v[52:53], v6, s[28:31], s40 offen
  buffer_load_dword v66, v7, s[28:31], s40 offen
  s_add_u32 s40, s43, 30720
  buffer_load_dwordx2 v[54:55], v6, s[28:31], s40 offen
  buffer_load_dword v67, v7, s[28:31], s40 offen
  s_add_u32 s40, s43, 81920
  buffer_load_dwordx2 v[56:57], v6, s[28:31], s40 offen
  buffer_load_dword v68, v7, s[28:31], s40 offen
  s_add_u32 s40, s43, 92160
  buffer_load_dwordx2 v[58:59], v6, s[28:31], s40 offen
  buffer_load_dword v69, v7, s[28:31], s40 offen
  s_add_u32 s40, s43, 102400
  buffer_load_dwordx2 v[60:61], v6, s[28:31], s40 offen
  buffer_load_dword v70, v7, s[28:31], s40 offen
  s_add_u32 s40, s43, 112640
  buffer_load_dwordx2 v[62:63], v6, s[28:31], s40 offen
  buffer_load_dword v71, v7, s[28:31], s40 offen
  v_perm_b32 v80, v228, v224, s60
  v_perm_b32 v81, v236, v232, s60
  v_perm_b32 v82, v244, v240, s60
  v_perm_b32 v83, v252, v248, s60
  v_perm_b32 v84, v229, v225, s60
  v_perm_b32 v85, v237, v233, s60
  v_perm_b32 v86, v245, v241, s60
  v_perm_b32 v87, v253, v249, s60
  v_perm_b32 v88, v230, v226, s60
  v_perm_b32 v89, v238, v234, s60
  v_perm_b32 v90, v246, v242, s60
  v_perm_b32 v91, v254, v250, s60
  v_perm_b32 v92, v231, v227, s60
  v_perm_b32 v93, v239, v235, s60
  v_perm_b32 v94, v247, v243, s60
  v_perm_b32 v95, v255, v251, s60
  s_barrier
  ds_write_b128 v2, v[80:83] offset:0
  ds_write_b128 v2, v[84:87] offset:4096
  ds_write_b128 v2, v[88:91] offset:8192
  ds_write_b128 v2, v[92:95] offset:12288
  s_waitcnt lgkmcnt(0)
  s_barrier
  ds_read_b128 v[80:83], v8 offset:0
  ds_read_b128 v[84:87], v8 offset:1024
  ds_read_b128 v[88:91], v8 offset:2048
  ds_read_b128 v[92:95], v8 offset:3072
  s_waitcnt lgkmcnt(3)
  ds_write_b128 v4, v[80:83] offset:4096
  s_waitcnt lgkmcnt(3)
  ds_write_b128 v4, v[84:87] offset:5120
  s_waitcnt lgkmcnt(3)
  ds_write_b128 v4, v[88:91] offset:28672
  s_waitcnt lgkmcnt(3)
  ds_write_b128 v4, v[92:95] offset:29696
  s_waitcnt lgkmcnt(0)
  v_perm_b32 v80, v228, v224, s65
  v_perm_b32 v81, v236, v232, s65
  v_perm_b32 v82, v244, v240, s65
  v_perm_b32 v83, v252, v248, s65
  v_perm_b32 v84, v229, v225, s65
  v_perm_b32 v85, v237, v233, s65
  v_perm_b32 v86, v245, v241, s65
  v_perm_b32 v87, v253, v249, s65
  v_perm_b32 v88, v230, v226, s65
  v_perm_b32 v89, v238, v234, s65
  v_perm_b32 v90, v246, v242, s65
  v_perm_b32 v91, v254, v250, s65
  v_perm_b32 v92, v231, v227, s65
  v_perm_b32 v93, v239, v235, s65
  v_perm_b32 v94, v247, v243, s65
  v_perm_b32 v95, v255, v251, s65
  s_barrier
  ds_write_b128 v2, v[80:83] offset:0
  ds_write_b128 v2, v[84:87] offset:4096
  ds_write_b128 v2, v[88:91] offset:8192
  ds_write_b128 v2, v[92:95] offset:12288
  s_waitcnt lgkmcnt(0)
  s_barrier
  ds_read_b128 a[128:131], v8 offset:0
  ds_read_b128 a[132:135], v8 offset:1024
  ds_read_b128 v[88:91], v8 offset:2048
  ds_read_b128 v[92:95], v8 offset:3072
  s_waitcnt lgkmcnt(1)
  ds_write_b128 v4, v[88:91] offset:30720
  s_waitcnt lgkmcnt(1)
  ds_write_b128 v4, v[92:95] offset:31744
  s_waitcnt lgkmcnt(0)
  s_waitcnt vmcnt(16)
  s_add_u32 s40, s44, 0
  buffer_load_dwordx2 v[192:193], v6, s[28:31], s40 offen
  buffer_load_dword v208, v7, s[28:31], s40 offen
  s_add_u32 s40, s44, 10240
  buffer_load_dwordx2 v[194:195], v6, s[28:31], s40 offen
  buffer_load_dword v209, v7, s[28:31], s40 offen
  s_add_u32 s40, s44, 20480
  buffer_load_dwordx2 v[196:197], v6, s[28:31], s40 offen
  buffer_load_dword v210, v7, s[28:31], s40 offen
  s_add_u32 s40, s44, 30720
  buffer_load_dwordx2 v[198:199], v6, s[28:31], s40 offen
  buffer_load_dword v211, v7, s[28:31], s40 offen
  s_add_u32 s40, s44, 81920
  buffer_load_dwordx2 v[200:201], v6, s[28:31], s40 offen
  buffer_load_dword v212, v7, s[28:31], s40 offen
  s_add_u32 s40, s44, 92160
  buffer_load_dwordx2 v[202:203], v6, s[28:31], s40 offen
  buffer_load_dword v213, v7, s[28:31], s40 offen
  s_add_u32 s40, s44, 102400
  buffer_load_dwordx2 v[204:205], v6, s[28:31], s40 offen
  buffer_load_dword v214, v7, s[28:31], s40 offen
  s_add_u32 s40, s44, 112640
  buffer_load_dwordx2 v[206:207], v6, s[28:31], s40 offen
  buffer_load_dword v215, v7, s[28:31], s40 offen
  v_perm_b32 v80, v18, v16, s60
  v_perm_b32 v81, v18, v16, s65
  v_perm_b32 v82, v22, v20, s60
  v_perm_b32 v83, v22, v20, s65
  v_perm_b32 v84, v26, v24, s60
  v_perm_b32 v85, v26, v24, s65
  v_perm_b32 v86, v30, v28, s60
  v_perm_b32 v87, v30, v28, s65
  v_accvgpr_write_b32 a0, v80
  v_accvgpr_write_b32 a1, v81
  v_accvgpr_write_b32 a2, v82
  v_accvgpr_write_b32 a3, v83
  v_accvgpr_write_b32 a4, v84
  v_accvgpr_write_b32 a5, v85
  v_accvgpr_write_b32 a6, v86
  v_accvgpr_write_b32 a7, v87
  v_perm_b32 v80, v19, v17, s60
  v_perm_b32 v81, v19, v17, s65
  v_perm_b32 v82, v23, v21, s60
  v_perm_b32 v83, v23, v21, s65
  v_perm_b32 v84, v27, v25, s60
  v_perm_b32 v85, v27, v25, s65
  v_perm_b32 v86, v31, v29, s60
  v_perm_b32 v87, v31, v29, s65
  v_accvgpr_write_b32 a8, v80
  v_accvgpr_write_b32 a9, v81
  v_accvgpr_write_b32 a10, v82
  v_accvgpr_write_b32 a11, v83
  v_accvgpr_write_b32 a12, v84
  v_accvgpr_write_b32 a13, v85
  v_accvgpr_write_b32 a14, v86
  v_accvgpr_write_b32 a15, v87
  v_perm_b32 v80, v33, v32, s60
  v_perm_b32 v81, v33, v32, s65
  v_perm_b32 v82, v35, v34, s60
  v_perm_b32 v83, v35, v34, s65
  v_perm_b32 v84, v37, v36, s60
  v_perm_b32 v85, v37, v36, s65
  v_perm_b32 v86, v39, v38, s60
  v_perm_b32 v87, v39, v38, s65
  s_cmp_ge_u32 s12, 2
  s_cbranch_scc1 L_c_x_46
  ds_write_b128 v4, v[80:83] offset:32768
  ds_write_b128 v4, v[84:87] offset:33792
  s_waitcnt lgkmcnt(0)
L_c_x_46:
  s_waitcnt vmcnt(16)
  s_add_u32 s40, s45, 0
  buffer_load_dwordx2 v[224:225], v6, s[28:31], s40 offen
  buffer_load_dword v240, v7, s[28:31], s40 offen
  s_add_u32 s40, s45, 10240
  buffer_load_dwordx2 v[226:227], v6, s[28:31], s40 offen
  buffer_load_dword v241, v7, s[28:31], s40 offen
  s_add_u32 s40, s45, 20480
  buffer_load_dwordx2 v[228:229], v6, s[28:31], s40 offen
  buffer_load_dword v242, v7, s[28:31], s40 offen
  s_add_u32 s40, s45, 30720
  buffer_load_dwordx2 v[230:231], v6, s[28:31], s40 offen
  buffer_load_dword v243, v7, s[28:31], s40 offen
  s_add_u32 s40, s45, 81920
  buffer_load_dwordx2 v[232:233], v6, s[28:31], s40 offen
  buffer_load_dword v244, v7, s[28:31], s40 offen
  s_add_u32 s40, s45, 92160
  buffer_load_dwordx2 v[234:235], v6, s[28:31], s40 offen
  buffer_load_dword v245, v7, s[28:31], s40 offen
  s_add_u32 s40, s45, 102400
  buffer_load_dwordx2 v[236:237], v6, s[28:31], s40 offen
  buffer_load_dword v246, v7, s[28:31], s40 offen
  s_add_u32 s40, s45, 112640
  buffer_load_dwordx2 v[238:239], v6, s[28:31], s40 offen
  buffer_load_dword v247, v7, s[28:31], s40 offen
  v_perm_b32 v80, v50, v48, s60
  v_perm_b32 v81, v50, v48, s65
  v_perm_b32 v82, v54, v52, s60
  v_perm_b32 v83, v54, v52, s65
  v_perm_b32 v84, v58, v56, s60
  v_perm_b32 v85, v58, v56, s65
  v_perm_b32 v86, v62, v60, s60
  v_perm_b32 v87, v62, v60, s65
  v_accvgpr_write_b32 a16, v80
  v_accvgpr_write_b32 a17, v81
  v_accvgpr_write_b32 a18, v82
  v_accvgpr_write_b32 a19, v83
  v_accvgpr_write_b32 a20, v84
  v_accvgpr_write_b32 a21, v85
  v_accvgpr_write_b32 a22, v86
  v_accvgpr_write_b32 a23, v87
  v_perm_b32 v80, v51, v49, s60
  v_perm_b32 v81, v51, v49, s65
  v_perm_b32 v82, v55, v53, s60
  v_perm_b32 v83, v55, v53, s65
  v_perm_b32 v84, v59, v57, s60
  v_perm_b32 v85, v59, v57, s65
  v_perm_b32 v86, v63, v61, s60
  v_perm_b32 v87, v63, v61, s65
  v_accvgpr_write_b32 a40, v80
  v_accvgpr_write_b32 a41, v81
  v_accvgpr_write_b32 a42, v82
  v_accvgpr_write_b32 a43, v83
  v_accvgpr_write_b32 a44, v84
  v_accvgpr_write_b32 a45, v85
  v_accvgpr_write_b32 a46, v86
  v_accvgpr_write_b32 a47, v87
  v_perm_b32 v80, v65, v64, s60
  v_perm_b32 v81, v65, v64, s65
  v_perm_b32 v82, v67, v66, s60
  v_perm_b32 v83, v67, v66, s65
  v_perm_b32 v84, v69, v68, s60
  v_perm_b32 v85, v69, v68, s65
  v_perm_b32 v86, v71, v70, s60
  v_perm_b32 v87, v71, v70, s65
  s_cmp_ge_u32 s12, 2
  s_cbranch_scc1 L_c_x_47
  ds_write_b128 v4, v[80:83] offset:34816
  ds_write_b128 v4, v[84:87] offset:35840
  s_waitcnt lgkmcnt(0)
L_c_x_47:
  s_waitcnt vmcnt(16)
  s_add_u32 s40, s37, 0
  buffer_load_dwordx4 v[16:19], v5, s[24:27], s40 offen
  s_add_u32 s40, s37, 8192
  buffer_load_dwordx4 v[20:23], v5, s[24:27], s40 offen
  s_add_u32 s40, s37, 32768
  buffer_load_dwordx4 v[24:27], v5, s[24:27], s40 offen
  s_add_u32 s40, s37, 40960
  buffer_load_dwordx4 v[28:31], v5, s[24:27], s40 offen
  s_add_u32 s40, s37, 16384
  buffer_load_dwordx4 v[32:35], v5, s[24:27], s40 offen
  s_add_u32 s40, s37, 24576
  buffer_load_dwordx4 v[36:39], v5, s[24:27], s40 offen
  s_add_u32 s40, s37, 49152
  buffer_load_dwordx4 v[40:43], v5, s[24:27], s40 offen
  s_add_u32 s40, s37, 57344
  buffer_load_dwordx4 v[44:47], v5, s[24:27], s40 offen
  v_lshrrev_b32_e64 v10, 2, v0
  buffer_load_dword v10, v10, s[8:11], 0 offen sc1
  v_perm_b32 v80, v194, v192, s60
  v_perm_b32 v81, v194, v192, s65
  v_perm_b32 v82, v198, v196, s60
  v_perm_b32 v83, v198, v196, s65
  v_perm_b32 v84, v202, v200, s60
  v_perm_b32 v85, v202, v200, s65
  v_perm_b32 v86, v206, v204, s60
  v_perm_b32 v87, v206, v204, s65
  v_accvgpr_write_b32 a24, v80
  v_accvgpr_write_b32 a25, v81
  v_accvgpr_write_b32 a26, v82
  v_accvgpr_write_b32 a27, v83
  v_accvgpr_write_b32 a28, v84
  v_accvgpr_write_b32 a29, v85
  v_accvgpr_write_b32 a30, v86
  v_accvgpr_write_b32 a31, v87
  v_perm_b32 v80, v195, v193, s60
  v_perm_b32 v81, v195, v193, s65
  v_perm_b32 v82, v199, v197, s60
  v_perm_b32 v83, v199, v197, s65
  v_perm_b32 v84, v203, v201, s60
  v_perm_b32 v85, v203, v201, s65
  v_perm_b32 v86, v207, v205, s60
  v_perm_b32 v87, v207, v205, s65
  v_accvgpr_write_b32 a48, v80
  v_accvgpr_write_b32 a49, v81
  v_accvgpr_write_b32 a50, v82
  v_accvgpr_write_b32 a51, v83
  v_accvgpr_write_b32 a52, v84
  v_accvgpr_write_b32 a53, v85
  v_accvgpr_write_b32 a54, v86
  v_accvgpr_write_b32 a55, v87
  v_perm_b32 v80, v209, v208, s60
  v_perm_b32 v81, v209, v208, s65
  v_perm_b32 v82, v211, v210, s60
  v_perm_b32 v83, v211, v210, s65
  v_perm_b32 v84, v213, v212, s60
  v_perm_b32 v85, v213, v212, s65
  v_perm_b32 v86, v215, v214, s60
  v_perm_b32 v87, v215, v214, s65
  s_cmp_ge_u32 s12, 2
  s_cbranch_scc1 L_c_x_48
  ds_write_b128 v4, v[80:83] offset:36864
  ds_write_b128 v4, v[84:87] offset:37888
  s_waitcnt lgkmcnt(0)
L_c_x_48:
  s_waitcnt vmcnt(8)
  s_add_u32 s40, s37, 262144
  buffer_load_dwordx4 v[48:51], v5, s[24:27], s40 offen
  s_add_u32 s40, s37, 270336
  buffer_load_dwordx4 v[52:55], v5, s[24:27], s40 offen
  s_add_u32 s40, s37, 294912
  buffer_load_dwordx4 v[56:59], v5, s[24:27], s40 offen
  s_add_u32 s40, s37, 303104
  buffer_load_dwordx4 v[60:63], v5, s[24:27], s40 offen
  s_add_u32 s40, s37, 278528
  buffer_load_dwordx4 v[64:67], v5, s[24:27], s40 offen
  s_add_u32 s40, s37, 286720
  buffer_load_dwordx4 v[68:71], v5, s[24:27], s40 offen
  s_add_u32 s40, s37, 311296
  buffer_load_dwordx4 v[72:75], v5, s[24:27], s40 offen
  s_add_u32 s40, s37, 319488
  buffer_load_dwordx4 v[76:79], v5, s[24:27], s40 offen
  v_perm_b32 v80, v226, v224, s60
  v_perm_b32 v81, v226, v224, s65
  v_perm_b32 v82, v230, v228, s60
  v_perm_b32 v83, v230, v228, s65
  v_perm_b32 v84, v234, v232, s60
  v_perm_b32 v85, v234, v232, s65
  v_perm_b32 v86, v238, v236, s60
  v_perm_b32 v87, v238, v236, s65
  v_accvgpr_write_b32 a32, v80
  v_accvgpr_write_b32 a33, v81
  v_accvgpr_write_b32 a34, v82
  v_accvgpr_write_b32 a35, v83
  v_accvgpr_write_b32 a36, v84
  v_accvgpr_write_b32 a37, v85
  v_accvgpr_write_b32 a38, v86
  v_accvgpr_write_b32 a39, v87
  v_perm_b32 v80, v227, v225, s60
  v_perm_b32 v81, v227, v225, s65
  v_perm_b32 v82, v231, v229, s60
  v_perm_b32 v83, v231, v229, s65
  v_perm_b32 v84, v235, v233, s60
  v_perm_b32 v85, v235, v233, s65
  v_perm_b32 v86, v239, v237, s60
  v_perm_b32 v87, v239, v237, s65
  v_accvgpr_write_b32 a56, v80
  v_accvgpr_write_b32 a57, v81
  v_accvgpr_write_b32 a58, v82
  v_accvgpr_write_b32 a59, v83
  v_accvgpr_write_b32 a60, v84
  v_accvgpr_write_b32 a61, v85
  v_accvgpr_write_b32 a62, v86
  v_accvgpr_write_b32 a63, v87
  v_perm_b32 v80, v241, v240, s60
  v_perm_b32 v81, v241, v240, s65
  v_perm_b32 v82, v243, v242, s60
  v_perm_b32 v83, v243, v242, s65
  v_perm_b32 v84, v245, v244, s60
  v_perm_b32 v85, v245, v244, s65
  v_perm_b32 v86, v247, v246, s60
  v_perm_b32 v87, v247, v246, s65
  s_cmp_ge_u32 s12, 2
  s_cbranch_scc1 L_c_x_49
  ds_write_b128 v4, v[80:83] offset:38912
  ds_write_b128 v4, v[84:87] offset:39936
  s_waitcnt lgkmcnt(0)
L_c_x_49:
  s_waitcnt vmcnt(8)
  v_perm_b32 v80, v20, v16, s60
  v_perm_b32 v81, v28, v24, s60
  v_perm_b32 v82, v36, v32, s60
  v_perm_b32 v83, v44, v40, s60
  v_perm_b32 v84, v21, v17, s60
  v_perm_b32 v85, v29, v25, s60
  v_perm_b32 v86, v37, v33, s60
  v_perm_b32 v87, v45, v41, s60
  v_perm_b32 v88, v22, v18, s60
  v_perm_b32 v89, v30, v26, s60
  v_perm_b32 v90, v38, v34, s60
  v_perm_b32 v91, v46, v42, s60
  v_perm_b32 v92, v23, v19, s60
  v_perm_b32 v93, v31, v27, s60
  v_perm_b32 v94, v39, v35, s60
  v_perm_b32 v95, v47, v43, s60
  s_barrier
  ds_write_b128 v2, v[80:83] offset:0
  ds_write_b128 v2, v[84:87] offset:4096
  ds_write_b128 v2, v[88:91] offset:8192
  ds_write_b128 v2, v[92:95] offset:12288
  s_waitcnt lgkmcnt(0)
  s_barrier
  ds_read_b128 v[192:195], v12
  ds_read_b128 v[208:211], v13
  ds_read_b128 v[224:227], v14
  ds_read_b128 v[240:243], v15
  s_waitcnt lgkmcnt(0)
  v_perm_b32 v80, v20, v16, s65
  v_perm_b32 v81, v28, v24, s65
  v_perm_b32 v82, v36, v32, s65
  v_perm_b32 v83, v44, v40, s65
  v_perm_b32 v84, v21, v17, s65
  v_perm_b32 v85, v29, v25, s65
  v_perm_b32 v86, v37, v33, s65
  v_perm_b32 v87, v45, v41, s65
  v_perm_b32 v88, v22, v18, s65
  v_perm_b32 v89, v30, v26, s65
  v_perm_b32 v90, v38, v34, s65
  v_perm_b32 v91, v46, v42, s65
  v_perm_b32 v92, v23, v19, s65
  v_perm_b32 v93, v31, v27, s65
  v_perm_b32 v94, v39, v35, s65
  v_perm_b32 v95, v47, v43, s65
  s_barrier
  ds_write_b128 v2, v[80:83] offset:0
  ds_write_b128 v2, v[84:87] offset:4096
  ds_write_b128 v2, v[88:91] offset:8192
  ds_write_b128 v2, v[92:95] offset:12288
  s_nop 0
  s_waitcnt lgkmcnt(0)
  s_barrier
  ds_read_b128 v[200:203], v12
  ds_read_b128 v[216:219], v13
  ds_read_b128 v[232:235], v14
  ds_read_b128 v[248:251], v15
  s_waitcnt lgkmcnt(0)
  s_waitcnt vmcnt(0)
  v_mov_b32 v9, v10
  s_lshr_b32 s40, s13, 1
  s_lshl_b32 s40, s40, 8
  s_add_u32 s80, s40, 0
  s_mov_b64 exec, 0x33
  buffer_load_dword v11, v0, s[4:7], s80 offen sc1
  s_mov_b64 exec, -1
  v_lshrrev_b32 v1, 2, v0
  buffer_load_dword v1, v1, s[4:7], s46 offen sc1
  s_getpc_b64 s[46:47]
L_c_pc:
  s_add_u32 s46, s46, L_c_loop-L_c_pc
  s_addc_u32 s47, s47, 0
  v_lshlrev_b32 v3, 3, v0
  global_load_dword v3, v3, s[46:47]
  v_perm_b32 v80, v52, v48, s60
  v_perm_b32 v81, v60, v56, s60
  v_perm_b32 v82, v68, v64, s60
  v_perm_b32 v83, v76, v72, s60
  v_perm_b32 v84, v53, v49, s60
  v_perm_b32 v85, v61, v57, s60
  v_perm_b32 v86, v69, v65, s60
  v_perm_b32 v87, v77, v73, s60
  v_perm_b32 v88, v54, v50, s60
  v_perm_b32 v89, v62, v58, s60
  v_perm_b32 v90, v70, v66, s60
  v_perm_b32 v91, v78, v74, s60
  v_perm_b32 v92, v55, v51, s60
  v_perm_b32 v93, v63, v59, s60
  v_perm_b32 v94, v71, v67, s60
  v_perm_b32 v95, v79, v75, s60
  s_barrier
  ds_write_b128 v2, v[80:83] offset:0
  ds_write_b128 v2, v[84:87] offset:4096
  ds_write_b128 v2, v[88:91] offset:8192
  ds_write_b128 v2, v[92:95] offset:12288
  s_waitcnt lgkmcnt(0)
  s_barrier
  ds_read_b128 v[196:199], v12
  ds_read_b128 v[212:215], v13
  ds_read_b128 v[228:231], v14
  ds_read_b128 v[244:247], v15
  s_waitcnt lgkmcnt(0)
  v_perm_b32 v80, v52, v48, s65
  v_perm_b32 v81, v60, v56, s65
  v_perm_b32 v82, v68, v64, s65
  v_perm_b32 v83, v76, v72, s65
  v_perm_b32 v84, v53, v49, s65
  v_perm_b32 v85, v61, v57, s65
  v_perm_b32 v86, v69, v65, s65
  v_perm_b32 v87, v77, v73, s65
  v_perm_b32 v88, v54, v50, s65
  v_perm_b32 v89, v62, v58, s65
  v_perm_b32 v90, v70, v66, s65
  v_perm_b32 v91, v78, v74, s65
  v_perm_b32 v92, v55, v51, s65
  v_perm_b32 v93, v63, v59, s65
  v_perm_b32 v94, v71, v67, s65
  v_perm_b32 v95, v79, v75, s65
  s_barrier
  ds_write_b128 v2, v[80:83] offset:0
  ds_write_b128 v2, v[84:87] offset:4096
  ds_write_b128 v2, v[88:91] offset:8192
  ds_write_b128 v2, v[92:95] offset:12288
  s_nop 0
  s_waitcnt lgkmcnt(0)
  s_barrier
  ds_read_b128 v[204:207], v12
  ds_read_b128 v[220:223], v13
  ds_read_b128 v[236:239], v14
  ds_read_b128 v[252:255], v15
  s_waitcnt lgkmcnt(0)
  s_waitcnt vmcnt(2)
  v_mov_b32 v15, v11
  v_mov_b32 v27, v9
  v_lshrrev_b32 v18, 4, v0
  v_and_b32 v16, 15, v18
  v_lshrrev_b32 v17, 4, v18
  v_and_b32 v20, 1, v18
  v_mov_b32 v21, 0x44444444
  v_mov_b32 v22, 0xeeeeeeee
  v_cmp_eq_u32 vcc, 1, v20
  s_waitcnt vmcnt(1)
  s_nop 0
  v_cndmask_b32_e64 v1, v21, v22, vcc
  s_lshl_b32 s40, s12, 9
  s_add_u32 s40, s40, 8192
  v_lshrrev_b32 v21, 1, v0
  s_waitcnt vmcnt(0)
  v_add_u32 v3, s40, v21
  v_and_b32 v19, 7, v16
  v_lshrrev_b32_e64 v25, 1, v16
  s_mul_i32 s41, s12, 1184
  s_add_u32 m0, s41, 10240
  v_lshlrev_b32 v21, 7, v17
  v_lshl_add_u32 v22, v25, 4, v21
  v_add_u32 v8, s40, v22
  v_and_b32 v22, 1, v25
  v_mul_u32_u24 v22, 288, v22
  v_lshrrev_b32 v23, 1, v25
  v_lshl_add_u32 v26, v23, 6, v22
  v_mul_u32_u24 v22, 640, v20
  v_add_u32 v22, v22, v26
  v_lshl_add_u32 v22, v17, 4, v22
  v_add_u32 v6, 10240, v22
  v_lshlrev_b32 v22, 8, v23
  v_lshl_add_u32 v22, v17, 6, v22
  v_and_b32 v24, 3, v16
  v_lshl_add_u32 v22, v24, 4, v22
  s_lshl_b32 s41, s12, 2
  s_add_u32 s41, s41, 14976
  v_add_u32_e64 v7, s41, v22
  v_mov_b32 v23, 0x3f80
  v_mov_b32 v24, 0x3f800000
  v_cmp_eq_u32 vcc, 1, v20
  s_nop 0
  s_nop 0
  v_cndmask_b32 v23, v23, v24, vcc
  v_lshlrev_b32 v24, 1, v17
  v_cmp_eq_u32 vcc, v25, v24
  s_nop 0
  s_nop 0
  v_cndmask_b32 v10, 0, v23, vcc
  v_add_u32 v24, 1, v24
  v_cmp_eq_u32 vcc, v25, v24
  s_nop 0
  s_nop 0
  v_cndmask_b32 v11, 0, v23, vcc
  v_lshrrev_b32 v22, 3, v18
  v_mul_u32_u24 v22, 5248, v22
  v_lshl_add_u32 v12, v19, 4, v22
  v_and_b32_e64 v22, 1, v19
  v_lshl_add_u32 v22, v17, 1, v22
  v_lshrrev_b32 v23, 2, v19
  v_lshl_add_u32 v22, v23, 4, v22
  v_lshlrev_b32 v22, 4, v22
  v_bfe_u32 v23, v19, 1, 1
  v_lshl_add_u32 v13, v23, 3, v22
  s_mul_i32 s58, s14, 524288
  s_add_u32 s57, s58, 458752
  s_add_u32 s58, s58, 65536
  s_mul_i32 s42, s13, 5248
  s_add_u32 s42, s42, s58
  s_sub_u32 s56, s42, 4096
  s_lshl_b32 s40, s12, 5
  s_add_u32 s40, s40, s13
  s_cmp_lt_u32 s40, 40
  s_cselect_b32 s48, 1, 0
  s_lshr_b32 s53, s40, 3
  s_and_b32 s54, s40, 1
  s_bfe_u32 s55, s40, 0x20001
  s_bfe_u32 s61, s40, 0x10002
  s_and_b32 s62, s40, 3
  s_cmp_eq_u32 s12, 0
  s_cselect_b32 s54, s54, s61
  s_cselect_b32 s55, s55, s62
  s_lshl_b32 s40, s40, 7
  s_add_u32 s43, s40, s58
  s_add_u32 s44, s43, 41984
  s_add_u32 s45, s43, 83968
  s_add_u32 s46, s43, 125952
  s_lshl_b32 s41, s53, 1
  s_add_u32 s41, s41, s54
  s_lshl_b32 s47, s41, 9
  s_lshl_b32 s40, s55, 6
  s_add_u32 s47, s47, s40
  s_mov_b32 s70, 0x00ff00ff
  s_mov_b32 s71, 0
  s_mov_b32 s72, 0x33333333
  s_mov_b32 s73, 0x33333333
  s_cmp_eq_u32 s14, 0
  s_cselect_b32 s74, 0x33333333, 0
  s_cselect_b32 s75, 0, 0x33333333
  s_cselect_b32 s68, -1, 0
  s_cselect_b32 s69, 0, -1
  s_mov_b32 s76, 0x55555555
  s_mov_b32 s77, 0x55555555
  s_mov_b32 s52, 0x10000
  s_mov_b32 s36, 0x3f80
  s_lshl_b32 s40, s13, 2
  s_add_u32 s40, s40, s12
  s_lshl_b32 s41, s40, 12
  s_add_u32 s61, s41, 33554432
  s_mov_b32 s62, s61
  s_lshr_b32 s41, s13, 2
  s_lshl_b32 s41, s41, 14
  s_and_b32 s53, s13, 3
  s_lshl_b32 s53, s53, 11
  s_add_u32 s41, s41, s53
  s_add_u32 s64, s41, 8388608
  s_lshl_b32 s53, s12, 9
  s_add_u32 s63, s64, s53
  s_lshl_b32 s40, s14, 14
  s_add_u32 s58, s40, 2097152
  s_xor_b32 s59, s58, 0x4000
  s_add_u32 s58, s58, s47
  s_add_u32 s47, s47, s57
  s_mov_b32 s49, 0
  s_mov_b32 s81, 0
  v_readlane_b32 s40, v27, 24
  s_mov_b32 s2, 0
  s_cmp_eq_u32 s40, 128
  s_cbranch_scc1 L_c_go
  s_mov_b32 s2, 3
  v_mov_b32 v27, 96
L_cnt_50:
  s_mov_b64 exec, 1
  buffer_load_dword v26, v27, s[8:11], 0 offen sc1
  s_mov_b64 exec, -1
  s_sub_u32 s66, s66, 1
  s_cbranch_scc1 L_end
  s_waitcnt vmcnt(0)
  v_readfirstlane_b32 s40, v26
  s_nop 0
  s_and_b32 s40, s40, -1
  s_cmp_eq_u32 s40, 128
  s_cbranch_scc1 L_cnt_50x
  s_sleep 4
  s_branch L_cnt_50
  s_nop 0
  s_nop 0
  s_nop 0
  s_nop 0
  s_nop 0
  s_nop 0
L_cnt_50x:
  v_lshrrev_b32 v27, 2, v0
  buffer_load_dword v27, v27, s[8:11], 0 offen sc1
L_c_go:
  s_waitcnt vmcnt(0)
  s_lshl_b32 s40, s14, 4
  v_readlane_b32 s81, v27, 25
  v_readlane_b32 s40, v27, s40
  s_nop 0
  s_cmp_lt_u32 s40, 32
  s_cbranch_scc1 L_c_run_s
L_c_run:
  s_and_b32 s81, s81, 0x2000
  s_add_u32 s58, s58, s81
  s_add_u32 s59, s59, s81
  s_add_u32 s58, s58, 0x8000
  s_mov_b32 s32, 0
  s_mov_b32 s33, 0x28000000
  s_lshl_b32 s37, s12, 10
  s_add_u32 s37, s37, 4096
  s_mov_b32 s65, m0
  s_cmp_eq_u32 s12, 3
  s_cselect_b32 s60, -1, 0
  s_mov_b32 s81, s64
  s_mov_b32 s64, 1638400
  s_mov_b32 s34, 0x3e0293ee
  s_mov_b32 s35, 0x3e0293ee
  s_add_u32 s40, s49, 0
  s_lshr_b32 s3, s40, 2
  s_and_b32 s40, s40, 3
  s_lshl_b32 s40, s40, 6
  s_add_u32 s15, s80, s40
  v_cmp_ge_u32 s[78:79], s3, v15
  s_nop 0
  s_or_b32 s40, s78, s2
  s_and_b32 s40, s40, 0x33
  s_cbranch_scc0 L_c_kv0x
L_c_kv0:
  s_mov_b64 exec, 3
  buffer_load_dword v15, v0, s[4:7], s15 offen sc1
  s_mov_b64 exec, -1
  s_sub_u32 s66, s66, 1
  s_cbranch_scc1 L_end
  s_waitcnt vmcnt(0)
  v_cmp_ge_u32 s[78:79], s3, v15
  s_nop 0
  s_and_b32 s40, s78, 3
  s_cbranch_scc1 L_c_kv0
  s_add_u32 s40, s49, 1
  s_lshr_b32 s3, s40, 2
  s_and_b32 s40, s40, 3
  s_lshl_b32 s40, s40, 6
  s_add_u32 s15, s80, s40
L_c_kv1:
  s_mov_b64 exec, 3
  buffer_load_dword v15, v0, s[4:7], s15 offen sc1
  s_mov_b64 exec, -1
  s_sub_u32 s66, s66, 1
  s_cbranch_scc1 L_end
  s_waitcnt vmcnt(0)
  v_cmp_ge_u32 s[78:79], s3, v15
  s_nop 0
  s_and_b32 s40, s78, 3
  s_cbranch_scc1 L_c_kv1
L_c_kv0x:
  buffer_load_dwordx4 v[88:91], v0, s[4:7], s61 offen offset:0 sc1
  buffer_load_dwordx4 v[92:95], v0, s[4:7], s61 offen offset:1024 sc1
  s_add_u32 s61, s61, 0x80000
  s_waitcnt lgkmcnt(0)
  s_barrier
  ds_read_b128 v[40:43], v4 offset:0
  ds_read_b128 v[44:47], v4 offset:1024
  ds_read_b128 v[48:51], v4 offset:2048
  ds_read_b128 v[52:55], v4 offset:3072
  s_add_u32 s41, s49, 3
  s_and_b32 s41, s41, 3
  s_lshl_b32 s41, s41, 13
  s_add_u32 s55, s41, s57
  s_add_u32 s53, s41, s47
  s_xor_b32 s41, s41, 0x4000
  s_add_u32 s54, s41, s47
  s_xor_b32 s55, s59, 0x4000
  s_waitcnt lgkmcnt(0)
  s_branch L_c_loop
L_c_loop:
  v_cmp_ge_u32 s[78:79], s3, v15
  s_and_b32 s40, s49, 1
  s_lshl_b32 s51, s40, 16
  s_xor_b32 s50, s51, 0x10000
  s_add_u32 s67, s49, 1
  v_xor_b32 v14, 1024, v2
  v_xor_b32 v9, 2048, v2
  v_xor_b32 v5, 3072, v2
  v_mov_b64 v[16:17], 0
  v_mov_b64 v[18:19], 0
  v_mov_b64 v[20:21], 0
  v_mov_b64 v[22:23], 0
  v_mov_b64 v[24:25], 0
  v_mov_b64 v[26:27], 0
  v_mov_b64 v[28:29], 0
  v_mov_b64 v[30:31], 0
  v_mov_b64 v[56:57], 0
  v_mov_b64 v[58:59], 0
  v_mov_b64 v[60:61], 0
  v_mov_b64 v[62:63], 0
  s_cmp_lg_u32 s49, 63
  s_cselect_b32 s40, 3, 0
  s_and_b32 s40, s78, s40
  s_cbranch_scc1 L_c_kvspin
L_c_kvok:
  s_add_u32 s40, s49, 2
  s_lshr_b32 s3, s40, 2
  s_and_b32 s40, s40, 3
  s_lshl_b32 s40, s40, 6
  s_add_u32 s15, s80, s40
  s_cmp_lg_u32 s12, 2
  s_cbranch_scc1 L_c_nx1
  buffer_load_dwordx4 v[84:87], v2, s[4:7], s55 offen offset:2048 sc1
L_c_nx1:
  buffer_load_dwordx4 v[64:67], v2, s[4:7], s55 offen sc1
  v_mov_b32_e64 v80, 0
  s_waitcnt lgkmcnt(0)
L_c_pollB:
  s_cmp_lg_u32 s12, 2
  s_cbranch_scc1 L_c_nx2
  s_waitcnt vmcnt(1)
  ds_write_b128 v2, v[84:87] offset:6144
  v_max_u32 v80, v84, v86
L_c_nx2:
  s_waitcnt vmcnt(0)
  ds_write_b128 v2, v[64:67]
  v_max3_u32 v76, v64, v66, v80
  v_cmp_eq_u32 vcc, -1, v76
  v_smfmac_f32_16x16x64_bf16 v[16:19], v[64:67], v[40:47], v1
  v_smfmac_f32_16x16x64_bf16 v[20:23], v[64:67], v[48:55], v1
  s_cbranch_vccnz L_c_Bretry
  v_smfmac_f32_16x16x64_bf16 v[24:27], v[64:67], a[64:71], v1
  s_waitcnt lgkmcnt(0)
  s_barrier
  ds_read_b128 v[76:79], v0 offset:8192
  ds_read_b128 v[68:71], v14 offset:0
  ds_read_b128 v[72:75], v9 offset:0
  v_smfmac_f32_16x16x64_bf16 v[28:31], v[64:67], a[72:79], v1
  ds_read_b128 v[40:43], v4 offset:4096
  v_smfmac_f32_16x16x64_bf16 v[56:59], v[64:67], a[80:87], v1
  s_mov_b32 m0, s37
  s_cmp_eq_u32 s12, 3
  buffer_load_dwordx4 v2, s[4:7], s59 offen sc1 lds
  s_cbranch_scc1 L_c_x3
L_c_nx3:
  v_smfmac_f32_16x16x64_bf16 v[60:63], v[64:67], a[88:95], v1
  ds_read_b128 v[64:67], v5 offset:0
  s_waitcnt lgkmcnt(4)
  v_smfmac_f32_16x16x64_bf16 v[16:19], v[76:79], a[96:103], v1
  s_nop 0
  ds_read_b128 v[44:47], v4 offset:5120
  v_smfmac_f32_16x16x64_bf16 v[20:23], v[76:79], a[104:111], v1
  s_nop 0
  ds_read_b128 v[48:51], v4 offset:6144
  v_smfmac_f32_16x16x64_bf16 v[24:27], v[76:79], a[112:119], v1
  s_mov_b64 exec, s[68:69]
  buffer_store_dwordx2 v[34:35], v3, s[4:7], s64 offen sc1
  s_mov_b64 exec, -1
  s_mov_b32 s64, s81
  v_smfmac_f32_16x16x64_bf16 v[28:31], v[76:79], a[120:127], v1
  ds_read_b128 v[52:55], v4 offset:7168
  s_waitcnt lgkmcnt(2)
  v_smfmac_f32_16x16x64_bf16 v[56:59], v[76:79], v[40:47], v1
  ds_read_b128 v[40:43], v4 offset:8192
  v_smfmac_f32_16x16x64_bf16 v[60:63], v[76:79], a[128:135], v1
  ds_read_b128 v[44:47], v4 offset:9216
  v_smfmac_f32_16x16x64_bf16 v[16:19], v[68:71], a[136:143], v1
  buffer_load_dwordx4 v[32:35], v0, s[4:7], s62 offen offset:2048 sc1
  s_waitcnt lgkmcnt(2)
  v_smfmac_f32_16x16x64_bf16 v[20:23], v[68:71], v[48:55], v1
  s_nop 0
  ds_read_b128 v[48:51], v4 offset:10240
  v_smfmac_f32_16x16x64_bf16 v[24:27], v[68:71], a[144:151], v1
  ds_read_b128 v[52:55], v4 offset:11264
  s_waitcnt lgkmcnt(2)
  v_smfmac_f32_16x16x64_bf16 v[28:31], v[68:71], v[40:47], v1
  s_nop 0
  ds_read_b128 v[40:43], v4 offset:12288
  v_smfmac_f32_16x16x64_bf16 v[56:59], v[68:71], a[152:159], v1
  buffer_load_dwordx4 v[36:39], v0, s[4:7], s62 offen offset:3072 sc1
  v_smfmac_f32_16x16x64_bf16 v[60:63], v[68:71], a[160:167], v1
  ds_read_b128 v[44:47], v4 offset:13312
  s_waitcnt lgkmcnt(2)
  v_smfmac_f32_16x16x64_bf16 v[16:19], v[72:75], v[48:55], v1
  s_nop 0
  ds_read_b128 v[48:51], v4 offset:14336
  v_smfmac_f32_16x16x64_bf16 v[20:23], v[72:75], a[168:175], v1
  ds_read_b128 v[52:55], v4 offset:15360
  v_smfmac_f32_16x16x64_bf16 v[24:27], v[72:75], a[176:183], v1
  s_nop 0
  s_waitcnt lgkmcnt(2)
  v_smfmac_f32_16x16x64_bf16 v[28:31], v[72:75], v[40:47], v1
  s_nop 0
  ds_read_b128 v[40:43], v4 offset:16384
  v_smfmac_f32_16x16x64_bf16 v[56:59], v[72:75], a[184:191], v1
  s_waitcnt vmcnt(3)
  ds_read_b128 v[80:83], v2 offset:4096
  ds_read_b128 v[84:87], v0 offset:9216
  s_waitcnt lgkmcnt(3)
  v_smfmac_f32_16x16x64_bf16 v[60:63], v[72:75], v[48:55], v1
  s_nop 0
  ds_read_b128 v[44:47], v4 offset:17408
  v_smfmac_f32_16x16x64_bf16 v[16:19], v[64:67], a[192:199], v1
  ds_read_b128 v[48:51], v4 offset:18432
  v_smfmac_f32_16x16x64_bf16 v[20:23], v[64:67], a[200:207], v1
  ds_read_b128 v[52:55], v4 offset:19456
  s_waitcnt lgkmcnt(3)
  v_max_u32 v76, v84, v86
  v_and_b32_e64 v76, s60, v76
  v_smfmac_f32_16x16x64_bf16 v[24:27], v[64:67], a[208:215], v1
  v_max3_u32 v76, v76, v80, v82
  s_waitcnt lgkmcnt(2)
  v_smfmac_f32_16x16x64_bf16 v[28:31], v[64:67], v[40:47], v1
  s_nop 0
  ds_read_b128 v[40:43], v4 offset:20480
  v_cmp_eq_u32 vcc, -1, v76
  v_smfmac_f32_16x16x64_bf16 v[56:59], v[64:67], a[216:223], v1
  ds_read_b128 v[44:47], v4 offset:21504
  s_waitcnt lgkmcnt(2)
  v_smfmac_f32_16x16x64_bf16 v[60:63], v[64:67], v[48:55], v1
  s_cbranch_vccnz L_c_remretry
L_c_remok:
  s_barrier
  ds_read_b128 v[76:79], v0 offset:9216
  v_smfmac_f32_16x16x64_bf16 v[16:19], v[80:83], a[224:231], v1
  s_add_u32 s59, s59, 0x8000
  ds_read_b128 v[68:71], v14 offset:4096
  v_smfmac_f32_16x16x64_bf16 v[20:23], v[80:83], a[232:239], v1
  s_mov_b32 m0, s65
  ds_read_b128 v[72:75], v9 offset:4096
  s_waitcnt lgkmcnt(3)
  v_smfmac_f32_16x16x64_bf16 v[24:27], v[80:83], v[40:47], v1
  ds_read_b128 v[64:67], v5 offset:4096
  v_smfmac_f32_16x16x64_bf16 v[28:31], v[80:83], a[240:247], v1
  ds_read_b128 v[48:51], v4 offset:22528
  v_lshrrev_b32 v5, 1, v0
  s_waitcnt lgkmcnt(4)
  v_smfmac_f32_16x16x64_bf16 v[16:19], v[76:79], a[248:255], v1
  ds_read_b128 v[52:55], v4 offset:23552
  v_and_b32 v5, 0x1e0, v5
  v_smfmac_f32_16x16x64_bf16 v[20:23], v[76:79], v[96:103], v1
  ds_read_b128 v[40:43], v4 offset:24576
  v_and_or_b32 v5, v0, 16, v5
  v_smfmac_f32_16x16x64_bf16 v[24:27], v[76:79], v[104:111], v1
  s_nop 0
  ds_read_b128 v[44:47], v4 offset:25600
  v_xor_b32 v14, 512, v8
  v_smfmac_f32_16x16x64_bf16 v[28:31], v[76:79], v[112:119], v1
  s_mov_b64 exec, 3
  buffer_load_dword v15, v0, s[4:7], s15 offen sc1
  s_mov_b64 exec, -1
  v_xor_b32 v9, 1024, v8
  s_waitcnt lgkmcnt(2)
  v_smfmac_f32_16x16x64_bf16 v[16:19], v[68:71], v[48:55], v1
  s_nop 0
  ds_read_b128 v[48:51], v4 offset:26624
  v_smfmac_f32_16x16x64_bf16 v[16:19], v[72:75], v[120:127], v1
  ds_read_b128 v[52:55], v4 offset:27648
  s_waitcnt lgkmcnt(2)
  v_smfmac_f32_16x16x64_bf16 v[16:19], v[64:67], v[40:47], v1
  ds_read_b128 v[40:43], v4 offset:28672
  v_smfmac_f32_16x16x64_bf16 v[20:23], v[68:71], v[128:135], v1
  ds_read_b128 v[44:47], v4 offset:29696
  v_smfmac_f32_16x16x64_bf16 v[20:23], v[72:75], v[136:143], v1
  v_add_f32 v16, v16, v17
  s_waitcnt lgkmcnt(2)
  v_smfmac_f32_16x16x64_bf16 v[20:23], v[64:67], v[48:55], v1
  ds_read_b128 v[48:51], v4 offset:30720
  v_add_f32_e64 v18, v18, v19
  v_smfmac_f32_16x16x64_bf16 v[24:27], v[68:71], v[144:151], v1
  ds_read_b128 v[52:55], v4 offset:31744
  v_cvt_pk_bf16_f32 v17, v16, v18
  v_smfmac_f32_16x16x64_bf16 v[24:27], v[72:75], v[152:159], v1
  v_add_f32 v20, v20, v21
  v_smfmac_f32_16x16x64_bf16 v[24:27], v[64:67], v[160:167], v1
  v_add_f32 v22, v22, v23
  v_smfmac_f32_16x16x64_bf16 v[28:31], v[68:71], v[168:175], v1
  v_cvt_pk_bf16_f32 v16, v20, v22
  v_smfmac_f32_16x16x64_bf16 v[28:31], v[72:75], v[176:183], v1
  v_add_f32 v24, v24, v25
  v_smfmac_f32_16x16x64_bf16 v[28:31], v[64:67], v[184:191], v1
  v_add_f32 v26, v26, v27
  v_mfma_f32_16x16x16_bf16 v[20:23], v[16:17], v[10:11], 0
  v_cvt_pk_bf16_f32 v25, v24, v26
  s_nop 0
  s_nop 0
  s_nop 0
  v_add_f32 v28, v28, v29
  v_add_f32_e64 v30, v30, v31
  v_cvt_pk_bf16_f32 v24, v28, v30
  s_mov_b64 vcc, s[72:73]
  s_nop 0
  v_mfma_f32_16x16x16_bf16 v[28:31], v[24:25], v[10:11], 0
  v_smfmac_f32_16x16x64_bf16 v[56:59], v[80:83], v[192:199], v1
  v_smfmac_f32_16x16x64_bf16 v[60:63], v[80:83], v[200:207], v1
  v_cvt_pk_bf16_f32 v84, v20, v28
  v_cvt_pk_bf16_f32 v85, v21, v29
  v_cvt_pk_bf16_f32 v86, v22, v30
  v_cvt_pk_bf16_f32 v87, v23, v31
  s_nop 0
  s_nop 0
  v_mfma_f32_16x16x32_bf16 v[28:31], v[84:87], v[84:87], 0
  v_mfma_f32_16x16x32_bf16 v[20:23], v[84:87], v[88:91], 0
  v_mfma_f32_16x16x32_bf16 v[24:27], v[84:87], v[92:95], 0
  buffer_load_dwordx4 v[88:91], v0, s[4:7], s61 offen offset:0 sc1
  v_cndmask_b32_dpp v30, v31, v30, vcc quad_perm:[2,3,0,1] row_mask:0xf bank_mask:0xf
  s_waitcnt lgkmcnt(2)
  v_smfmac_f32_16x16x64_bf16 v[56:59], v[76:79], v[40:47], v1
  ds_write_b32 v7, v30
  ds_write_addtid_b32 v22
  ds_write_addtid_b32 v23 offset:288
  s_waitcnt lgkmcnt(3)
  v_smfmac_f32_16x16x64_bf16 v[60:63], v[76:79], v[48:55], v1
  ds_write_addtid_b32 v26 offset:640
  ds_write_addtid_b32 v27 offset:928
  v_smfmac_f32_16x16x64_bf16 v[56:59], v[68:71], v[208:215], v1
  s_cmp_eq_u32 s49, 63
  v_min_u32_e64 v84, -2, v84
  s_cbranch_scc1 L_c_last
  s_mov_b64 vcc, s[76:77]
  s_bitcmp1_b64 s[32:33], s49
  v_smfmac_f32_16x16x64_bf16 v[60:63], v[68:71], v[216:223], v1
  s_waitcnt lgkmcnt(0)
  s_barrier
  ds_read_b128 v[76:79], v0 offset:14976
  ds_read_b128 v[16:19], v6 offset:0
  ds_read_b128 v[20:23], v6 offset:1184
  ds_read_b128 v[24:27], v6 offset:2368
  ds_read_b128 v[28:31], v6 offset:3552
  v_smfmac_f32_16x16x64_bf16 v[56:59], v[72:75], v[224:231], v1
  buffer_load_dwordx4 v[92:95], v0, s[4:7], s61 offen offset:1024 sc1
  v_mov_b64 v[68:69], 0
  v_smfmac_f32_16x16x64_bf16 v[60:63], v[72:75], v[232:239], v1
  s_mov_b64 exec, s[74:75]
  buffer_store_dwordx4 v[84:87], v5, s[4:7], s63 offen sc1
  s_mov_b64 exec, -1
  v_mov_b64 v[70:71], 0
  v_smfmac_f32_16x16x64_bf16 v[56:59], v[64:67], v[240:247], v1
  ds_read_b128 v[40:43], v4 offset:32768
  v_mov_b64_e64 v[72:73], 0
  v_smfmac_f32_16x16x64_bf16 v[60:63], v[64:67], v[248:255], v1
  ds_read_b128 v[44:47], v4 offset:33792
  v_mov_b64 v[74:75], 0
  v_mov_b64 v[64:65], 0
  v_mov_b64 v[66:67], 0
  s_waitcnt lgkmcnt(6)
  v_pk_add_f32 v[76:77], v[76:77], v[78:79]
  s_waitcnt lgkmcnt(4)
  v_pk_add_f32 v[16:17], v[16:17], v[20:21]
  v_pk_add_f32 v[18:19], v[18:19], v[22:23]
  v_add_f32 v20, v76, v77
  s_waitcnt lgkmcnt(3)
  v_pk_add_f32 v[16:17], v[16:17], v[24:25]
  v_pk_add_f32 v[18:19], v[18:19], v[26:27]
  s_waitcnt lgkmcnt(2)
  v_pk_add_f32 v[16:17], v[16:17], v[28:29]
  v_pk_add_f32 v[18:19], v[18:19], v[30:31]
  v_max3_f32 v22, v16, v17, v20
  v_max3_f32 v22, v22, v18, v19
  v_add_f32 v56, v56, v57
  v_add_f32 v58, v58, v59
  v_max_f32_dpp v22, v22, v22 quad_perm:[1,0,3,2] row_mask:0xf bank_mask:0xf
  v_mov_b32 v21, v22
  v_add_f32 v60, v60, v61
  v_add_f32 v62, v62, v63
  v_permlane16_swap_b32 v22, v21
  v_max_f32 v22, v22, v21
  v_mov_b32 v21, v22
  v_cvt_pk_bf16_f32 v84, v56, v58
  v_cvt_pk_bf16_f32 v86, v60, v62
  v_permlane32_swap_b32 v22, v21
  v_max_f32 v22, v22, v21
  v_mul_f32_e64 v22, s34, v22
  v_pk_fma_f32 v[16:17], v[16:17], s[34:35], v[22:23] op_sel_hi:[1,1,0] neg_lo:[0,0,1] neg_hi:[0,0,1]
  v_pk_fma_f32 v[18:19], v[18:19], s[34:35], v[22:23] op_sel_hi:[1,1,0] neg_lo:[0,0,1] neg_hi:[0,0,1]
  v_exp_f32 v16, v16
  v_exp_f32 v17, v17
  v_exp_f32_e64 v18, v18
  v_exp_f32_e64 v19, v19
  v_cvt_pk_bf16_f32 v76, v16, v17
  v_cvt_pk_bf16_f32 v77, v18, v19
  v_fma_f32 v20, v20, s34, -v22
  v_mov_b32_dpp v78, v76 quad_perm:[1,0,3,2] row_mask:0xf bank_mask:0xf
  v_mov_b32_dpp v79, v77 quad_perm:[1,0,3,2] row_mask:0xf bank_mask:0xf
  v_exp_f32 v20, v20
  v_add_f32_e64 v16, v16, v17
  s_waitcnt vmcnt(5)
  v_mfma_f32_16x16x32_bf16 v[24:27], v[32:35], v[76:79], 0
  ds_read_b128 v[48:51], v4 offset:34816
  v_mov_b32_dpp v21, v20 quad_perm:[1,0,3,2] row_mask:0xf bank_mask:0xf
  v_cvt_pk_bf16_f32 v80, v20, v21
  s_waitcnt vmcnt(4)
  v_mfma_f32_16x16x32_bf16 v[28:31], v[36:39], v[76:79], 0
  ds_read_b128 v[52:55], v4 offset:35840
  v_mov_b32 v81, 0
  v_add_f32 v18, v18, v19
  v_add_f32 v16, v16, v20
  v_mfma_f32_16x16x16_bf16 v[24:27], v[84:85], v[80:81], v[24:27]
  ds_read_b128 v[56:59], v4 offset:36864
  v_add_f32_e64 v16, v16, v18
  v_mfma_f32_16x16x16_bf16 v[28:31], v[86:87], v[80:81], v[28:31]
  ds_read_b128 v[60:63], v4 offset:37888
  v_add_f32_dpp v16, v16, v16 quad_perm:[1,0,3,2] row_mask:0xf bank_mask:0xf
  v_mov_b32 v21, v16
  v_xor_b32 v5, 1536, v8
  v_mov_b32 v35, v86
  v_permlane16_swap_b32 v16, v21
  v_add_f32 v16, v16, v21
  v_mov_b32 v21, v16
  v_min_u32 v34, -2, v84
  s_cbranch_scc1 L_c_vm
L_c_vmx:
  v_permlane32_swap_b32 v16, v21
  v_add_f32 v16, v16, v21
  v_rcp_f32 v20, v16
  v_cndmask_b32_dpp v24, v28, v24, vcc quad_perm:[1,0,3,2] row_mask:0xf bank_mask:0xf
  v_cndmask_b32_dpp v25, v29, v25, vcc quad_perm:[1,0,3,2] row_mask:0xf bank_mask:0xf
  v_cndmask_b32_dpp v26, v30, v26, vcc quad_perm:[1,0,3,2] row_mask:0xf bank_mask:0xf
  v_cndmask_b32_dpp v27, v31, v27, vcc quad_perm:[1,0,3,2] row_mask:0xf bank_mask:0xf
  v_pk_mul_f32 v[24:25], v[24:25], v[20:21] op_sel_hi:[1,0]
  v_pk_mul_f32 v[26:27], v[26:27], v[20:21] op_sel_hi:[1,0]
  v_cvt_pk_bf16_f32 v16, v24, v25
  v_cvt_pk_bf16_f32 v17, v26, v27
  s_cmp_ge_u32 s12, 2
  ds_write_b64 v3, v[16:17]
  s_cbranch_scc1 L_c_h23
  v_mov_b32_dpp v36, v16 quad_perm:[0,0,2,2] row_mask:0xf bank_mask:0xf
  v_mov_b32_dpp v37, v17 quad_perm:[0,0,2,2] row_mask:0xf bank_mask:0xf
  v_mov_b32_dpp v38, v16 quad_perm:[1,1,3,3] row_mask:0xf bank_mask:0xf
  v_mov_b32_dpp v39, v17 quad_perm:[1,1,3,3] row_mask:0xf bank_mask:0xf
  s_add_u32 s61, s61, 0x80000
  s_add_u32 s62, s62, 0x80000
  s_waitcnt lgkmcnt(5)
  v_smfmac_f32_16x16x64_bf16 v[72:75], v[36:39], v[40:47], v1
  s_nop 0
  v_smfmac_f32_16x16x64_bf16 v[64:67], v[36:39], a[0:7], v1
  s_waitcnt lgkmcnt(0)
  s_barrier
  ds_read_b128 v[20:23], v14
  ds_read_b128 v[24:27], v9
  ds_read_b128 v[28:31], v5
  ds_read_b128 v[40:43], v4 offset:38912
  ds_read_b128 v[44:47], v4 offset:39936
  v_smfmac_f32_16x16x64_bf16 v[68:71], v[36:39], a[8:15], v1
  v_mov_b32 v32, 0xfffe0000
  s_add_u32 s63, s63, 0x20000
  s_add_u32 s81, s81, 0x20000
  s_waitcnt lgkmcnt(4)
  v_smfmac_f32_16x16x64_bf16 v[72:75], v[20:23], v[48:55], v1
  s_waitcnt lgkmcnt(3)
  v_smfmac_f32_16x16x64_bf16 v[72:75], v[24:27], v[56:63], v1
  v_smfmac_f32_16x16x64_bf16 v[64:67], v[20:23], a[16:23], v1
  s_waitcnt lgkmcnt(0)
  v_smfmac_f32_16x16x64_bf16 v[72:75], v[28:31], v[40:47], v1
  v_smfmac_f32_16x16x64_bf16 v[64:67], v[24:27], a[24:31], v1
  s_nop 0
  v_smfmac_f32_16x16x64_bf16 v[64:67], v[28:31], a[32:39], v1
  v_add_u32_e64 v73, s51, v73
  v_and_or_b32 v73, v73, v32, s50
  v_smfmac_f32_16x16x64_bf16 v[68:71], v[20:23], a[40:47], v1
  v_cvt_pk_bf16_f32 v72, v72, v73
  v_cvt_pk_bf16_f32 v74, v74, v75
  v_smfmac_f32_16x16x64_bf16 v[68:71], v[24:27], a[48:55], v1
  v_mov_b32_dpp v73, v72 quad_perm:[1,0,3,2] row_mask:0xf bank_mask:0xf
  v_mov_b32_dpp v75, v74 quad_perm:[1,0,3,2] row_mask:0xf bank_mask:0xf
  v_smfmac_f32_16x16x64_bf16 v[68:71], v[28:31], a[56:63], v1
  s_mov_b64 exec, s[76:77]
  buffer_store_dwordx4 v[72:75], v3, s[4:7], s56 offen
  s_mov_b64 exec, -1
  v_add_u32 v65, s51, v65
  v_and_or_b32 v65, v65, v32, s50
  v_cvt_pk_bf16_f32 v64, v64, v65
  v_cvt_pk_bf16_f32 v66, v66, v67
  s_nop 0
  v_cvt_pk_bf16_f32 v65, v68, v69
  v_cvt_pk_bf16_f32 v67, v70, v71
  buffer_store_dwordx4 v[64:67], v2, s[4:7], s42 offen
  s_mov_b32 s49, s67
  v_and_b32 v84, 16, v0
  v_lshlrev_b32_e64 v84, v84, s36
  v_bfe_u32 v85, v0, 5, 3
  v_cmp_eq_u32_e64 vcc, 0, v85
  v_cmp_eq_u32 s[38:39], 1, v85
  v_cmp_eq_u32 s[40:41], 2, v85
  v_cndmask_b32 v36, 0, v84, vcc
  v_cmp_eq_u32 vcc, 3, v85
  v_cndmask_b32 v37, 0, v84, s[38:39]
  v_cndmask_b32 v38, 0, v84, s[40:41]
  v_cndmask_b32 v39, 0, v84, vcc
  v_mov_b64 v[86:87], -1
  s_cmp_eq_u32 s48, 0
  s_cbranch_scc1 L_c_idle
  s_cmp_eq_u32 s12, 1
  s_cbranch_scc1 L_c_pa1
  s_nop 0
  s_nop 14
  s_nop 0
  s_nop 0
L_c_pa1:
  s_nop 0
  s_nop 14
  s_nop 0
  s_nop 2
  buffer_load_dwordx4 v[16:19], v12, s[4:7], s43 offen sc1
  buffer_load_dwordx4 v[20:23], v12, s[4:7], s44 offen sc1
  buffer_load_dwordx4 v[24:27], v12, s[4:7], s45 offen sc1
  buffer_load_dwordx4 v[28:31], v12, s[4:7], s46 offen sc1
  ds_read_b128 v[40:43], v4 offset:0
  ds_read_b128 v[44:47], v4 offset:1024
  ds_read_b128 v[48:51], v4 offset:2048
  ds_read_b128 v[52:55], v4 offset:3072
  s_add_u32 s41, s49, 3
  s_and_b32 s41, s41, 3
  s_lshl_b32 s41, s41, 13
  s_add_u32 s55, s41, s57
  s_add_u32 s53, s41, s47
  s_xor_b32 s41, s41, 0x4000
  s_add_u32 s54, s41, s47
  s_nop 0
  s_nop 12
  buffer_load_dwordx4 v[64:67], v12, s[4:7], s43 offen sc1
  buffer_load_dwordx4 v[68:71], v12, s[4:7], s44 offen sc1
  buffer_load_dwordx4 v[72:75], v12, s[4:7], s45 offen sc1
  buffer_load_dwordx4 v[76:79], v12, s[4:7], s46 offen sc1
  s_mov_b64 exec, s[70:71]
  buffer_store_dwordx2 v[86:87], v13, s[4:7], s54 offen
  s_mov_b64 exec, -1
  s_waitcnt vmcnt(8)
  v_mfma_f32_16x16x32_bf16 v[56:59], v[36:39], v[16:19], 0
  s_waitcnt vmcnt(7)
  v_mfma_f32_16x16x32_bf16 v[56:59], v[36:39], v[20:23], v[56:59]
  v_bitop3_b32 v84, v16, v20, s50 bitop3:0x7e
  s_waitcnt vmcnt(6)
  v_mfma_f32_16x16x32_bf16 v[56:59], v[36:39], v[24:27], v[56:59]
  s_waitcnt vmcnt(5)
  v_mfma_f32_16x16x32_bf16 v[56:59], v[36:39], v[28:31], v[56:59]
  v_bitop3_b32 v85, v24, v28, s50 bitop3:0x7e
  v_bitop3_b32 v84, v84, v85, s52 bitop3:0xa8
  v_cmp_ne_u32 vcc, 0, v84
  s_nop 0
  s_nop 0
  s_nop 2
  v_add_f32_dpp v56, v56, v56 row_ror:8 row_mask:0xf bank_mask:0xf
  v_add_f32_dpp v57, v57, v57 row_ror:8 row_mask:0xf bank_mask:0xf
  v_add_f32_dpp v58, v58, v58 row_ror:8 row_mask:0xf bank_mask:0xf
  v_add_f32_dpp v59, v59, v59 row_ror:8 row_mask:0xf bank_mask:0xf
  v_cvt_pk_bf16_f32 v56, v56, v57
  v_cvt_pk_bf16_f32 v57, v58, v59
  v_min_u32 v56, -2, v56
  s_cbranch_vccnz L_c_A2
L_c_okA:
  s_mov_b64 exec, s[70:71]
  buffer_store_dwordx2 v[56:57], v13, s[4:7], s53 offen
  buffer_store_dwordx2 v[56:57], v13, s[4:7], s58 offen sc1
  s_mov_b64 exec, -1
  s_add_u32 s58, s58, 0x8000
L_c_nored:
  s_barrier
  s_branch L_c_loop
  s_nop 0
L_c_A2:
  s_waitcnt vmcnt(1)
  v_mfma_f32_16x16x32_bf16 v[56:59], v[36:39], v[64:67], 0
  v_mfma_f32_16x16x32_bf16 v[56:59], v[36:39], v[68:71], v[56:59]
  v_bitop3_b32 v84, v64, v68, s50 bitop3:0x7e
  v_mfma_f32_16x16x32_bf16 v[56:59], v[36:39], v[72:75], v[56:59]
  v_mfma_f32_16x16x32_bf16 v[56:59], v[36:39], v[76:79], v[56:59]
  v_bitop3_b32 v85, v72, v76, s50 bitop3:0x7e
  v_bitop3_b32 v84, v84, v85, s52 bitop3:0xa8
  v_cmp_ne_u32 vcc, 0, v84
  s_nop 4
  v_add_f32_dpp v56, v56, v56 row_ror:8 row_mask:0xf bank_mask:0xf
  v_add_f32_dpp v57, v57, v57 row_ror:8 row_mask:0xf bank_mask:0xf
  v_add_f32_dpp v58, v58, v58 row_ror:8 row_mask:0xf bank_mask:0xf
  v_add_f32_dpp v59, v59, v59 row_ror:8 row_mask:0xf bank_mask:0xf
  v_cvt_pk_bf16_f32 v56, v56, v57
  v_cvt_pk_bf16_f32 v57, v58, v59
  v_min_u32 v56, -2, v56
  s_cbranch_vccz L_c_okA
L_c_pollA:
  buffer_load_dwordx4 v[16:19], v12, s[4:7], s43 offen sc1
  buffer_load_dwordx4 v[20:23], v12, s[4:7], s44 offen sc1
  buffer_load_dwordx4 v[24:27], v12, s[4:7], s45 offen sc1
  buffer_load_dwordx4 v[28:31], v12, s[4:7], s46 offen sc1
  s_sub_u32 s66, s66, 1
  s_cbranch_scc1 L_end
  s_waitcnt vmcnt(3)
  v_mfma_f32_16x16x32_bf16 v[56:59], v[36:39], v[16:19], 0
  s_waitcnt vmcnt(2)
  v_mfma_f32_16x16x32_bf16 v[56:59], v[36:39], v[20:23], v[56:59]
  v_bitop3_b32 v84, v16, v20, s50 bitop3:0x7e
  s_waitcnt vmcnt(1)
  v_mfma_f32_16x16x32_bf16 v[56:59], v[36:39], v[24:27], v[56:59]
  s_waitcnt vmcnt(0)
  v_mfma_f32_16x16x32_bf16 v[56:59], v[36:39], v[28:31], v[56:59]
  v_bitop3_b32 v85, v24, v28, s50 bitop3:0x7e
  v_bitop3_b32 v84, v84, v85, s52 bitop3:0xa8
  v_cmp_ne_u32 vcc, 0, v84
  s_nop 4
  v_add_f32_dpp v56, v56, v56 row_ror:8 row_mask:0xf bank_mask:0xf
  v_add_f32_dpp v57, v57, v57 row_ror:8 row_mask:0xf bank_mask:0xf
  v_add_f32_dpp v58, v58, v58 row_ror:8 row_mask:0xf bank_mask:0xf
  v_add_f32_dpp v59, v59, v59 row_ror:8 row_mask:0xf bank_mask:0xf
  v_cvt_pk_bf16_f32 v56, v56, v57
  v_cvt_pk_bf16_f32 v57, v58, v59
  v_min_u32 v56, -2, v56
  s_cbranch_vccnz L_c_pollA
  s_branch L_c_okA
  s_nop 0
  s_nop 0
  s_nop 0
L_c_h23:
  v_mov_b32_dpp v36, v16 quad_perm:[0,0,2,2] row_mask:0xf bank_mask:0xf
  v_mov_b32_dpp v37, v17 quad_perm:[0,0,2,2] row_mask:0xf bank_mask:0xf
  v_mov_b32_dpp v38, v16 quad_perm:[1,1,3,3] row_mask:0xf bank_mask:0xf
  v_mov_b32_dpp v39, v17 quad_perm:[1,1,3,3] row_mask:0xf bank_mask:0xf
  s_add_u32 s61, s61, 0x80000
  s_add_u32 s62, s62, 0x80000
  v_smfmac_f32_16x16x64_bf16 v[64:67], v[36:39], a[0:7], v1
  v_smfmac_f32_16x16x64_bf16 v[68:71], v[36:39], a[8:15], v1
  s_waitcnt lgkmcnt(0)
  s_barrier
  ds_read_b128 v[20:23], v14
  ds_read_b128 v[24:27], v9
  ds_read_b128 v[28:31], v5
  v_mov_b32 v32, 0xfffe0000
  s_add_u32 s63, s63, 0x20000
  s_add_u32 s81, s81, 0x20000
  s_waitcnt lgkmcnt(2)
  v_smfmac_f32_16x16x64_bf16 v[64:67], v[20:23], a[16:23], v1
  s_waitcnt lgkmcnt(1)
  v_smfmac_f32_16x16x64_bf16 v[64:67], v[24:27], a[24:31], v1
  s_nop 0
  s_waitcnt lgkmcnt(0)
  v_smfmac_f32_16x16x64_bf16 v[64:67], v[28:31], a[32:39], v1
  v_smfmac_f32_16x16x64_bf16 v[68:71], v[20:23], a[40:47], v1
  v_smfmac_f32_16x16x64_bf16 v[68:71], v[24:27], a[48:55], v1
  v_smfmac_f32_16x16x64_bf16 v[68:71], v[28:31], a[56:63], v1
  v_add_u32 v65, s51, v65
  v_and_or_b32 v65, v65, v32, s50
  v_cvt_pk_bf16_f32 v64, v64, v65
  v_cvt_pk_bf16_f32 v66, v66, v67
  s_nop 3
  v_cvt_pk_bf16_f32 v65, v68, v69
  v_cvt_pk_bf16_f32 v67, v70, v71
  buffer_store_dwordx4 v[64:67], v2, s[4:7], s42 offen
  s_mov_b32 s49, s67
  s_branch L_c_idle0
L_c_idle0:
L_c_idle:
  ds_read_b128 v[40:43], v4 offset:0
  ds_read_b128 v[44:47], v4 offset:1024
  ds_read_b128 v[48:51], v4 offset:2048
  ds_read_b128 v[52:55], v4 offset:3072
  s_add_u32 s41, s49, 3
  s_and_b32 s41, s41, 3
  s_lshl_b32 s41, s41, 13
  s_add_u32 s55, s41, s57
  s_add_u32 s53, s41, s47
  s_xor_b32 s41, s41, 0x4000
  s_add_u32 s54, s41, s47
  s_waitcnt vmcnt(2)
  s_branch L_c_nored
  s_nop 0
L_c_x3:
  s_movk_i32 m0, 0x2000
  s_nop 0
  buffer_load_dwordx4 v2, s[4:7], s59 offen offset:1024 sc1 lds
  s_branch L_c_nx3
  s_nop 0
L_c_remretry:
  s_cmp_lg_u32 s12, 3
  s_cbranch_scc1 L_c_rr1
  s_movk_i32 m0, 0x2000
  s_nop 0
  buffer_load_dwordx4 v2, s[4:7], s59 offen offset:1024 sc1 lds
L_c_rr1:
  s_mov_b32 m0, s37
  s_nop 0
  buffer_load_dwordx4 v2, s[4:7], s59 offen sc1 lds
  s_sub_u32 s66, s66, 1
  s_cbranch_scc1 L_end
  s_waitcnt vmcnt(0)
  ds_read_b128 v[80:83], v2 offset:4096
  ds_read_b128 v[84:87], v0 offset:9216
  s_waitcnt lgkmcnt(0)
  v_max_u32 v76, v84, v86
  v_and_b32 v76, s60, v76
  v_max3_u32 v76, v76, v80, v82
  v_cmp_eq_u32 vcc, -1, v76
  s_cbranch_vccnz L_c_remretry
  s_branch L_c_remok
L_c_vm:
  s_mov_b64 exec, s[68:69]
  buffer_store_dwordx2 v[34:35], v3, s[4:7], s64 offen sc1
  s_mov_b64 exec, -1
  s_branch L_c_vmx
L_c_kvspin:
  s_add_u32 s40, s49, 1
  s_lshr_b32 s3, s40, 2
  s_and_b32 s40, s40, 3
  s_lshl_b32 s40, s40, 6
  s_add_u32 s15, s80, s40
L_c_kvspin2:
  s_mov_b64 exec, 3
  buffer_load_dword v15, v0, s[4:7], s15 offen sc1
  s_mov_b64 exec, -1
  s_sub_u32 s66, s66, 1
  s_cbranch_scc1 L_end
  s_waitcnt vmcnt(0)
  v_cmp_ge_u32 s[78:79], s3, v15
  s_nop 0
  s_and_b32 s40, s78, 3
  s_cbranch_scc1 L_c_kvspin2
  s_branch L_c_kvok
  s_nop 0
  s_nop 0
  s_nop 0
L_c_Bretry:
  s_cmp_lg_u32 s12, 2
  s_cbranch_scc1 L_c_br1
  buffer_load_dwordx4 v[84:87], v2, s[4:7], s55 offen offset:2048 sc1
L_c_br1:
  buffer_load_dwordx4 v[64:67], v2, s[4:7], s55 offen sc1
  s_sub_u32 s66, s66, 1
  s_cbranch_scc1 L_end
  s_nop 3
  v_mov_b64 v[16:17], 0
  v_mov_b64 v[18:19], 0
  v_mov_b64 v[20:21], 0
  v_mov_b64 v[22:23], 0
  s_branch L_c_pollB
L_c_last:
  s_mov_b64 exec, s[74:75]
  buffer_store_dwordx4 v[84:87], v5, s[4:7], s63 offen sc1
  s_mov_b64 exec, -1
  v_smfmac_f32_16x16x64_bf16 v[60:63], v[68:71], v[216:223], v1
  v_smfmac_f32_16x16x64_bf16 v[56:59], v[72:75], v[224:231], v1
  v_smfmac_f32_16x16x64_bf16 v[60:63], v[72:75], v[232:239], v1
  v_smfmac_f32_16x16x64_bf16 v[56:59], v[64:67], v[240:247], v1
  v_smfmac_f32_16x16x64_bf16 v[60:63], v[64:67], v[248:255], v1
  s_nop 3
  v_add_f32 v56, v56, v57
  v_add_f32 v58, v58, v59
  s_nop 1
  v_add_f32 v60, v60, v61
  v_add_f32 v62, v62, v63
  v_cvt_pk_bf16_f32 v56, v56, v58
  v_cvt_pk_bf16_f32 v57, v60, v62
  v_min_u32 v56, -2, v56
  s_mov_b64 exec, s[68:69]
  buffer_store_dwordx2 v[56:57], v3, s[4:7], s64 offen sc1
  s_mov_b64 exec, -1
  s_waitcnt vmcnt(0) lgkmcnt(0)
  s_branch L_end
  s_nop 0
L_c_run_s:
  s_and_b32 s81, s81, 0x2000
  s_add_u32 s58, s58, s81
  s_add_u32 s59, s59, s81
  s_add_u32 s58, s58, 0x8000
  s_mov_b32 s32, 0
  s_mov_b32 s33, 0x28000000
  s_lshl_b32 s37, s12, 10
  s_add_u32 s37, s37, 4096
  s_mov_b32 s65, m0
  s_cmp_eq_u32 s12, 3
  s_cselect_b32 s60, -1, 0
  s_mov_b32 s81, s64
  s_mov_b32 s64, 1638400
  s_mov_b32 s34, 0x3e0293ee
  s_mov_b32 s35, 0x3e0293ee
  s_add_u32 s40, s49, 0
  s_lshr_b32 s3, s40, 2
  s_and_b32 s40, s40, 3
  s_lshl_b32 s40, s40, 6
  s_add_u32 s15, s80, s40
  v_cmp_ge_u32 s[78:79], s3, v15
  s_nop 0
  s_or_b32 s40, s78, s2
  s_and_b32 s40, s40, 0x33
  s_cbranch_scc0 L_c_kv0x_s
L_c_kv0_s:
  s_mov_b64 exec, 3
  buffer_load_dword v15, v0, s[4:7], s15 offen sc1
  s_mov_b64 exec, -1
  s_sub_u32 s66, s66, 1
  s_cbranch_scc1 L_end
  s_waitcnt vmcnt(0)
  v_cmp_ge_u32 s[78:79], s3, v15
  s_nop 0
  s_and_b32 s40, s78, 3
  s_cbranch_scc1 L_c_kv0_s
  s_add_u32 s40, s49, 1
  s_lshr_b32 s3, s40, 2
  s_and_b32 s40, s40, 3
  s_lshl_b32 s40, s40, 6
  s_add_u32 s15, s80, s40
L_c_kv1_s:
  s_mov_b64 exec, 3
  buffer_load_dword v15, v0, s[4:7], s15 offen sc1
  s_mov_b64 exec, -1
  s_sub_u32 s66, s66, 1
  s_cbranch_scc1 L_end
  s_waitcnt vmcnt(0)
  v_cmp_ge_u32 s[78:79], s3, v15
  s_nop 0
  s_and_b32 s40, s78, 3
  s_cbranch_scc1 L_c_kv1_s
L_c_kv0x_s:
  buffer_load_dwordx4 v[88:91], v0, s[4:7], s61 offen offset:0 sc1
  buffer_load_dwordx4 v[92:95], v0, s[4:7], s61 offen offset:1024 sc1
  s_add_u32 s61, s61, 0x80000
  s_waitcnt lgkmcnt(0)
  s_barrier
  ds_read_b128 v[40:43], v4 offset:0
  ds_read_b128 v[44:47], v4 offset:1024
  ds_read_b128 v[48:51], v4 offset:2048
  ds_read_b128 v[52:55], v4 offset:3072
  s_add_u32 s41, s49, 3
  s_and_b32 s41, s41, 3
  s_lshl_b32 s41, s41, 13
  s_add_u32 s55, s41, s57
  s_add_u32 s53, s41, s47
  s_xor_b32 s41, s41, 0x4000
  s_add_u32 s54, s41, s47
  s_xor_b32 s55, s59, 0x4000
  s_waitcnt lgkmcnt(0)
  s_branch L_c_loop_s
  s_nop 0
  s_nop 0
  s_nop 0
  s_nop 0
  s_nop 0
  s_nop 0
L_c_loop_s:
  v_cmp_ge_u32 s[78:79], s3, v15
  s_and_b32 s40, s49, 1
  s_lshl_b32 s51, s40, 16
  s_xor_b32 s50, s51, 0x10000
  s_add_u32 s67, s49, 1
  v_xor_b32 v14, 1024, v2
  v_xor_b32 v9, 2048, v2
  v_xor_b32 v5, 3072, v2
  v_mov_b64 v[16:17], 0
  v_mov_b64 v[18:19], 0
  v_mov_b64 v[20:21], 0
  v_mov_b64 v[22:23], 0
  v_mov_b64 v[24:25], 0
  v_mov_b64 v[26:27], 0
  v_mov_b64 v[28:29], 0
  v_mov_b64 v[30:31], 0
  v_mov_b64 v[56:57], 0
  v_mov_b64 v[58:59], 0
  v_mov_b64 v[60:61], 0
  v_mov_b64 v[62:63], 0
  s_cmp_lg_u32 s49, 63
  s_cselect_b32 s40, 3, 0
  s_and_b32 s40, s78, s40
  s_cbranch_scc1 L_c_kvspin_s
L_c_kvok_s:
  s_add_u32 s40, s49, 2
  s_lshr_b32 s3, s40, 2
  s_and_b32 s40, s40, 3
  s_lshl_b32 s40, s40, 6
  s_add_u32 s15, s80, s40
  s_cmp_lg_u32 s12, 2
  s_cbranch_scc1 L_c_nx1_s
  buffer_load_dwordx4 v[84:87], v2, s[4:7], s55 offen offset:2048 sc1
L_c_nx1_s:
  buffer_load_dwordx4 v[64:67], v2, s[4:7], s55 offen sc1
  v_mov_b32_e64 v80, 0
  s_waitcnt lgkmcnt(0)
L_c_pollB_s:
  s_cmp_lg_u32 s12, 2
  s_cbranch_scc1 L_c_nx2_s
  s_waitcnt vmcnt(1)
  ds_write_b128 v2, v[84:87] offset:6144
  v_max_u32 v80, v84, v86
L_c_nx2_s:
  s_waitcnt vmcnt(0)
  ds_write_b128 v2, v[64:67]
  v_max3_u32 v76, v64, v66, v80
  v_cmp_eq_u32 vcc, -1, v76
  v_smfmac_f32_16x16x64_bf16 v[16:19], v[64:67], v[40:47], v1
  v_smfmac_f32_16x16x64_bf16 v[20:23], v[64:67], v[48:55], v1
  s_cbranch_vccnz L_c_Bretry_s
  v_smfmac_f32_16x16x64_bf16 v[24:27], v[64:67], a[64:71], v1
  s_waitcnt lgkmcnt(0)
  s_barrier
  ds_read_b128 v[76:79], v0 offset:8192
  ds_read_b128 v[68:71], v14 offset:0
  ds_read_b128 v[72:75], v9 offset:0
  v_smfmac_f32_16x16x64_bf16 v[28:31], v[64:67], a[72:79], v1
  ds_read_b128 v[40:43], v4 offset:4096
  v_smfmac_f32_16x16x64_bf16 v[56:59], v[64:67], a[80:87], v1
  s_mov_b32 m0, s37
  s_cmp_eq_u32 s12, 3
  buffer_load_dwordx4 v2, s[4:7], s59 offen sc1 lds
  s_cbranch_scc1 L_c_x3_s
L_c_nx3_s:
  v_smfmac_f32_16x16x64_bf16 v[60:63], v[64:67], a[88:95], v1
  ds_read_b128 v[64:67], v5 offset:0
  s_waitcnt lgkmcnt(4)
  v_smfmac_f32_16x16x64_bf16 v[16:19], v[76:79], a[96:103], v1
  s_nop 0
  ds_read_b128 v[44:47], v4 offset:5120
  v_smfmac_f32_16x16x64_bf16 v[20:23], v[76:79], a[104:111], v1
  s_nop 0
  ds_read_b128 v[48:51], v4 offset:6144
  v_smfmac_f32_16x16x64_bf16 v[24:27], v[76:79], a[112:119], v1
  s_mov_b64 exec, s[68:69]
  buffer_store_dwordx2 v[34:35], v3, s[4:7], s64 offen sc1
  s_mov_b64 exec, -1
  s_mov_b32 s64, s81
  v_smfmac_f32_16x16x64_bf16 v[28:31], v[76:79], a[120:127], v1
  ds_read_b128 v[52:55], v4 offset:7168
  s_waitcnt lgkmcnt(2)
  v_smfmac_f32_16x16x64_bf16 v[56:59], v[76:79], v[40:47], v1
  ds_read_b128 v[40:43], v4 offset:8192
  v_smfmac_f32_16x16x64_bf16 v[60:63], v[76:79], a[128:135], v1
  ds_read_b128 v[44:47], v4 offset:9216
  v_smfmac_f32_16x16x64_bf16 v[16:19], v[68:71], a[136:143], v1
  buffer_load_dwordx4 v[32:35], v0, s[4:7], s62 offen offset:2048 sc1
  s_waitcnt lgkmcnt(2)
  v_smfmac_f32_16x16x64_bf16 v[20:23], v[68:71], v[48:55], v1
  s_nop 0
  ds_read_b128 v[48:51], v4 offset:10240
  v_smfmac_f32_16x16x64_bf16 v[24:27], v[68:71], a[144:151], v1
  ds_read_b128 v[52:55], v4 offset:11264
  s_waitcnt lgkmcnt(2)
  v_smfmac_f32_16x16x64_bf16 v[28:31], v[68:71], v[40:47], v1
  s_nop 0
  ds_read_b128 v[40:43], v4 offset:12288
  v_smfmac_f32_16x16x64_bf16 v[56:59], v[68:71], a[152:159], v1
  buffer_load_dwordx4 v[36:39], v0, s[4:7], s62 offen offset:3072 sc1
  v_smfmac_f32_16x16x64_bf16 v[60:63], v[68:71], a[160:167], v1
  ds_read_b128 v[44:47], v4 offset:13312
  s_waitcnt lgkmcnt(2)
  v_smfmac_f32_16x16x64_bf16 v[16:19], v[72:75], v[48:55], v1
  s_nop 0
  ds_read_b128 v[48:51], v4 offset:14336
  v_smfmac_f32_16x16x64_bf16 v[20:23], v[72:75], a[168:175], v1
  ds_read_b128 v[52:55], v4 offset:15360
  v_smfmac_f32_16x16x64_bf16 v[24:27], v[72:75], a[176:183], v1
  s_nop 0
  s_waitcnt lgkmcnt(2)
  v_smfmac_f32_16x16x64_bf16 v[28:31], v[72:75], v[40:47], v1
  s_nop 0
  ds_read_b128 v[40:43], v4 offset:16384
  v_smfmac_f32_16x16x64_bf16 v[56:59], v[72:75], a[184:191], v1
  s_waitcnt vmcnt(3)
  ds_read_b128 v[80:83], v2 offset:4096
  ds_read_b128 v[84:87], v0 offset:9216
  s_waitcnt lgkmcnt(3)
  v_smfmac_f32_16x16x64_bf16 v[60:63], v[72:75], v[48:55], v1
  s_nop 0
  ds_read_b128 v[44:47], v4 offset:17408
  v_smfmac_f32_16x16x64_bf16 v[16:19], v[64:67], a[192:199], v1
  ds_read_b128 v[48:51], v4 offset:18432
  v_smfmac_f32_16x16x64_bf16 v[20:23], v[64:67], a[200:207], v1
  ds_read_b128 v[52:55], v4 offset:19456
  s_waitcnt lgkmcnt(3)
  v_max_u32 v76, v84, v86
  v_and_b32_e64 v76, s60, v76
  v_smfmac_f32_16x16x64_bf16 v[24:27], v[64:67], a[208:215], v1
  v_max3_u32 v76, v76, v80, v82
  s_waitcnt lgkmcnt(2)
  v_smfmac_f32_16x16x64_bf16 v[28:31], v[64:67], v[40:47], v1
  s_nop 0
  ds_read_b128 v[40:43], v4 offset:20480
  v_cmp_eq_u32 vcc, -1, v76
  v_smfmac_f32_16x16x64_bf16 v[56:59], v[64:67], a[216:223], v1
  ds_read_b128 v[44:47], v4 offset:21504
  s_waitcnt lgkmcnt(2)
  v_smfmac_f32_16x16x64_bf16 v[60:63], v[64:67], v[48:55], v1
  s_cbranch_vccnz L_c_remretry_s
L_c_remok_s:
  s_barrier
  ds_read_b128 v[76:79], v0 offset:9216
  v_smfmac_f32_16x16x64_bf16 v[16:19], v[80:83], a[224:231], v1
  s_add_u32 s59, s59, 0x8000
  ds_read_b128 v[68:71], v14 offset:4096
  v_smfmac_f32_16x16x64_bf16 v[20:23], v[80:83], a[232:239], v1
  s_mov_b32 m0, s65
  ds_read_b128 v[72:75], v9 offset:4096
  s_waitcnt lgkmcnt(3)
  v_smfmac_f32_16x16x64_bf16 v[24:27], v[80:83], v[40:47], v1
  ds_read_b128 v[64:67], v5 offset:4096
  v_smfmac_f32_16x16x64_bf16 v[28:31], v[80:83], a[240:247], v1
  ds_read_b128 v[48:51], v4 offset:22528
  v_lshrrev_b32 v5, 1, v0
  s_waitcnt lgkmcnt(4)
  v_smfmac_f32_16x16x64_bf16 v[16:19], v[76:79], a[248:255], v1
  ds_read_b128 v[52:55], v4 offset:23552
  v_and_b32 v5, 0x1e0, v5
  v_smfmac_f32_16x16x64_bf16 v[20:23], v[76:79], v[96:103], v1
  ds_read_b128 v[40:43], v4 offset:24576
  v_and_or_b32 v5, v0, 16, v5
  v_smfmac_f32_16x16x64_bf16 v[24:27], v[76:79], v[104:111], v1
  s_nop 0
  ds_read_b128 v[44:47], v4 offset:25600
  v_xor_b32 v14, 512, v8
  v_smfmac_f32_16x16x64_bf16 v[28:31], v[76:79], v[112:119], v1
  s_mov_b64 exec, 3
  buffer_load_dword v15, v0, s[4:7], s15 offen sc1
  s_mov_b64 exec, -1
  v_xor_b32 v9, 1024, v8
  s_waitcnt lgkmcnt(2)
  v_smfmac_f32_16x16x64_bf16 v[16:19], v[68:71], v[48:55], v1
  s_nop 0
  ds_read_b128 v[48:51], v4 offset:26624
  v_smfmac_f32_16x16x64_bf16 v[16:19], v[72:75], v[120:127], v1
  ds_read_b128 v[52:55], v4 offset:27648
  s_waitcnt lgkmcnt(2)
  v_smfmac_f32_16x16x64_bf16 v[16:19], v[64:67], v[40:47], v1
  ds_read_b128 v[40:43], v4 offset:28672
  v_smfmac_f32_16x16x64_bf16 v[20:23], v[68:71], v[128:135], v1
  ds_read_b128 v[44:47], v4 offset:29696
  v_smfmac_f32_16x16x64_bf16 v[20:23], v[72:75], v[136:143], v1
  v_add_f32 v16, v16, v17
  s_waitcnt lgkmcnt(2)
  v_smfmac_f32_16x16x64_bf16 v[20:23], v[64:67], v[48:55], v1
  ds_read_b128 v[48:51], v4 offset:30720
  v_add_f32_e64 v18, v18, v19
  v_smfmac_f32_16x16x64_bf16 v[24:27], v[68:71], v[144:151], v1
  ds_read_b128 v[52:55], v4 offset:31744
  v_cvt_pk_bf16_f32 v17, v16, v18
  v_smfmac_f32_16x16x64_bf16 v[24:27], v[72:75], v[152:159], v1
  v_add_f32 v20, v20, v21
  v_smfmac_f32_16x16x64_bf16 v[24:27], v[64:67], v[160:167], v1
  v_add_f32 v22, v22, v23
  v_smfmac_f32_16x16x64_bf16 v[28:31], v[68:71], v[168:175], v1
  v_cvt_pk_bf16_f32 v16, v20, v22
  v_smfmac_f32_16x16x64_bf16 v[28:31], v[72:75], v[176:183], v1
  v_add_f32 v24, v24, v25
  v_smfmac_f32_16x16x64_bf16 v[28:31], v[64:67], v[184:191], v1
  v_add_f32 v26, v26, v27
  v_mfma_f32_16x16x16_bf16 v[20:23], v[16:17], v[10:11], 0
  v_cvt_pk_bf16_f32 v25, v24, v26
  s_nop 0
  s_nop 0
  s_nop 0
  v_add_f32 v28, v28, v29
  v_add_f32_e64 v30, v30, v31
  v_cvt_pk_bf16_f32 v24, v28, v30
  s_mov_b64 vcc, s[72:73]
  s_nop 0
  v_mfma_f32_16x16x16_bf16 v[28:31], v[24:25], v[10:11], 0
  v_smfmac_f32_16x16x64_bf16 v[56:59], v[80:83], v[192:199], v1
  v_smfmac_f32_16x16x64_bf16 v[60:63], v[80:83], v[200:207], v1
  v_cvt_pk_bf16_f32 v84, v20, v28
  v_cvt_pk_bf16_f32 v85, v21, v29
  v_cvt_pk_bf16_f32 v86, v22, v30
  v_cvt_pk_bf16_f32 v87, v23, v31
  s_nop 0
  s_nop 0
  v_mfma_f32_16x16x32_bf16 v[28:31], v[84:87], v[84:87], 0
  v_mfma_f32_16x16x32_bf16 v[20:23], v[84:87], v[88:91], 0
  v_mfma_f32_16x16x32_bf16 v[24:27], v[84:87], v[92:95], 0
  buffer_load_dwordx4 v[88:91], v0, s[4:7], s61 offen offset:0 sc1
  v_cndmask_b32_dpp v30, v31, v30, vcc quad_perm:[2,3,0,1] row_mask:0xf bank_mask:0xf
  s_waitcnt lgkmcnt(2)
  v_smfmac_f32_16x16x64_bf16 v[56:59], v[76:79], v[40:47], v1
  ds_write_b32 v7, v30
  ds_write_addtid_b32 v22
  ds_write_addtid_b32 v23 offset:288
  s_waitcnt lgkmcnt(3)
  v_smfmac_f32_16x16x64_bf16 v[60:63], v[76:79], v[48:55], v1
  ds_write_addtid_b32 v26 offset:640
  ds_write_addtid_b32 v27 offset:928
  v_smfmac_f32_16x16x64_bf16 v[56:59], v[68:71], v[208:215], v1
  s_cmp_eq_u32 s49, 63
  v_min_u32_e64 v84, -2, v84
  s_cbranch_scc1 L_c_last_s
  s_mov_b64 vcc, s[76:77]
  s_bitcmp1_b64 s[32:33], s49
  v_smfmac_f32_16x16x64_bf16 v[60:63], v[68:71], v[216:223], v1
  s_waitcnt lgkmcnt(0)
  s_barrier
  ds_read_b128 v[76:79], v0 offset:14976
  ds_read_b128 v[16:19], v6 offset:0
  ds_read_b128 v[20:23], v6 offset:1184
  ds_read_b128 v[24:27], v6 offset:2368
  ds_read_b128 v[28:31], v6 offset:3552
  v_smfmac_f32_16x16x64_bf16 v[56:59], v[72:75], v[224:231], v1
  buffer_load_dwordx4 v[92:95], v0, s[4:7], s61 offen offset:1024 sc1
  v_mov_b64 v[68:69], 0
  v_smfmac_f32_16x16x64_bf16 v[60:63], v[72:75], v[232:239], v1
  s_mov_b64 exec, s[74:75]
  buffer_store_dwordx4 v[84:87], v5, s[4:7], s63 offen sc1
  s_mov_b64 exec, -1
  v_mov_b64 v[70:71], 0
  v_smfmac_f32_16x16x64_bf16 v[56:59], v[64:67], v[240:247], v1
  ds_read_b128 v[40:43], v4 offset:32768
  v_mov_b64_e64 v[72:73], 0
  v_smfmac_f32_16x16x64_bf16 v[60:63], v[64:67], v[248:255], v1
  ds_read_b128 v[44:47], v4 offset:33792
  v_mov_b64 v[74:75], 0
  v_mov_b64 v[64:65], 0
  v_mov_b64 v[66:67], 0
  s_waitcnt lgkmcnt(6)
  v_pk_add_f32 v[76:77], v[76:77], v[78:79]
  s_waitcnt lgkmcnt(4)
  v_pk_add_f32 v[16:17], v[16:17], v[20:21]
  v_pk_add_f32 v[18:19], v[18:19], v[22:23]
  v_add_f32 v20, v76, v77
  s_waitcnt lgkmcnt(3)
  v_pk_add_f32 v[16:17], v[16:17], v[24:25]
  v_pk_add_f32 v[18:19], v[18:19], v[26:27]
  s_waitcnt lgkmcnt(2)
  v_pk_add_f32 v[16:17], v[16:17], v[28:29]
  v_pk_add_f32 v[18:19], v[18:19], v[30:31]
  v_max3_f32 v22, v16, v17, v20
  v_max3_f32 v22, v22, v18, v19
  v_add_f32 v56, v56, v57
  v_add_f32 v58, v58, v59
  v_max_f32_dpp v22, v22, v22 quad_perm:[1,0,3,2] row_mask:0xf bank_mask:0xf
  v_mov_b32 v21, v22
  v_add_f32 v60, v60, v61
  v_add_f32 v62, v62, v63
  v_permlane16_swap_b32 v22, v21
  v_max_f32 v22, v22, v21
  v_mov_b32 v21, v22
  v_cvt_pk_bf16_f32 v84, v56, v58
  v_cvt_pk_bf16_f32 v86, v60, v62
  v_permlane32_swap_b32 v22, v21
  v_max_f32 v22, v22, v21
  v_mul_f32_e64 v22, s34, v22
  v_pk_fma_f32 v[16:17], v[16:17], s[34:35], v[22:23] op_sel_hi:[1,1,0] neg_lo:[0,0,1] neg_hi:[0,0,1]
  v_pk_fma_f32 v[18:19], v[18:19], s[34:35], v[22:23] op_sel_hi:[1,1,0] neg_lo:[0,0,1] neg_hi:[0,0,1]
  v_exp_f32 v16, v16
  v_exp_f32 v17, v17
  v_exp_f32_e64 v18, v18
  v_exp_f32_e64 v19, v19
  v_cvt_pk_bf16_f32 v76, v16, v17
  v_cvt_pk_bf16_f32 v77, v18, v19
  v_fma_f32 v20, v20, s34, -v22
  v_mov_b32_dpp v78, v76 quad_perm:[1,0,3,2] row_mask:0xf bank_mask:0xf
  v_mov_b32_dpp v79, v77 quad_perm:[1,0,3,2] row_mask:0xf bank_mask:0xf
  v_exp_f32 v20, v20
  v_add_f32_e64 v16, v16, v17
  s_waitcnt vmcnt(5)
  v_mfma_f32_16x16x32_bf16 v[24:27], v[32:35], v[76:79], 0
  ds_read_b128 v[48:51], v4 offset:34816
  v_mov_b32_dpp v21, v20 quad_perm:[1,0,3,2] row_mask:0xf bank_mask:0xf
  v_cvt_pk_bf16_f32 v80, v20, v21
  s_waitcnt vmcnt(4)
  v_mfma_f32_16x16x32_bf16 v[28:31], v[36:39], v[76:79], 0
  ds_read_b128 v[52:55], v4 offset:35840
  v_mov_b32 v81, 0
  v_add_f32 v18, v18, v19
  v_add_f32 v16, v16, v20
  v_mfma_f32_16x16x16_bf16 v[24:27], v[84:85], v[80:81], v[24:27]
  ds_read_b128 v[56:59], v4 offset:36864
  v_add_f32_e64 v16, v16, v18
  v_mfma_f32_16x16x16_bf16 v[28:31], v[86:87], v[80:81], v[28:31]
  ds_read_b128 v[60:63], v4 offset:37888
  v_add_f32_dpp v16, v16, v16 quad_perm:[1,0,3,2] row_mask:0xf bank_mask:0xf
  v_mov_b32 v21, v16
  v_xor_b32 v5, 1536, v8
  v_mov_b32 v35, v86
  v_permlane16_swap_b32 v16, v21
  v_add_f32 v16, v16, v21
  v_mov_b32 v21, v16
  v_min_u32 v34, -2, v84
  s_cbranch_scc1 L_c_vm_s
L_c_vmx_s:
  v_permlane32_swap_b32 v16, v21
  v_add_f32 v16, v16, v21
  v_rcp_f32 v20, v16
  v_cndmask_b32_dpp v24, v28, v24, vcc quad_perm:[1,0,3,2] row_mask:0xf bank_mask:0xf
  v_cndmask_b32_dpp v25, v29, v25, vcc quad_perm:[1,0,3,2] row_mask:0xf bank_mask:0xf
  v_cndmask_b32_dpp v26, v30, v26, vcc quad_perm:[1,0,3,2] row_mask:0xf bank_mask:0xf
  v_cndmask_b32_dpp v27, v31, v27, vcc quad_perm:[1,0,3,2] row_mask:0xf bank_mask:0xf
  v_pk_mul_f32 v[24:25], v[24:25], v[20:21] op_sel_hi:[1,0]
  v_pk_mul_f32 v[26:27], v[26:27], v[20:21] op_sel_hi:[1,0]
  v_cvt_pk_bf16_f32 v16, v24, v25
  v_cvt_pk_bf16_f32 v17, v26, v27
  s_cmp_ge_u32 s12, 2
  ds_write_b64 v3, v[16:17]
  s_cbranch_scc1 L_c_h23_s
  v_mov_b32_dpp v36, v16 quad_perm:[0,0,2,2] row_mask:0xf bank_mask:0xf
  v_mov_b32_dpp v37, v17 quad_perm:[0,0,2,2] row_mask:0xf bank_mask:0xf
  v_mov_b32_dpp v38, v16 quad_perm:[1,1,3,3] row_mask:0xf bank_mask:0xf
  v_mov_b32_dpp v39, v17 quad_perm:[1,1,3,3] row_mask:0xf bank_mask:0xf
  s_add_u32 s61, s61, 0x80000
  s_add_u32 s62, s62, 0x80000
  s_waitcnt lgkmcnt(5)
  v_smfmac_f32_16x16x64_bf16 v[72:75], v[36:39], v[40:47], v1
  s_nop 0
  v_smfmac_f32_16x16x64_bf16 v[64:67], v[36:39], a[0:7], v1
  s_waitcnt lgkmcnt(0)
  s_barrier
  ds_read_b128 v[20:23], v14
  ds_read_b128 v[24:27], v9
  ds_read_b128 v[28:31], v5
  ds_read_b128 v[40:43], v4 offset:38912
  ds_read_b128 v[44:47], v4 offset:39936
  v_smfmac_f32_16x16x64_bf16 v[68:71], v[36:39], a[8:15], v1
  v_mov_b32 v32, 0xfffe0000
  s_add_u32 s63, s63, 0x20000
  s_add_u32 s81, s81, 0x20000
  s_waitcnt lgkmcnt(4)
  v_smfmac_f32_16x16x64_bf16 v[72:75], v[20:23], v[48:55], v1
  s_waitcnt lgkmcnt(3)
  v_smfmac_f32_16x16x64_bf16 v[72:75], v[24:27], v[56:63], v1
  v_smfmac_f32_16x16x64_bf16 v[64:67], v[20:23], a[16:23], v1
  s_waitcnt lgkmcnt(0)
  v_smfmac_f32_16x16x64_bf16 v[72:75], v[28:31], v[40:47], v1
  v_smfmac_f32_16x16x64_bf16 v[64:67], v[24:27], a[24:31], v1
  s_nop 0
  v_smfmac_f32_16x16x64_bf16 v[64:67], v[28:31], a[32:39], v1
  v_add_u32_e64 v73, s51, v73
  v_and_or_b32 v73, v73, v32, s50
  v_smfmac_f32_16x16x64_bf16 v[68:71], v[20:23], a[40:47], v1
  v_cvt_pk_bf16_f32 v72, v72, v73
  v_cvt_pk_bf16_f32 v74, v74, v75
  v_smfmac_f32_16x16x64_bf16 v[68:71], v[24:27], a[48:55], v1
  v_mov_b32_dpp v73, v72 quad_perm:[1,0,3,2] row_mask:0xf bank_mask:0xf
  v_mov_b32_dpp v75, v74 quad_perm:[1,0,3,2] row_mask:0xf bank_mask:0xf
  v_smfmac_f32_16x16x64_bf16 v[68:71], v[28:31], a[56:63], v1
  s_mov_b64 exec, s[76:77]
  buffer_store_dwordx4 v[72:75], v3, s[4:7], s56 offen sc1
  s_mov_b64 exec, -1
  v_add_u32 v65, s51, v65
  v_and_or_b32 v65, v65, v32, s50
  v_cvt_pk_bf16_f32 v64, v64, v65
  v_cvt_pk_bf16_f32 v66, v66, v67
  s_nop 0
  v_cvt_pk_bf16_f32 v65, v68, v69
  v_cvt_pk_bf16_f32 v67, v70, v71
  buffer_store_dwordx4 v[64:67], v2, s[4:7], s42 offen sc1
  s_mov_b32 s49, s67
  v_and_b32 v84, 16, v0
  v_lshlrev_b32_e64 v84, v84, s36
  v_bfe_u32 v85, v0, 5, 3
  v_cmp_eq_u32_e64 vcc, 0, v85
  v_cmp_eq_u32 s[38:39], 1, v85
  v_cmp_eq_u32 s[40:41], 2, v85
  v_cndmask_b32 v36, 0, v84, vcc
  v_cmp_eq_u32 vcc, 3, v85
  v_cndmask_b32 v37, 0, v84, s[38:39]
  v_cndmask_b32 v38, 0, v84, s[40:41]
  v_cndmask_b32 v39, 0, v84, vcc
  v_mov_b64 v[86:87], -1
  s_cmp_eq_u32 s48, 0
  s_cbranch_scc1 L_c_idle_s
  s_cmp_eq_u32 s12, 1
  s_cbranch_scc1 L_c_pa1_s
  s_nop 0
  s_nop 14
  s_nop 0
  s_nop 0
L_c_pa1_s:
  s_nop 0
  s_nop 14
  s_nop 0
  s_nop 2
  buffer_load_dwordx4 v[16:19], v12, s[4:7], s43 offen sc1
  buffer_load_dwordx4 v[20:23], v12, s[4:7], s44 offen sc1
  buffer_load_dwordx4 v[24:27], v12, s[4:7], s45 offen sc1
  buffer_load_dwordx4 v[28:31], v12, s[4:7], s46 offen sc1
  ds_read_b128 v[40:43], v4 offset:0
  ds_read_b128 v[44:47], v4 offset:1024
  ds_read_b128 v[48:51], v4 offset:2048
  ds_read_b128 v[52:55], v4 offset:3072
  s_add_u32 s41, s49, 3
  s_and_b32 s41, s41, 3
  s_lshl_b32 s41, s41, 13
  s_add_u32 s55, s41, s57
  s_add_u32 s53, s41, s47
  s_xor_b32 s41, s41, 0x4000
  s_add_u32 s54, s41, s47
  s_nop 0
  s_nop 12
  buffer_load_dwordx4 v[64:67], v12, s[4:7], s43 offen sc1
  buffer_load_dwordx4 v[68:71], v12, s[4:7], s44 offen sc1
  buffer_load_dwordx4 v[72:75], v12, s[4:7], s45 offen sc1
  buffer_load_dwordx4 v[76:79], v12, s[4:7], s46 offen sc1
  s_mov_b64 exec, s[70:71]
  buffer_store_dwordx2 v[86:87], v13, s[4:7], s54 offen sc1
  s_mov_b64 exec, -1
  s_waitcnt vmcnt(8)
  v_mfma_f32_16x16x32_bf16 v[56:59], v[36:39], v[16:19], 0
  s_waitcnt vmcnt(7)
  v_mfma_f32_16x16x32_bf16 v[56:59], v[36:39], v[20:23], v[56:59]
  v_bitop3_b32 v84, v16, v20, s50 bitop3:0x7e
  s_waitcnt vmcnt(6)
  v_mfma_f32_16x16x32_bf16 v[56:59], v[36:39], v[24:27], v[56:59]
  s_waitcnt vmcnt(5)
  v_mfma_f32_16x16x32_bf16 v[56:59], v[36:39], v[28:31], v[56:59]
  v_bitop3_b32 v85, v24, v28, s50 bitop3:0x7e
  v_bitop3_b32 v84, v84, v85, s52 bitop3:0xa8
  v_cmp_ne_u32 vcc, 0, v84
  s_nop 0
  s_nop 0
  s_nop 2
  v_add_f32_dpp v56, v56, v56 row_ror:8 row_mask:0xf bank_mask:0xf
  v_add_f32_dpp v57, v57, v57 row_ror:8 row_mask:0xf bank_mask:0xf
  v_add_f32_dpp v58, v58, v58 row_ror:8 row_mask:0xf bank_mask:0xf
  v_add_f32_dpp v59, v59, v59 row_ror:8 row_mask:0xf bank_mask:0xf
  v_cvt_pk_bf16_f32 v56, v56, v57
  v_cvt_pk_bf16_f32 v57, v58, v59
  v_min_u32 v56, -2, v56
  s_cbranch_vccnz L_c_A2_s
L_c_okA_s:
  s_mov_b64 exec, s[70:71]
  buffer_store_dwordx2 v[56:57], v13, s[4:7], s53 offen sc1
  buffer_store_dwordx2 v[56:57], v13, s[4:7], s58 offen sc1
  s_mov_b64 exec, -1
  s_add_u32 s58, s58, 0x8000
L_c_nored_s:
  s_barrier
  s_branch L_c_loop_s
  s_nop 0
L_c_A2_s:
  s_waitcnt vmcnt(1)
  v_mfma_f32_16x16x32_bf16 v[56:59], v[36:39], v[64:67], 0
  v_mfma_f32_16x16x32_bf16 v[56:59], v[36:39], v[68:71], v[56:59]
  v_bitop3_b32 v84, v64, v68, s50 bitop3:0x7e
  v_mfma_f32_16x16x32_bf16 v[56:59], v[36:39], v[72:75], v[56:59]
  v_mfma_f32_16x16x32_bf16 v[56:59], v[36:39], v[76:79], v[56:59]
  v_bitop3_b32 v85, v72, v76, s50 bitop3:0x7e
  v_bitop3_b32 v84, v84, v85, s52 bitop3:0xa8
  v_cmp_ne_u32 vcc, 0, v84
  s_nop 4
  v_add_f32_dpp v56, v56, v56 row_ror:8 row_mask:0xf bank_mask:0xf
  v_add_f32_dpp v57, v57, v57 row_ror:8 row_mask:0xf bank_mask:0xf
  v_add_f32_dpp v58, v58, v58 row_ror:8 row_mask:0xf bank_mask:0xf
  v_add_f32_dpp v59, v59, v59 row_ror:8 row_mask:0xf bank_mask:0xf
  v_cvt_pk_bf16_f32 v56, v56, v57
  v_cvt_pk_bf16_f32 v57, v58, v59
  v_min_u32 v56, -2, v56
  s_cbranch_vccz L_c_okA_s
L_c_pollA_s:
  buffer_load_dwordx4 v[16:19], v12, s[4:7], s43 offen sc1
  buffer_load_dwordx4 v[20:23], v12, s[4:7], s44 offen sc1
  buffer_load_dwordx4 v[24:27], v12, s[4:7], s45 offen sc1
  buffer_load_dwordx4 v[28:31], v12, s[4:7], s46 offen sc1
  s_sub_u32 s66, s66, 1
  s_cbranch_scc1 L_end
  s_waitcnt vmcnt(3)
  v_mfma_f32_16x16x32_bf16 v[56:59], v[36:39], v[16:19], 0
  s_waitcnt vmcnt(2)
  v_mfma_f32_16x16x32_bf16 v[56:59], v[36:39], v[20:23], v[56:59]
  v_bitop3_b32 v84, v16, v20, s50 bitop3:0x7e
  s_waitcnt vmcnt(1)
  v_mfma_f32_16x16x32_bf16 v[56:59], v[36:39], v[24:27], v[56:59]
  s_waitcnt vmcnt(0)
  v_mfma_f32_16x16x32_bf16 v[56:59], v[36:39], v[28:31], v[56:59]
  v_bitop3_b32 v85, v24, v28, s50 bitop3:0x7e
  v_bitop3_b32 v84, v84, v85, s52 bitop3:0xa8
  v_cmp_ne_u32 vcc, 0, v84
  s_nop 4
  v_add_f32_dpp v56, v56, v56 row_ror:8 row_mask:0xf bank_mask:0xf
  v_add_f32_dpp v57, v57, v57 row_ror:8 row_mask:0xf bank_mask:0xf
  v_add_f32_dpp v58, v58, v58 row_ror:8 row_mask:0xf bank_mask:0xf
  v_add_f32_dpp v59, v59, v59 row_ror:8 row_mask:0xf bank_mask:0xf
  v_cvt_pk_bf16_f32 v56, v56, v57
  v_cvt_pk_bf16_f32 v57, v58, v59
  v_min_u32 v56, -2, v56
  s_cbranch_vccnz L_c_pollA_s
  s_branch L_c_okA_s
  s_nop 0
  s_nop 0
  s_nop 0
L_c_h23_s:
  v_mov_b32_dpp v36, v16 quad_perm:[0,0,2,2] row_mask:0xf bank_mask:0xf
  v_mov_b32_dpp v37, v17 quad_perm:[0,0,2,2] row_mask:0xf bank_mask:0xf
  v_mov_b32_dpp v38, v16 quad_perm:[1,1,3,3] row_mask:0xf bank_mask:0xf
  v_mov_b32_dpp v39, v17 quad_perm:[1,1,3,3] row_mask:0xf bank_mask:0xf
  s_add_u32 s61, s61, 0x80000
  s_add_u32 s62, s62, 0x80000
  v_smfmac_f32_16x16x64_bf16 v[64:67], v[36:39], a[0:7], v1
  v_smfmac_f32_16x16x64_bf16 v[68:71], v[36:39], a[8:15], v1
  s_waitcnt lgkmcnt(0)
  s_barrier
  ds_read_b128 v[20:23], v14
  ds_read_b128 v[24:27], v9
  ds_read_b128 v[28:31], v5
  v_mov_b32 v32, 0xfffe0000
  s_add_u32 s63, s63, 0x20000
  s_add_u32 s81, s81, 0x20000
  s_waitcnt lgkmcnt(2)
  v_smfmac_f32_16x16x64_bf16 v[64:67], v[20:23], a[16:23], v1
  s_waitcnt lgkmcnt(1)
  v_smfmac_f32_16x16x64_bf16 v[64:67], v[24:27], a[24:31], v1
  s_nop 0
  s_waitcnt lgkmcnt(0)
  v_smfmac_f32_16x16x64_bf16 v[64:67], v[28:31], a[32:39], v1
  v_smfmac_f32_16x16x64_bf16 v[68:71], v[20:23], a[40:47], v1
  v_smfmac_f32_16x16x64_bf16 v[68:71], v[24:27], a[48:55], v1
  v_smfmac_f32_16x16x64_bf16 v[68:71], v[28:31], a[56:63], v1
  v_add_u32 v65, s51, v65
  v_and_or_b32 v65, v65, v32, s50
  v_cvt_pk_bf16_f32 v64, v64, v65
  v_cvt_pk_bf16_f32 v66, v66, v67
  s_nop 3
  v_cvt_pk_bf16_f32 v65, v68, v69
  v_cvt_pk_bf16_f32 v67, v70, v71
  buffer_store_dwordx4 v[64:67], v2, s[4:7], s42 offen sc1
  s_mov_b32 s49, s67
  s_branch L_c_idle0_s
L_c_idle0_s:
L_c_idle_s:
  ds_read_b128 v[40:43], v4 offset:0
  ds_read_b128 v[44:47], v4 offset:1024
  ds_read_b128 v[48:51], v4 offset:2048
  ds_read_b128 v[52:55], v4 offset:3072
  s_add_u32 s41, s49, 3
  s_and_b32 s41, s41, 3
  s_lshl_b32 s41, s41, 13
  s_add_u32 s55, s41, s57
  s_add_u32 s53, s41, s47
  s_xor_b32 s41, s41, 0x4000
  s_add_u32 s54, s41, s47
  s_waitcnt vmcnt(2)
  s_branch L_c_nored_s
  s_nop 0
L_c_x3_s:
  s_movk_i32 m0, 0x2000
  s_nop 0
  buffer_load_dwordx4 v2, s[4:7], s59 offen offset:1024 sc1 lds
  s_branch L_c_nx3_s
  s_nop 0
L_c_remretry_s:
  s_cmp_lg_u32 s12, 3
  s_cbranch_scc1 L_c_rr1_s
  s_movk_i32 m0, 0x2000
  s_nop 0
  buffer_load_dwordx4 v2, s[4:7], s59 offen offset:1024 sc1 lds
L_c_rr1_s:
  s_mov_b32 m0, s37
  s_nop 0
  buffer_load_dwordx4 v2, s[4:7], s59 offen sc1 lds
  s_sub_u32 s66, s66, 1
  s_cbranch_scc1 L_end
  s_waitcnt vmcnt(0)
  ds_read_b128 v[80:83], v2 offset:4096
  ds_read_b128 v[84:87], v0 offset:9216
  s_waitcnt lgkmcnt(0)
  v_max_u32 v76, v84, v86
  v_and_b32 v76, s60, v76
  v_max3_u32 v76, v76, v80, v82
  v_cmp_eq_u32 vcc, -1, v76
  s_cbranch_vccnz L_c_remretry_s
  s_branch L_c_remok_s
L_c_vm_s:
  s_mov_b64 exec, s[68:69]
  buffer_store_dwordx2 v[34:35], v3, s[4:7], s64 offen sc1
  s_mov_b64 exec, -1
  s_branch L_c_vmx_s
L_c_kvspin_s:
  s_add_u32 s40, s49, 1
  s_lshr_b32 s3, s40, 2
  s_and_b32 s40, s40, 3
  s_lshl_b32 s40, s40, 6
  s_add_u32 s15, s80, s40
L_c_kvspin2_s:
  s_mov_b64 exec, 3
  buffer_load_dword v15, v0, s[4:7], s15 offen sc1
  s_mov_b64 exec, -1
  s_sub_u32 s66, s66, 1
  s_cbranch_scc1 L_end
  s_waitcnt vmcnt(0)
  v_cmp_ge_u32 s[78:79], s3, v15
  s_nop 0
  s_and_b32 s40, s78, 3
  s_cbranch_scc1 L_c_kvspin2_s
  s_branch L_c_kvok_s
  s_nop 0
  s_nop 0
  s_nop 0
L_c_Bretry_s:
  s_cmp_lg_u32 s12, 2
  s_cbranch_scc1 L_c_br1_s
  buffer_load_dwordx4 v[84:87], v2, s[4:7], s55 offen offset:2048 sc1
L_c_br1_s:
  buffer_load_dwordx4 v[64:67], v2, s[4:7], s55 offen sc1
  s_sub_u32 s66, s66, 1
  s_cbranch_scc1 L_end
  s_nop 3
  v_mov_b64 v[16:17], 0
  v_mov_b64 v[18:19], 0
  v_mov_b64 v[20:21], 0
  v_mov_b64 v[22:23], 0
  s_branch L_c_pollB_s
L_c_last_s:
  s_mov_b64 exec, s[74:75]
  buffer_store_dwordx4 v[84:87], v5, s[4:7], s63 offen sc1
  s_mov_b64 exec, -1
  v_smfmac_f32_16x16x64_bf16 v[60:63], v[68:71], v[216:223], v1
  v_smfmac_f32_16x16x64_bf16 v[56:59], v[72:75], v[224:231], v1
  v_smfmac_f32_16x16x64_bf16 v[60:63], v[72:75], v[232:239], v1
  v_smfmac_f32_16x16x64_bf16 v[56:59], v[64:67], v[240:247], v1
  v_smfmac_f32_16x16x64_bf16 v[60:63], v[64:67], v[248:255], v1
  s_nop 3
  v_add_f32 v56, v56, v57
  v_add_f32 v58, v58, v59
  s_nop 1
  v_add_f32 v60, v60, v61
  v_add_f32 v62, v62, v63
  v_cvt_pk_bf16_f32 v56, v56, v58
  v_cvt_pk_bf16_f32 v57, v60, v62
  v_min_u32 v56, -2, v56
  s_mov_b64 exec, s[68:69]
  buffer_store_dwordx2 v[56:57], v3, s[4:7], s64 offen sc1
  s_mov_b64 exec, -1
  s_waitcnt vmcnt(0) lgkmcnt(0)
  s_branch L_end
  s_nop 0
  s_nop 0
  s_nop 0
  s_nop 0
  s_nop 0
L_p_run_s:
  s_lshl_b32 s58, s61, 5
  s_add_u32 s58, s58, s13
  s_and_b32 s59, s52, s15
  s_lshl_b32 s59, s59, 4
  s_add_u32 s59, s59, s58
  s_mul_i32 s74, s59, 1280
  s_lshl_b32 s67, s58, 13
  s_and_b32 s59, s12, 1
  s_lshl_b32 s59, s59, 10
  s_add_u32 s67, s67, s59
  s_add_u32 s67, s67, 16777216
  s_lshl_b32 s68, s58, 14
  s_add_u32 s68, s68, 33554432
  s_lshr_b32 s69, s58, 2
  s_lshl_b32 s69, s69, 14
  s_and_b32 s59, s13, 3
  s_lshl_b32 s59, s59, 11
  s_add_u32 s69, s69, s59
  s_add_u32 s69, s69, 8388608
  s_lshr_b32 s59, s12, 1
  s_lshl_b32 s59, s59, 10
  s_add_u32 s55, s69, s59
  s_add_u32 s55, s55, 0x2000
  s_lshl_b32 s59, s59, 3
  s_add_u32 s75, s68, s59
  buffer_load_dwordx4 v[60:63], v1, s[4:7], s67 offen offset:0 sc1
  buffer_load_dwordx4 v[64:67], v1, s[4:7], s67 offen offset:2048 sc1
  s_add_u32 s67, s67, 4096
  buffer_load_dwordx4 v[68:71], v1, s[4:7], s67 offen offset:0 sc1
  buffer_load_dwordx4 v[72:75], v1, s[4:7], s67 offen offset:2048 sc1
  buffer_load_dwordx4 v[76:79], v1, s[4:7], s68 offen offset:0 sc1
  buffer_load_dwordx4 v[80:83], v1, s[4:7], s68 offen offset:1024 sc1
  buffer_load_dwordx4 v[108:111], v1, s[4:7], s75 offen offset:2048 sc1
  s_add_u32 s68, s68, 4096
  buffer_load_dwordx4 v[84:87], v1, s[4:7], s68 offen offset:0 sc1
  buffer_load_dwordx4 v[88:91], v1, s[4:7], s68 offen offset:1024 sc1
  buffer_load_dwordx4 v[112:115], v1, s[4:7], s75 offen offset:3072 sc1
  s_add_u32 s68, s68, 4096
  s_add_u32 s75, s75, 4096
  buffer_load_dwordx4 v[92:95], v1, s[4:7], s68 offen offset:0 sc1
  buffer_load_dwordx4 v[96:99], v1, s[4:7], s68 offen offset:1024 sc1
  buffer_load_dwordx4 v[116:119], v1, s[4:7], s75 offen offset:2048 sc1
  s_add_u32 s68, s68, 4096
  buffer_load_dwordx4 v[100:103], v1, s[4:7], s68 offen offset:0 sc1
  buffer_load_dwordx4 v[104:107], v1, s[4:7], s68 offen offset:1024 sc1
  buffer_load_dwordx4 v[120:123], v1, s[4:7], s75 offen offset:3072 sc1
  v_lshlrev_b32_e64 v190, 1, v11
  buffer_load_dwordx4 v[168:171], v4, s[4:7], s69 offen offset:0 sc1
  buffer_load_dwordx2 v[184:185], v190, s[4:7], s55 offen offset:0 sc1
  buffer_load_dwordx4 v[172:175], v4, s[4:7], s69 offen offset:512 sc1
  buffer_load_dwordx2 v[186:187], v190, s[4:7], s55 offen offset:512 sc1
  buffer_load_dwordx4 v[176:179], v4, s[4:7], s69 offen offset:1024 sc1
  buffer_load_dwordx4 v[180:183], v4, s[4:7], s69 offen offset:1536 sc1
  s_waitcnt vmcnt(6)
L_p_loop_s:
  v_mfma_f32_16x16x32_bf16 v[124:127], v[76:79], v[60:63], 0
  s_nop 0
  v_mfma_f32_16x16x32_bf16 v[124:127], v[84:87], v[64:67], v[124:127]
  v_mfma_f32_16x16x32_bf16 v[124:127], v[92:95], v[68:71], v[124:127]
  v_mfma_f32_16x16x32_bf16 v[124:127], v[100:103], v[72:75], v[124:127]
  v_mfma_f32_16x16x32_bf16 v[128:131], v[80:83], v[60:63], 0
  v_mfma_f32_16x16x32_bf16 v[128:131], v[88:91], v[64:67], v[128:131]
  v_mfma_f32_16x16x32_bf16 v[128:131], v[96:99], v[68:71], v[128:131]
  v_mfma_f32_16x16x32_bf16 v[128:131], v[104:107], v[72:75], v[128:131]
  v_mov_b32 v3, 0xff800000
  v_cndmask_b32 v124, v3, v124, s[76:77]
  v_cndmask_b32 v125, v3, v125, s[78:79]
  v_cndmask_b32 v126, v3, v126, s[80:81]
  v_cndmask_b32 v127, v3, v127, s[82:83]
  s_nop 0
  s_nop 1
  v_cndmask_b32 v128, v3, v128, s[84:85]
  v_cndmask_b32 v129, v3, v129, s[86:87]
  v_cndmask_b32 v130, v3, v130, s[88:89]
  v_cndmask_b32 v131, v3, v131, s[90:91]
  v_max_f32_e64 v136, v124, v125
  v_max3_f32 v136, v136, v126, v127
  v_max3_f32 v136, v136, v128, v129
  v_max3_f32 v136, v136, v130, v131
  s_branch L_p_km1_s
  s_nop 0
  s_nop 0
  s_nop 0
  s_nop 0
  s_nop 0
  s_nop 0
  s_nop 0
L_p_pr_s:
  s_cmp_ge_u32 s61, 58
  s_cbranch_scc1 L_p_km_s
  s_sleep 2
  v_lshlrev_b32 v190, 1, v11
  s_mov_b32 exec_lo, 1
  s_mov_b32 exec_hi, 1
  buffer_load_dword v188, v190, s[4:7], s55 offen offset:512 sc1
  s_mov_b64 exec, -1
  s_sub_u32 s54, s54, 1
  s_cbranch_scc1 L_end
  s_waitcnt vmcnt(0)
  v_cmp_eq_u32 vcc, -1, v188
  s_nop 0
  s_or_b32 s58, vcc_lo, vcc_hi
  s_bitcmp1_b32 s58, 0
  s_cbranch_scc1 L_p_pr_s
L_p_km_s:
  v_lshlrev_b32 v190, 1, v11
  buffer_load_dwordx4 v[168:171], v4, s[4:7], s69 offen offset:0 sc1
  buffer_load_dwordx2 v[184:185], v190, s[4:7], s55 offen offset:0 sc1
  buffer_load_dwordx4 v[172:175], v4, s[4:7], s69 offen offset:512 sc1
  buffer_load_dwordx2 v[186:187], v190, s[4:7], s55 offen offset:512 sc1
  buffer_load_dwordx4 v[176:179], v4, s[4:7], s69 offen offset:1024 sc1
  buffer_load_dwordx4 v[180:183], v4, s[4:7], s69 offen offset:1536 sc1
L_p_km1_s:
  s_sub_u32 s54, s54, 1
  s_cbranch_scc1 L_end
  s_waitcnt vmcnt(0)
  v_max3_u32 v2, v168, v172, v176
  v_max3_u32 v2, v2, v180, v184
  v_max_u32 v2, v2, v186
  v_cmp_eq_u32 vcc, -1, v2
  s_cbranch_vccnz L_p_pr_s
  buffer_load_dwordx2 v[56:57], v10, s[16:19], s74 offen
  v_mfma_f32_16x16x32_bf16 v[132:135], v[168:171], v[60:63], 0
  v_mfma_f32_16x16x32_bf16 v[132:135], v[172:175], v[64:67], v[132:135]
  v_mfma_f32_16x16x32_bf16 v[132:135], v[176:179], v[68:71], v[132:135]
  v_mfma_f32_16x16x32_bf16 v[132:135], v[180:183], v[72:75], v[132:135]
  s_nop 7
  v_max3_f32 v136, v136, v132, v133
  v_mov_b32 v137, v136
  s_nop 1
  v_permlane16_swap_b32 v136, v137
  v_max_f32 v136, v136, v137
  v_mov_b32 v137, v136
  s_nop 1
  v_permlane32_swap_b32 v136, v137
  v_max_f32 v136, v136, v137
  v_mul_f32 v136, s97, v136
  v_fma_f32 v124, v124, s97, -v136
  v_fma_f32 v125, v125, s97, -v136
  v_fma_f32 v126, v126, s97, -v136
  v_fma_f32 v127, v127, s97, -v136
  v_fma_f32 v128, v128, s97, -v136
  v_fma_f32 v129, v129, s97, -v136
  v_fma_f32 v130, v130, s97, -v136
  v_fma_f32 v131, v131, s97, -v136
  v_fma_f32 v132, v132, s97, -v136
  v_fma_f32 v133, v133, s97, -v136
  v_exp_f32 v124, v124
  v_exp_f32 v125, v125
  v_exp_f32 v126, v126
  v_exp_f32 v127, v127
  v_exp_f32 v128, v128
  v_exp_f32 v129, v129
  v_exp_f32 v130, v130
  v_exp_f32 v131, v131
  v_exp_f32 v132, v132
  v_exp_f32 v133, v133
  v_cvt_pk_bf16_f32 v138, v124, v125
  v_cvt_pk_bf16_f32 v139, v126, v127
  v_cvt_pk_bf16_f32 v140, v128, v129
  v_cvt_pk_bf16_f32 v141, v130, v131
  v_cvt_pk_bf16_f32 v142, v132, v133
  v_mov_b32 v143, 0
  v_mov_b32 v144, 0
  v_mov_b32_e64 v145, v142
  v_mfma_f32_16x16x32_bf16 v[168:171], v[108:111], v[138:141], 0
  v_mfma_f32_16x16x32_bf16 v[172:175], v[112:115], v[138:141], 0
  v_mfma_f32_16x16x32_bf16 v[176:179], v[116:119], v[138:141], 0
  v_mfma_f32_16x16x32_bf16 v[180:183], v[120:123], v[138:141], 0
  v_mfma_f32_16x16x16_bf16 v[168:171], v[184:185], v[142:143], v[168:171]
  v_mfma_f32_16x16x16_bf16 v[172:175], v[184:185], v[144:145], v[172:175]
  v_mfma_f32_16x16x16_bf16 v[176:179], v[186:187], v[142:143], v[176:179]
  v_mfma_f32_16x16x16_bf16 v[180:183], v[186:187], v[144:145], v[180:183]
  v_add_f32 v124, v124, v125
  v_add_f32 v124, v124, v126
  v_add_f32 v124, v124, v127
  v_add_f32 v124, v124, v128
  v_add_f32 v124, v124, v129
  v_add_f32 v124, v124, v130
  v_add_f32 v124, v124, v131
  v_add_f32 v124, v124, v132
  v_add_f32 v124, v124, v133
  v_mov_b32 v137, v124
  s_nop 1
  v_permlane16_swap_b32 v124, v137
  v_add_f32 v124, v124, v137
  v_mov_b32 v137, v124
  s_nop 0
  s_nop 0
  v_permlane32_swap_b32 v124, v137
  v_add_f32 v124, v124, v137
  v_rcp_f32 v124, v124
  s_nop 0
  v_pk_mul_f32 v[168:169], v[168:169], v[124:125] op_sel_hi:[1,0]
  v_pk_mul_f32 v[170:171], v[170:171], v[124:125] op_sel_hi:[1,0]
  v_pk_mul_f32 v[172:173], v[172:173], v[124:125] op_sel_hi:[1,0]
  v_pk_mul_f32 v[174:175], v[174:175], v[124:125] op_sel_hi:[1,0]
  v_pk_mul_f32 v[176:177], v[176:177], v[124:125] op_sel_hi:[1,0]
  v_pk_mul_f32 v[178:179], v[178:179], v[124:125] op_sel_hi:[1,0]
  v_pk_mul_f32 v[180:181], v[180:181], v[124:125] op_sel_hi:[1,0]
  v_pk_mul_f32 v[182:183], v[182:183], v[124:125] op_sel_hi:[1,0]
  v_cvt_pk_bf16_f32 v128, v168, v172
  v_cvt_pk_bf16_f32 v129, v176, v180
  v_cvt_pk_bf16_f32 v130, v169, v173
  v_cvt_pk_bf16_f32 v131, v177, v181
  v_cvt_pk_bf16_f32 v132, v170, v174
  v_cvt_pk_bf16_f32 v133, v178, v182
  v_cvt_pk_bf16_f32 v134, v171, v175
  v_cvt_pk_bf16_f32 v135, v179, v183
  ds_write_b128 v5, v[128:131]
  ds_write_b128 v5, v[132:135] offset:512
  s_and_b32 s58, s52, s3
  s_lshl_b32 s58, s58, 12
  s_add_u32 s58, s58, 122880
  v_add_u32_e64 v2, s58, v1
  s_waitcnt lgkmcnt(0)
  s_barrier
  ds_read_b128 v[76:79], v2 offset:0
  ds_read_b128 v[80:83], v2 offset:1024
  ds_read_b128 v[84:87], v2 offset:2048
  ds_read_b128 v[88:91], v2 offset:3072
  ds_read_b128 v[92:95], v2 offset:4096
  ds_read_b128 v[96:99], v2 offset:5120
  ds_read_b128 v[100:103], v2 offset:6144
  ds_read_b128 v[104:107], v2 offset:7168
  s_waitcnt lgkmcnt(7)
  v_mfma_f32_16x16x32_bf16 v[124:127], v[76:79], a[0:3], 0
  s_waitcnt lgkmcnt(6)
  v_mfma_f32_16x16x32_bf16 v[124:127], v[80:83], a[4:7], v[124:127]
  s_waitcnt lgkmcnt(5)
  v_mfma_f32_16x16x32_bf16 v[124:127], v[84:87], a[8:11], v[124:127]
  s_waitcnt lgkmcnt(4)
  v_mfma_f32_16x16x32_bf16 v[124:127], v[88:91], a[12:15], v[124:127]
  v_mfma_f32_16x16x32_bf16 v[128:131], v[76:79], a[16:19], 0
  v_mfma_f32_16x16x32_bf16 v[128:131], v[80:83], a[20:23], v[128:131]
  v_mfma_f32_16x16x32_bf16 v[128:131], v[84:87], a[24:27], v[128:131]
  v_mfma_f32_16x16x32_bf16 v[128:131], v[88:91], a[28:31], v[128:131]
  v_mfma_f32_16x16x32_bf16 v[132:135], v[76:79], a[32:35], 0
  v_mfma_f32_16x16x32_bf16 v[132:135], v[80:83], a[36:39], v[132:135]
  v_mfma_f32_16x16x32_bf16 v[132:135], v[84:87], a[40:43], v[132:135]
  v_mfma_f32_16x16x32_bf16 v[132:135], v[88:91], a[44:47], v[132:135]
  v_mfma_f32_16x16x32_bf16 v[136:139], v[76:79], a[48:51], 0
  v_mfma_f32_16x16x32_bf16 v[136:139], v[80:83], a[52:55], v[136:139]
  v_mfma_f32_16x16x32_bf16 v[136:139], v[84:87], a[56:59], v[136:139]
  v_mfma_f32_16x16x32_bf16 v[136:139], v[88:91], a[60:63], v[136:139]
  v_mfma_f32_16x16x32_bf16 v[140:143], v[76:79], a[64:67], 0
  v_mfma_f32_16x16x32_bf16 v[140:143], v[80:83], a[68:71], v[140:143]
  v_mfma_f32_16x16x32_bf16 v[140:143], v[84:87], a[72:75], v[140:143]
  v_mfma_f32_16x16x32_bf16 v[140:143], v[88:91], a[76:79], v[140:143]
  v_mfma_f32_16x16x32_bf16 v[144:147], v[76:79], a[80:83], 0
  v_mfma_f32_16x16x32_bf16 v[144:147], v[80:83], a[84:87], v[144:147]
  v_mfma_f32_16x16x32_bf16 v[144:147], v[84:87], a[88:91], v[144:147]
  v_mfma_f32_16x16x32_bf16 v[144:147], v[88:91], a[92:95], v[144:147]
  v_mfma_f32_16x16x32_bf16 v[148:151], v[76:79], a[96:99], 0
  v_mfma_f32_16x16x32_bf16 v[148:151], v[80:83], a[100:103], v[148:151]
  v_mfma_f32_16x16x32_bf16 v[148:151], v[84:87], a[104:107], v[148:151]
  v_mfma_f32_16x16x32_bf16 v[148:151], v[88:91], a[108:111], v[148:151]
  v_mfma_f32_16x16x32_bf16 v[152:155], v[76:79], a[112:115], 0
  v_mfma_f32_16x16x32_bf16 v[152:155], v[80:83], a[116:119], v[152:155]
  v_mfma_f32_16x16x32_bf16 v[152:155], v[84:87], a[120:123], v[152:155]
  v_mfma_f32_16x16x32_bf16 v[152:155], v[88:91], a[124:127], v[152:155]
  v_mfma_f32_16x16x32_bf16 v[156:159], v[76:79], a[128:131], 0
  v_mfma_f32_16x16x32_bf16 v[156:159], v[80:83], a[132:135], v[156:159]
  v_mfma_f32_16x16x32_bf16 v[156:159], v[84:87], a[136:139], v[156:159]
  v_mfma_f32_16x16x32_bf16 v[156:159], v[88:91], a[140:143], v[156:159]
  v_mfma_f32_16x16x32_bf16 v[160:163], v[76:79], a[144:147], 0
  v_mfma_f32_16x16x32_bf16 v[160:163], v[80:83], a[148:151], v[160:163]
  v_mfma_f32_16x16x32_bf16 v[160:163], v[84:87], a[152:155], v[160:163]
  v_mfma_f32_16x16x32_bf16 v[160:163], v[88:91], a[156:159], v[160:163]
  v_cvt_pk_bf16_f32 v164, v124, v128
  v_cvt_pk_bf16_f32 v165, v132, v136
  v_cvt_pk_bf16_f32 v166, v140, v144
  v_cvt_pk_bf16_f32 v167, v148, v152
  s_nop 0
  s_nop 2
  v_cvt_pk_bf16_f32 v180, v156, v160
  v_cvt_pk_bf16_f32 v168, v125, v129
  v_cvt_pk_bf16_f32 v169, v133, v137
  v_cvt_pk_bf16_f32 v170, v141, v145
  v_cvt_pk_bf16_f32 v171, v149, v153
  v_cvt_pk_bf16_f32 v181, v157, v161
  v_cvt_pk_bf16_f32 v172, v126, v130
  v_cvt_pk_bf16_f32 v173, v134, v138
  v_cvt_pk_bf16_f32 v174, v142, v146
  v_cvt_pk_bf16_f32 v175, v150, v154
  v_cvt_pk_bf16_f32 v182, v158, v162
  v_cvt_pk_bf16_f32 v176, v127, v131
  v_cvt_pk_bf16_f32 v177, v135, v139
  v_cvt_pk_bf16_f32 v178, v143, v147
  v_cvt_pk_bf16_f32 v179, v151, v155
  v_cvt_pk_bf16_f32 v183, v159, v163
  s_cmp_lg_u32 s3, 0
  s_cbranch_scc1 L_ph_22_s
  s_waitcnt lgkmcnt(3)
  v_mfma_f32_16x16x32_bf16 v[124:127], v[92:95], a[0:3], 0
  s_waitcnt lgkmcnt(2)
  v_mfma_f32_16x16x32_bf16 v[124:127], v[96:99], a[4:7], v[124:127]
  s_waitcnt lgkmcnt(1)
  v_mfma_f32_16x16x32_bf16 v[124:127], v[100:103], a[8:11], v[124:127]
  s_waitcnt lgkmcnt(0)
  v_mfma_f32_16x16x32_bf16 v[124:127], v[104:107], a[12:15], v[124:127]
  s_add_u32 s58, s63, 0
  buffer_store_dwordx4 v[164:167], v6, s[4:7], s58 offen sc1
  v_mfma_f32_16x16x32_bf16 v[128:131], v[92:95], a[16:19], 0
  v_mfma_f32_16x16x32_bf16 v[128:131], v[96:99], a[20:23], v[128:131]
  s_nop 0
  v_mfma_f32_16x16x32_bf16 v[128:131], v[100:103], a[24:27], v[128:131]
  v_mfma_f32_16x16x32_bf16 v[128:131], v[104:107], a[28:31], v[128:131]
  buffer_store_dword v180, v7, s[4:7], s58 offen offset:1024 sc1
  v_mfma_f32_16x16x32_bf16 v[132:135], v[92:95], a[32:35], 0
  v_mfma_f32_16x16x32_bf16 v[132:135], v[96:99], a[36:39], v[132:135]
  v_mfma_f32_16x16x32_bf16 v[132:135], v[100:103], a[40:43], v[132:135]
  v_mfma_f32_16x16x32_bf16 v[132:135], v[104:107], a[44:47], v[132:135]
  s_add_u32 s58, s63, 41216
  buffer_store_dwordx4 v[168:171], v6, s[4:7], s58 offen sc1
  v_mfma_f32_16x16x32_bf16 v[136:139], v[92:95], a[48:51], 0
  v_mfma_f32_16x16x32_bf16 v[136:139], v[96:99], a[52:55], v[136:139]
  v_mfma_f32_16x16x32_bf16 v[136:139], v[100:103], a[56:59], v[136:139]
  v_mfma_f32_16x16x32_bf16 v[136:139], v[104:107], a[60:63], v[136:139]
  buffer_store_dword v181, v7, s[4:7], s58 offen offset:1024 sc1
  v_mfma_f32_16x16x32_bf16 v[140:143], v[92:95], a[64:67], 0
  v_mfma_f32_16x16x32_bf16 v[140:143], v[96:99], a[68:71], v[140:143]
  v_mfma_f32_16x16x32_bf16 v[140:143], v[100:103], a[72:75], v[140:143]
  v_mfma_f32_16x16x32_bf16 v[140:143], v[104:107], a[76:79], v[140:143]
  s_add_u32 s58, s63, 82432
  buffer_store_dwordx4 v[172:175], v6, s[4:7], s58 offen sc1
  v_mfma_f32_16x16x32_bf16 v[144:147], v[92:95], a[80:83], 0
  v_mfma_f32_16x16x32_bf16 v[144:147], v[96:99], a[84:87], v[144:147]
  v_mfma_f32_16x16x32_bf16 v[144:147], v[100:103], a[88:91], v[144:147]
  v_mfma_f32_16x16x32_bf16 v[144:147], v[104:107], a[92:95], v[144:147]
  buffer_store_dword v182, v7, s[4:7], s58 offen offset:1024 sc1
  v_mfma_f32_16x16x32_bf16 v[148:151], v[92:95], a[96:99], 0
  v_mfma_f32_16x16x32_bf16 v[148:151], v[96:99], a[100:103], v[148:151]
  v_mfma_f32_16x16x32_bf16 v[148:151], v[100:103], a[104:107], v[148:151]
  v_mfma_f32_16x16x32_bf16 v[148:151], v[104:107], a[108:111], v[148:151]
  s_add_u32 s58, s63, 123648
  buffer_store_dwordx4 v[176:179], v6, s[4:7], s58 offen sc1
  v_mfma_f32_16x16x32_bf16 v[152:155], v[92:95], a[112:115], 0
  v_mfma_f32_16x16x32_bf16 v[152:155], v[96:99], a[116:119], v[152:155]
  v_mfma_f32_16x16x32_bf16 v[152:155], v[100:103], a[120:123], v[152:155]
  v_mfma_f32_16x16x32_bf16 v[152:155], v[104:107], a[124:127], v[152:155]
  buffer_store_dword v183, v7, s[4:7], s58 offen offset:1024 sc1
  v_mfma_f32_16x16x32_bf16 v[156:159], v[92:95], a[128:131], 0
  v_mfma_f32_16x16x32_bf16 v[156:159], v[96:99], a[132:135], v[156:159]
  v_mfma_f32_16x16x32_bf16 v[156:159], v[100:103], a[136:139], v[156:159]
  v_mfma_f32_16x16x32_bf16 v[156:159], v[104:107], a[140:143], v[156:159]
  v_mfma_f32_16x16x32_bf16 v[160:163], v[92:95], a[144:147], 0
  v_mfma_f32_16x16x32_bf16 v[160:163], v[96:99], a[148:151], v[160:163]
  v_mfma_f32_16x16x32_bf16 v[160:163], v[100:103], a[152:155], v[160:163]
  v_mfma_f32_16x16x32_bf16 v[160:163], v[104:107], a[156:159], v[160:163]
  v_cvt_pk_bf16_f32 v164, v124, v128
  v_cvt_pk_bf16_f32 v165, v132, v136
  v_cvt_pk_bf16_f32 v166, v140, v144
  v_cvt_pk_bf16_f32 v167, v148, v152
  s_nop 0
  s_nop 2
  v_cvt_pk_bf16_f32 v180, v156, v160
  s_add_u32 s58, s63, 659456
  buffer_store_dwordx4 v[164:167], v6, s[4:7], s58 offen sc1
  buffer_store_dword v180, v7, s[4:7], s58 offen offset:1024 sc1
  v_cvt_pk_bf16_f32 v168, v125, v129
  v_cvt_pk_bf16_f32 v169, v133, v137
  v_cvt_pk_bf16_f32 v170, v141, v145
  v_cvt_pk_bf16_f32 v171, v149, v153
  v_cvt_pk_bf16_f32 v181, v157, v161
  s_add_u32 s58, s63, 700672
  buffer_store_dwordx4 v[168:171], v6, s[4:7], s58 offen sc1
  buffer_store_dword v181, v7, s[4:7], s58 offen offset:1024 sc1
  v_cvt_pk_bf16_f32 v172, v126, v130
  v_cvt_pk_bf16_f32 v173, v134, v138
  v_cvt_pk_bf16_f32 v174, v142, v146
  v_cvt_pk_bf16_f32 v175, v150, v154
  v_cvt_pk_bf16_f32 v182, v158, v162
  s_add_u32 s58, s63, 741888
  buffer_store_dwordx4 v[172:175], v6, s[4:7], s58 offen sc1
  buffer_store_dword v182, v7, s[4:7], s58 offen offset:1024 sc1
  v_cvt_pk_bf16_f32 v176, v127, v131
  v_cvt_pk_bf16_f32 v177, v135, v139
  v_cvt_pk_bf16_f32 v178, v143, v147
  v_cvt_pk_bf16_f32 v179, v151, v155
  v_cvt_pk_bf16_f32 v183, v159, v163
  s_add_u32 s58, s63, 783104
  buffer_store_dwordx4 v[176:179], v6, s[4:7], s58 offen sc1
  buffer_store_dword v183, v7, s[4:7], s58 offen offset:1024 sc1
L_ph_22x_s:
  s_waitcnt vmcnt(0)
  s_barrier
  s_cmp_lg_u32 s12, 0
  s_cbranch_scc1 L_ps_23_s
  s_lshl_b32 s58, s13, 2
  s_add_u32 s58, s58, s66
  v_mov_b32 v2, s62
  s_mov_b64 exec, 1
  buffer_store_dword v2, v0, s[4:7], s58 offen offset:0 sc1
  s_mov_b64 exec, -1
L_ps_23_s:
  s_lshr_b32 s58, s13, 4
  s_and_b32 s58, s58, s3
  s_cbranch_scc1 L_p_noln_s
  s_cmp_lg_u32 s12, 0
  s_cbranch_scc1 L_pw_24x_s
  s_mov_b32 exec_lo, 0xffffffff
  s_mov_b32 exec_hi, 0
L_pw_24_s:
  buffer_load_dword v2, v11, s[4:7], s66 offen offset:0 sc1
  s_sub_u32 s54, s54, 1
  s_cbranch_scc1 L_end
  s_waitcnt vmcnt(0)
  v_cmp_gt_u32_e64 vcc, s62, v2
  s_cbranch_vccnz L_pw_24_s
L_pw_24y_s:
  s_mov_b64 exec, -1
L_pw_24x_s:
  s_barrier
  s_cmp_lt_u32 s61, 6
  s_cbranch_scc1 L_q_in_s
  buffer_load_dwordx4 v[156:159], v9, s[4:7], s72 offen offset:1024 sc1
  s_add_u32 s58, s72, 20480
  buffer_load_dwordx4 v[160:163], v9, s[4:7], s58 offen offset:1024 sc1
  buffer_load_dwordx4 v[124:127], v8, s[4:7], s72 offen sc1
  s_add_u32 s58, s72, 5120
  buffer_load_dwordx4 v[128:131], v8, s[4:7], s58 offen sc1
  s_add_u32 s58, s72, 10240
  buffer_load_dwordx4 v[132:135], v8, s[4:7], s58 offen sc1
  s_add_u32 s58, s72, 15360
  buffer_load_dwordx4 v[136:139], v8, s[4:7], s58 offen sc1
  s_add_u32 s58, s72, 20480
  buffer_load_dwordx4 v[140:143], v8, s[4:7], s58 offen sc1
  s_add_u32 s58, s72, 25600
  buffer_load_dwordx4 v[144:147], v8, s[4:7], s58 offen sc1
  s_add_u32 s58, s72, 30720
  buffer_load_dwordx4 v[148:151], v8, s[4:7], s58 offen sc1
  s_add_u32 s58, s72, 35840
  buffer_load_dwordx4 v[152:155], v8, s[4:7], s58 offen sc1
  v_lshlrev_b32 v168, 16, v56
  v_and_b32 v169, 0xffff0000, v56
  v_lshlrev_b32 v170, 16, v57
  v_and_b32 v171, 0xffff0000, v57
  s_lshl_b32 s58, s12, 3
  s_add_u32 s58, s58, 135168
  v_mov_b32 v2, s58
  v_mov_b32 v3, 135168
  s_waitcnt vmcnt(9)
  v_mfma_f32_16x16x32_bf16 v[164:167], v[20:23], v[156:159], 0
  s_waitcnt vmcnt(8)
  v_mfma_f32_16x16x32_bf16 v[164:167], v[20:23], v[160:163], v[164:167]
  s_nop 0
  s_nop 6
  v_add_f32_dpp v164, v164, v164 row_ror:4 row_mask:0xf bank_mask:0xf
  v_add_f32_dpp v165, v165, v165 row_ror:4 row_mask:0xf bank_mask:0xf
  v_add_f32_dpp v166, v166, v166 row_ror:4 row_mask:0xf bank_mask:0xf
  v_add_f32_dpp v167, v167, v167 row_ror:4 row_mask:0xf bank_mask:0xf
  v_add_f32_dpp v164, v164, v164 row_ror:8 row_mask:0xf bank_mask:0xf
  v_add_f32_dpp v165, v165, v165 row_ror:8 row_mask:0xf bank_mask:0xf
  v_add_f32_dpp v166, v166, v166 row_ror:8 row_mask:0xf bank_mask:0xf
  v_add_f32_dpp v167, v167, v167 row_ror:8 row_mask:0xf bank_mask:0xf
  s_waitcnt vmcnt(7)
  s_nop 0
  v_mfma_f32_16x16x32_bf16 v[164:167], v[16:19], v[124:127], v[164:167]
  s_waitcnt vmcnt(6)
  v_mfma_f32_16x16x32_bf16 v[164:167], v[16:19], v[128:131], v[164:167]
  s_waitcnt vmcnt(5)
  v_mfma_f32_16x16x32_bf16 v[164:167], v[16:19], v[132:135], v[164:167]
  s_waitcnt vmcnt(4)
  v_mfma_f32_16x16x32_bf16 v[164:167], v[16:19], v[136:139], v[164:167]
  s_waitcnt vmcnt(3)
  v_mfma_f32_16x16x32_bf16 v[164:167], v[16:19], v[140:143], v[164:167]
  s_waitcnt vmcnt(2)
  v_mfma_f32_16x16x32_bf16 v[164:167], v[16:19], v[144:147], v[164:167]
  s_waitcnt vmcnt(1)
  v_mfma_f32_16x16x32_bf16 v[164:167], v[16:19], v[148:151], v[164:167]
  s_nop 0
  s_waitcnt vmcnt(0)
  v_mfma_f32_16x16x32_bf16 v[164:167], v[16:19], v[152:155], v[164:167]
  s_nop 7
  v_cvt_pk_bf16_f32 v165, v164, v165
  v_lshlrev_b32 v164, 16, v165
  v_and_b32 v165, 0xffff0000, v165
  v_pk_fma_f32 v[180:181], v[164:165], v[40:41], v[168:169]
  v_cvt_pk_bf16_f32 v56, v180, v181
  v_lshlrev_b32_e64 v180, 16, v56
  v_and_b32 v181, 0xffff0000, v56
  v_cvt_pk_bf16_f32 v167, v166, v167
  v_lshlrev_b32_e64 v166, 16, v167
  v_and_b32 v167, 0xffff0000, v167
  v_pk_fma_f32 v[182:183], v[166:167], v[42:43], v[170:171]
  v_cvt_pk_bf16_f32 v57, v182, v183
  v_lshlrev_b32 v182, 16, v57
  v_and_b32 v183, 0xffff0000, v57
  v_readfirstlane_b32 s58, v180
  s_nop 0
  s_nop 0
  v_subrev_f32 v164, s58, v180
  v_subrev_f32 v165, s58, v181
  v_subrev_f32 v166, s58, v182
  v_subrev_f32 v167, s58, v183
  v_pk_add_f32 v[168:169], v[164:165], v[166:167]
  v_pk_mul_f32 v[170:171], v[164:165], v[164:165]
  v_pk_fma_f32 v[170:171], v[166:167], v[166:167], v[170:171]
  v_add_f32 v168, v168, v169
  v_add_f32 v169, v170, v171
  v_cndmask_b32 v168, 0, v168, s[98:99]
  v_cndmask_b32 v169, 0, v169, s[98:99]
  s_nop 0
  v_add_f32_dpp v168, v168, v168 quad_perm:[1,0,3,2] row_mask:0xf bank_mask:0xf
  v_add_f32_dpp v169, v169, v169 quad_perm:[1,0,3,2] row_mask:0xf bank_mask:0xf
  s_nop 0
  v_add_f32_dpp v168, v168, v168 quad_perm:[2,3,0,1] row_mask:0xf bank_mask:0xf
  v_add_f32_dpp v169, v169, v169 quad_perm:[2,3,0,1] row_mask:0xf bank_mask:0xf
  s_nop 0
  v_add_f32_dpp v168, v168, v168 row_ror:4 row_mask:0xf bank_mask:0xf
  v_add_f32_dpp v169, v169, v169 row_ror:4 row_mask:0xf bank_mask:0xf
  s_nop 0
  v_add_f32_dpp v168, v168, v168 row_ror:8 row_mask:0xf bank_mask:0xf
  v_add_f32_dpp v169, v169, v169 row_ror:8 row_mask:0xf bank_mask:0xf
  v_mov_b64 v[170:171], v[168:169]
  s_nop 0
  s_nop 0
  v_permlane16_swap_b32 v168, v170
  v_permlane16_swap_b32 v169, v171
  v_pk_add_f32 v[168:169], v[168:169], v[170:171]
  v_mov_b64 v[170:171], v[168:169]
  s_nop 0
  s_nop 0
  v_permlane32_swap_b32 v168, v170
  v_permlane32_swap_b32 v169, v171
  v_pk_add_f32 v[168:169], v[168:169], v[170:171]
  v_mul_f32 v170, 0x3bcccccd, v168
  v_fma_f32 v169, -v170, v168, v169
  v_add_f32_e64 v168, s58, v170
  s_mov_b64 exec, 1
  ds_write_b64 v2, v[168:169]
  s_mov_b64 exec, -1
  s_waitcnt lgkmcnt(0)
  s_barrier
  ds_read_b128 v[168:171], v3
  ds_read_b128 v[172:175], v3 offset:16
  s_waitcnt lgkmcnt(1)
  v_pk_add_f32 v[176:177], v[168:169], v[170:171]
  s_waitcnt lgkmcnt(0)
  v_pk_add_f32 v[178:179], v[172:173], v[174:175]
  v_pk_add_f32 v[176:177], v[176:177], v[178:179]
  v_mul_f32 v176, 0x3e800000, v176
  v_sub_f32 v168, v168, v176
  v_sub_f32 v170, v170, v176
  v_sub_f32 v172, v172, v176
  v_sub_f32 v174, v174, v176
  v_mul_f32 v168, v168, v168
  v_fmac_f32 v168, v170, v170
  v_fmac_f32_e64 v168, v172, v172
  v_fmac_f32_e64 v168, v174, v174
  v_fmac_f32 v177, 0x43200000, v168
  v_mov_b32 v168, 0x3727c5ac
  v_fmac_f32 v168, 0x3acccccd, v177
  v_rsq_f32_e64 v168, v168
  v_pk_add_f32 v[164:165], v[180:181], v[176:177] op_sel_hi:[1,0] neg_lo:[0,1] neg_hi:[0,1]
  v_pk_add_f32 v[166:167], v[182:183], v[176:177] op_sel_hi:[1,0] neg_lo:[0,1] neg_hi:[0,1]
  v_pk_mul_f32 v[164:165], v[164:165], v[168:169] op_sel_hi:[1,0]
  v_pk_mul_f32 v[166:167], v[166:167], v[168:169] op_sel_hi:[1,0]
  v_pk_fma_f32 v[164:165], v[164:165], v[48:49], v[44:45]
  v_pk_fma_f32 v[166:167], v[166:167], v[50:51], v[46:47]
  v_cvt_pk_bf16_f32 v164, v164, v165
  v_cvt_pk_bf16_f32 v165, v166, v167
  buffer_store_dwordx2 v[164:165], v12, s[4:7], s65 offen sc1
L_p_noln_s:
  s_waitcnt vmcnt(0)
  s_barrier
  s_cmp_lg_u32 s12, 0
  s_cbranch_scc1 L_ps_25_s
  s_lshl_b32 s58, s13, 2
  s_add_u32 s58, s58, s66
  v_mov_b32_e64 v2, s62
  s_mov_b64 exec, 1
  buffer_store_dword v2, v0, s[4:7], s58 offen offset:128 sc1
  s_mov_b64 exec, -1
L_ps_25_s:
  s_mov_b32 s92, s74
  v_mov_b64_e64 v[58:59], v[56:57]
  s_add_u32 s61, s61, 6
  s_lshr_b32 s58, s52, 1
  s_add_u32 s58, s58, 61
  s_sub_u32 s59, s61, 62
  s_cmp_lt_u32 s59, 4
  s_cselect_b32 s15, 1, 0
  s_cselect_b32 s61, s58, s61
L_p_join_s:
  s_lshl_b32 s58, s61, 5
  s_add_u32 s58, s58, s13
  s_and_b32 s59, s52, s15
  s_lshl_b32 s59, s59, 4
  s_add_u32 s59, s59, s58
  s_mul_i32 s74, s59, 1280
  s_lshl_b32 s67, s58, 13
  s_and_b32 s59, s12, 1
  s_lshl_b32 s59, s59, 10
  s_add_u32 s67, s67, s59
  s_add_u32 s67, s67, 16777216
  s_lshl_b32 s68, s58, 14
  s_add_u32 s68, s68, 33554432
  s_lshr_b32 s69, s58, 2
  s_lshl_b32 s69, s69, 14
  s_and_b32 s59, s13, 3
  s_lshl_b32 s59, s59, 11
  s_add_u32 s69, s69, s59
  s_add_u32 s69, s69, 8388608
  s_lshr_b32 s59, s12, 1
  s_lshl_b32 s59, s59, 10
  s_add_u32 s55, s69, s59
  s_add_u32 s55, s55, 0x2000
  s_lshl_b32 s59, s59, 3
  s_add_u32 s75, s68, s59
  s_cmp_ge_u32 s13, 27
  s_cbranch_scc1 L_p_noffn_s
  s_cmp_lg_u32 s12, 0
  s_cbranch_scc1 L_pw_26x_s
  s_mov_b32 exec_lo, 0xffffffff
  s_mov_b32 exec_hi, 0
L_pw_26_s:
  buffer_load_dword v2, v11, s[4:7], s66 offen offset:128 sc1
  s_sub_u32 s54, s54, 1
  s_cbranch_scc1 L_end
  s_waitcnt vmcnt(0)
  v_cmp_gt_u32 vcc, s62, v2
  s_cbranch_vccnz L_pw_26_s
L_pw_26y_s:
  s_mov_b64 exec, -1
L_pw_26x_s:
  s_barrier
  s_lshl_b32 s60, s12, 11
  s_add_u32 m0, s60, 0
  s_add_u32 s60, s65, m0
  buffer_load_dwordx4 v1, s[4:7], s60 offen sc1 lds
  s_lshl_b32 s60, s12, 11
  s_add_u32 m0, s60, 8192
  s_add_u32 s60, s65, m0
  buffer_load_dwordx4 v1, s[4:7], s60 offen sc1 lds
  s_lshl_b32 s60, s12, 11
  s_add_u32 m0, s60, 16384
  s_add_u32 s60, s65, m0
  buffer_load_dwordx4 v1, s[4:7], s60 offen sc1 lds
  s_lshl_b32 s60, s12, 11
  s_add_u32 m0, s60, 24576
  s_add_u32 s60, s65, m0
  buffer_load_dwordx4 v1, s[4:7], s60 offen sc1 lds
  s_lshl_b32 s60, s12, 11
  s_add_u32 m0, s60, 32768
  s_add_u32 s60, s65, m0
  buffer_load_dwordx4 v1, s[4:7], s60 offen sc1 lds
  s_cmp_lg_u32 s3, 0
  s_cbranch_scc1 L_p_hd_s
  s_lshl_b32 s60, s12, 11
  s_add_u32 m0, s60, 1024
  s_add_u32 s60, s65, m0
  buffer_load_dwordx4 v1, s[4:7], s60 offen sc1 lds
  s_lshl_b32 s60, s12, 11
  s_add_u32 m0, s60, 9216
  s_add_u32 s60, s65, m0
  buffer_load_dwordx4 v1, s[4:7], s60 offen sc1 lds
  s_lshl_b32 s60, s12, 11
  s_add_u32 m0, s60, 17408
  s_add_u32 s60, s65, m0
  buffer_load_dwordx4 v1, s[4:7], s60 offen sc1 lds
  s_lshl_b32 s60, s12, 11
  s_add_u32 m0, s60, 25600
  s_add_u32 s60, s65, m0
  buffer_load_dwordx4 v1, s[4:7], s60 offen sc1 lds
  s_lshl_b32 s60, s12, 11
  s_add_u32 m0, s60, 33792
  s_add_u32 s60, s65, m0
  buffer_load_dwordx4 v1, s[4:7], s60 offen sc1 lds
  s_waitcnt vmcnt(5)
L_p_hdx_s:
  s_barrier
  ds_read_b128 v[124:127], v1 offset:0
  ds_read_b128 v[128:131], v1 offset:2048
  ds_read_b128 v[132:135], v1 offset:4096
  ds_read_b128 v[136:139], v1 offset:6144
  s_waitcnt lgkmcnt(3)
  v_mfma_f32_16x16x32_bf16 v[148:151], a[160:163], v[124:127], 0
  ds_read_b128 v[140:143], v1 offset:8192
  v_mfma_f32_16x16x32_bf16 v[152:155], a[164:167], v[124:127], 0
  s_waitcnt lgkmcnt(3)
  v_mfma_f32_16x16x32_bf16 v[148:151], a[168:171], v[128:131], v[148:151]
  ds_read_b128 v[144:147], v1 offset:10240
  v_mfma_f32_16x16x32_bf16 v[152:155], a[172:175], v[128:131], v[152:155]
  s_waitcnt lgkmcnt(3)
  v_mfma_f32_16x16x32_bf16 v[148:151], a[176:179], v[132:135], v[148:151]
  ds_read_b128 v[124:127], v1 offset:12288
  v_mfma_f32_16x16x32_bf16 v[152:155], a[180:183], v[132:135], v[152:155]
  s_waitcnt lgkmcnt(3)
  v_mfma_f32_16x16x32_bf16 v[148:151], a[184:187], v[136:139], v[148:151]
  ds_read_b128 v[128:131], v1 offset:14336
  v_mfma_f32_16x16x32_bf16 v[152:155], a[188:191], v[136:139], v[152:155]
  s_nop 0
  s_waitcnt lgkmcnt(3)
  v_mfma_f32_16x16x32_bf16 v[148:151], a[192:195], v[140:143], v[148:151]
  ds_read_b128 v[132:135], v1 offset:16384
  v_mfma_f32_16x16x32_bf16 v[152:155], a[196:199], v[140:143], v[152:155]
  s_nop 0
  s_waitcnt lgkmcnt(3)
  v_mfma_f32_16x16x32_bf16 v[148:151], a[200:203], v[144:147], v[148:151]
  ds_read_b128 v[136:139], v1 offset:18432
  v_mfma_f32_16x16x32_bf16 v[152:155], a[204:207], v[144:147], v[152:155]
  s_nop 0
  s_waitcnt lgkmcnt(3)
  v_mfma_f32_16x16x32_bf16 v[148:151], a[208:211], v[124:127], v[148:151]
  ds_read_b128 v[140:143], v1 offset:20480
  v_mfma_f32_16x16x32_bf16 v[152:155], a[212:215], v[124:127], v[152:155]
  s_nop 0
  s_waitcnt lgkmcnt(3)
  v_mfma_f32_16x16x32_bf16 v[148:151], a[216:219], v[128:131], v[148:151]
  ds_read_b128 v[144:147], v1 offset:22528
  v_mfma_f32_16x16x32_bf16 v[152:155], a[220:223], v[128:131], v[152:155]
  s_nop 0
  s_waitcnt lgkmcnt(3)
  v_mfma_f32_16x16x32_bf16 v[148:151], a[224:227], v[132:135], v[148:151]
  ds_read_b128 v[124:127], v1 offset:24576
  v_mfma_f32_16x16x32_bf16 v[152:155], a[228:231], v[132:135], v[152:155]
  s_nop 0
  s_waitcnt lgkmcnt(3)
  v_mfma_f32_16x16x32_bf16 v[148:151], a[232:235], v[136:139], v[148:151]
  ds_read_b128 v[128:131], v1 offset:26624
  v_mfma_f32_16x16x32_bf16 v[152:155], a[236:239], v[136:139], v[152:155]
  s_waitcnt vmcnt(0)
  s_barrier
  s_waitcnt lgkmcnt(3)
  v_mfma_f32_16x16x32_bf16 v[148:151], a[240:243], v[140:143], v[148:151]
  s_nop 0
  ds_read_b128 v[132:135], v1 offset:28672
  v_mfma_f32_16x16x32_bf16 v[152:155], a[244:247], v[140:143], v[152:155]
  buffer_load_dwordx4 v[60:63], v1, s[4:7], s67 offen offset:0 sc1
  s_waitcnt lgkmcnt(3)
  v_mfma_f32_16x16x32_bf16 v[148:151], a[248:251], v[144:147], v[148:151]
  s_nop 0
  ds_read_b128 v[136:139], v1 offset:30720
  v_mfma_f32_16x16x32_bf16 v[152:155], a[252:255], v[144:147], v[152:155]
  s_waitcnt lgkmcnt(3)
  v_mfma_f32_16x16x32_bf16 v[148:151], v[192:195], v[124:127], v[148:151]
  s_nop 0
  ds_read_b128 v[140:143], v1 offset:32768
  v_mfma_f32_16x16x32_bf16 v[152:155], v[196:199], v[124:127], v[152:155]
  buffer_load_dwordx4 v[64:67], v1, s[4:7], s67 offen offset:2048 sc1
  s_waitcnt lgkmcnt(3)
  v_mfma_f32_16x16x32_bf16 v[148:151], v[200:203], v[128:131], v[148:151]
  s_nop 0
  ds_read_b128 v[144:147], v1 offset:34816
  v_mfma_f32_16x16x32_bf16 v[152:155], v[204:207], v[128:131], v[152:155]
  s_waitcnt lgkmcnt(3)
  v_mfma_f32_16x16x32_bf16 v[148:151], v[208:211], v[132:135], v[148:151]
  s_nop 0
  ds_read_b128 v[124:127], v1 offset:36864
  v_mfma_f32_16x16x32_bf16 v[152:155], v[212:215], v[132:135], v[152:155]
  s_add_u32 s67, s67, 4096
  buffer_load_dwordx4 v[68:71], v1, s[4:7], s67 offen offset:0 sc1
  s_waitcnt lgkmcnt(3)
  v_mfma_f32_16x16x32_bf16 v[148:151], v[216:219], v[136:139], v[148:151]
  ds_read_b128 v[128:131], v1 offset:38912
  v_mfma_f32_16x16x32_bf16 v[152:155], v[220:223], v[136:139], v[152:155]
  s_waitcnt lgkmcnt(3)
  v_mfma_f32_16x16x32_bf16 v[148:151], v[224:227], v[140:143], v[148:151]
  ds_read_b128 v[132:135], v1 offset:1024
  v_mfma_f32_16x16x32_bf16 v[152:155], v[228:231], v[140:143], v[152:155]
  buffer_load_dwordx4 v[72:75], v1, s[4:7], s67 offen offset:2048 sc1
  s_waitcnt lgkmcnt(3)
  v_mfma_f32_16x16x32_bf16 v[148:151], v[232:235], v[144:147], v[148:151]
  ds_read_b128 v[136:139], v1 offset:3072
  v_mfma_f32_16x16x32_bf16 v[152:155], v[236:239], v[144:147], v[152:155]
  s_waitcnt lgkmcnt(3)
  v_mfma_f32_16x16x32_bf16 v[148:151], v[240:243], v[124:127], v[148:151]
  ds_read_b128 v[140:143], v1 offset:5120
  v_mfma_f32_16x16x32_bf16 v[152:155], v[244:247], v[124:127], v[152:155]
  buffer_load_dwordx4 v[76:79], v1, s[4:7], s68 offen offset:0 sc1
  s_waitcnt lgkmcnt(3)
  v_mfma_f32_16x16x32_bf16 v[148:151], v[248:251], v[128:131], v[148:151]
  ds_read_b128 v[144:147], v1 offset:7168
  v_mfma_f32_16x16x32_bf16 v[152:155], v[252:255], v[128:131], v[152:155]
  s_cmp_lg_u32 s3, 0
  s_cbranch_scc1 L_p_hg_s
  s_waitcnt lgkmcnt(3)
  v_mfma_f32_16x16x32_bf16 v[156:159], a[160:163], v[132:135], 0
  ds_read_b128 v[124:127], v1 offset:9216
  v_mfma_f32_16x16x32_bf16 v[160:163], a[164:167], v[132:135], 0
  buffer_load_dwordx4 v[80:83], v1, s[4:7], s68 offen offset:1024 sc1
  s_waitcnt lgkmcnt(3)
  v_mfma_f32_16x16x32_bf16 v[156:159], a[168:171], v[136:139], v[156:159]
  s_nop 0
  ds_read_b128 v[128:131], v1 offset:11264
  v_mfma_f32_16x16x32_bf16 v[160:163], a[172:175], v[136:139], v[160:163]
  s_waitcnt lgkmcnt(3)
  v_mfma_f32_16x16x32_bf16 v[156:159], a[176:179], v[140:143], v[156:159]
  s_nop 0
  ds_read_b128 v[132:135], v1 offset:13312
  v_cvt_pk_bf16_f32 v149, v148, v149
  v_mfma_f32_16x16x32_bf16 v[160:163], a[180:183], v[140:143], v[160:163]
  buffer_load_dwordx4 v[108:111], v1, s[4:7], s75 offen offset:2048 sc1
  v_lshlrev_b32 v148, 16, v149
  s_waitcnt lgkmcnt(3)
  v_mfma_f32_16x16x32_bf16 v[156:159], a[184:187], v[144:147], v[156:159]
  ds_read_b128 v[136:139], v1 offset:15360
  v_and_b32 v149, 0xffff0000, v149
  v_mfma_f32_16x16x32_bf16 v[160:163], a[188:191], v[144:147], v[160:163]
  v_cvt_pk_bf16_f32 v151, v150, v151
  s_waitcnt lgkmcnt(3)
  v_mfma_f32_16x16x32_bf16 v[156:159], a[192:195], v[124:127], v[156:159]
  ds_read_b128 v[140:143], v1 offset:17408
  v_lshlrev_b32 v150, 16, v151
  v_mfma_f32_16x16x32_bf16 v[160:163], a[196:199], v[124:127], v[160:163]
  s_add_u32 s68, s68, 4096
  buffer_load_dwordx4 v[84:87], v1, s[4:7], s68 offen offset:0 sc1
  v_and_b32 v151, 0xffff0000, v151
  s_waitcnt lgkmcnt(3)
  v_mfma_f32_16x16x32_bf16 v[156:159], a[200:203], v[128:131], v[156:159]
  s_nop 0
  ds_read_b128 v[144:147], v1 offset:19456
  v_cvt_pk_bf16_f32 v153, v152, v153
  v_mfma_f32_16x16x32_bf16 v[160:163], a[204:207], v[128:131], v[160:163]
  v_lshlrev_b32 v152, 16, v153
  s_waitcnt lgkmcnt(3)
  v_mfma_f32_16x16x32_bf16 v[156:159], a[208:211], v[132:135], v[156:159]
  ds_read_b128 v[124:127], v1 offset:21504
  v_and_b32 v153, 0xffff0000, v153
  v_mfma_f32_16x16x32_bf16 v[160:163], a[212:215], v[132:135], v[160:163]
  buffer_load_dwordx4 v[88:91], v1, s[4:7], s68 offen offset:1024 sc1
  v_cvt_pk_bf16_f32 v155, v154, v155
  s_waitcnt lgkmcnt(3)
  v_mfma_f32_16x16x32_bf16 v[156:159], a[216:219], v[136:139], v[156:159]
  ds_read_b128 v[128:131], v1 offset:23552
  v_lshlrev_b32 v154, 16, v155
  v_mfma_f32_16x16x32_bf16 v[160:163], a[220:223], v[136:139], v[160:163]
  v_and_b32 v155, 0xffff0000, v155
  s_waitcnt lgkmcnt(3)
  v_mfma_f32_16x16x32_bf16 v[156:159], a[224:227], v[140:143], v[156:159]
  ds_read_b128 v[132:135], v1 offset:25600
  v_max_f32 v148, 0, v148
  v_mfma_f32_16x16x32_bf16 v[160:163], a[228:231], v[140:143], v[160:163]
  buffer_load_dwordx4 v[112:115], v1, s[4:7], s75 offen offset:3072 sc1
  v_mul_f32 v148, v148, v152
  s_waitcnt lgkmcnt(3)
  v_mfma_f32_16x16x32_bf16 v[156:159], a[232:235], v[144:147], v[156:159]
  ds_read_b128 v[136:139], v1 offset:27648
  v_max_f32 v149, 0, v149
  v_mfma_f32_16x16x32_bf16 v[160:163], a[236:239], v[144:147], v[160:163]
  v_mul_f32_e64 v149, v149, v153
  s_waitcnt lgkmcnt(3)
  v_mfma_f32_16x16x32_bf16 v[156:159], a[240:243], v[124:127], v[156:159]
  ds_read_b128 v[140:143], v1 offset:29696
  v_max_f32_e64 v150, 0, v150
  v_mfma_f32_16x16x32_bf16 v[160:163], a[244:247], v[124:127], v[160:163]
  s_add_u32 s68, s68, 4096
  s_add_u32 s75, s75, 4096
  buffer_load_dwordx4 v[92:95], v1, s[4:7], s68 offen offset:0 sc1
  v_mul_f32 v150, v150, v154
  s_waitcnt lgkmcnt(3)
  v_mfma_f32_16x16x32_bf16 v[156:159], a[248:251], v[128:131], v[156:159]
  ds_read_b128 v[144:147], v1 offset:31744
  v_max_f32_e64 v151, 0, v151
  v_mfma_f32_16x16x32_bf16 v[160:163], a[252:255], v[128:131], v[160:163]
  v_mul_f32 v151, v151, v155
  s_waitcnt lgkmcnt(3)
  v_mfma_f32_16x16x32_bf16 v[156:159], v[192:195], v[132:135], v[156:159]
  ds_read_b128 v[124:127], v1 offset:33792
  v_cvt_pk_bf16_f32 v148, v148, v149
  v_mfma_f32_16x16x32_bf16 v[160:163], v[196:199], v[132:135], v[160:163]
  buffer_load_dwordx4 v[96:99], v1, s[4:7], s68 offen offset:1024 sc1
  v_cvt_pk_bf16_f32 v149, v150, v151
  s_waitcnt lgkmcnt(3)
  v_mfma_f32_16x16x32_bf16 v[156:159], v[200:203], v[136:139], v[156:159]
  ds_read_b128 v[128:131], v1 offset:35840
  ds_write_b64 v13, v[148:149] offset:0
  v_mfma_f32_16x16x32_bf16 v[160:163], v[204:207], v[136:139], v[160:163]
  s_waitcnt lgkmcnt(4)
  v_mfma_f32_16x16x32_bf16 v[156:159], v[208:211], v[140:143], v[156:159]
  ds_read_b128 v[132:135], v1 offset:37888
  v_mfma_f32_16x16x32_bf16 v[160:163], v[212:215], v[140:143], v[160:163]
  buffer_load_dwordx4 v[116:119], v1, s[4:7], s75 offen offset:2048 sc1
  s_waitcnt lgkmcnt(4)
  v_mfma_f32_16x16x32_bf16 v[156:159], v[216:219], v[144:147], v[156:159]
  ds_read_b128 v[136:139], v1 offset:39936
  v_mfma_f32_16x16x32_bf16 v[160:163], v[220:223], v[144:147], v[160:163]
  s_waitcnt lgkmcnt(4)
  v_mfma_f32_16x16x32_bf16 v[156:159], v[224:227], v[124:127], v[156:159]
  v_mfma_f32_16x16x32_bf16 v[160:163], v[228:231], v[124:127], v[160:163]
  s_add_u32 s68, s68, 4096
  buffer_load_dwordx4 v[100:103], v1, s[4:7], s68 offen offset:0 sc1
  s_waitcnt lgkmcnt(3)
  v_mfma_f32_16x16x32_bf16 v[156:159], v[232:235], v[128:131], v[156:159]
  v_mfma_f32_16x16x32_bf16 v[160:163], v[236:239], v[128:131], v[160:163]
  s_waitcnt lgkmcnt(1)
  v_mfma_f32_16x16x32_bf16 v[156:159], v[240:243], v[132:135], v[156:159]
  v_mfma_f32_16x16x32_bf16 v[160:163], v[244:247], v[132:135], v[160:163]
  buffer_load_dwordx4 v[104:107], v1, s[4:7], s68 offen offset:1024 sc1
  s_waitcnt lgkmcnt(0)
  v_mfma_f32_16x16x32_bf16 v[156:159], v[248:251], v[136:139], v[156:159]
  s_nop 0
  v_mfma_f32_16x16x32_bf16 v[160:163], v[252:255], v[136:139], v[160:163]
  buffer_load_dwordx4 v[120:123], v1, s[4:7], s75 offen offset:3072 sc1
  s_nop 0
  s_nop 1
  v_cvt_pk_bf16_f32 v157, v156, v157
  v_lshlrev_b32 v156, 16, v157
  v_and_b32 v157, 0xffff0000, v157
  v_cvt_pk_bf16_f32 v159, v158, v159
  v_lshlrev_b32 v158, 16, v159
  v_and_b32 v159, 0xffff0000, v159
  v_cvt_pk_bf16_f32 v161, v160, v161
  v_lshlrev_b32 v160, 16, v161
  v_and_b32 v161, 0xffff0000, v161
  v_cvt_pk_bf16_f32 v163, v162, v163
  v_lshlrev_b32 v162, 16, v163
  v_and_b32 v163, 0xffff0000, v163
  v_max_f32 v156, 0, v156
  v_mul_f32 v156, v156, v160
  v_max_f32 v157, 0, v157
  v_mul_f32 v157, v157, v161
  v_max_f32_e64 v158, 0, v158
  v_mul_f32_e64 v158, v158, v162
  v_max_f32_e64 v159, 0, v159
  v_mul_f32_e64 v159, v159, v163
  v_cvt_pk_bf16_f32 v156, v156, v157
  v_cvt_pk_bf16_f32 v157, v158, v159
  ds_write_b64 v13, v[156:157] offset:2048
L_p_hgx_s:
  v_add_u32 v2, 131072, v1
  s_nop 0
  s_waitcnt lgkmcnt(0)
  s_barrier
  ds_read_b128 v[184:187], v2 offset:0
  ds_read_b128 v[188:191], v2 offset:1024
  ds_read_b128 v[24:27], v14 offset:0
  ds_read_b128 v[28:31], v14 offset:1024
  ds_read_b128 v[32:35], v14 offset:2048
  ds_read_b128 v[36:39], v14 offset:3072
  s_waitcnt lgkmcnt(3)
  v_mfma_f32_16x16x32_bf16 v[124:127], v[184:187], v[24:27], 0
  ds_read_b128 v[24:27], v14 offset:4096
  s_waitcnt lgkmcnt(3)
  v_mfma_f32_16x16x32_bf16 v[124:127], v[188:191], v[28:31], v[124:127]
  ds_read_b128 v[28:31], v14 offset:5120
  s_waitcnt lgkmcnt(3)
  v_mfma_f32_16x16x32_bf16 v[128:131], v[184:187], v[32:35], 0
  ds_read_b128 v[32:35], v14 offset:6144
  s_waitcnt lgkmcnt(3)
  v_mfma_f32_16x16x32_bf16 v[128:131], v[188:191], v[36:39], v[128:131]
  ds_read_b128 v[36:39], v14 offset:7168
  s_waitcnt lgkmcnt(3)
  v_mfma_f32_16x16x32_bf16 v[132:135], v[184:187], v[24:27], 0
  ds_read_b128 v[24:27], v14 offset:8192
  s_waitcnt lgkmcnt(3)
  v_mfma_f32_16x16x32_bf16 v[132:135], v[188:191], v[28:31], v[132:135]
  ds_read_b128 v[28:31], v14 offset:9216
  s_waitcnt lgkmcnt(3)
  v_mfma_f32_16x16x32_bf16 v[136:139], v[184:187], v[32:35], 0
  ds_read_b128 v[32:35], v14 offset:10240
  s_waitcnt lgkmcnt(3)
  v_mfma_f32_16x16x32_bf16 v[136:139], v[188:191], v[36:39], v[136:139]
  ds_read_b128 v[36:39], v14 offset:11264
  s_waitcnt lgkmcnt(3)
  v_mfma_f32_16x16x32_bf16 v[140:143], v[184:187], v[24:27], 0
  ds_read_b128 v[24:27], v14 offset:12288
  s_waitcnt lgkmcnt(3)
  v_mfma_f32_16x16x32_bf16 v[140:143], v[188:191], v[28:31], v[140:143]
  ds_read_b128 v[28:31], v14 offset:13312
  s_waitcnt lgkmcnt(3)
  v_mfma_f32_16x16x32_bf16 v[144:147], v[184:187], v[32:35], 0
  ds_read_b128 v[32:35], v14 offset:14336
  s_waitcnt lgkmcnt(3)
  v_mfma_f32_16x16x32_bf16 v[144:147], v[188:191], v[36:39], v[144:147]
  ds_read_b128 v[36:39], v14 offset:15360
  s_waitcnt lgkmcnt(3)
  v_mfma_f32_16x16x32_bf16 v[148:151], v[184:187], v[24:27], 0
  ds_read_b128 v[24:27], v14 offset:16384
  s_waitcnt lgkmcnt(3)
  v_mfma_f32_16x16x32_bf16 v[148:151], v[188:191], v[28:31], v[148:151]
  ds_read_b128 v[28:31], v14 offset:17408
  s_waitcnt lgkmcnt(3)
  v_mfma_f32_16x16x32_bf16 v[152:155], v[184:187], v[32:35], 0
  ds_read_b128 v[32:35], v14 offset:18432
  s_waitcnt lgkmcnt(3)
  v_mfma_f32_16x16x32_bf16 v[152:155], v[188:191], v[36:39], v[152:155]
  ds_read_b128 v[36:39], v14 offset:19456
  s_waitcnt lgkmcnt(3)
  v_mfma_f32_16x16x32_bf16 v[156:159], v[184:187], v[24:27], 0
  ds_read_b128 v[24:27], v14 offset:0
  s_waitcnt lgkmcnt(3)
  v_mfma_f32_16x16x32_bf16 v[156:159], v[188:191], v[28:31], v[156:159]
  ds_read_b128 v[28:31], v14 offset:1024
  s_waitcnt lgkmcnt(3)
  v_mfma_f32_16x16x32_bf16 v[160:163], v[184:187], v[32:35], 0
  ds_read_b128 v[32:35], v14 offset:2048
  s_waitcnt lgkmcnt(3)
  v_mfma_f32_16x16x32_bf16 v[160:163], v[188:191], v[36:39], v[160:163]
  ds_read_b128 v[36:39], v14 offset:3072
  ds_read_b128 v[184:187], v2 offset:2048
  ds_read_b128 v[188:191], v2 offset:3072
  v_cvt_pk_bf16_f32 v164, v124, v128
  v_cvt_pk_bf16_f32 v165, v132, v136
  v_cvt_pk_bf16_f32 v166, v140, v144
  v_cvt_pk_bf16_f32 v167, v148, v152
  s_nop 0
  v_cvt_pk_bf16_f32 v180, v156, v160
  v_cvt_pk_bf16_f32 v168, v125, v129
  v_cvt_pk_bf16_f32 v169, v133, v137
  v_cvt_pk_bf16_f32 v170, v141, v145
  v_cvt_pk_bf16_f32 v171, v149, v153
  v_cvt_pk_bf16_f32 v181, v157, v161
  v_cvt_pk_bf16_f32 v172, v126, v130
  v_cvt_pk_bf16_f32 v173, v134, v138
  v_cvt_pk_bf16_f32 v174, v142, v146
  v_cvt_pk_bf16_f32 v175, v150, v154
  v_cvt_pk_bf16_f32 v182, v158, v162
  v_cvt_pk_bf16_f32 v176, v127, v131
  v_cvt_pk_bf16_f32 v177, v135, v139
  v_cvt_pk_bf16_f32 v178, v143, v147
  v_cvt_pk_bf16_f32 v179, v151, v155
  v_cvt_pk_bf16_f32 v183, v159, v163
  s_cmp_lg_u32 s3, 0
  s_cbranch_scc1 L_ph_27_s
  s_waitcnt lgkmcnt(1)
  v_mfma_f32_16x16x32_bf16 v[124:127], v[184:187], v[24:27], 0
  ds_read_b128 v[24:27], v14 offset:4096
  s_waitcnt lgkmcnt(1)
  v_mfma_f32_16x16x32_bf16 v[124:127], v[188:191], v[28:31], v[124:127]
  ds_read_b128 v[28:31], v14 offset:5120
  s_add_u32 s58, s64, 0
  buffer_store_dwordx4 v[164:167], v6, s[4:7], s58 offen sc1
  v_mfma_f32_16x16x32_bf16 v[128:131], v[184:187], v[32:35], 0
  s_nop 0
  ds_read_b128 v[32:35], v14 offset:6144
  v_mfma_f32_16x16x32_bf16 v[128:131], v[188:191], v[36:39], v[128:131]
  ds_read_b128 v[36:39], v14 offset:7168
  buffer_store_dword v180, v7, s[4:7], s58 offen offset:1024 sc1
  s_waitcnt lgkmcnt(3)
  v_mfma_f32_16x16x32_bf16 v[132:135], v[184:187], v[24:27], 0
  ds_read_b128 v[24:27], v14 offset:8192
  s_waitcnt lgkmcnt(3)
  v_mfma_f32_16x16x32_bf16 v[132:135], v[188:191], v[28:31], v[132:135]
  ds_read_b128 v[28:31], v14 offset:9216
  s_add_u32 s58, s64, 41216
  buffer_store_dwordx4 v[168:171], v6, s[4:7], s58 offen sc1
  s_waitcnt lgkmcnt(3)
  v_mfma_f32_16x16x32_bf16 v[136:139], v[184:187], v[32:35], 0
  ds_read_b128 v[32:35], v14 offset:10240
  s_waitcnt lgkmcnt(3)
  v_mfma_f32_16x16x32_bf16 v[136:139], v[188:191], v[36:39], v[136:139]
  ds_read_b128 v[36:39], v14 offset:11264
  buffer_store_dword v181, v7, s[4:7], s58 offen offset:1024 sc1
  s_waitcnt lgkmcnt(3)
  v_mfma_f32_16x16x32_bf16 v[140:143], v[184:187], v[24:27], 0
  ds_read_b128 v[24:27], v14 offset:12288
  s_waitcnt lgkmcnt(3)
  v_mfma_f32_16x16x32_bf16 v[140:143], v[188:191], v[28:31], v[140:143]
  ds_read_b128 v[28:31], v14 offset:13312
  s_add_u32 s58, s64, 82432
  buffer_store_dwordx4 v[172:175], v6, s[4:7], s58 offen sc1
  s_waitcnt lgkmcnt(3)
  v_mfma_f32_16x16x32_bf16 v[144:147], v[184:187], v[32:35], 0
  ds_read_b128 v[32:35], v14 offset:14336
  s_waitcnt lgkmcnt(3)
  v_mfma_f32_16x16x32_bf16 v[144:147], v[188:191], v[36:39], v[144:147]
  ds_read_b128 v[36:39], v14 offset:15360
  buffer_store_dword v182, v7, s[4:7], s58 offen offset:1024 sc1
  s_waitcnt lgkmcnt(3)
  v_mfma_f32_16x16x32_bf16 v[148:151], v[184:187], v[24:27], 0
  ds_read_b128 v[24:27], v14 offset:16384
  s_waitcnt lgkmcnt(3)
  v_mfma_f32_16x16x32_bf16 v[148:151], v[188:191], v[28:31], v[148:151]
  ds_read_b128 v[28:31], v14 offset:17408
  s_add_u32 s58, s64, 123648
  buffer_store_dwordx4 v[176:179], v6, s[4:7], s58 offen sc1
  s_waitcnt lgkmcnt(3)
  v_mfma_f32_16x16x32_bf16 v[152:155], v[184:187], v[32:35], 0
  ds_read_b128 v[32:35], v14 offset:18432
  s_waitcnt lgkmcnt(3)
  v_mfma_f32_16x16x32_bf16 v[152:155], v[188:191], v[36:39], v[152:155]
  ds_read_b128 v[36:39], v14 offset:19456
  buffer_store_dword v183, v7, s[4:7], s58 offen offset:1024 sc1
  s_waitcnt lgkmcnt(3)
  v_mfma_f32_16x16x32_bf16 v[156:159], v[184:187], v[24:27], 0
  s_waitcnt lgkmcnt(2)
  v_mfma_f32_16x16x32_bf16 v[156:159], v[188:191], v[28:31], v[156:159]
  s_waitcnt lgkmcnt(1)
  v_mfma_f32_16x16x32_bf16 v[160:163], v[184:187], v[32:35], 0
  s_waitcnt lgkmcnt(0)
  v_mfma_f32_16x16x32_bf16 v[160:163], v[188:191], v[36:39], v[160:163]
  v_cvt_pk_bf16_f32 v164, v124, v128
  v_cvt_pk_bf16_f32 v165, v132, v136
  v_cvt_pk_bf16_f32 v166, v140, v144
  v_cvt_pk_bf16_f32 v167, v148, v152
  s_nop 0
  s_nop 2
  v_cvt_pk_bf16_f32 v180, v156, v160
  s_add_u32 s58, s64, 659456
  buffer_store_dwordx4 v[164:167], v6, s[4:7], s58 offen sc1
  buffer_store_dword v180, v7, s[4:7], s58 offen offset:1024 sc1
  v_cvt_pk_bf16_f32 v168, v125, v129
  v_cvt_pk_bf16_f32 v169, v133, v137
  v_cvt_pk_bf16_f32 v170, v141, v145
  v_cvt_pk_bf16_f32 v171, v149, v153
  v_cvt_pk_bf16_f32 v181, v157, v161
  s_add_u32 s58, s64, 700672
  buffer_store_dwordx4 v[168:171], v6, s[4:7], s58 offen sc1
  buffer_store_dword v181, v7, s[4:7], s58 offen offset:1024 sc1
  v_cvt_pk_bf16_f32 v172, v126, v130
  v_cvt_pk_bf16_f32 v173, v134, v138
  v_cvt_pk_bf16_f32 v174, v142, v146
  v_cvt_pk_bf16_f32 v175, v150, v154
  v_cvt_pk_bf16_f32 v182, v158, v162
  s_add_u32 s58, s64, 741888
  buffer_store_dwordx4 v[172:175], v6, s[4:7], s58 offen sc1
  buffer_store_dword v182, v7, s[4:7], s58 offen offset:1024 sc1
  v_cvt_pk_bf16_f32 v176, v127, v131
  v_cvt_pk_bf16_f32 v177, v135, v139
  v_cvt_pk_bf16_f32 v178, v143, v147
  v_cvt_pk_bf16_f32 v179, v151, v155
  v_cvt_pk_bf16_f32 v183, v159, v163
  s_add_u32 s58, s64, 783104
  buffer_store_dwordx4 v[176:179], v6, s[4:7], s58 offen sc1
  buffer_store_dword v183, v7, s[4:7], s58 offen offset:1024 sc1
L_ph_27x_s:
  s_branch L_p_fin_s
  s_nop 0
L_p_noffn_s:
  buffer_load_dwordx4 v[60:63], v1, s[4:7], s67 offen offset:0 sc1
  buffer_load_dwordx4 v[64:67], v1, s[4:7], s67 offen offset:2048 sc1
  s_add_u32 s67, s67, 4096
  buffer_load_dwordx4 v[68:71], v1, s[4:7], s67 offen offset:0 sc1
  buffer_load_dwordx4 v[72:75], v1, s[4:7], s67 offen offset:2048 sc1
  buffer_load_dwordx4 v[76:79], v1, s[4:7], s68 offen offset:0 sc1
  buffer_load_dwordx4 v[80:83], v1, s[4:7], s68 offen offset:1024 sc1
  buffer_load_dwordx4 v[108:111], v1, s[4:7], s75 offen offset:2048 sc1
  s_add_u32 s68, s68, 4096
  buffer_load_dwordx4 v[84:87], v1, s[4:7], s68 offen offset:0 sc1
  buffer_load_dwordx4 v[88:91], v1, s[4:7], s68 offen offset:1024 sc1
  buffer_load_dwordx4 v[112:115], v1, s[4:7], s75 offen offset:3072 sc1
  s_add_u32 s68, s68, 4096
  s_add_u32 s75, s75, 4096
  buffer_load_dwordx4 v[92:95], v1, s[4:7], s68 offen offset:0 sc1
  buffer_load_dwordx4 v[96:99], v1, s[4:7], s68 offen offset:1024 sc1
  buffer_load_dwordx4 v[116:119], v1, s[4:7], s75 offen offset:2048 sc1
  s_add_u32 s68, s68, 4096
  buffer_load_dwordx4 v[100:103], v1, s[4:7], s68 offen offset:0 sc1
  buffer_load_dwordx4 v[104:107], v1, s[4:7], s68 offen offset:1024 sc1
  buffer_load_dwordx4 v[120:123], v1, s[4:7], s75 offen offset:3072 sc1
L_p_fin_s:
  s_waitcnt vmcnt(0)
  s_barrier
  s_cmp_lg_u32 s12, 0
  s_cbranch_scc1 L_ps_28_s
  s_lshl_b32 s58, s13, 2
  s_add_u32 s58, s58, s66
  v_mov_b32 v2, s62
  s_mov_b64 exec, 1
  buffer_store_dword v2, v0, s[4:7], s58 offen offset:256 sc1
  s_mov_b64 exec, -1
L_ps_28_s:
  s_lshr_b32 s58, s13, 4
  s_and_b32 s58, s58, s3
  s_cbranch_scc1 L_p_out_s
  s_cmp_lg_u32 s12, 0
  s_cbranch_scc1 L_pw_29x_s
  s_mov_b32 exec_lo, 0x7ffffff
  s_mov_b32 exec_hi, 0
L_pw_29_s:
  buffer_load_dword v2, v11, s[4:7], s66 offen offset:256 sc1
  s_sub_u32 s54, s54, 1
  s_cbranch_scc1 L_end
  s_waitcnt vmcnt(0)
  v_cmp_gt_u32 vcc, s62, v2
  s_cbranch_vccnz L_pw_29_s
L_pw_29y_s:
  s_mov_b64 exec, -1
L_pw_29x_s:
  s_barrier
  v_mov_b32 v3, 0x7f000000
  v_cndmask_b32 v2, v3, v8, s[100:101]
  v_cndmask_b32 v3, v3, v9, s[70:71]
  buffer_load_dwordx4 v[156:159], v9, s[4:7], s73 offen offset:1024 sc1
  s_add_u32 s58, s73, 20480
  buffer_load_dwordx4 v[160:163], v3, s[4:7], s58 offen offset:1024 sc1
  buffer_load_dwordx4 v[124:127], v8, s[4:7], s73 offen sc1
  s_add_u32 s58, s73, 5120
  buffer_load_dwordx4 v[128:131], v8, s[4:7], s58 offen sc1
  s_add_u32 s58, s73, 10240
  buffer_load_dwordx4 v[132:135], v8, s[4:7], s58 offen sc1
  s_add_u32 s58, s73, 15360
  buffer_load_dwordx4 v[136:139], v8, s[4:7], s58 offen sc1
  s_add_u32 s58, s73, 20480
  buffer_load_dwordx4 v[140:143], v8, s[4:7], s58 offen sc1
  s_add_u32 s58, s73, 25600
  buffer_load_dwordx4 v[144:147], v8, s[4:7], s58 offen sc1
  s_add_u32 s58, s73, 30720
  buffer_load_dwordx4 v[148:151], v2, s[4:7], s58 offen sc1
  v_lshlrev_b32_e64 v190, 1, v11
  buffer_load_dwordx4 v[168:171], v4, s[4:7], s69 offen offset:0 sc1
  buffer_load_dwordx2 v[184:185], v190, s[4:7], s55 offen offset:0 sc1
  buffer_load_dwordx4 v[172:175], v4, s[4:7], s69 offen offset:512 sc1
  buffer_load_dwordx2 v[186:187], v190, s[4:7], s55 offen offset:512 sc1
  buffer_load_dwordx4 v[176:179], v4, s[4:7], s69 offen offset:1024 sc1
  buffer_load_dwordx4 v[180:183], v4, s[4:7], s69 offen offset:1536 sc1
  s_waitcnt vmcnt(14)
  v_mfma_f32_16x16x32_bf16 v[164:167], v[20:23], v[156:159], 0
  s_waitcnt vmcnt(13)
  v_mfma_f32_16x16x32_bf16 v[164:167], v[20:23], v[160:163], v[164:167]
  s_nop 0
  s_nop 6
  v_add_f32_dpp v164, v164, v164 row_ror:4 row_mask:0xf bank_mask:0xf
  v_add_f32_dpp v165, v165, v165 row_ror:4 row_mask:0xf bank_mask:0xf
  v_add_f32_dpp v166, v166, v166 row_ror:4 row_mask:0xf bank_mask:0xf
  v_add_f32_dpp v167, v167, v167 row_ror:4 row_mask:0xf bank_mask:0xf
  v_add_f32_dpp v164, v164, v164 row_ror:8 row_mask:0xf bank_mask:0xf
  v_add_f32_dpp v165, v165, v165 row_ror:8 row_mask:0xf bank_mask:0xf
  v_add_f32_dpp v166, v166, v166 row_ror:8 row_mask:0xf bank_mask:0xf
  v_add_f32_dpp v167, v167, v167 row_ror:8 row_mask:0xf bank_mask:0xf
  s_waitcnt vmcnt(12)
  s_nop 0
  v_mfma_f32_16x16x32_bf16 v[164:167], v[16:19], v[124:127], v[164:167]
  s_waitcnt vmcnt(11)
  v_mfma_f32_16x16x32_bf16 v[164:167], v[16:19], v[128:131], v[164:167]
  s_waitcnt vmcnt(10)
  v_mfma_f32_16x16x32_bf16 v[164:167], v[16:19], v[132:135], v[164:167]
  s_waitcnt vmcnt(9)
  v_mfma_f32_16x16x32_bf16 v[164:167], v[16:19], v[136:139], v[164:167]
  s_waitcnt vmcnt(8)
  v_mfma_f32_16x16x32_bf16 v[164:167], v[16:19], v[140:143], v[164:167]
  s_waitcnt vmcnt(7)
  v_mfma_f32_16x16x32_bf16 v[164:167], v[16:19], v[144:147], v[164:167]
  s_waitcnt vmcnt(6)
  v_mfma_f32_16x16x32_bf16 v[164:167], v[16:19], v[148:151], v[164:167]
  v_lshlrev_b32_e64 v160, 16, v58
  v_and_b32 v161, 0xffff0000, v58
  v_lshlrev_b32 v162, 16, v59
  v_and_b32 v163, 0xffff0000, v59
  s_nop 3
  v_cvt_pk_bf16_f32 v165, v164, v165
  v_lshlrev_b32 v164, 16, v165
  v_and_b32 v165, 0xffff0000, v165
  v_pk_fma_f32 v[164:165], v[164:165], v[52:53], v[160:161]
  v_cvt_pk_bf16_f32 v167, v166, v167
  v_lshlrev_b32 v166, 16, v167
  v_and_b32 v167, 0xffff0000, v167
  v_pk_fma_f32 v[166:167], v[166:167], v[54:55], v[162:163]
  v_cvt_pk_bf16_f32 v164, v164, v165
  v_cvt_pk_bf16_f32 v165, v166, v167
  buffer_store_dwordx2 v[164:165], v10, s[48:51], s92 offen
  s_mov_b32 s3, s15
  s_add_u32 s62, s62, 1
  s_cmp_lt_u32 s61, 64
  s_cbranch_scc1 L_p_loop_s
L_p_out_s:
  s_branch L_end
L_ph_22_s:
  s_add_u32 s58, s63, 0
  buffer_store_dwordx4 v[164:167], v6, s[4:7], s58 offen sc1
  buffer_store_dword v180, v7, s[4:7], s58 offen offset:1024 sc1
  s_add_u32 s58, s63, 41216
  buffer_store_dwordx4 v[168:171], v6, s[4:7], s58 offen sc1
  buffer_store_dword v181, v7, s[4:7], s58 offen offset:1024 sc1
  s_add_u32 s58, s63, 82432
  buffer_store_dwordx4 v[172:175], v6, s[4:7], s58 offen sc1
  buffer_store_dword v182, v7, s[4:7], s58 offen offset:1024 sc1
  s_add_u32 s58, s63, 123648
  buffer_store_dwordx4 v[176:179], v6, s[4:7], s58 offen sc1
  buffer_store_dword v183, v7, s[4:7], s58 offen offset:1024 sc1
  s_waitcnt lgkmcnt(0)
  s_branch L_ph_22x_s
L_p_hd_s:
  s_waitcnt vmcnt(0)
  s_branch L_p_hdx_s
  s_nop 0
  s_nop 0
  s_nop 0
L_p_hg_s:
  s_nop 7
  v_cvt_pk_bf16_f32 v149, v148, v149
  v_lshlrev_b32 v148, 16, v149
  v_and_b32 v149, 0xffff0000, v149
  v_cvt_pk_bf16_f32 v151, v150, v151
  v_lshlrev_b32 v150, 16, v151
  v_and_b32 v151, 0xffff0000, v151
  v_cvt_pk_bf16_f32 v153, v152, v153
  v_lshlrev_b32 v152, 16, v153
  v_and_b32 v153, 0xffff0000, v153
  v_cvt_pk_bf16_f32 v155, v154, v155
  v_lshlrev_b32 v154, 16, v155
  v_and_b32 v155, 0xffff0000, v155
  v_max_f32 v148, 0, v148
  v_mul_f32 v148, v148, v152
  v_max_f32 v149, 0, v149
  v_mul_f32 v149, v149, v153
  v_max_f32 v150, 0, v150
  v_mul_f32 v150, v150, v154
  v_max_f32 v151, 0, v151
  v_mul_f32 v151, v151, v155
  v_cvt_pk_bf16_f32 v148, v148, v149
  v_cvt_pk_bf16_f32 v149, v150, v151
  ds_write_b64 v13, v[148:149] offset:0
  s_branch L_p_hgx_s
L_ph_27_s:
  s_add_u32 s58, s64, 0
  buffer_store_dwordx4 v[164:167], v6, s[4:7], s58 offen sc1
  buffer_store_dword v180, v7, s[4:7], s58 offen offset:1024 sc1
  s_add_u32 s58, s64, 41216
  buffer_store_dwordx4 v[168:171], v6, s[4:7], s58 offen sc1
  buffer_store_dword v181, v7, s[4:7], s58 offen offset:1024 sc1
  s_add_u32 s58, s64, 82432
  buffer_store_dwordx4 v[172:175], v6, s[4:7], s58 offen sc1
  buffer_store_dword v182, v7, s[4:7], s58 offen offset:1024 sc1
  s_add_u32 s58, s64, 123648
  buffer_store_dwordx4 v[176:179], v6, s[4:7], s58 offen sc1
  buffer_store_dword v183, v7, s[4:7], s58 offen offset:1024 sc1
  s_waitcnt lgkmcnt(0)
  s_branch L_ph_27x_s
  s_nop 0
  s_nop 0
  s_nop 0
  s_nop 0
  s_nop 0
  s_nop 0
L_q_in_s:
  s_mov_b32 s2, s74
  s_add_u32 s61, s61, 6
  s_lshr_b32 s58, s52, 1
  s_add_u32 s58, s58, 61
  s_sub_u32 s59, s61, 62
  s_cmp_lt_u32 s59, 4
  s_cselect_b32 s15, 1, 0
  s_cselect_b32 s61, s58, s61
  s_lshl_b32 s58, s61, 5
  s_add_u32 s58, s58, s13
  s_and_b32 s59, s52, s15
  s_lshl_b32 s59, s59, 4
  s_add_u32 s59, s59, s58
  s_mul_i32 s74, s59, 1280
  s_lshl_b32 s67, s58, 13
  s_and_b32 s59, s12, 1
  s_lshl_b32 s59, s59, 10
  s_add_u32 s67, s67, s59
  s_add_u32 s67, s67, 16777216
  s_lshl_b32 s68, s58, 14
  s_add_u32 s68, s68, 33554432
  s_lshr_b32 s69, s58, 2
  s_lshl_b32 s69, s69, 14
  s_and_b32 s59, s13, 3
  s_lshl_b32 s59, s59, 11
  s_add_u32 s69, s69, s59
  s_add_u32 s69, s69, 8388608
  s_lshr_b32 s59, s12, 1
  s_lshl_b32 s59, s59, 10
  s_add_u32 s55, s69, s59
  s_add_u32 s55, s55, 0x2000
  s_lshl_b32 s59, s59, 3
  s_add_u32 s75, s68, s59
  buffer_load_dwordx4 v[156:159], v9, s[4:7], s72 offen offset:1024 sc1
  s_add_u32 s58, s72, 20480
  buffer_load_dwordx4 v[160:163], v9, s[4:7], s58 offen offset:1024 sc1
  buffer_load_dwordx4 v[124:127], v8, s[4:7], s72 offen sc1
  s_add_u32 s58, s72, 5120
  buffer_load_dwordx4 v[128:131], v8, s[4:7], s58 offen sc1
  s_add_u32 s58, s72, 10240
  buffer_load_dwordx4 v[132:135], v8, s[4:7], s58 offen sc1
  s_add_u32 s58, s72, 15360
  buffer_load_dwordx4 v[136:139], v8, s[4:7], s58 offen sc1
  s_add_u32 s58, s72, 20480
  buffer_load_dwordx4 v[140:143], v8, s[4:7], s58 offen sc1
  s_add_u32 s58, s72, 25600
  buffer_load_dwordx4 v[144:147], v8, s[4:7], s58 offen sc1
  s_add_u32 s58, s72, 30720
  buffer_load_dwordx4 v[148:151], v8, s[4:7], s58 offen sc1
  s_add_u32 s58, s72, 35840
  buffer_load_dwordx4 v[152:155], v8, s[4:7], s58 offen sc1
  buffer_load_dwordx4 v[60:63], v1, s[4:7], s67 offen offset:0 sc1
  buffer_load_dwordx4 v[64:67], v1, s[4:7], s67 offen offset:2048 sc1
  s_add_u32 s67, s67, 4096
  buffer_load_dwordx4 v[68:71], v1, s[4:7], s67 offen offset:0 sc1
  buffer_load_dwordx4 v[72:75], v1, s[4:7], s67 offen offset:2048 sc1
  buffer_load_dwordx4 v[76:79], v1, s[4:7], s68 offen offset:0 sc1
  buffer_load_dwordx4 v[80:83], v1, s[4:7], s68 offen offset:1024 sc1
  buffer_load_dwordx4 v[108:111], v1, s[4:7], s75 offen offset:2048 sc1
  s_add_u32 s68, s68, 4096
  buffer_load_dwordx4 v[84:87], v1, s[4:7], s68 offen offset:0 sc1
  buffer_load_dwordx4 v[88:91], v1, s[4:7], s68 offen offset:1024 sc1
  buffer_load_dwordx4 v[112:115], v1, s[4:7], s75 offen offset:3072 sc1
  s_add_u32 s68, s68, 4096
  s_add_u32 s75, s75, 4096
  buffer_load_dwordx4 v[92:95], v1, s[4:7], s68 offen offset:0 sc1
  buffer_load_dwordx4 v[96:99], v1, s[4:7], s68 offen offset:1024 sc1
  buffer_load_dwordx4 v[116:119], v1, s[4:7], s75 offen offset:2048 sc1
  s_add_u32 s68, s68, 4096
  buffer_load_dwordx4 v[100:103], v1, s[4:7], s68 offen offset:0 sc1
  buffer_load_dwordx4 v[104:107], v1, s[4:7], s68 offen offset:1024 sc1
  buffer_load_dwordx4 v[120:123], v1, s[4:7], s75 offen offset:3072 sc1
  v_lshlrev_b32 v168, 16, v56
  v_and_b32 v169, 0xffff0000, v56
  v_lshlrev_b32 v170, 16, v57
  v_and_b32 v171, 0xffff0000, v57
  s_lshl_b32 s58, s12, 3
  s_add_u32 s58, s58, 135168
  v_mov_b32 v2, s58
  v_mov_b32 v3, 135168
  s_waitcnt vmcnt(25)
  v_mfma_f32_16x16x32_bf16 v[164:167], v[20:23], v[156:159], 0
  s_waitcnt vmcnt(24)
  v_mfma_f32_16x16x32_bf16 v[164:167], v[20:23], v[160:163], v[164:167]
  s_nop 0
  s_nop 6
  v_add_f32_dpp v164, v164, v164 row_ror:4 row_mask:0xf bank_mask:0xf
  v_add_f32_dpp v165, v165, v165 row_ror:4 row_mask:0xf bank_mask:0xf
  v_add_f32_dpp v166, v166, v166 row_ror:4 row_mask:0xf bank_mask:0xf
  v_add_f32_dpp v167, v167, v167 row_ror:4 row_mask:0xf bank_mask:0xf
  v_add_f32_dpp v164, v164, v164 row_ror:8 row_mask:0xf bank_mask:0xf
  v_add_f32_dpp v165, v165, v165 row_ror:8 row_mask:0xf bank_mask:0xf
  v_add_f32_dpp v166, v166, v166 row_ror:8 row_mask:0xf bank_mask:0xf
  v_add_f32_dpp v167, v167, v167 row_ror:8 row_mask:0xf bank_mask:0xf
  s_waitcnt vmcnt(23)
  s_nop 0
  v_mfma_f32_16x16x32_bf16 v[164:167], v[16:19], v[124:127], v[164:167]
  s_waitcnt vmcnt(22)
  v_mfma_f32_16x16x32_bf16 v[164:167], v[16:19], v[128:131], v[164:167]
  s_waitcnt vmcnt(21)
  v_mfma_f32_16x16x32_bf16 v[164:167], v[16:19], v[132:135], v[164:167]
  s_waitcnt vmcnt(20)
  v_mfma_f32_16x16x32_bf16 v[164:167], v[16:19], v[136:139], v[164:167]
  s_waitcnt vmcnt(19)
  v_mfma_f32_16x16x32_bf16 v[164:167], v[16:19], v[140:143], v[164:167]
  s_waitcnt vmcnt(18)
  v_mfma_f32_16x16x32_bf16 v[164:167], v[16:19], v[144:147], v[164:167]
  s_waitcnt vmcnt(17)
  v_mfma_f32_16x16x32_bf16 v[164:167], v[16:19], v[148:151], v[164:167]
  s_nop 0
  s_waitcnt vmcnt(16)
  v_mfma_f32_16x16x32_bf16 v[164:167], v[16:19], v[152:155], v[164:167]
  s_nop 7
  v_cvt_pk_bf16_f32 v165, v164, v165
  v_lshlrev_b32 v164, 16, v165
  v_and_b32 v165, 0xffff0000, v165
  v_pk_fma_f32 v[180:181], v[164:165], v[40:41], v[168:169]
  v_cvt_pk_bf16_f32 v56, v180, v181
  v_lshlrev_b32_e64 v180, 16, v56
  v_and_b32 v181, 0xffff0000, v56
  v_cvt_pk_bf16_f32 v167, v166, v167
  v_lshlrev_b32_e64 v166, 16, v167
  v_and_b32 v167, 0xffff0000, v167
  v_pk_fma_f32 v[182:183], v[166:167], v[42:43], v[170:171]
  v_cvt_pk_bf16_f32 v57, v182, v183
  v_lshlrev_b32 v182, 16, v57
  v_and_b32 v183, 0xffff0000, v57
  v_readfirstlane_b32 s58, v180
  s_nop 0
  s_nop 0
  v_subrev_f32 v164, s58, v180
  v_subrev_f32 v165, s58, v181
  v_subrev_f32 v166, s58, v182
  v_subrev_f32 v167, s58, v183
  v_pk_add_f32 v[168:169], v[164:165], v[166:167]
  v_pk_mul_f32 v[170:171], v[164:165], v[164:165]
  v_pk_fma_f32 v[170:171], v[166:167], v[166:167], v[170:171]
  v_add_f32 v168, v168, v169
  v_add_f32 v169, v170, v171
  v_cndmask_b32 v168, 0, v168, s[98:99]
  v_cndmask_b32 v169, 0, v169, s[98:99]
  s_nop 0
  v_add_f32_dpp v168, v168, v168 quad_perm:[1,0,3,2] row_mask:0xf bank_mask:0xf
  v_add_f32_dpp v169, v169, v169 quad_perm:[1,0,3,2] row_mask:0xf bank_mask:0xf
  s_nop 0
  v_add_f32_dpp v168, v168, v168 quad_perm:[2,3,0,1] row_mask:0xf bank_mask:0xf
  v_add_f32_dpp v169, v169, v169 quad_perm:[2,3,0,1] row_mask:0xf bank_mask:0xf
  s_nop 0
  v_add_f32_dpp v168, v168, v168 row_ror:4 row_mask:0xf bank_mask:0xf
  v_add_f32_dpp v169, v169, v169 row_ror:4 row_mask:0xf bank_mask:0xf
  s_nop 0
  v_add_f32_dpp v168, v168, v168 row_ror:8 row_mask:0xf bank_mask:0xf
  v_add_f32_dpp v169, v169, v169 row_ror:8 row_mask:0xf bank_mask:0xf
  v_mov_b64 v[170:171], v[168:169]
  s_nop 0
  s_nop 0
  v_permlane16_swap_b32 v168, v170
  v_permlane16_swap_b32 v169, v171
  v_pk_add_f32 v[168:169], v[168:169], v[170:171]
  v_mov_b64 v[170:171], v[168:169]
  s_nop 0
  s_nop 0
  v_permlane32_swap_b32 v168, v170
  v_permlane32_swap_b32 v169, v171
  v_pk_add_f32 v[168:169], v[168:169], v[170:171]
  v_mul_f32 v170, 0x3bcccccd, v168
  v_fma_f32 v169, -v170, v168, v169
  v_add_f32_e64 v168, s58, v170
  s_mov_b64 exec, 1
  ds_write_b64 v2, v[168:169]
  s_mov_b64 exec, -1
  s_waitcnt lgkmcnt(0)
  s_barrier
  ds_read_b128 v[168:171], v3
  ds_read_b128 v[172:175], v3 offset:16
  s_waitcnt lgkmcnt(1)
  v_pk_add_f32 v[176:177], v[168:169], v[170:171]
  s_waitcnt lgkmcnt(0)
  v_pk_add_f32 v[178:179], v[172:173], v[174:175]
  v_pk_add_f32 v[176:177], v[176:177], v[178:179]
  v_mul_f32 v176, 0x3e800000, v176
  v_sub_f32 v168, v168, v176
  v_sub_f32 v170, v170, v176
  v_sub_f32 v172, v172, v176
  v_sub_f32 v174, v174, v176
  v_mul_f32 v168, v168, v168
  v_fmac_f32 v168, v170, v170
  v_fmac_f32 v168, v172, v172
  v_fmac_f32 v168, v174, v174
  v_fmac_f32 v177, 0x43200000, v168
  v_mov_b32 v168, 0x3727c5ac
  v_fmac_f32 v168, 0x3acccccd, v177
  v_rsq_f32_e64 v168, v168
  v_pk_add_f32 v[164:165], v[180:181], v[176:177] op_sel_hi:[1,0] neg_lo:[0,1] neg_hi:[0,1]
  v_pk_add_f32 v[166:167], v[182:183], v[176:177] op_sel_hi:[1,0] neg_lo:[0,1] neg_hi:[0,1]
  v_pk_mul_f32 v[164:165], v[164:165], v[168:169] op_sel_hi:[1,0]
  v_pk_mul_f32 v[166:167], v[166:167], v[168:169] op_sel_hi:[1,0]
  v_pk_fma_f32 v[164:165], v[164:165], v[48:49], v[44:45]
  v_pk_fma_f32 v[166:167], v[166:167], v[50:51], v[46:47]
  v_cvt_pk_bf16_f32 v164, v164, v165
  v_cvt_pk_bf16_f32 v165, v166, v167
  buffer_store_dwordx2 v[164:165], v12, s[4:7], s65 offen sc1
  v_lshlrev_b32_e64 v190, 1, v11
  buffer_load_dwordx4 v[168:171], v4, s[4:7], s69 offen offset:0 sc1
  buffer_load_dwordx2 v[184:185], v190, s[4:7], s55 offen offset:0 sc1
  buffer_load_dwordx4 v[172:175], v4, s[4:7], s69 offen offset:512 sc1
  buffer_load_dwordx2 v[186:187], v190, s[4:7], s55 offen offset:512 sc1
  buffer_load_dwordx4 v[176:179], v4, s[4:7], s69 offen offset:1024 sc1
  buffer_load_dwordx4 v[180:183], v4, s[4:7], s69 offen offset:1536 sc1
  s_waitcnt vmcnt(6)
  s_barrier
  s_cmp_lg_u32 s12, 0
  s_cbranch_scc1 L_ps_30_s
  s_lshl_b32 s58, s13, 2
  s_add_u32 s58, s58, s66
  v_mov_b32 v2, s62
  s_mov_b64 exec, 1
  buffer_store_dword v2, v0, s[4:7], s58 offen offset:128 sc1
  s_mov_b64 exec, -1
L_ps_30_s:
  s_branch L_q_att_s
  s_nop 0
L_q_loop_s:
  s_sub_u32 s93, s62, 1
  buffer_load_dwordx4 v[156:159], v9, s[4:7], s72 offen offset:1024 sc1
  s_add_u32 s58, s72, 20480
  buffer_load_dwordx4 v[160:163], v9, s[4:7], s58 offen offset:1024 sc1
  buffer_load_dwordx4 v[124:127], v8, s[4:7], s72 offen sc1
  s_add_u32 s58, s72, 5120
  buffer_load_dwordx4 v[128:131], v8, s[4:7], s58 offen sc1
  s_add_u32 s58, s72, 10240
  buffer_load_dwordx4 v[132:135], v8, s[4:7], s58 offen sc1
  s_add_u32 s58, s72, 15360
  buffer_load_dwordx4 v[136:139], v8, s[4:7], s58 offen sc1
  s_add_u32 s58, s72, 20480
  buffer_load_dwordx4 v[140:143], v8, s[4:7], s58 offen sc1
  s_add_u32 s58, s72, 25600
  buffer_load_dwordx4 v[144:147], v8, s[4:7], s58 offen sc1
  s_add_u32 s58, s72, 30720
  buffer_load_dwordx4 v[148:151], v8, s[4:7], s58 offen sc1
  s_add_u32 s58, s72, 35840
  buffer_load_dwordx4 v[152:155], v8, s[4:7], s58 offen sc1
  s_waitcnt vmcnt(10)
  s_barrier
  s_cmp_lg_u32 s12, 0
  s_cbranch_scc1 L_ps_31_s
  s_lshl_b32 s58, s13, 2
  s_add_u32 s58, s58, s66
  v_mov_b32 v2, s93
  s_mov_b64 exec, 1
  buffer_store_dword v2, v0, s[4:7], s58 offen offset:256 sc1
  s_mov_b64 exec, -1
L_ps_31_s:
  v_lshlrev_b32 v168, 16, v56
  v_and_b32 v169, 0xffff0000, v56
  v_lshlrev_b32 v170, 16, v57
  v_and_b32 v171, 0xffff0000, v57
  s_lshl_b32 s58, s12, 3
  s_add_u32 s58, s58, 135168
  v_mov_b32 v2, s58
  v_mov_b32 v3, 135168
  s_waitcnt vmcnt(9)
  v_mfma_f32_16x16x32_bf16 v[164:167], v[20:23], v[156:159], 0
  s_waitcnt vmcnt(8)
  v_mfma_f32_16x16x32_bf16 v[164:167], v[20:23], v[160:163], v[164:167]
  s_nop 0
  s_nop 0
  s_nop 5
  v_add_f32_dpp v164, v164, v164 row_ror:4 row_mask:0xf bank_mask:0xf
  v_add_f32_dpp v165, v165, v165 row_ror:4 row_mask:0xf bank_mask:0xf
  v_add_f32_dpp v166, v166, v166 row_ror:4 row_mask:0xf bank_mask:0xf
  v_add_f32_dpp v167, v167, v167 row_ror:4 row_mask:0xf bank_mask:0xf
  v_add_f32_dpp v164, v164, v164 row_ror:8 row_mask:0xf bank_mask:0xf
  v_add_f32_dpp v165, v165, v165 row_ror:8 row_mask:0xf bank_mask:0xf
  v_add_f32_dpp v166, v166, v166 row_ror:8 row_mask:0xf bank_mask:0xf
  v_add_f32_dpp v167, v167, v167 row_ror:8 row_mask:0xf bank_mask:0xf
  s_waitcnt vmcnt(7)
  s_nop 0
  v_mfma_f32_16x16x32_bf16 v[164:167], v[16:19], v[124:127], v[164:167]
  s_waitcnt vmcnt(6)
  v_mfma_f32_16x16x32_bf16 v[164:167], v[16:19], v[128:131], v[164:167]
  s_waitcnt vmcnt(5)
  v_mfma_f32_16x16x32_bf16 v[164:167], v[16:19], v[132:135], v[164:167]
  s_waitcnt vmcnt(4)
  v_mfma_f32_16x16x32_bf16 v[164:167], v[16:19], v[136:139], v[164:167]
  s_waitcnt vmcnt(3)
  v_mfma_f32_16x16x32_bf16 v[164:167], v[16:19], v[140:143], v[164:167]
  s_nop 0
  s_waitcnt vmcnt(2)
  v_mfma_f32_16x16x32_bf16 v[164:167], v[16:19], v[144:147], v[164:167]
  s_waitcnt vmcnt(1)
  v_mfma_f32_16x16x32_bf16 v[164:167], v[16:19], v[148:151], v[164:167]
  s_waitcnt vmcnt(0)
  v_mfma_f32_16x16x32_bf16 v[164:167], v[16:19], v[152:155], v[164:167]
  s_nop 0
  s_nop 0
  s_nop 5
  v_cvt_pk_bf16_f32 v165, v164, v165
  v_lshlrev_b32 v164, 16, v165
  v_and_b32 v165, 0xffff0000, v165
  v_pk_fma_f32 v[180:181], v[164:165], v[40:41], v[168:169]
  v_cvt_pk_bf16_f32 v56, v180, v181
  v_lshlrev_b32_e64 v180, 16, v56
  v_and_b32 v181, 0xffff0000, v56
  v_cvt_pk_bf16_f32 v167, v166, v167
  v_lshlrev_b32_e64 v166, 16, v167
  v_and_b32 v167, 0xffff0000, v167
  v_pk_fma_f32 v[182:183], v[166:167], v[42:43], v[170:171]
  v_cvt_pk_bf16_f32 v57, v182, v183
  v_lshlrev_b32 v182, 16, v57
  v_and_b32 v183, 0xffff0000, v57
  v_readfirstlane_b32 s58, v180
  s_nop 0
  s_nop 0
  v_subrev_f32 v164, s58, v180
  v_subrev_f32 v165, s58, v181
  v_subrev_f32 v166, s58, v182
  v_subrev_f32 v167, s58, v183
  v_pk_add_f32 v[168:169], v[164:165], v[166:167]
  v_pk_mul_f32 v[170:171], v[164:165], v[164:165]
  v_pk_fma_f32 v[170:171], v[166:167], v[166:167], v[170:171]
  v_add_f32 v168, v168, v169
  v_add_f32 v169, v170, v171
  v_cndmask_b32 v168, 0, v168, s[98:99]
  v_cndmask_b32 v169, 0, v169, s[98:99]
  s_nop 0
  v_add_f32_dpp v168, v168, v168 quad_perm:[1,0,3,2] row_mask:0xf bank_mask:0xf
  v_add_f32_dpp v169, v169, v169 quad_perm:[1,0,3,2] row_mask:0xf bank_mask:0xf
  s_nop 0
  v_add_f32_dpp v168, v168, v168 quad_perm:[2,3,0,1] row_mask:0xf bank_mask:0xf
  v_add_f32_dpp v169, v169, v169 quad_perm:[2,3,0,1] row_mask:0xf bank_mask:0xf
  s_nop 0
  v_add_f32_dpp v168, v168, v168 row_ror:4 row_mask:0xf bank_mask:0xf
  v_add_f32_dpp v169, v169, v169 row_ror:4 row_mask:0xf bank_mask:0xf
  s_nop 0
  v_add_f32_dpp v168, v168, v168 row_ror:8 row_mask:0xf bank_mask:0xf
  v_add_f32_dpp v169, v169, v169 row_ror:8 row_mask:0xf bank_mask:0xf
  buffer_load_dword v24, v11, s[4:7], s66 offen offset:256 sc1
  v_mov_b64 v[170:171], v[168:169]
  s_nop 1
  v_permlane16_swap_b32 v168, v170
  v_permlane16_swap_b32 v169, v171
  v_pk_add_f32 v[168:169], v[168:169], v[170:171]
  v_mov_b64 v[170:171], v[168:169]
  s_nop 0
  s_nop 0
  v_permlane32_swap_b32 v168, v170
  v_permlane32_swap_b32 v169, v171
  v_pk_add_f32 v[168:169], v[168:169], v[170:171]
  v_mul_f32 v170, 0x3bcccccd, v168
  v_fma_f32 v169, -v170, v168, v169
  v_add_f32 v168, s58, v170
  s_mov_b64 exec, 1
  ds_write_b64 v2, v[168:169]
  s_mov_b64 exec, -1
  s_waitcnt lgkmcnt(0)
  s_barrier
  ds_read_b128 v[168:171], v3
  ds_read_b128 v[172:175], v3 offset:16
  s_waitcnt lgkmcnt(1)
  v_pk_add_f32 v[176:177], v[168:169], v[170:171]
  s_waitcnt lgkmcnt(0)
  v_pk_add_f32 v[178:179], v[172:173], v[174:175]
  v_pk_add_f32 v[176:177], v[176:177], v[178:179]
  v_mul_f32 v176, 0x3e800000, v176
  v_sub_f32 v168, v168, v176
  v_sub_f32 v170, v170, v176
  v_sub_f32 v172, v172, v176
  v_sub_f32 v174, v174, v176
  v_mul_f32 v168, v168, v168
  v_fmac_f32 v168, v170, v170
  v_fmac_f32 v168, v172, v172
  v_fmac_f32 v168, v174, v174
  v_fmac_f32 v177, 0x43200000, v168
  v_mov_b32 v168, 0x3727c5ac
  v_fmac_f32 v168, 0x3acccccd, v177
  v_rsq_f32_e64 v168, v168
  v_pk_add_f32 v[164:165], v[180:181], v[176:177] op_sel_hi:[1,0] neg_lo:[0,1] neg_hi:[0,1]
  v_pk_add_f32 v[166:167], v[182:183], v[176:177] op_sel_hi:[1,0] neg_lo:[0,1] neg_hi:[0,1]
  v_pk_mul_f32 v[164:165], v[164:165], v[168:169] op_sel_hi:[1,0]
  v_pk_mul_f32 v[166:167], v[166:167], v[168:169] op_sel_hi:[1,0]
  v_pk_fma_f32 v[164:165], v[164:165], v[48:49], v[44:45]
  v_pk_fma_f32 v[166:167], v[166:167], v[50:51], v[46:47]
  v_cvt_pk_bf16_f32 v164, v164, v165
  v_cvt_pk_bf16_f32 v165, v166, v167
  buffer_store_dwordx2 v[164:165], v12, s[4:7], s65 offen sc1
  s_mov_b32 exec_lo, 0x7ffffff
  s_mov_b32 exec_hi, 0
  s_waitcnt vmcnt(1)
  v_cmp_gt_u32 vcc, s93, v24
  s_cbranch_vccz L_pw_32y_s
L_pw_32_s:
  buffer_load_dword v2, v11, s[4:7], s66 offen offset:256 sc1
  s_sub_u32 s54, s54, 1
  s_cbranch_scc1 L_end
  s_waitcnt vmcnt(0)
  v_cmp_gt_u32 vcc, s93, v2
  s_cbranch_vccnz L_pw_32_s
L_pw_32y_s:
  s_mov_b64 exec, -1
L_pw_32x_s:
  v_mov_b32 v3, 0x7f000000
  v_cndmask_b32 v2, v3, v8, s[100:101]
  v_cndmask_b32 v3, v3, v9, s[70:71]
  buffer_load_dwordx4 v[156:159], v9, s[4:7], s73 offen offset:1024 sc1
  s_add_u32 s58, s73, 20480
  buffer_load_dwordx4 v[160:163], v3, s[4:7], s58 offen offset:1024 sc1
  buffer_load_dwordx4 v[124:127], v8, s[4:7], s73 offen sc1
  s_add_u32 s58, s73, 5120
  buffer_load_dwordx4 v[128:131], v8, s[4:7], s58 offen sc1
  s_add_u32 s58, s73, 10240
  buffer_load_dwordx4 v[132:135], v8, s[4:7], s58 offen sc1
  s_add_u32 s58, s73, 15360
  buffer_load_dwordx4 v[136:139], v8, s[4:7], s58 offen sc1
  s_add_u32 s58, s73, 20480
  buffer_load_dwordx4 v[140:143], v8, s[4:7], s58 offen sc1
  s_add_u32 s58, s73, 25600
  buffer_load_dwordx4 v[144:147], v8, s[4:7], s58 offen sc1
  s_add_u32 s58, s73, 30720
  buffer_load_dwordx4 v[148:151], v2, s[4:7], s58 offen sc1
  s_waitcnt vmcnt(9)
  s_barrier
  s_cmp_lg_u32 s12, 0
  s_cbranch_scc1 L_ps_33_s
  s_lshl_b32 s58, s13, 2
  s_add_u32 s58, s58, s66
  v_mov_b32 v2, s62
  s_mov_b64 exec, 1
  buffer_store_dword v2, v0, s[4:7], s58 offen offset:128 sc1
  s_mov_b64 exec, -1
L_ps_33_s:
  v_lshlrev_b32 v190, 1, v11
  buffer_load_dwordx4 v[168:171], v4, s[4:7], s69 offen offset:0 sc1
  buffer_load_dwordx2 v[184:185], v190, s[4:7], s55 offen offset:0 sc1
  buffer_load_dwordx4 v[172:175], v4, s[4:7], s69 offen offset:512 sc1
  buffer_load_dwordx2 v[186:187], v190, s[4:7], s55 offen offset:512 sc1
  buffer_load_dwordx4 v[176:179], v4, s[4:7], s69 offen offset:1024 sc1
  buffer_load_dwordx4 v[180:183], v4, s[4:7], s69 offen offset:1536 sc1
  s_waitcnt vmcnt(14)
  v_mfma_f32_16x16x32_bf16 v[164:167], v[20:23], v[156:159], 0
  s_waitcnt vmcnt(13)
  v_mfma_f32_16x16x32_bf16 v[164:167], v[20:23], v[160:163], v[164:167]
  s_nop 0
  s_nop 0
  s_nop 0
  s_nop 4
  v_add_f32_dpp v164, v164, v164 row_ror:4 row_mask:0xf bank_mask:0xf
  v_add_f32_dpp v165, v165, v165 row_ror:4 row_mask:0xf bank_mask:0xf
  v_add_f32_dpp v166, v166, v166 row_ror:4 row_mask:0xf bank_mask:0xf
  v_add_f32_dpp v167, v167, v167 row_ror:4 row_mask:0xf bank_mask:0xf
  v_add_f32_dpp v164, v164, v164 row_ror:8 row_mask:0xf bank_mask:0xf
  v_add_f32_dpp v165, v165, v165 row_ror:8 row_mask:0xf bank_mask:0xf
  v_add_f32_dpp v166, v166, v166 row_ror:8 row_mask:0xf bank_mask:0xf
  v_add_f32_dpp v167, v167, v167 row_ror:8 row_mask:0xf bank_mask:0xf
  s_waitcnt vmcnt(12)
  s_nop 0
  v_mfma_f32_16x16x32_bf16 v[164:167], v[16:19], v[124:127], v[164:167]
  s_waitcnt vmcnt(11)
  v_mfma_f32_16x16x32_bf16 v[164:167], v[16:19], v[128:131], v[164:167]
  s_waitcnt vmcnt(10)
  v_mfma_f32_16x16x32_bf16 v[164:167], v[16:19], v[132:135], v[164:167]
  s_nop 0
  s_waitcnt vmcnt(9)
  v_mfma_f32_16x16x32_bf16 v[164:167], v[16:19], v[136:139], v[164:167]
  s_waitcnt vmcnt(8)
  v_mfma_f32_16x16x32_bf16 v[164:167], v[16:19], v[140:143], v[164:167]
  s_waitcnt vmcnt(7)
  v_mfma_f32_16x16x32_bf16 v[164:167], v[16:19], v[144:147], v[164:167]
  s_waitcnt vmcnt(6)
  v_mfma_f32_16x16x32_bf16 v[164:167], v[16:19], v[148:151], v[164:167]
  v_lshlrev_b32 v160, 16, v58
  v_and_b32 v161, 0xffff0000, v58
  v_lshlrev_b32_e64 v162, 16, v59
  v_and_b32 v163, 0xffff0000, v59
  s_nop 0
  s_nop 0
  s_nop 0
  s_nop 0
  v_cvt_pk_bf16_f32 v165, v164, v165
  v_lshlrev_b32 v164, 16, v165
  v_and_b32 v165, 0xffff0000, v165
  v_pk_fma_f32 v[164:165], v[164:165], v[52:53], v[160:161]
  v_cvt_pk_bf16_f32 v167, v166, v167
  v_lshlrev_b32 v166, 16, v167
  v_and_b32 v167, 0xffff0000, v167
  v_pk_fma_f32 v[166:167], v[166:167], v[54:55], v[162:163]
  v_cvt_pk_bf16_f32 v164, v164, v165
  v_cvt_pk_bf16_f32 v165, v166, v167
  buffer_store_dwordx2 v[164:165], v10, s[48:51], s92 offen
  s_waitcnt vmcnt(63)
  s_barrier
  s_cmp_lg_u32 s12, 0
  s_cbranch_scc1 L_ps_34_s
  s_lshl_b32 s58, s13, 2
  s_add_u32 s58, s58, s66
  v_mov_b32 v2, s93
  s_mov_b64 exec, 1
  buffer_store_dword v2, v0, s[4:7], s58 offen offset:384 sc1
  s_mov_b64 exec, -1
L_ps_34_s:
L_q_att_s:
  s_mov_b32 s92, s2
  v_mov_b64 v[58:59], v[56:57]
  s_cmp_lt_u32 s61, 56
  s_cbranch_scc1 L_q_go_s
  s_sub_u32 s93, s62, 1
  s_cmp_lg_u32 s12, 0
  s_cbranch_scc1 L_pw_35x_s
  s_mov_b32 exec_lo, 0xffffffff
  s_mov_b32 exec_hi, 0
L_pw_35_s:
  buffer_load_dword v2, v11, s[4:7], s66 offen offset:384 sc1
  s_sub_u32 s54, s54, 1
  s_cbranch_scc1 L_end
  s_waitcnt vmcnt(0)
  v_cmp_gt_u32 vcc, s93, v2
  s_cbranch_vccnz L_pw_35_s
L_pw_35y_s:
  s_mov_b64 exec, -1
L_pw_35x_s:
  s_barrier
  s_waitcnt vmcnt(0)
  s_branch L_p_join_s
  s_nop 0
L_q_go_s:
  s_add_u32 s96, s62, 1
  s_sub_u32 s93, s62, 1
  v_mfma_f32_16x16x32_bf16 v[124:127], v[76:79], v[60:63], 0
  v_mfma_f32_16x16x32_bf16 v[124:127], v[84:87], v[64:67], v[124:127]
  v_mfma_f32_16x16x32_bf16 v[124:127], v[92:95], v[68:71], v[124:127]
  v_mfma_f32_16x16x32_bf16 v[124:127], v[100:103], v[72:75], v[124:127]
  v_mfma_f32_16x16x32_bf16 v[128:131], v[80:83], v[60:63], 0
  v_mfma_f32_16x16x32_bf16 v[128:131], v[88:91], v[64:67], v[128:131]
  v_mfma_f32_16x16x32_bf16 v[128:131], v[96:99], v[68:71], v[128:131]
  v_mfma_f32_16x16x32_bf16 v[128:131], v[104:107], v[72:75], v[128:131]
  v_mov_b32 v3, 0xff800000
  v_cndmask_b32 v124, v3, v124, s[76:77]
  v_cndmask_b32 v125, v3, v125, s[78:79]
  v_cndmask_b32 v126, v3, v126, s[80:81]
  v_cndmask_b32 v127, v3, v127, s[82:83]
  s_nop 0
  s_nop 1
  v_cndmask_b32 v128, v3, v128, s[84:85]
  v_cndmask_b32 v129, v3, v129, s[86:87]
  v_cndmask_b32 v130, v3, v130, s[88:89]
  v_cndmask_b32 v131, v3, v131, s[90:91]
  v_max_f32 v136, v124, v125
  v_max3_f32 v136, v136, v126, v127
  v_max3_f32 v136, v136, v128, v129
  v_max3_f32 v136, v136, v130, v131
  s_branch L_p_km1q_s
L_p_prq_s:
  s_cmp_ge_u32 s61, 58
  s_cbranch_scc1 L_p_kmq_s
  s_sleep 2
  v_lshlrev_b32 v190, 1, v11
  s_mov_b32 exec_lo, 1
  s_mov_b32 exec_hi, 1
  buffer_load_dword v188, v190, s[4:7], s55 offen offset:512 sc1
  s_mov_b64 exec, -1
  s_sub_u32 s54, s54, 1
  s_cbranch_scc1 L_end
  s_waitcnt vmcnt(0)
  v_cmp_eq_u32 vcc, -1, v188
  s_nop 0
  s_or_b32 s58, vcc_lo, vcc_hi
  s_bitcmp1_b32 s58, 0
  s_cbranch_scc1 L_p_prq_s
L_p_kmq_s:
  v_lshlrev_b32 v190, 1, v11
  buffer_load_dwordx4 v[168:171], v4, s[4:7], s69 offen offset:0 sc1
  buffer_load_dwordx2 v[184:185], v190, s[4:7], s55 offen offset:0 sc1
  buffer_load_dwordx4 v[172:175], v4, s[4:7], s69 offen offset:512 sc1
  buffer_load_dwordx2 v[186:187], v190, s[4:7], s55 offen offset:512 sc1
  buffer_load_dwordx4 v[176:179], v4, s[4:7], s69 offen offset:1024 sc1
  buffer_load_dwordx4 v[180:183], v4, s[4:7], s69 offen offset:1536 sc1
L_p_km1q_s:
  s_sub_u32 s54, s54, 1
  s_cbranch_scc1 L_end
  s_waitcnt vmcnt(0)
  v_max3_u32 v2, v168, v172, v176
  v_max3_u32 v2, v2, v180, v184
  v_max_u32 v2, v2, v186
  v_cmp_eq_u32 vcc, -1, v2
  s_cbranch_vccnz L_p_prq_s
  buffer_load_dword v24, v11, s[4:7], s66 offen offset:128 sc1
  buffer_load_dwordx2 v[56:57], v10, s[16:19], s74 offen
  v_mfma_f32_16x16x32_bf16 v[132:135], v[168:171], v[60:63], 0
  v_mfma_f32_16x16x32_bf16 v[132:135], v[172:175], v[64:67], v[132:135]
  v_mfma_f32_16x16x32_bf16 v[132:135], v[176:179], v[68:71], v[132:135]
  v_mfma_f32_16x16x32_bf16 v[132:135], v[180:183], v[72:75], v[132:135]
  s_nop 7
  v_max3_f32 v136, v136, v132, v133
  v_mov_b32 v137, v136
  s_nop 1
  v_permlane16_swap_b32 v136, v137
  v_max_f32 v136, v136, v137
  v_mov_b32 v137, v136
  s_nop 1
  v_permlane32_swap_b32 v136, v137
  v_max_f32 v136, v136, v137
  v_mul_f32 v136, s97, v136
  v_fma_f32 v124, v124, s97, -v136
  v_fma_f32 v125, v125, s97, -v136
  v_fma_f32 v126, v126, s97, -v136
  v_fma_f32 v127, v127, s97, -v136
  v_fma_f32 v128, v128, s97, -v136
  v_fma_f32 v129, v129, s97, -v136
  v_fma_f32 v130, v130, s97, -v136
  v_fma_f32 v131, v131, s97, -v136
  v_fma_f32 v132, v132, s97, -v136
  v_fma_f32 v133, v133, s97, -v136
  v_exp_f32 v124, v124
  v_exp_f32 v125, v125
  v_exp_f32 v126, v126
  v_exp_f32 v127, v127
  v_exp_f32 v128, v128
  v_exp_f32 v129, v129
  v_exp_f32 v130, v130
  v_exp_f32 v131, v131
  v_exp_f32 v132, v132
  v_exp_f32 v133, v133
  v_cvt_pk_bf16_f32 v138, v124, v125
  v_cvt_pk_bf16_f32 v139, v126, v127
  v_cvt_pk_bf16_f32 v140, v128, v129
  v_cvt_pk_bf16_f32 v141, v130, v131
  v_cvt_pk_bf16_f32 v142, v132, v133
  v_mov_b32 v143, 0
  v_mov_b32 v144, 0
  v_mov_b32_e64 v145, v142
  v_mfma_f32_16x16x32_bf16 v[168:171], v[108:111], v[138:141], 0
  v_mfma_f32_16x16x32_bf16 v[172:175], v[112:115], v[138:141], 0
  v_mfma_f32_16x16x32_bf16 v[176:179], v[116:119], v[138:141], 0
  v_mfma_f32_16x16x32_bf16 v[180:183], v[120:123], v[138:141], 0
  v_mfma_f32_16x16x16_bf16 v[168:171], v[184:185], v[142:143], v[168:171]
  v_mfma_f32_16x16x16_bf16 v[172:175], v[184:185], v[144:145], v[172:175]
  v_mfma_f32_16x16x16_bf16 v[176:179], v[186:187], v[142:143], v[176:179]
  v_mfma_f32_16x16x16_bf16 v[180:183], v[186:187], v[144:145], v[180:183]
  v_add_f32 v124, v124, v125
  v_add_f32 v124, v124, v126
  v_add_f32 v124, v124, v127
  v_add_f32 v124, v124, v128
  v_add_f32 v124, v124, v129
  v_add_f32 v124, v124, v130
  v_add_f32 v124, v124, v131
  v_add_f32 v124, v124, v132
  v_add_f32 v124, v124, v133
  v_mov_b32 v137, v124
  s_nop 1
  v_permlane16_swap_b32 v124, v137
  v_add_f32 v124, v124, v137
  v_mov_b32 v137, v124
  s_nop 0
  s_nop 0
  v_permlane32_swap_b32 v124, v137
  v_add_f32 v124, v124, v137
  v_rcp_f32 v124, v124
  s_nop 0
  v_pk_mul_f32 v[168:169], v[168:169], v[124:125] op_sel_hi:[1,0]
  v_pk_mul_f32 v[170:171], v[170:171], v[124:125] op_sel_hi:[1,0]
  v_pk_mul_f32 v[172:173], v[172:173], v[124:125] op_sel_hi:[1,0]
  v_pk_mul_f32 v[174:175], v[174:175], v[124:125] op_sel_hi:[1,0]
  v_pk_mul_f32 v[176:177], v[176:177], v[124:125] op_sel_hi:[1,0]
  v_pk_mul_f32 v[178:179], v[178:179], v[124:125] op_sel_hi:[1,0]
  v_pk_mul_f32 v[180:181], v[180:181], v[124:125] op_sel_hi:[1,0]
  v_pk_mul_f32 v[182:183], v[182:183], v[124:125] op_sel_hi:[1,0]
  v_cvt_pk_bf16_f32 v128, v168, v172
  v_cvt_pk_bf16_f32 v129, v176, v180
  v_cvt_pk_bf16_f32 v130, v169, v173
  v_cvt_pk_bf16_f32 v131, v177, v181
  v_cvt_pk_bf16_f32 v132, v170, v174
  v_cvt_pk_bf16_f32 v133, v178, v182
  v_cvt_pk_bf16_f32 v134, v171, v175
  v_cvt_pk_bf16_f32 v135, v179, v183
  ds_write_b128 v5, v[128:131]
  ds_write_b128 v5, v[132:135] offset:512
  s_mov_b32 exec_lo, 0xffffffff
  s_mov_b32 exec_hi, 0
  s_waitcnt vmcnt(1)
  v_cmp_gt_u32 vcc, s62, v24
  s_cbranch_vccz L_pw_36y_s
L_pw_36_s:
  buffer_load_dword v2, v11, s[4:7], s66 offen offset:128 sc1
  s_sub_u32 s54, s54, 1
  s_cbranch_scc1 L_end
  s_waitcnt vmcnt(0)
  v_cmp_gt_u32 vcc, s62, v2
  s_cbranch_vccnz L_pw_36_s
L_pw_36y_s:
  s_mov_b64 exec, -1
L_pw_36x_s:
  s_and_b32 s58, s52, s3
  s_lshl_b32 s58, s58, 12
  s_add_u32 s58, s58, 122880
  v_add_u32 v2, s58, v1
  s_waitcnt lgkmcnt(0)
  s_barrier
  ds_read_b128 v[76:79], v2 offset:0
  ds_read_b128 v[80:83], v2 offset:1024
  ds_read_b128 v[84:87], v2 offset:2048
  ds_read_b128 v[88:91], v2 offset:3072
  ds_read_b128 v[92:95], v2 offset:4096
  ds_read_b128 v[96:99], v2 offset:5120
  ds_read_b128 v[100:103], v2 offset:6144
  ds_read_b128 v[104:107], v2 offset:7168
  s_waitcnt lgkmcnt(7)
  v_mfma_f32_16x16x32_bf16 v[124:127], v[76:79], a[0:3], 0
  s_waitcnt lgkmcnt(6)
  v_mfma_f32_16x16x32_bf16 v[124:127], v[80:83], a[4:7], v[124:127]
  s_nop 0
  s_waitcnt lgkmcnt(5)
  v_mfma_f32_16x16x32_bf16 v[124:127], v[84:87], a[8:11], v[124:127]
  s_waitcnt lgkmcnt(4)
  v_mfma_f32_16x16x32_bf16 v[124:127], v[88:91], a[12:15], v[124:127]
  s_lshl_b32 s60, s12, 11
  s_add_u32 m0, s60, 0
  s_add_u32 s60, s65, m0
  buffer_load_dwordx4 v1, s[4:7], s60 offen sc1 lds
  v_mfma_f32_16x16x32_bf16 v[128:131], v[76:79], a[16:19], 0
  v_mfma_f32_16x16x32_bf16 v[128:131], v[80:83], a[20:23], v[128:131]
  v_mfma_f32_16x16x32_bf16 v[128:131], v[84:87], a[24:27], v[128:131]
  v_mfma_f32_16x16x32_bf16 v[128:131], v[88:91], a[28:31], v[128:131]
  s_lshl_b32 s60, s12, 11
  s_add_u32 m0, s60, 8192
  s_add_u32 s60, s65, m0
  buffer_load_dwordx4 v1, s[4:7], s60 offen sc1 lds
  v_mfma_f32_16x16x32_bf16 v[132:135], v[76:79], a[32:35], 0
  v_mfma_f32_16x16x32_bf16 v[132:135], v[80:83], a[36:39], v[132:135]
  v_mfma_f32_16x16x32_bf16 v[132:135], v[84:87], a[40:43], v[132:135]
  v_mfma_f32_16x16x32_bf16 v[132:135], v[88:91], a[44:47], v[132:135]
  s_lshl_b32 s60, s12, 11
  s_add_u32 m0, s60, 16384
  s_add_u32 s60, s65, m0
  buffer_load_dwordx4 v1, s[4:7], s60 offen sc1 lds
  v_mfma_f32_16x16x32_bf16 v[136:139], v[76:79], a[48:51], 0
  v_mfma_f32_16x16x32_bf16 v[136:139], v[80:83], a[52:55], v[136:139]
  v_mfma_f32_16x16x32_bf16 v[136:139], v[84:87], a[56:59], v[136:139]
  v_mfma_f32_16x16x32_bf16 v[136:139], v[88:91], a[60:63], v[136:139]
  s_lshl_b32 s60, s12, 11
  s_add_u32 m0, s60, 24576
  s_add_u32 s60, s65, m0
  buffer_load_dwordx4 v1, s[4:7], s60 offen sc1 lds
  v_mfma_f32_16x16x32_bf16 v[140:143], v[76:79], a[64:67], 0
  v_mfma_f32_16x16x32_bf16 v[140:143], v[80:83], a[68:71], v[140:143]
  v_mfma_f32_16x16x32_bf16 v[140:143], v[84:87], a[72:75], v[140:143]
  v_mfma_f32_16x16x32_bf16 v[140:143], v[88:91], a[76:79], v[140:143]
  s_lshl_b32 s60, s12, 11
  s_add_u32 m0, s60, 32768
  s_add_u32 s60, s65, m0
  buffer_load_dwordx4 v1, s[4:7], s60 offen sc1 lds
  v_mfma_f32_16x16x32_bf16 v[144:147], v[76:79], a[80:83], 0
  v_mfma_f32_16x16x32_bf16 v[144:147], v[80:83], a[84:87], v[144:147]
  v_mfma_f32_16x16x32_bf16 v[144:147], v[84:87], a[88:91], v[144:147]
  v_mfma_f32_16x16x32_bf16 v[144:147], v[88:91], a[92:95], v[144:147]
  s_lshl_b32 s60, s12, 11
  s_add_u32 m0, s60, 1024
  s_add_u32 s60, s65, m0
  buffer_load_dwordx4 v1, s[4:7], s60 offen sc1 lds
  v_mfma_f32_16x16x32_bf16 v[148:151], v[76:79], a[96:99], 0
  v_mfma_f32_16x16x32_bf16 v[148:151], v[80:83], a[100:103], v[148:151]
  v_mfma_f32_16x16x32_bf16 v[148:151], v[84:87], a[104:107], v[148:151]
  v_mfma_f32_16x16x32_bf16 v[148:151], v[88:91], a[108:111], v[148:151]
  s_lshl_b32 s60, s12, 11
  s_add_u32 m0, s60, 9216
  s_add_u32 s60, s65, m0
  buffer_load_dwordx4 v1, s[4:7], s60 offen sc1 lds
  v_mfma_f32_16x16x32_bf16 v[152:155], v[76:79], a[112:115], 0
  v_mfma_f32_16x16x32_bf16 v[152:155], v[80:83], a[116:119], v[152:155]
  v_mfma_f32_16x16x32_bf16 v[152:155], v[84:87], a[120:123], v[152:155]
  v_mfma_f32_16x16x32_bf16 v[152:155], v[88:91], a[124:127], v[152:155]
  s_lshl_b32 s60, s12, 11
  s_add_u32 m0, s60, 17408
  s_add_u32 s60, s65, m0
  buffer_load_dwordx4 v1, s[4:7], s60 offen sc1 lds
  v_mfma_f32_16x16x32_bf16 v[156:159], v[76:79], a[128:131], 0
  v_mfma_f32_16x16x32_bf16 v[156:159], v[80:83], a[132:135], v[156:159]
  v_mfma_f32_16x16x32_bf16 v[156:159], v[84:87], a[136:139], v[156:159]
  v_mfma_f32_16x16x32_bf16 v[156:159], v[88:91], a[140:143], v[156:159]
  s_lshl_b32 s60, s12, 11
  s_add_u32 m0, s60, 25600
  s_add_u32 s60, s65, m0
  buffer_load_dwordx4 v1, s[4:7], s60 offen sc1 lds
  v_mfma_f32_16x16x32_bf16 v[160:163], v[76:79], a[144:147], 0
  v_mfma_f32_16x16x32_bf16 v[160:163], v[80:83], a[148:151], v[160:163]
  v_mfma_f32_16x16x32_bf16 v[160:163], v[84:87], a[152:155], v[160:163]
  v_mfma_f32_16x16x32_bf16 v[160:163], v[88:91], a[156:159], v[160:163]
  s_lshl_b32 s60, s12, 11
  s_add_u32 m0, s60, 33792
  s_add_u32 s60, s65, m0
  buffer_load_dwordx4 v1, s[4:7], s60 offen sc1 lds
  v_cvt_pk_bf16_f32 v164, v124, v128
  v_cvt_pk_bf16_f32 v165, v132, v136
  v_cvt_pk_bf16_f32 v166, v140, v144
  v_cvt_pk_bf16_f32 v167, v148, v152
  v_cvt_pk_bf16_f32 v180, v156, v160
  v_cvt_pk_bf16_f32 v168, v125, v129
  v_cvt_pk_bf16_f32 v169, v133, v137
  v_cvt_pk_bf16_f32 v170, v141, v145
  v_cvt_pk_bf16_f32 v171, v149, v153
  v_cvt_pk_bf16_f32 v181, v157, v161
  v_cvt_pk_bf16_f32 v172, v126, v130
  v_cvt_pk_bf16_f32 v173, v134, v138
  v_cvt_pk_bf16_f32 v174, v142, v146
  v_cvt_pk_bf16_f32 v175, v150, v154
  v_cvt_pk_bf16_f32 v182, v158, v162
  v_cvt_pk_bf16_f32 v176, v127, v131
  v_cvt_pk_bf16_f32 v177, v135, v139
  v_cvt_pk_bf16_f32 v178, v143, v147
  v_cvt_pk_bf16_f32 v179, v151, v155
  v_cvt_pk_bf16_f32 v183, v159, v163
  s_waitcnt lgkmcnt(3)
  v_mfma_f32_16x16x32_bf16 v[124:127], v[92:95], a[0:3], 0
  s_waitcnt lgkmcnt(2)
  v_mfma_f32_16x16x32_bf16 v[124:127], v[96:99], a[4:7], v[124:127]
  s_nop 0
  s_waitcnt lgkmcnt(1)
  v_mfma_f32_16x16x32_bf16 v[124:127], v[100:103], a[8:11], v[124:127]
  s_waitcnt lgkmcnt(0)
  v_mfma_f32_16x16x32_bf16 v[124:127], v[104:107], a[12:15], v[124:127]
  s_add_u32 s58, s63, 0
  buffer_store_dwordx4 v[164:167], v6, s[4:7], s58 offen sc1
  v_mfma_f32_16x16x32_bf16 v[128:131], v[92:95], a[16:19], 0
  v_mfma_f32_16x16x32_bf16 v[128:131], v[96:99], a[20:23], v[128:131]
  v_mfma_f32_16x16x32_bf16 v[128:131], v[100:103], a[24:27], v[128:131]
  v_mfma_f32_16x16x32_bf16 v[128:131], v[104:107], a[28:31], v[128:131]
  buffer_store_dword v180, v7, s[4:7], s58 offen offset:1024 sc1
  v_mfma_f32_16x16x32_bf16 v[132:135], v[92:95], a[32:35], 0
  v_mfma_f32_16x16x32_bf16 v[132:135], v[96:99], a[36:39], v[132:135]
  v_mfma_f32_16x16x32_bf16 v[132:135], v[100:103], a[40:43], v[132:135]
  v_mfma_f32_16x16x32_bf16 v[132:135], v[104:107], a[44:47], v[132:135]
  s_add_u32 s58, s63, 41216
  buffer_store_dwordx4 v[168:171], v6, s[4:7], s58 offen sc1
  v_mfma_f32_16x16x32_bf16 v[136:139], v[92:95], a[48:51], 0
  v_mfma_f32_16x16x32_bf16 v[136:139], v[96:99], a[52:55], v[136:139]
  v_mfma_f32_16x16x32_bf16 v[136:139], v[100:103], a[56:59], v[136:139]
  v_mfma_f32_16x16x32_bf16 v[136:139], v[104:107], a[60:63], v[136:139]
  buffer_store_dword v181, v7, s[4:7], s58 offen offset:1024 sc1
  v_mfma_f32_16x16x32_bf16 v[140:143], v[92:95], a[64:67], 0
  v_mfma_f32_16x16x32_bf16 v[140:143], v[96:99], a[68:71], v[140:143]
  v_mfma_f32_16x16x32_bf16 v[140:143], v[100:103], a[72:75], v[140:143]
  v_mfma_f32_16x16x32_bf16 v[140:143], v[104:107], a[76:79], v[140:143]
  s_add_u32 s58, s63, 82432
  buffer_store_dwordx4 v[172:175], v6, s[4:7], s58 offen sc1
  v_mfma_f32_16x16x32_bf16 v[144:147], v[92:95], a[80:83], 0
  v_mfma_f32_16x16x32_bf16 v[144:147], v[96:99], a[84:87], v[144:147]
  v_mfma_f32_16x16x32_bf16 v[144:147], v[100:103], a[88:91], v[144:147]
  v_mfma_f32_16x16x32_bf16 v[144:147], v[104:107], a[92:95], v[144:147]
  buffer_store_dword v182, v7, s[4:7], s58 offen offset:1024 sc1
  v_mfma_f32_16x16x32_bf16 v[148:151], v[92:95], a[96:99], 0
  v_mfma_f32_16x16x32_bf16 v[148:151], v[96:99], a[100:103], v[148:151]
  v_mfma_f32_16x16x32_bf16 v[148:151], v[100:103], a[104:107], v[148:151]
  v_mfma_f32_16x16x32_bf16 v[148:151], v[104:107], a[108:111], v[148:151]
  s_add_u32 s58, s63, 123648
  buffer_store_dwordx4 v[176:179], v6, s[4:7], s58 offen sc1
  v_mfma_f32_16x16x32_bf16 v[152:155], v[92:95], a[112:115], 0
  v_mfma_f32_16x16x32_bf16 v[152:155], v[96:99], a[116:119], v[152:155]
  v_mfma_f32_16x16x32_bf16 v[152:155], v[100:103], a[120:123], v[152:155]
  v_mfma_f32_16x16x32_bf16 v[152:155], v[104:107], a[124:127], v[152:155]
  buffer_store_dword v183, v7, s[4:7], s58 offen offset:1024 sc1
  v_mfma_f32_16x16x32_bf16 v[156:159], v[92:95], a[128:131], 0
  v_mfma_f32_16x16x32_bf16 v[156:159], v[96:99], a[132:135], v[156:159]
  v_mfma_f32_16x16x32_bf16 v[156:159], v[100:103], a[136:139], v[156:159]
  v_mfma_f32_16x16x32_bf16 v[156:159], v[104:107], a[140:143], v[156:159]
  v_mfma_f32_16x16x32_bf16 v[160:163], v[92:95], a[144:147], 0
  v_mfma_f32_16x16x32_bf16 v[160:163], v[96:99], a[148:151], v[160:163]
  v_mfma_f32_16x16x32_bf16 v[160:163], v[100:103], a[152:155], v[160:163]
  v_mfma_f32_16x16x32_bf16 v[160:163], v[104:107], a[156:159], v[160:163]
  v_cvt_pk_bf16_f32 v164, v124, v128
  v_cvt_pk_bf16_f32 v165, v132, v136
  v_cvt_pk_bf16_f32 v166, v140, v144
  v_cvt_pk_bf16_f32 v167, v148, v152
  s_nop 0
  s_nop 2
  v_cvt_pk_bf16_f32 v180, v156, v160
  s_add_u32 s58, s63, 659456
  buffer_store_dwordx4 v[164:167], v6, s[4:7], s58 offen sc1
  buffer_store_dword v180, v7, s[4:7], s58 offen offset:1024 sc1
  v_cvt_pk_bf16_f32 v168, v125, v129
  v_cvt_pk_bf16_f32 v169, v133, v137
  v_cvt_pk_bf16_f32 v170, v141, v145
  v_cvt_pk_bf16_f32 v171, v149, v153
  v_cvt_pk_bf16_f32 v181, v157, v161
  s_add_u32 s58, s63, 700672
  buffer_store_dwordx4 v[168:171], v6, s[4:7], s58 offen sc1
  buffer_store_dword v181, v7, s[4:7], s58 offen offset:1024 sc1
  v_cvt_pk_bf16_f32 v172, v126, v130
  v_cvt_pk_bf16_f32 v173, v134, v138
  v_cvt_pk_bf16_f32 v174, v142, v146
  v_cvt_pk_bf16_f32 v175, v150, v154
  v_cvt_pk_bf16_f32 v182, v158, v162
  s_add_u32 s58, s63, 741888
  buffer_store_dwordx4 v[172:175], v6, s[4:7], s58 offen sc1
  buffer_store_dword v182, v7, s[4:7], s58 offen offset:1024 sc1
  v_cvt_pk_bf16_f32 v176, v127, v131
  v_cvt_pk_bf16_f32 v177, v135, v139
  v_cvt_pk_bf16_f32 v178, v143, v147
  v_cvt_pk_bf16_f32 v179, v151, v155
  v_cvt_pk_bf16_f32 v183, v159, v163
  s_add_u32 s58, s63, 783104
  buffer_store_dwordx4 v[176:179], v6, s[4:7], s58 offen sc1
  buffer_store_dword v183, v7, s[4:7], s58 offen offset:1024 sc1
L_ph_37x_s:
  s_mov_b32 s2, s74
  s_add_u32 s61, s61, 6
  s_lshr_b32 s58, s52, 1
  s_add_u32 s58, s58, 61
  s_sub_u32 s59, s61, 62
  s_cmp_lt_u32 s59, 4
  s_cselect_b32 s15, 1, 0
  s_cselect_b32 s61, s58, s61
  s_lshl_b32 s58, s61, 5
  s_add_u32 s58, s58, s13
  s_and_b32 s59, s52, s15
  s_lshl_b32 s59, s59, 4
  s_add_u32 s59, s59, s58
  s_mul_i32 s74, s59, 1280
  s_lshl_b32 s67, s58, 13
  s_and_b32 s59, s12, 1
  s_lshl_b32 s59, s59, 10
  s_add_u32 s67, s67, s59
  s_add_u32 s67, s67, 16777216
  s_lshl_b32 s68, s58, 14
  s_add_u32 s68, s68, 33554432
  s_lshr_b32 s69, s58, 2
  s_lshl_b32 s69, s69, 14
  s_and_b32 s59, s13, 3
  s_lshl_b32 s59, s59, 11
  s_add_u32 s69, s69, s59
  s_add_u32 s69, s69, 8388608
  s_lshr_b32 s59, s12, 1
  s_lshl_b32 s59, s59, 10
  s_add_u32 s55, s69, s59
  s_add_u32 s55, s55, 0x2000
  s_lshl_b32 s59, s59, 3
  s_add_u32 s75, s68, s59
  s_cmp_ge_u32 s13, 27
  s_cbranch_scc1 L_q_noffn_s
  s_waitcnt vmcnt(16)
  s_barrier
  buffer_load_dword v3, v11, s[4:7], s66 offen offset:384 sc1
  ds_read_b128 v[124:127], v1 offset:0
  ds_read_b128 v[128:131], v1 offset:2048
  ds_read_b128 v[132:135], v1 offset:4096
  ds_read_b128 v[136:139], v1 offset:6144
  s_waitcnt lgkmcnt(3)
  v_mfma_f32_16x16x32_bf16 v[148:151], a[160:163], v[124:127], 0
  ds_read_b128 v[140:143], v1 offset:8192
  v_mfma_f32_16x16x32_bf16 v[152:155], a[164:167], v[124:127], 0
  s_waitcnt lgkmcnt(3)
  v_mfma_f32_16x16x32_bf16 v[148:151], a[168:171], v[128:131], v[148:151]
  ds_read_b128 v[144:147], v1 offset:10240
  v_mfma_f32_16x16x32_bf16 v[152:155], a[172:175], v[128:131], v[152:155]
  buffer_load_dwordx4 v[60:63], v1, s[4:7], s67 offen offset:0 sc1
  s_waitcnt lgkmcnt(3)
  v_mfma_f32_16x16x32_bf16 v[148:151], a[176:179], v[132:135], v[148:151]
  s_nop 0
  ds_read_b128 v[124:127], v1 offset:12288
  v_mfma_f32_16x16x32_bf16 v[152:155], a[180:183], v[132:135], v[152:155]
  s_waitcnt lgkmcnt(3)
  v_mfma_f32_16x16x32_bf16 v[148:151], a[184:187], v[136:139], v[148:151]
  s_nop 0
  ds_read_b128 v[128:131], v1 offset:14336
  v_mfma_f32_16x16x32_bf16 v[152:155], a[188:191], v[136:139], v[152:155]
  buffer_load_dwordx4 v[64:67], v1, s[4:7], s67 offen offset:2048 sc1
  s_waitcnt lgkmcnt(3)
  v_mfma_f32_16x16x32_bf16 v[148:151], a[192:195], v[140:143], v[148:151]
  s_nop 0
  ds_read_b128 v[132:135], v1 offset:16384
  v_mfma_f32_16x16x32_bf16 v[152:155], a[196:199], v[140:143], v[152:155]
  s_waitcnt lgkmcnt(3)
  v_mfma_f32_16x16x32_bf16 v[148:151], a[200:203], v[144:147], v[148:151]
  s_nop 0
  ds_read_b128 v[136:139], v1 offset:18432
  v_mfma_f32_16x16x32_bf16 v[152:155], a[204:207], v[144:147], v[152:155]
  s_waitcnt lgkmcnt(3)
  v_mfma_f32_16x16x32_bf16 v[148:151], a[208:211], v[124:127], v[148:151]
  s_nop 0
  ds_read_b128 v[140:143], v1 offset:20480
  v_mfma_f32_16x16x32_bf16 v[152:155], a[212:215], v[124:127], v[152:155]
  s_add_u32 s67, s67, 4096
  buffer_load_dwordx4 v[68:71], v1, s[4:7], s67 offen offset:0 sc1
  s_waitcnt lgkmcnt(3)
  v_mfma_f32_16x16x32_bf16 v[148:151], a[216:219], v[128:131], v[148:151]
  ds_read_b128 v[144:147], v1 offset:22528
  v_mfma_f32_16x16x32_bf16 v[152:155], a[220:223], v[128:131], v[152:155]
  s_waitcnt lgkmcnt(3)
  v_mfma_f32_16x16x32_bf16 v[148:151], a[224:227], v[132:135], v[148:151]
  ds_read_b128 v[124:127], v1 offset:24576
  v_mfma_f32_16x16x32_bf16 v[152:155], a[228:231], v[132:135], v[152:155]
  buffer_load_dwordx4 v[72:75], v1, s[4:7], s67 offen offset:2048 sc1
  s_waitcnt lgkmcnt(3)
  v_mfma_f32_16x16x32_bf16 v[148:151], a[232:235], v[136:139], v[148:151]
  ds_read_b128 v[128:131], v1 offset:26624
  v_mfma_f32_16x16x32_bf16 v[152:155], a[236:239], v[136:139], v[152:155]
  s_waitcnt lgkmcnt(3)
  v_mfma_f32_16x16x32_bf16 v[148:151], a[240:243], v[140:143], v[148:151]
  ds_read_b128 v[132:135], v1 offset:28672
  v_mfma_f32_16x16x32_bf16 v[152:155], a[244:247], v[140:143], v[152:155]
  s_nop 0
  s_waitcnt lgkmcnt(3)
  v_mfma_f32_16x16x32_bf16 v[148:151], a[248:251], v[144:147], v[148:151]
  ds_read_b128 v[136:139], v1 offset:30720
  v_mfma_f32_16x16x32_bf16 v[152:155], a[252:255], v[144:147], v[152:155]
  buffer_load_dwordx4 v[76:79], v1, s[4:7], s68 offen offset:0 sc1
  s_waitcnt lgkmcnt(3)
  v_mfma_f32_16x16x32_bf16 v[148:151], v[192:195], v[124:127], v[148:151]
  ds_read_b128 v[140:143], v1 offset:32768
  v_mfma_f32_16x16x32_bf16 v[152:155], v[196:199], v[124:127], v[152:155]
  s_waitcnt lgkmcnt(3)
  v_mfma_f32_16x16x32_bf16 v[148:151], v[200:203], v[128:131], v[148:151]
  ds_read_b128 v[144:147], v1 offset:34816
  v_mfma_f32_16x16x32_bf16 v[152:155], v[204:207], v[128:131], v[152:155]
  buffer_load_dwordx4 v[80:83], v1, s[4:7], s68 offen offset:1024 sc1
  s_waitcnt lgkmcnt(3)
  v_mfma_f32_16x16x32_bf16 v[148:151], v[208:211], v[132:135], v[148:151]
  ds_read_b128 v[124:127], v1 offset:36864
  v_mfma_f32_16x16x32_bf16 v[152:155], v[212:215], v[132:135], v[152:155]
  s_waitcnt lgkmcnt(3)
  v_mfma_f32_16x16x32_bf16 v[148:151], v[216:219], v[136:139], v[148:151]
  ds_read_b128 v[128:131], v1 offset:38912
  v_mfma_f32_16x16x32_bf16 v[152:155], v[220:223], v[136:139], v[152:155]
  s_nop 0
  s_waitcnt lgkmcnt(3)
  v_mfma_f32_16x16x32_bf16 v[148:151], v[224:227], v[140:143], v[148:151]
  ds_read_b128 v[132:135], v1 offset:1024
  v_mfma_f32_16x16x32_bf16 v[152:155], v[228:231], v[140:143], v[152:155]
  buffer_load_dwordx4 v[108:111], v1, s[4:7], s75 offen offset:2048 sc1
  s_waitcnt lgkmcnt(3)
  v_mfma_f32_16x16x32_bf16 v[148:151], v[232:235], v[144:147], v[148:151]
  ds_read_b128 v[136:139], v1 offset:3072
  v_mfma_f32_16x16x32_bf16 v[152:155], v[236:239], v[144:147], v[152:155]
  s_waitcnt lgkmcnt(3)
  v_mfma_f32_16x16x32_bf16 v[148:151], v[240:243], v[124:127], v[148:151]
  ds_read_b128 v[140:143], v1 offset:5120
  v_mfma_f32_16x16x32_bf16 v[152:155], v[244:247], v[124:127], v[152:155]
  s_add_u32 s68, s68, 4096
  buffer_load_dwordx4 v[84:87], v1, s[4:7], s68 offen offset:0 sc1
  s_waitcnt lgkmcnt(3)
  v_mfma_f32_16x16x32_bf16 v[148:151], v[248:251], v[128:131], v[148:151]
  ds_read_b128 v[144:147], v1 offset:7168
  v_mfma_f32_16x16x32_bf16 v[152:155], v[252:255], v[128:131], v[152:155]
  s_waitcnt lgkmcnt(3)
  v_mfma_f32_16x16x32_bf16 v[156:159], a[160:163], v[132:135], 0
  ds_read_b128 v[124:127], v1 offset:9216
  v_mfma_f32_16x16x32_bf16 v[160:163], a[164:167], v[132:135], 0
  s_waitcnt lgkmcnt(3)
  v_mfma_f32_16x16x32_bf16 v[156:159], a[168:171], v[136:139], v[156:159]
  s_nop 0
  ds_read_b128 v[128:131], v1 offset:11264
  v_mfma_f32_16x16x32_bf16 v[160:163], a[172:175], v[136:139], v[160:163]
  buffer_load_dwordx4 v[88:91], v1, s[4:7], s68 offen offset:1024 sc1
  s_waitcnt lgkmcnt(3)
  v_mfma_f32_16x16x32_bf16 v[156:159], a[176:179], v[140:143], v[156:159]
  s_nop 0
  ds_read_b128 v[132:135], v1 offset:13312
  v_cvt_pk_bf16_f32 v149, v148, v149
  v_mfma_f32_16x16x32_bf16 v[160:163], a[180:183], v[140:143], v[160:163]
  v_lshlrev_b32 v148, 16, v149
  s_waitcnt lgkmcnt(3)
  v_mfma_f32_16x16x32_bf16 v[156:159], a[184:187], v[144:147], v[156:159]
  ds_read_b128 v[136:139], v1 offset:15360
  v_and_b32 v149, 0xffff0000, v149
  v_mfma_f32_16x16x32_bf16 v[160:163], a[188:191], v[144:147], v[160:163]
  buffer_load_dwordx4 v[112:115], v1, s[4:7], s75 offen offset:3072 sc1
  v_cvt_pk_bf16_f32 v151, v150, v151
  s_waitcnt vmcnt(11)
  s_barrier
  s_cmp_lg_u32 s12, 0
  s_cbranch_scc1 L_ps_38_s
  s_lshl_b32 s58, s13, 2
  s_add_u32 s58, s58, s66
  v_mov_b32 v2, s96
  s_mov_b64 exec, 1
  buffer_store_dword v2, v0, s[4:7], s58 offen offset:0 sc1
  s_mov_b64 exec, -1
L_ps_38_s:
  s_waitcnt lgkmcnt(3)
  v_mfma_f32_16x16x32_bf16 v[156:159], a[192:195], v[124:127], v[156:159]
  ds_read_b128 v[140:143], v1 offset:17408
  v_lshlrev_b32 v150, 16, v151
  v_mfma_f32_16x16x32_bf16 v[160:163], a[196:199], v[124:127], v[160:163]
  v_and_b32 v151, 0xffff0000, v151
  s_waitcnt lgkmcnt(3)
  v_mfma_f32_16x16x32_bf16 v[156:159], a[200:203], v[128:131], v[156:159]
  ds_read_b128 v[144:147], v1 offset:19456
  v_cvt_pk_bf16_f32 v153, v152, v153
  v_mfma_f32_16x16x32_bf16 v[160:163], a[204:207], v[128:131], v[160:163]
  v_lshlrev_b32 v152, 16, v153
  s_waitcnt lgkmcnt(3)
  v_mfma_f32_16x16x32_bf16 v[156:159], a[208:211], v[132:135], v[156:159]
  ds_read_b128 v[124:127], v1 offset:21504
  v_and_b32 v153, 0xffff0000, v153
  v_mfma_f32_16x16x32_bf16 v[160:163], a[212:215], v[132:135], v[160:163]
  s_add_u32 s68, s68, 4096
  s_add_u32 s75, s75, 4096
  buffer_load_dwordx4 v[92:95], v1, s[4:7], s68 offen offset:0 sc1
  v_cvt_pk_bf16_f32 v155, v154, v155
  s_waitcnt lgkmcnt(3)
  v_mfma_f32_16x16x32_bf16 v[156:159], a[216:219], v[136:139], v[156:159]
  ds_read_b128 v[128:131], v1 offset:23552
  v_lshlrev_b32 v154, 16, v155
  v_mfma_f32_16x16x32_bf16 v[160:163], a[220:223], v[136:139], v[160:163]
  v_and_b32 v155, 0xffff0000, v155
  s_waitcnt lgkmcnt(3)
  v_mfma_f32_16x16x32_bf16 v[156:159], a[224:227], v[140:143], v[156:159]
  s_nop 0
  ds_read_b128 v[132:135], v1 offset:25600
  v_max_f32 v148, 0, v148
  v_mfma_f32_16x16x32_bf16 v[160:163], a[228:231], v[140:143], v[160:163]
  buffer_load_dwordx4 v[96:99], v1, s[4:7], s68 offen offset:1024 sc1
  v_mul_f32 v148, v148, v152
  s_waitcnt lgkmcnt(3)
  v_mfma_f32_16x16x32_bf16 v[156:159], a[232:235], v[144:147], v[156:159]
  ds_read_b128 v[136:139], v1 offset:27648
  v_max_f32 v149, 0, v149
  v_mfma_f32_16x16x32_bf16 v[160:163], a[236:239], v[144:147], v[160:163]
  v_mul_f32 v149, v149, v153
  s_waitcnt lgkmcnt(3)
  v_mfma_f32_16x16x32_bf16 v[156:159], a[240:243], v[124:127], v[156:159]
  ds_read_b128 v[140:143], v1 offset:29696
  v_max_f32_e64 v150, 0, v150
  v_mfma_f32_16x16x32_bf16 v[160:163], a[244:247], v[124:127], v[160:163]
  v_mul_f32 v150, v150, v154
  s_waitcnt lgkmcnt(3)
  v_mfma_f32_16x16x32_bf16 v[156:159], a[248:251], v[128:131], v[156:159]
  ds_read_b128 v[144:147], v1 offset:31744
  v_max_f32_e64 v151, 0, v151
  v_mfma_f32_16x16x32_bf16 v[160:163], a[252:255], v[128:131], v[160:163]
  buffer_load_dwordx4 v[116:119], v1, s[4:7], s75 offen offset:2048 sc1
  v_mul_f32_e64 v151, v151, v155
  s_waitcnt lgkmcnt(3)
  v_mfma_f32_16x16x32_bf16 v[156:159], v[192:195], v[132:135], v[156:159]
  ds_read_b128 v[124:127], v1 offset:33792
  v_cvt_pk_bf16_f32 v148, v148, v149
  v_mfma_f32_16x16x32_bf16 v[160:163], v[196:199], v[132:135], v[160:163]
  v_cvt_pk_bf16_f32 v149, v150, v151
  s_waitcnt lgkmcnt(3)
  v_mfma_f32_16x16x32_bf16 v[156:159], v[200:203], v[136:139], v[156:159]
  ds_read_b128 v[128:131], v1 offset:35840
  ds_write_b64 v13, v[148:149] offset:0
  v_mfma_f32_16x16x32_bf16 v[160:163], v[204:207], v[136:139], v[160:163]
  s_add_u32 s68, s68, 4096
  buffer_load_dwordx4 v[100:103], v1, s[4:7], s68 offen offset:0 sc1
  s_waitcnt lgkmcnt(4)
  v_mfma_f32_16x16x32_bf16 v[156:159], v[208:211], v[140:143], v[156:159]
  ds_read_b128 v[132:135], v1 offset:37888
  v_mfma_f32_16x16x32_bf16 v[160:163], v[212:215], v[140:143], v[160:163]
  s_waitcnt lgkmcnt(4)
  v_mfma_f32_16x16x32_bf16 v[156:159], v[216:219], v[144:147], v[156:159]
  ds_read_b128 v[136:139], v1 offset:39936
  v_mfma_f32_16x16x32_bf16 v[160:163], v[220:223], v[144:147], v[160:163]
  buffer_load_dwordx4 v[104:107], v1, s[4:7], s68 offen offset:1024 sc1
  s_waitcnt lgkmcnt(4)
  v_mfma_f32_16x16x32_bf16 v[156:159], v[224:227], v[124:127], v[156:159]
  v_mfma_f32_16x16x32_bf16 v[160:163], v[228:231], v[124:127], v[160:163]
  s_waitcnt lgkmcnt(3)
  v_mfma_f32_16x16x32_bf16 v[156:159], v[232:235], v[128:131], v[156:159]
  v_mfma_f32_16x16x32_bf16 v[160:163], v[236:239], v[128:131], v[160:163]
  buffer_load_dwordx4 v[120:123], v1, s[4:7], s75 offen offset:3072 sc1
  s_waitcnt lgkmcnt(1)
  v_mfma_f32_16x16x32_bf16 v[156:159], v[240:243], v[132:135], v[156:159]
  s_nop 0
  v_mfma_f32_16x16x32_bf16 v[160:163], v[244:247], v[132:135], v[160:163]
  s_waitcnt lgkmcnt(0)
  v_mfma_f32_16x16x32_bf16 v[156:159], v[248:251], v[136:139], v[156:159]
  v_mfma_f32_16x16x32_bf16 v[160:163], v[252:255], v[136:139], v[160:163]
  s_nop 0
  s_nop 0
  s_nop 0
  s_nop 0
  v_cvt_pk_bf16_f32 v157, v156, v157
  v_lshlrev_b32 v156, 16, v157
  v_and_b32 v157, 0xffff0000, v157
  v_cvt_pk_bf16_f32 v159, v158, v159
  v_lshlrev_b32 v158, 16, v159
  v_and_b32 v159, 0xffff0000, v159
  v_cvt_pk_bf16_f32 v161, v160, v161
  v_lshlrev_b32 v160, 16, v161
  v_and_b32 v161, 0xffff0000, v161
  v_cvt_pk_bf16_f32 v163, v162, v163
  v_lshlrev_b32 v162, 16, v163
  v_and_b32 v163, 0xffff0000, v163
  v_max_f32 v156, 0, v156
  v_mul_f32 v156, v156, v160
  v_max_f32 v157, 0, v157
  v_mul_f32 v157, v157, v161
  v_max_f32 v158, 0, v158
  v_mul_f32 v158, v158, v162
  v_max_f32 v159, 0, v159
  v_mul_f32_e64 v159, v159, v163
  v_cvt_pk_bf16_f32 v156, v156, v157
  v_cvt_pk_bf16_f32 v157, v158, v159
  ds_write_b64 v13, v[156:157] offset:2048
  s_mov_b32 exec_lo, 0xffffffff
  s_mov_b32 exec_hi, 0
  s_waitcnt vmcnt(16)
  v_cmp_gt_u32_e64 vcc, s93, v3
  s_cbranch_vccz L_pw_39y_s
L_pw_39_s:
  buffer_load_dword v2, v11, s[4:7], s66 offen offset:384 sc1
  s_sub_u32 s54, s54, 1
  s_cbranch_scc1 L_end
  s_waitcnt vmcnt(0)
  v_cmp_gt_u32_e64 vcc, s93, v2
  s_cbranch_vccnz L_pw_39_s
L_pw_39y_s:
  s_mov_b64 exec, -1
L_pw_39x_s:
  v_add_u32 v2, 131072, v1
  s_waitcnt lgkmcnt(0)
  s_barrier
  ds_read_b128 v[184:187], v2 offset:0
  ds_read_b128 v[188:191], v2 offset:1024
  ds_read_b128 v[24:27], v14 offset:0
  ds_read_b128 v[28:31], v14 offset:1024
  ds_read_b128 v[32:35], v14 offset:2048
  ds_read_b128 v[36:39], v14 offset:3072
  s_waitcnt lgkmcnt(3)
  v_mfma_f32_16x16x32_bf16 v[124:127], v[184:187], v[24:27], 0
  ds_read_b128 v[24:27], v14 offset:4096
  s_waitcnt lgkmcnt(3)
  v_mfma_f32_16x16x32_bf16 v[124:127], v[188:191], v[28:31], v[124:127]
  ds_read_b128 v[28:31], v14 offset:5120
  s_waitcnt lgkmcnt(3)
  v_mfma_f32_16x16x32_bf16 v[128:131], v[184:187], v[32:35], 0
  ds_read_b128 v[32:35], v14 offset:6144
  s_waitcnt lgkmcnt(3)
  v_mfma_f32_16x16x32_bf16 v[128:131], v[188:191], v[36:39], v[128:131]
  ds_read_b128 v[36:39], v14 offset:7168
  s_waitcnt lgkmcnt(3)
  v_mfma_f32_16x16x32_bf16 v[132:135], v[184:187], v[24:27], 0
  ds_read_b128 v[24:27], v14 offset:8192
  s_waitcnt lgkmcnt(3)
  v_mfma_f32_16x16x32_bf16 v[132:135], v[188:191], v[28:31], v[132:135]
  ds_read_b128 v[28:31], v14 offset:9216
  s_waitcnt lgkmcnt(3)
  v_mfma_f32_16x16x32_bf16 v[136:139], v[184:187], v[32:35], 0
  ds_read_b128 v[32:35], v14 offset:10240
  s_waitcnt lgkmcnt(3)
  v_mfma_f32_16x16x32_bf16 v[136:139], v[188:191], v[36:39], v[136:139]
  ds_read_b128 v[36:39], v14 offset:11264
  s_waitcnt lgkmcnt(3)
  v_mfma_f32_16x16x32_bf16 v[140:143], v[184:187], v[24:27], 0
  ds_read_b128 v[24:27], v14 offset:12288
  s_waitcnt lgkmcnt(3)
  v_mfma_f32_16x16x32_bf16 v[140:143], v[188:191], v[28:31], v[140:143]
  ds_read_b128 v[28:31], v14 offset:13312
  s_waitcnt lgkmcnt(3)
  v_mfma_f32_16x16x32_bf16 v[144:147], v[184:187], v[32:35], 0
  ds_read_b128 v[32:35], v14 offset:14336
  s_waitcnt lgkmcnt(3)
  v_mfma_f32_16x16x32_bf16 v[144:147], v[188:191], v[36:39], v[144:147]
  ds_read_b128 v[36:39], v14 offset:15360
  s_waitcnt lgkmcnt(3)
  v_mfma_f32_16x16x32_bf16 v[148:151], v[184:187], v[24:27], 0
  ds_read_b128 v[24:27], v14 offset:16384
  s_waitcnt lgkmcnt(3)
  v_mfma_f32_16x16x32_bf16 v[148:151], v[188:191], v[28:31], v[148:151]
  ds_read_b128 v[28:31], v14 offset:17408
  s_waitcnt lgkmcnt(3)
  v_mfma_f32_16x16x32_bf16 v[152:155], v[184:187], v[32:35], 0
  ds_read_b128 v[32:35], v14 offset:18432
  s_waitcnt lgkmcnt(3)
  v_mfma_f32_16x16x32_bf16 v[152:155], v[188:191], v[36:39], v[152:155]
  ds_read_b128 v[36:39], v14 offset:19456
  s_waitcnt lgkmcnt(3)
  v_mfma_f32_16x16x32_bf16 v[156:159], v[184:187], v[24:27], 0
  ds_read_b128 v[24:27], v14 offset:0
  s_waitcnt lgkmcnt(3)
  v_mfma_f32_16x16x32_bf16 v[156:159], v[188:191], v[28:31], v[156:159]
  ds_read_b128 v[28:31], v14 offset:1024
  buffer_load_dword v3, v11, s[4:7], s66 offen sc1
  s_waitcnt lgkmcnt(3)
  v_mfma_f32_16x16x32_bf16 v[160:163], v[184:187], v[32:35], 0
  ds_read_b128 v[32:35], v14 offset:2048
  s_waitcnt lgkmcnt(3)
  v_mfma_f32_16x16x32_bf16 v[160:163], v[188:191], v[36:39], v[160:163]
  ds_read_b128 v[36:39], v14 offset:3072
  ds_read_b128 v[184:187], v2 offset:2048
  ds_read_b128 v[188:191], v2 offset:3072
  v_cvt_pk_bf16_f32 v164, v124, v128
  v_cvt_pk_bf16_f32 v165, v132, v136
  v_cvt_pk_bf16_f32 v166, v140, v144
  v_cvt_pk_bf16_f32 v167, v148, v152
  s_nop 0
  v_cvt_pk_bf16_f32 v180, v156, v160
  v_cvt_pk_bf16_f32 v168, v125, v129
  v_cvt_pk_bf16_f32 v169, v133, v137
  v_cvt_pk_bf16_f32 v170, v141, v145
  v_cvt_pk_bf16_f32 v171, v149, v153
  v_cvt_pk_bf16_f32 v181, v157, v161
  v_cvt_pk_bf16_f32 v172, v126, v130
  v_cvt_pk_bf16_f32 v173, v134, v138
  v_cvt_pk_bf16_f32 v174, v142, v146
  v_cvt_pk_bf16_f32 v175, v150, v154
  v_cvt_pk_bf16_f32 v182, v158, v162
  v_cvt_pk_bf16_f32 v176, v127, v131
  v_cvt_pk_bf16_f32 v177, v135, v139
  v_cvt_pk_bf16_f32 v178, v143, v147
  v_cvt_pk_bf16_f32 v179, v151, v155
  v_cvt_pk_bf16_f32 v183, v159, v163
  s_waitcnt lgkmcnt(1)
  v_mfma_f32_16x16x32_bf16 v[124:127], v[184:187], v[24:27], 0
  ds_read_b128 v[24:27], v14 offset:4096
  s_waitcnt lgkmcnt(1)
  v_mfma_f32_16x16x32_bf16 v[124:127], v[188:191], v[28:31], v[124:127]
  ds_read_b128 v[28:31], v14 offset:5120
  s_add_u32 s58, s64, 0
  buffer_store_dwordx4 v[164:167], v6, s[4:7], s58 offen sc1
  v_mfma_f32_16x16x32_bf16 v[128:131], v[184:187], v[32:35], 0
  s_nop 0
  ds_read_b128 v[32:35], v14 offset:6144
  v_mfma_f32_16x16x32_bf16 v[128:131], v[188:191], v[36:39], v[128:131]
  ds_read_b128 v[36:39], v14 offset:7168
  buffer_store_dword v180, v7, s[4:7], s58 offen offset:1024 sc1
  s_waitcnt lgkmcnt(3)
  v_mfma_f32_16x16x32_bf16 v[132:135], v[184:187], v[24:27], 0
  ds_read_b128 v[24:27], v14 offset:8192
  s_waitcnt lgkmcnt(3)
  v_mfma_f32_16x16x32_bf16 v[132:135], v[188:191], v[28:31], v[132:135]
  ds_read_b128 v[28:31], v14 offset:9216
  s_add_u32 s58, s64, 41216
  buffer_store_dwordx4 v[168:171], v6, s[4:7], s58 offen sc1
  s_waitcnt lgkmcnt(3)
  v_mfma_f32_16x16x32_bf16 v[136:139], v[184:187], v[32:35], 0
  ds_read_b128 v[32:35], v14 offset:10240
  s_waitcnt lgkmcnt(3)
  v_mfma_f32_16x16x32_bf16 v[136:139], v[188:191], v[36:39], v[136:139]
  ds_read_b128 v[36:39], v14 offset:11264
  buffer_store_dword v181, v7, s[4:7], s58 offen offset:1024 sc1
  s_waitcnt lgkmcnt(3)
  v_mfma_f32_16x16x32_bf16 v[140:143], v[184:187], v[24:27], 0
  ds_read_b128 v[24:27], v14 offset:12288
  s_waitcnt lgkmcnt(3)
  v_mfma_f32_16x16x32_bf16 v[140:143], v[188:191], v[28:31], v[140:143]
  ds_read_b128 v[28:31], v14 offset:13312
  s_add_u32 s58, s64, 82432
  buffer_store_dwordx4 v[172:175], v6, s[4:7], s58 offen sc1
  s_waitcnt lgkmcnt(3)
  v_mfma_f32_16x16x32_bf16 v[144:147], v[184:187], v[32:35], 0
  ds_read_b128 v[32:35], v14 offset:14336
  s_waitcnt lgkmcnt(3)
  v_mfma_f32_16x16x32_bf16 v[144:147], v[188:191], v[36:39], v[144:147]
  ds_read_b128 v[36:39], v14 offset:15360
  buffer_store_dword v182, v7, s[4:7], s58 offen offset:1024 sc1
  s_waitcnt lgkmcnt(3)
  v_mfma_f32_16x16x32_bf16 v[148:151], v[184:187], v[24:27], 0
  ds_read_b128 v[24:27], v14 offset:16384
  s_waitcnt lgkmcnt(3)
  v_mfma_f32_16x16x32_bf16 v[148:151], v[188:191], v[28:31], v[148:151]
  ds_read_b128 v[28:31], v14 offset:17408
  s_add_u32 s58, s64, 123648
  buffer_store_dwordx4 v[176:179], v6, s[4:7], s58 offen sc1
  s_waitcnt lgkmcnt(3)
  v_mfma_f32_16x16x32_bf16 v[152:155], v[184:187], v[32:35], 0
  ds_read_b128 v[32:35], v14 offset:18432
  s_waitcnt lgkmcnt(3)
  v_mfma_f32_16x16x32_bf16 v[152:155], v[188:191], v[36:39], v[152:155]
  ds_read_b128 v[36:39], v14 offset:19456
  buffer_store_dword v183, v7, s[4:7], s58 offen offset:1024 sc1
  s_waitcnt lgkmcnt(3)
  v_mfma_f32_16x16x32_bf16 v[156:159], v[184:187], v[24:27], 0
  s_waitcnt lgkmcnt(2)
  v_mfma_f32_16x16x32_bf16 v[156:159], v[188:191], v[28:31], v[156:159]
  s_waitcnt lgkmcnt(1)
  v_mfma_f32_16x16x32_bf16 v[160:163], v[184:187], v[32:35], 0
  s_waitcnt lgkmcnt(0)
  v_mfma_f32_16x16x32_bf16 v[160:163], v[188:191], v[36:39], v[160:163]
  v_cvt_pk_bf16_f32 v164, v124, v128
  v_cvt_pk_bf16_f32 v165, v132, v136
  v_cvt_pk_bf16_f32 v166, v140, v144
  v_cvt_pk_bf16_f32 v167, v148, v152
  s_nop 0
  s_nop 2
  v_cvt_pk_bf16_f32 v180, v156, v160
  s_add_u32 s58, s64, 659456
  buffer_store_dwordx4 v[164:167], v6, s[4:7], s58 offen sc1
  buffer_store_dword v180, v7, s[4:7], s58 offen offset:1024 sc1
  v_cvt_pk_bf16_f32 v168, v125, v129
  v_cvt_pk_bf16_f32 v169, v133, v137
  v_cvt_pk_bf16_f32 v170, v141, v145
  v_cvt_pk_bf16_f32 v171, v149, v153
  v_cvt_pk_bf16_f32 v181, v157, v161
  s_add_u32 s58, s64, 700672
  buffer_store_dwordx4 v[168:171], v6, s[4:7], s58 offen sc1
  buffer_store_dword v181, v7, s[4:7], s58 offen offset:1024 sc1
  v_cvt_pk_bf16_f32 v172, v126, v130
  v_cvt_pk_bf16_f32 v173, v134, v138
  v_cvt_pk_bf16_f32 v174, v142, v146
  v_cvt_pk_bf16_f32 v175, v150, v154
  v_cvt_pk_bf16_f32 v182, v158, v162
  s_add_u32 s58, s64, 741888
  buffer_store_dwordx4 v[172:175], v6, s[4:7], s58 offen sc1
  buffer_store_dword v182, v7, s[4:7], s58 offen offset:1024 sc1
  v_cvt_pk_bf16_f32 v176, v127, v131
  v_cvt_pk_bf16_f32 v177, v135, v139
  v_cvt_pk_bf16_f32 v178, v143, v147
  v_cvt_pk_bf16_f32 v179, v151, v155
  v_cvt_pk_bf16_f32 v183, v159, v163
  s_add_u32 s58, s64, 783104
  buffer_store_dwordx4 v[176:179], v6, s[4:7], s58 offen sc1
  buffer_store_dword v183, v7, s[4:7], s58 offen offset:1024 sc1
L_ph_40x_s:
  s_mov_b32 exec_lo, 0xffffffff
  s_mov_b32 exec_hi, 0
  s_waitcnt vmcnt(16)
  v_cmp_gt_u32 vcc, s96, v3
  s_cbranch_vccz L_pw_41y_s
L_pw_41_s:
  buffer_load_dword v2, v11, s[4:7], s66 offen offset:0 sc1
  s_sub_u32 s54, s54, 1
  s_cbranch_scc1 L_end
  s_waitcnt vmcnt(0)
  v_cmp_gt_u32 vcc, s96, v2
  s_cbranch_vccnz L_pw_41_s
L_pw_41y_s:
  s_mov_b64 exec, -1
L_pw_41x_s:
  s_branch L_q_fin_s
  s_nop 0
L_q_noffn_s:
  s_waitcnt vmcnt(0)
  s_barrier
  s_cmp_lg_u32 s12, 0
  s_cbranch_scc1 L_ps_42_s
  s_lshl_b32 s58, s13, 2
  s_add_u32 s58, s58, s66
  v_mov_b32 v2, s96
  s_mov_b64 exec, 1
  buffer_store_dword v2, v0, s[4:7], s58 offen offset:0 sc1
  s_mov_b64 exec, -1
L_ps_42_s:
  buffer_load_dwordx4 v[60:63], v1, s[4:7], s67 offen offset:0 sc1
  buffer_load_dwordx4 v[64:67], v1, s[4:7], s67 offen offset:2048 sc1
  s_add_u32 s67, s67, 4096
  buffer_load_dwordx4 v[68:71], v1, s[4:7], s67 offen offset:0 sc1
  buffer_load_dwordx4 v[72:75], v1, s[4:7], s67 offen offset:2048 sc1
  buffer_load_dwordx4 v[76:79], v1, s[4:7], s68 offen offset:0 sc1
  buffer_load_dwordx4 v[80:83], v1, s[4:7], s68 offen offset:1024 sc1
  buffer_load_dwordx4 v[108:111], v1, s[4:7], s75 offen offset:2048 sc1
  s_add_u32 s68, s68, 4096
  buffer_load_dwordx4 v[84:87], v1, s[4:7], s68 offen offset:0 sc1
  buffer_load_dwordx4 v[88:91], v1, s[4:7], s68 offen offset:1024 sc1
  buffer_load_dwordx4 v[112:115], v1, s[4:7], s75 offen offset:3072 sc1
  s_add_u32 s68, s68, 4096
  s_add_u32 s75, s75, 4096
  buffer_load_dwordx4 v[92:95], v1, s[4:7], s68 offen offset:0 sc1
  buffer_load_dwordx4 v[96:99], v1, s[4:7], s68 offen offset:1024 sc1
  buffer_load_dwordx4 v[116:119], v1, s[4:7], s75 offen offset:2048 sc1
  s_add_u32 s68, s68, 4096
  buffer_load_dwordx4 v[100:103], v1, s[4:7], s68 offen offset:0 sc1
  buffer_load_dwordx4 v[104:107], v1, s[4:7], s68 offen offset:1024 sc1
  buffer_load_dwordx4 v[120:123], v1, s[4:7], s75 offen offset:3072 sc1
  s_cmp_lg_u32 s12, 0
  s_cbranch_scc1 L_pw_43x_s
  s_mov_b32 exec_lo, 0xffffffff
  s_mov_b32 exec_hi, 0
L_pw_43_s:
  buffer_load_dword v2, v11, s[4:7], s66 offen offset:0 sc1
  s_sub_u32 s54, s54, 1
  s_cbranch_scc1 L_end
  s_waitcnt vmcnt(0)
  v_cmp_gt_u32 vcc, s96, v2
  s_cbranch_vccnz L_pw_43_s
L_pw_43y_s:
  s_mov_b64 exec, -1
L_pw_43x_s:
  s_barrier
L_q_fin_s:
  s_add_u32 s62, s62, 1
  s_branch L_q_loop_s
.section .rodata,"a"
.p2align 6
.amdhsa_kernel adaLN_cond__memory_aug_recurrent_mem_tr__glu_gated_reglu__prompt_kernel
  .amdhsa_next_free_vgpr 512
  .amdhsa_next_free_sgpr 102
  .amdhsa_accum_offset 256
  .amdhsa_group_segment_fixed_size 0
  .amdhsa_kernarg_size 128
  .amdhsa_user_sgpr_count 2
  .amdhsa_user_sgpr_kernarg_segment_ptr 1
  .amdhsa_system_sgpr_workgroup_id_x 1
  .amdhsa_float_denorm_mode_32 3
.end_amdhsa_kernel
```
